```python
import torch

def _softmax(x, axis=-1):
    return torch.softmax(x, dim=axis)
def _gelu(x):
    return torch.nn.functional.gelu(x, approximate="tanh")
def _silu(x):
    return torch.nn.functional.silu(x)
def _sigmoid(x):
    return torch.sigmoid(x)
def _layernorm(x, axis=-1, eps=1e-5):
    m = x.mean(dim=axis, keepdim=True)
    v = x.var(dim=axis, keepdim=True, unbiased=False)
    return (x - m) / torch.sqrt(v + eps)
def _scatter_add(tgt, idx, src, axis=0):
    return tgt.clone().index_add_(axis, idx, src)
def _segment_sum(src, seg, n):
    out = torch.zeros((n,) + src.shape[1:], dtype=src.dtype)
    return out.index_add_(0, seg, src)
def _pad(x, pw):
    flat = tuple(v for pair in reversed(pw) for v in pair)
    return torch.nn.functional.pad(x, flat)

kernel_name = 'standalone__deep_cross_fibinet__recsys'

def setup_inputs():

    _w = (lambda a: (lambda t: t.to(torch.bfloat16) if t.is_floating_point() else t)(torch.as_tensor(a)))
    B, F, D = 4096, 26, 64
    V = min(100000, 100000)
    Fr = max(F // 2, 1)
    H = min(F * D, 256)
    return {
        "idx": _w((lambda lo, hi, *s: torch.randint(lo, hi, s))(0, V, B, F).to(torch.int64)),
        "table": _w((lambda *s: torch.randn(*s, dtype=torch.bfloat16) * 1.6)(V, D)),
        "se_w1": _w((lambda *s: torch.randn(*s, dtype=torch.bfloat16) * 1.6)(F, Fr)),
        "se_w2": _w((lambda *s: torch.randn(*s, dtype=torch.bfloat16) * 1.6)(Fr, F)),
        "w_bi": _w((lambda *s: torch.randn(*s, dtype=torch.bfloat16) * 0.05)(D, D) * (D ** -0.5)),
        "w_cross": _w((lambda *s: torch.randn(*s, dtype=torch.bfloat16) * 0.05)(2 * F * F * D) * 0.01),
        "w_deep1": _w((lambda *s: torch.randn(*s, dtype=torch.bfloat16) * 0.8)(F * D, H) * ((F * D) ** -0.5)),
        "w_deep2": _w((lambda *s: torch.randn(*s, dtype=torch.bfloat16) * 0.05)(H) * 0.01),
    }

def reference(idx, table, se_w1, se_w2, w_bi, w_cross, w_deep1, w_deep2):
    emb = table[idx]
    B = emb.shape[0]
    z = emb.mean(axis=-1)
    a = _sigmoid(_gelu(z @ se_w1) @ se_w2)
    v = a[:, :, None] * emb
    eW = torch.einsum('bfd,de->bfe', emb, w_bi)
    vW = torch.einsum('bfd,de->bfe', v, w_bi)
    p = torch.einsum('bie,bje->bije', eW, emb).reshape(B, -1)
    q = torch.einsum('bie,bje->bije', vW, v).reshape(B, -1)
    cross_feat = torch.concatenate([p, q], axis=-1)
    logit_cross = cross_feat @ w_cross
    h = _gelu(emb.reshape(B, -1) @ w_deep1)
    logit_deep = h @ w_deep2
    return logit_cross + logit_deep
```

```asm
; @launch grid=(256,1,1) block=(512,1,1) lds=163840
.amdgcn_target "amdgcn-amd-amdhsa--gfx950"
.text
.globl standalone__deep_cross_fibinet__recsys_kernel
.p2align 8
.type standalone__deep_cross_fibinet__recsys_kernel,@function
standalone__deep_cross_fibinet__recsys_kernel:
    s_cmp_ge_u32 s2, 256
    s_cbranch_scc1 L_exit
    s_load_dwordx2 s[8:9], s[0:1], 0
    s_load_dwordx2 s[16:17], s[0:1], 48
    s_load_dwordx2 s[12:13], s[0:1], 8
    s_load_dwordx8 s[84:91], s[0:1], 16
    s_load_dwordx8 s[92:99], s[0:1], 56
    v_lshrrev_b32 v1, 6, v0
    s_lshr_b32 s56, s2, 5
    v_readfirstlane_b32 s52, v1
    s_and_b32 s57, s2, 7
    s_lshl3_add_u32 s53, s56, s57
    s_bfe_u32 s54, s2, 0x10003
    s_mov_b32 s10, 425984
    s_mov_b32 s11, 0x00020000
    s_mov_b32 s18, 851968
    s_mov_b32 s19, 0x00020000
    s_mov_b32 s14, 12800000
    s_mov_b32 s15, 0x00020000
    s_bitcmp1_b32 s2, 4
    s_cbranch_scc1 L_B
    v_bfe_u32 v228, v0, 3, 5
    v_mul_u32_u24 v228, 104, v228
    v_and_b32 v229, 7, v0
    v_lshl_add_u32 v228, v229, 4, v228
    v_lshrrev_b32 v229, 8, v0
    v_lshl_add_u32 v228, v229, 2, v228
    s_lshl1_add_u32 s56, s53, s54
    s_mul_i32 s56, s56, 3328
    s_mov_b32 s30, 676
    s_mov_b32 s31, 0x00020000
    s_mov_b32 s34, 676
    s_mov_b32 s35, 0x00020000
    s_mov_b32 s26, 8192
    s_mov_b32 s27, 0x00020000
    s_mov_b32 s22, 173056
    s_mov_b32 s23, 0x00020000
    s_mov_b32 s38, 512
    s_mov_b32 s39, 0x00020000
    s_mov_b32 s42, 8192
    s_mov_b32 s43, 0x00020000
    s_mov_b32 s46, 256
    s_mov_b32 s47, 0x00020000
    s_mov_b32 s50, 268435456
    s_mov_b32 s51, 0x00020000
    s_waitcnt lgkmcnt(0)
    buffer_load_dwordx3 v[2:4], v228, s[8:11], s56 offen
    s_mov_b64 s[28:29], s[84:85]
    s_mov_b64 s[32:33], s[86:87]
    s_mov_b64 s[24:25], s[88:89]
    s_mov_b64 s[20:21], s[90:91]
    s_mov_b64 s[36:37], s[92:93]
    s_mov_b64 s[40:41], s[94:95]
    s_mov_b64 s[44:45], s[96:97]
    s_mov_b64 s[48:49], s[98:99]
    v_lshrrev_b32 v229, 4, v0
    v_xor_b32 v229, v229, v0
    v_and_b32 v229, 7, v229
    v_lshlrev_b32 v1, 4, v229
    s_lshl_b32 s60, s52, 10
    s_mov_b32 s61, s60
    s_lshr_b32 s56, s2, 5
    s_lshl1_add_u32 s56, s56, s54
    s_lshl3_add_u32 s56, s56, s52
    s_lshl_b32 s56, s56, 10
    v_and_b32 v230, 63, v0
    v_lshl_add_u32 v7, v230, 7, s56
    v_lshlrev_b32 v231, 4, v0
    s_lshl_b32 s57, s52, 7
    v_lshl_add_u32 v232, v230, 4, s57
    s_barrier
    s_mov_b64 exec, 0xff
    s_mov_b32 s56, 65536
    buffer_load_dword v8, v7, s[16:19], s56 offen
    s_mov_b32 s56, 196608
    buffer_load_dword v8, v7, s[16:19], s56 offen
    s_add_u32 m0, s57, 155648
    s_nop 0
    buffer_load_dwordx4 v232, s[28:31], 0 offen lds
    s_add_u32 m0, s57, 156672
    s_nop 0
    buffer_load_dwordx4 v232, s[32:35], 0 offen lds
    s_mov_b64 exec, -1
    s_add_u32 m0, s60, 147456
    s_nop 0
    buffer_load_dwordx4 v231, s[24:27], 0 offen lds
    s_mov_b32 s64, 0x05040100
    s_mov_b32 s65, 0x07060302
    s_mov_b32 s66, 0xc0135761
    s_mov_b32 s67, 0xbdd2d3e8
    s_mov_b32 s68, 0xffff0000
    s_mov_b32 s69, 0xbfb8aa3b
    s_waitcnt vmcnt(5)
    v_lshlrev_b32 v2, 7, v2
    v_lshlrev_b32 v4, 7, v4
    s_nop 0
    v_add_u32_dpp v5, v2, v1 row_newbcast:0 row_mask:0xf bank_mask:0x3
    s_nop 1
    v_add_u32_dpp v5, v2, v1 row_newbcast:8 row_mask:0xf bank_mask:0xc
    s_add_u32 m0, s60, 0
    s_nop 0
    buffer_load_dwordx4 v5, s[12:15], 0 offen lds
    v_add_u32_dpp v6, v4, v1 row_newbcast:0 row_mask:0xf bank_mask:0x3
    s_nop 1
    v_add_u32_dpp v6, v4, v1 row_newbcast:8 row_mask:0xf bank_mask:0xc
    s_add_u32 m0, s60, 8192
    s_nop 0
    buffer_load_dwordx4 v6, s[12:15], 0 offen lds
    v_add_u32_dpp v5, v2, v1 row_newbcast:1 row_mask:0xf bank_mask:0x3
    s_nop 1
    v_add_u32_dpp v5, v2, v1 row_newbcast:9 row_mask:0xf bank_mask:0xc
    s_add_u32 m0, s60, 16384
    s_nop 0
    buffer_load_dwordx4 v5, s[12:15], 0 offen lds
    v_add_u32_dpp v6, v4, v1 row_newbcast:1 row_mask:0xf bank_mask:0x3
    s_nop 1
    v_add_u32_dpp v6, v4, v1 row_newbcast:9 row_mask:0xf bank_mask:0xc
    s_add_u32 m0, s60, 24576
    s_nop 0
    buffer_load_dwordx4 v6, s[12:15], 0 offen lds
    v_add_u32_dpp v5, v2, v1 row_newbcast:2 row_mask:0xf bank_mask:0x3
    s_nop 1
    v_add_u32_dpp v5, v2, v1 row_newbcast:10 row_mask:0xf bank_mask:0xc
    s_add_u32 m0, s60, 32768
    s_nop 0
    buffer_load_dwordx4 v5, s[12:15], 0 offen lds
    v_and_b32 v196, 15, v0
    v_bfe_u32 v197, v0, 4, 2
    v_lshrrev_b32 v228, 1, v196
    s_and_b32 s56, s52, 1
    s_lshl_b32 s56, s56, 11
    v_lshl_add_u32 v229, v196, 7, s56
    v_xor_b32 v230, v197, v228
    v_lshl_add_u32 v10, v230, 4, v229
    v_xor_b32 v12, 64, v10
    v_xor_b32 v11, 0x800, v10
    v_xor_b32 v13, 0x800, v12
    v_xor_b32 v230, s52, v228
    v_lshlrev_b32 v230, 4, v230
    v_add_u32 v231, v230, v229
    v_lshl_add_u32 v14, v197, 13, v231
    v_xor_b32 v15, 0x800, v14
    v_lshl_add_u32 v16, v197, 12, v231
    v_add_u32 v16, 98304, v16
    v_xor_b32 v17, 0x800, v16
    v_lshl_add_u32 v231, v196, 7, v230
    v_lshl_add_u32 v18, v197, 12, v231
    v_min_u32 v232, 1, v197
    v_lshl_add_u32 v19, v232, 11, v231
    v_add_u32 v19, 49152, v19
    v_lshrrev_b32 v228, 2, v196
    v_and_b32 v229, 3, v196
    v_lshlrev_b32 v230, 1, v228
    v_add_u32 v231, 1, v230
    v_cmp_eq_u32 vcc, 1, v229
    s_nop 1
    v_cndmask_b32 v230, v230, v231, vcc
    v_add_u32 v231, 8, v228
    v_and_b32 v233, 11, v196
    v_cmp_eq_u32 vcc, 2, v233
    s_nop 1
    v_cndmask_b32 v230, v230, v231, vcc
    v_lshrrev_b32 v231, 1, v230
    v_xor_b32 v231, s52, v231
    v_lshlrev_b32 v231, 4, v231
    v_lshl_add_u32 v231, v230, 7, v231
    v_add_u32 v231, 106496, v231
    v_mul_u32_u24 v233, 2560, v197
    v_add_u32 v20, v233, v231
    v_mul_u32_u24 v233, 1280, v232
    v_add_u32 v21, v233, v231
    v_add_u32 v21, 30720, v21
    s_bfe_u32 s56, s52, 0x10001
    s_lshl_b32 s57, s56, 2
    v_add_u32 v229, s57, v229
    v_lshrrev_b32 v230, 1, v229
    v_lshlrev_b32 v230, 3, v230
    v_lshl_add_u32 v230, v228, 1, v230
    v_and_b32 v231, 1, v229
    v_add_u32 v230, v230, v231
    v_add_u32 v231, 24, v228
    v_cmp_lt_u32 vcc, 5, v229
    s_nop 1
    v_cndmask_b32 v230, v230, v231, vcc
    v_mul_u32_u24 v231, 208, v197
    v_lshl_add_u32 v198, v230, 1, v231
    v_add_u32 v198, 156672, v198
    v_mul_u32_u24 v231, 52, v197
    v_lshl_add_u32 v199, v196, 1, v231
    v_add_u32 v199, 155648, v199
    v_mul_u32_u24 v231, 26, v197
    v_lshl_add_u32 v200, v196, 1, v231
    v_add_u32 v200, 156272, v200
    s_and_b32 s57, s52, 1
    s_mul_i32 s58, s57, 2304
    s_sub_u32 s59, 2304, s58
    v_mul_u32_u24 v231, 144, v196
    v_lshl_add_u32 v233, v197, 5, v231
    v_add_u32 v233, 157696, v233
    v_add_u32 v29, s58, v233
    v_add_u32 v30, s59, v233
    s_lshl_b32 s56, s56, 4
    v_add_u32 v28, s56, v29
    v_lshl_add_u32 v233, v197, 2, v231
    s_lshl_b32 s56, s52, 4
    s_add_u32 s56, s56, 147456
    v_add_u32 v233, s56, v233
    v_add_u32 v31, s58, v233
    v_add_u32 v9, s59, v233
    v_lshrrev_b32 v228, 2, v196
    v_and_b32 v229, 1, v196
    v_lshl_add_u32 v228, v228, 1, v229
    v_lshlrev_b32 v228, 1, v228
    v_lshl_add_u32 v228, v197, 10, v228
    s_lshl_b32 s56, s52, 4
    s_add_u32 s56, s56, 147456
    v_add_u32 v201, s56, v228
    v_bfe_u32 v228, v0, 3, 4
    v_bfe_u32 v229, v228, 1, 1
    v_lshlrev_b32 v229, 3, v229
    v_lshrrev_b32 v230, 2, v228
    v_lshl_add_u32 v229, v230, 1, v229
    v_and_b32 v230, 1, v228
    v_add_u32 v229, v229, v230
    v_lshl_add_u32 v229, v229, 7, v1
    s_lshr_b32 s56, s52, 1
    s_mul_i32 s56, s56, 3328
    v_add_u32 v27, s56, v229
    s_lshr_b32 s56, s52, 2
    s_mul_i32 s56, s56, 6656
    s_sub_u32 s62, 79872, s56
    s_and_b32 s56, s52, 3
    s_lshl_b32 s56, s56, 10
    s_add_u32 s63, s56, 49152
    v_lshrrev_b32 v228, 3, v0
    v_and_b32 v233, 7, v0
    v_add_u32 v229, 0, v228
    v_mul_u32_u24 v230, 205, v229
    v_lshrrev_b32 v230, 11, v230
    v_mul_u32_u24 v231, 10, v230
    v_sub_u32 v231, v229, v231
    v_lshl_add_u32 v230, v230, 4, v229
    v_lshrrev_b32 v231, 1, v231
    v_xor_b32 v231, v231, v233
    v_lshlrev_b32 v231, 4, v231
    v_lshl_add_u32 v231, v230, 7, v231
    v_add_u32 v22, 2048, v231
    v_add_u32 v229, 64, v228
    v_mul_u32_u24 v230, 205, v229
    v_lshrrev_b32 v230, 11, v230
    v_mul_u32_u24 v231, 10, v230
    v_sub_u32 v231, v229, v231
    v_lshl_add_u32 v230, v230, 4, v229
    v_lshrrev_b32 v231, 1, v231
    v_xor_b32 v231, v231, v233
    v_lshlrev_b32 v231, 4, v231
    v_lshl_add_u32 v231, v230, 7, v231
    v_add_u32 v23, 2048, v231
    v_add_u32 v229, 128, v228
    v_mul_u32_u24 v230, 205, v229
    v_lshrrev_b32 v230, 11, v230
    v_mul_u32_u24 v231, 10, v230
    v_sub_u32 v231, v229, v231
    v_lshl_add_u32 v230, v230, 4, v229
    v_lshrrev_b32 v231, 1, v231
    v_xor_b32 v231, v231, v233
    v_lshlrev_b32 v231, 4, v231
    v_lshl_add_u32 v231, v230, 7, v231
    v_add_u32 v24, 2048, v231
    v_add_u32 v229, 192, v228
    v_mul_u32_u24 v230, 205, v229
    v_lshrrev_b32 v230, 11, v230
    v_mul_u32_u24 v231, 10, v230
    v_sub_u32 v231, v229, v231
    v_lshl_add_u32 v230, v230, 4, v229
    v_lshrrev_b32 v231, 1, v231
    v_xor_b32 v231, v231, v233
    v_lshlrev_b32 v231, 4, v231
    v_lshl_add_u32 v231, v230, 7, v231
    v_add_u32 v25, 2048, v231
    v_add_u32 v229, 256, v228
    v_mul_u32_u24 v230, 205, v229
    v_lshrrev_b32 v230, 11, v230
    v_mul_u32_u24 v231, 10, v230
    v_sub_u32 v231, v229, v231
    v_lshl_add_u32 v230, v230, 4, v229
    v_lshrrev_b32 v231, 1, v231
    v_xor_b32 v231, v231, v233
    v_lshlrev_b32 v231, 4, v231
    v_lshl_add_u32 v231, v230, 7, v231
    v_add_u32 v26, 2048, v231
    v_mov_b32 v231, 0x7ffffff0
    v_cmp_lt_u32 vcc, 259, v229
    s_nop 1
    v_cndmask_b32 v26, v26, v231, vcc
    v_mov_b32 v144, 0
    v_mov_b32 v145, 0
    v_mov_b32 v146, 0
    v_mov_b32 v147, 0
    v_mov_b32 v67, 0
    v_mov_b32 v75, 0
    v_mov_b32 v83, 0
    v_mov_b32 v91, 0
    v_mov_b32 v148, 0
    v_mov_b32 v149, 0
    v_mov_b32 v150, 0
    v_mov_b32 v151, 0
    v_mov_b32 v71, 0
    v_mov_b32 v79, 0
    v_mov_b32 v87, 0
    v_mov_b32 v95, 0
    v_mov_b32 v163, 0
    v_mov_b32 v252, 0
    v_mov_b32 v253, 0
    v_mov_b32 v254, 0
    v_mov_b32 v255, 0
    s_waitcnt vmcnt(5)
    s_barrier
    ds_read_u16 v204, v201 offset:0
    ds_read_u16 v205, v201 offset:128
    ds_read_u16 v206, v201 offset:256
    ds_read_u16 v207, v201 offset:384
    ds_read_u16 v208, v201 offset:512
    ds_read_u16 v209, v201 offset:640
    ds_read_u16 v210, v201 offset:768
    ds_read_u16 v211, v201 offset:896
    ds_read_u16 v212, v201 offset:4096
    ds_read_u16 v213, v201 offset:4224
    ds_read_u16 v214, v201 offset:4352
    ds_read_u16 v215, v201 offset:4480
    s_waitcnt lgkmcnt(4)
    ds_read_u16 v216, v201 offset:4608
    ds_read_u16 v217, v201 offset:4736
    ds_read_u16 v218, v201 offset:4864
    ds_read_u16 v219, v201 offset:4992
    v_and_b32 v228, 3, v196
    v_cmp_eq_u32 vcc, 2, v228
    v_mov_b32 v229, 0x3c803c80
    s_nop 0
    v_cndmask_b32 v229, 0, v229, vcc
    v_cmp_gt_u32 vcc, 2, v228
    s_waitcnt lgkmcnt(0)
    v_lshl_or_b32 v152, v205, 16, v204
    v_cndmask_b32 v152, v229, v152, vcc
    v_lshl_or_b32 v153, v207, 16, v206
    v_cndmask_b32 v153, v229, v153, vcc
    v_lshl_or_b32 v154, v209, 16, v208
    v_cndmask_b32 v154, v229, v154, vcc
    v_lshl_or_b32 v155, v211, 16, v210
    v_cndmask_b32 v155, v229, v155, vcc
    v_lshl_or_b32 v156, v213, 16, v212
    v_cndmask_b32 v156, v229, v156, vcc
    v_lshl_or_b32 v157, v215, 16, v214
    v_cndmask_b32 v157, v229, v157, vcc
    v_lshl_or_b32 v158, v217, 16, v216
    v_cndmask_b32 v158, v229, v158, vcc
    v_lshl_or_b32 v159, v219, 16, v218
    v_cndmask_b32 v159, v229, v159, vcc
    ds_read_u16 v204, v199 offset:0
    ds_read_u16 v205, v199 offset:26
    ds_read_u16 v206, v199 offset:208
    ds_read_u16 v207, v199 offset:234
    ds_read_u16 v208, v199 offset:416
    ds_read_u16 v209, v199 offset:442
    ds_read_u16 v167, v200
    ds_read_u16 v212, v198 offset:0
    ds_read_u16 v213, v198 offset:52
    ds_read_u16 v214, v198 offset:104
    ds_read_u16 v215, v198 offset:156
    s_waitcnt lgkmcnt(0)
    v_lshl_or_b32 v164, v205, 16, v204
    v_lshl_or_b32 v165, v207, 16, v206
    v_lshl_or_b32 v166, v209, 16, v208
    v_lshl_or_b32 v168, v213, 16, v212
    v_lshl_or_b32 v169, v215, 16, v214
    s_waitcnt vmcnt(4)
    s_barrier
    v_add_u32_dpp v6, v4, v1 row_newbcast:2 row_mask:0xf bank_mask:0x3
    s_nop 1
    v_add_u32_dpp v6, v4, v1 row_newbcast:10 row_mask:0xf bank_mask:0xc
    s_add_u32 m0, s60, 40960
    s_nop 0
    buffer_load_dwordx4 v6, s[12:15], 0 offen lds
    s_mov_b64 exec, 0xff
    s_mov_b32 s56, 327680
    buffer_load_dword v8, v7, s[16:19], s56 offen
    s_mov_b64 exec, -1
    ds_read_b128 v[196:199], v10 offset:0
    ds_read_b128 v[200:203], v12 offset:0
    ds_read_b128 v[204:207], v11 offset:0
    ds_read_b128 v[208:211], v13 offset:0
    ds_read_b128 v[212:215], v10 offset:4096
    ds_read_b128 v[216:219], v12 offset:4096
    ds_read_b128 v[220:223], v11 offset:4096
    ds_read_b128 v[224:227], v13 offset:4096
    s_waitcnt lgkmcnt(6)
    v_mfma_f32_16x16x32_bf16 v[180:183], v[152:155], v[196:199], 0
    v_mfma_f32_16x16x32_bf16 v[180:183], v[156:159], v[200:203], v[180:183]
    s_waitcnt lgkmcnt(4)
    v_mfma_f32_16x16x32_bf16 v[184:187], v[152:155], v[204:207], 0
    v_mfma_f32_16x16x32_bf16 v[184:187], v[156:159], v[208:211], v[184:187]
    s_waitcnt lgkmcnt(2)
    v_mfma_f32_16x16x32_bf16 v[188:191], v[152:155], v[212:215], 0
    v_mfma_f32_16x16x32_bf16 v[188:191], v[156:159], v[216:219], v[188:191]
    s_waitcnt lgkmcnt(0)
    v_mfma_f32_16x16x32_bf16 v[192:195], v[152:155], v[220:223], 0
    v_mfma_f32_16x16x32_bf16 v[192:195], v[156:159], v[224:227], v[192:195]
    s_nop 4
    v_cvt_pk_bf16_f32 v32, v180, v188
    v_cvt_pk_bf16_f32 v40, v181, v189
    s_nop 0
    v_cvt_pk_bf16_f32 v36, v184, v192
    v_cvt_pk_bf16_f32 v44, v185, v193
    s_mov_b32 exec_lo, 65535
    s_mov_b32 exec_hi, 0
    v_cvt_pk_bf16_f32 v160, v182, v190
    s_mov_b64 exec, -1
    s_waitcnt vmcnt(5)
    s_barrier
    v_add_u32_dpp v5, v2, v1 row_newbcast:3 row_mask:0xf bank_mask:0x3
    s_nop 1
    v_add_u32_dpp v5, v2, v1 row_newbcast:11 row_mask:0xf bank_mask:0xc
    s_add_u32 m0, s60, 49152
    s_nop 0
    buffer_load_dwordx4 v5, s[12:15], 0 offen lds
    s_mov_b64 exec, 0xff
    s_mov_b32 s56, 458752
    buffer_load_dword v8, v7, s[16:19], s56 offen
    s_mov_b64 exec, -1
    ds_read_b128 v[196:199], v10 offset:8192
    ds_read_b128 v[200:203], v12 offset:8192
    ds_read_b128 v[204:207], v11 offset:8192
    ds_read_b128 v[208:211], v13 offset:8192
    ds_read_b128 v[212:215], v10 offset:12288
    ds_read_b128 v[216:219], v12 offset:12288
    ds_read_b128 v[220:223], v11 offset:12288
    ds_read_b128 v[224:227], v13 offset:12288
    s_waitcnt lgkmcnt(6)
    v_mfma_f32_16x16x32_bf16 v[180:183], v[152:155], v[196:199], 0
    v_mfma_f32_16x16x32_bf16 v[180:183], v[156:159], v[200:203], v[180:183]
    s_waitcnt lgkmcnt(4)
    v_mfma_f32_16x16x32_bf16 v[184:187], v[152:155], v[204:207], 0
    v_mfma_f32_16x16x32_bf16 v[184:187], v[156:159], v[208:211], v[184:187]
    s_waitcnt lgkmcnt(2)
    v_mfma_f32_16x16x32_bf16 v[188:191], v[152:155], v[212:215], 0
    v_mfma_f32_16x16x32_bf16 v[188:191], v[156:159], v[216:219], v[188:191]
    s_waitcnt lgkmcnt(0)
    v_mfma_f32_16x16x32_bf16 v[192:195], v[152:155], v[220:223], 0
    v_mfma_f32_16x16x32_bf16 v[192:195], v[156:159], v[224:227], v[192:195]
    s_nop 4
    v_cvt_pk_bf16_f32 v48, v180, v188
    v_cvt_pk_bf16_f32 v56, v181, v189
    s_nop 0
    v_cvt_pk_bf16_f32 v52, v184, v192
    v_cvt_pk_bf16_f32 v60, v185, v193
    s_mov_b32 exec_lo, 4294901760
    s_mov_b32 exec_hi, 0
    v_cvt_pk_bf16_f32 v160, v182, v190
    s_mov_b64 exec, -1
    s_waitcnt vmcnt(6)
    s_barrier
    v_add_u32_dpp v6, v4, v1 row_newbcast:3 row_mask:0xf bank_mask:0x3
    s_nop 1
    v_add_u32_dpp v6, v4, v1 row_newbcast:11 row_mask:0xf bank_mask:0xc
    s_add_u32 m0, s60, 57344
    s_nop 0
    buffer_load_dwordx4 v6, s[12:15], 0 offen lds
    s_mov_b64 exec, 0xff
    s_mov_b32 s56, 589824
    buffer_load_dword v8, v7, s[16:19], s56 offen
    s_mov_b64 exec, -1
    ds_read_b128 v[196:199], v10 offset:16384
    ds_read_b128 v[200:203], v12 offset:16384
    ds_read_b128 v[204:207], v11 offset:16384
    ds_read_b128 v[208:211], v13 offset:16384
    ds_read_b128 v[212:215], v10 offset:20480
    ds_read_b128 v[216:219], v12 offset:20480
    ds_read_b128 v[220:223], v11 offset:20480
    ds_read_b128 v[224:227], v13 offset:20480
    s_waitcnt lgkmcnt(6)
    v_mfma_f32_16x16x32_bf16 v[180:183], v[152:155], v[196:199], 0
    v_mfma_f32_16x16x32_bf16 v[180:183], v[156:159], v[200:203], v[180:183]
    s_waitcnt lgkmcnt(4)
    v_mfma_f32_16x16x32_bf16 v[184:187], v[152:155], v[204:207], 0
    v_mfma_f32_16x16x32_bf16 v[184:187], v[156:159], v[208:211], v[184:187]
    s_waitcnt lgkmcnt(2)
    v_mfma_f32_16x16x32_bf16 v[188:191], v[152:155], v[212:215], 0
    v_mfma_f32_16x16x32_bf16 v[188:191], v[156:159], v[216:219], v[188:191]
    s_waitcnt lgkmcnt(0)
    v_mfma_f32_16x16x32_bf16 v[192:195], v[152:155], v[220:223], 0
    v_mfma_f32_16x16x32_bf16 v[192:195], v[156:159], v[224:227], v[192:195]
    s_nop 4
    v_cvt_pk_bf16_f32 v64, v180, v188
    v_cvt_pk_bf16_f32 v72, v181, v189
    s_nop 0
    v_cvt_pk_bf16_f32 v68, v184, v192
    v_cvt_pk_bf16_f32 v76, v185, v193
    s_mov_b32 exec_lo, 0
    s_mov_b32 exec_hi, 65535
    v_cvt_pk_bf16_f32 v160, v182, v190
    s_mov_b64 exec, -1
    s_waitcnt vmcnt(7)
    s_barrier
    v_add_u32_dpp v5, v2, v1 row_newbcast:4 row_mask:0xf bank_mask:0x3
    s_nop 1
    v_add_u32_dpp v5, v2, v1 row_newbcast:12 row_mask:0xf bank_mask:0xc
    s_add_u32 m0, s60, 65536
    s_nop 0
    buffer_load_dwordx4 v5, s[12:15], 0 offen lds
    s_mov_b64 exec, 0xff
    s_mov_b32 s56, 720896
    buffer_load_dword v8, v7, s[16:19], s56 offen
    s_mov_b64 exec, -1
    ds_read_b128 v[196:199], v10 offset:24576
    ds_read_b128 v[200:203], v12 offset:24576
    ds_read_b128 v[204:207], v11 offset:24576
    ds_read_b128 v[208:211], v13 offset:24576
    ds_read_b128 v[212:215], v10 offset:28672
    ds_read_b128 v[216:219], v12 offset:28672
    ds_read_b128 v[220:223], v11 offset:28672
    ds_read_b128 v[224:227], v13 offset:28672
    s_waitcnt lgkmcnt(6)
    v_mfma_f32_16x16x32_bf16 v[180:183], v[152:155], v[196:199], 0
    v_mfma_f32_16x16x32_bf16 v[180:183], v[156:159], v[200:203], v[180:183]
    s_waitcnt lgkmcnt(4)
    v_mfma_f32_16x16x32_bf16 v[184:187], v[152:155], v[204:207], 0
    v_mfma_f32_16x16x32_bf16 v[184:187], v[156:159], v[208:211], v[184:187]
    s_waitcnt lgkmcnt(2)
    v_mfma_f32_16x16x32_bf16 v[188:191], v[152:155], v[212:215], 0
    v_mfma_f32_16x16x32_bf16 v[188:191], v[156:159], v[216:219], v[188:191]
    s_waitcnt lgkmcnt(0)
    v_mfma_f32_16x16x32_bf16 v[192:195], v[152:155], v[220:223], 0
    v_mfma_f32_16x16x32_bf16 v[192:195], v[156:159], v[224:227], v[192:195]
    ds_read_b128 v[96:99], v14 offset:0
    ds_read_b128 v[100:103], v15 offset:0
    ds_read_b128 v[104:107], v14 offset:4096
    ds_read_b128 v[108:111], v15 offset:4096
    s_nop 0
    v_cvt_pk_bf16_f32 v80, v180, v188
    v_cvt_pk_bf16_f32 v88, v181, v189
    s_nop 0
    v_cvt_pk_bf16_f32 v84, v184, v192
    v_cvt_pk_bf16_f32 v92, v185, v193
    s_mov_b32 exec_lo, 0
    s_mov_b32 exec_hi, 4294901760
    v_cvt_pk_bf16_f32 v160, v182, v190
    s_mov_b64 exec, -1
    v_permlane32_swap_b32 v32, v64
    v_permlane32_swap_b32 v48, v80
    v_permlane32_swap_b32 v40, v72
    v_permlane32_swap_b32 v56, v88
    v_permlane32_swap_b32 v36, v68
    v_permlane32_swap_b32 v52, v84
    v_permlane32_swap_b32 v44, v76
    v_permlane32_swap_b32 v60, v92
    v_permlane16_swap_b32 v32, v48
    v_permlane16_swap_b32 v64, v80
    v_permlane16_swap_b32 v40, v56
    v_permlane16_swap_b32 v72, v88
    v_permlane16_swap_b32 v36, v52
    v_permlane16_swap_b32 v68, v84
    v_permlane16_swap_b32 v44, v60
    v_permlane16_swap_b32 v76, v92
    s_waitcnt lgkmcnt(0)
    s_waitcnt vmcnt(8)
    s_barrier
    v_add_u32_dpp v6, v4, v1 row_newbcast:4 row_mask:0xf bank_mask:0x3
    s_nop 1
    v_add_u32_dpp v6, v4, v1 row_newbcast:12 row_mask:0xf bank_mask:0xc
    s_add_u32 m0, s60, 73728
    s_nop 0
    buffer_load_dwordx4 v6, s[12:15], 0 offen lds
    s_mov_b64 exec, 0xff
    s_mov_b32 s56, 0
    buffer_load_dword v8, v7, s[20:23], s56 offen
    s_mov_b64 exec, -1
    ds_read_b128 v[196:199], v10 offset:32768
    ds_read_b128 v[200:203], v12 offset:32768
    ds_read_b128 v[204:207], v11 offset:32768
    ds_read_b128 v[208:211], v13 offset:32768
    ds_read_b128 v[212:215], v10 offset:36864
    ds_read_b128 v[216:219], v12 offset:36864
    ds_read_b128 v[220:223], v11 offset:36864
    ds_read_b128 v[224:227], v13 offset:36864
    s_waitcnt lgkmcnt(6)
    v_mfma_f32_16x16x32_bf16 v[180:183], v[152:155], v[196:199], 0
    v_mfma_f32_16x16x32_bf16 v[180:183], v[156:159], v[200:203], v[180:183]
    s_waitcnt lgkmcnt(4)
    v_mfma_f32_16x16x32_bf16 v[184:187], v[152:155], v[204:207], 0
    v_mfma_f32_16x16x32_bf16 v[184:187], v[156:159], v[208:211], v[184:187]
    s_waitcnt lgkmcnt(2)
    v_mfma_f32_16x16x32_bf16 v[188:191], v[152:155], v[212:215], 0
    v_mfma_f32_16x16x32_bf16 v[188:191], v[156:159], v[216:219], v[188:191]
    s_waitcnt lgkmcnt(0)
    v_mfma_f32_16x16x32_bf16 v[192:195], v[152:155], v[220:223], 0
    v_mfma_f32_16x16x32_bf16 v[192:195], v[156:159], v[224:227], v[192:195]
    s_nop 4
    v_cvt_pk_bf16_f32 v33, v180, v188
    v_cvt_pk_bf16_f32 v41, v181, v189
    s_nop 0
    v_cvt_pk_bf16_f32 v37, v184, v192
    v_cvt_pk_bf16_f32 v45, v185, v193
    s_mov_b32 exec_lo, 65535
    s_mov_b32 exec_hi, 0
    v_cvt_pk_bf16_f32 v161, v182, v190
    s_mov_b64 exec, -1
    s_waitcnt vmcnt(9)
    s_barrier
    v_add_u32_dpp v5, v2, v1 row_newbcast:5 row_mask:0xf bank_mask:0x3
    s_nop 1
    v_add_u32_dpp v5, v2, v1 row_newbcast:13 row_mask:0xf bank_mask:0xc
    s_add_u32 m0, s60, 81920
    s_nop 0
    buffer_load_dwordx4 v5, s[12:15], 0 offen lds
    s_mov_b64 exec, 0xff
    s_mov_b32 s56, 131072
    buffer_load_dword v8, v7, s[20:23], s56 offen
    s_mov_b64 exec, -1
    ds_read_b128 v[196:199], v10 offset:40960
    ds_read_b128 v[200:203], v12 offset:40960
    ds_read_b128 v[204:207], v11 offset:40960
    ds_read_b128 v[208:211], v13 offset:40960
    ds_read_b128 v[212:215], v10 offset:45056
    ds_read_b128 v[216:219], v12 offset:45056
    ds_read_b128 v[220:223], v11 offset:45056
    ds_read_b128 v[224:227], v13 offset:45056
    s_waitcnt lgkmcnt(6)
    v_mfma_f32_16x16x32_bf16 v[180:183], v[152:155], v[196:199], 0
    v_mfma_f32_16x16x32_bf16 v[180:183], v[156:159], v[200:203], v[180:183]
    s_waitcnt lgkmcnt(4)
    v_mfma_f32_16x16x32_bf16 v[184:187], v[152:155], v[204:207], 0
    v_mfma_f32_16x16x32_bf16 v[184:187], v[156:159], v[208:211], v[184:187]
    s_waitcnt lgkmcnt(2)
    v_mfma_f32_16x16x32_bf16 v[188:191], v[152:155], v[212:215], 0
    v_mfma_f32_16x16x32_bf16 v[188:191], v[156:159], v[216:219], v[188:191]
    s_waitcnt lgkmcnt(0)
    v_mfma_f32_16x16x32_bf16 v[192:195], v[152:155], v[220:223], 0
    v_mfma_f32_16x16x32_bf16 v[192:195], v[156:159], v[224:227], v[192:195]
    s_nop 4
    v_cvt_pk_bf16_f32 v49, v180, v188
    v_cvt_pk_bf16_f32 v57, v181, v189
    s_nop 0
    v_cvt_pk_bf16_f32 v53, v184, v192
    v_cvt_pk_bf16_f32 v61, v185, v193
    s_mov_b32 exec_lo, 4294901760
    s_mov_b32 exec_hi, 0
    v_cvt_pk_bf16_f32 v161, v182, v190
    s_mov_b64 exec, -1
    s_waitcnt vmcnt(9)
    s_barrier
    v_add_u32_dpp v6, v4, v1 row_newbcast:5 row_mask:0xf bank_mask:0x3
    s_nop 1
    v_add_u32_dpp v6, v4, v1 row_newbcast:13 row_mask:0xf bank_mask:0xc
    s_add_u32 m0, s60, 90112
    s_nop 0
    buffer_load_dwordx4 v6, s[12:15], 0 offen lds
    s_mov_b64 exec, 1
    v_mov_b32 v7, 0
    buffer_load_dword v8, v7, s[40:43], 0 offen
    buffer_load_dword v8, v7, s[44:47], 0 offen
    buffer_load_dword v8, v7, s[48:51], 0 offen
    s_mov_b64 exec, -1
    ds_read_b128 v[196:199], v10 offset:49152
    ds_read_b128 v[200:203], v12 offset:49152
    ds_read_b128 v[204:207], v11 offset:49152
    ds_read_b128 v[208:211], v13 offset:49152
    ds_read_b128 v[212:215], v10 offset:53248
    ds_read_b128 v[216:219], v12 offset:53248
    ds_read_b128 v[220:223], v11 offset:53248
    ds_read_b128 v[224:227], v13 offset:53248
    s_waitcnt lgkmcnt(6)
    v_mfma_f32_16x16x32_bf16 v[180:183], v[152:155], v[196:199], 0
    v_mfma_f32_16x16x32_bf16 v[180:183], v[156:159], v[200:203], v[180:183]
    s_waitcnt lgkmcnt(4)
    v_mfma_f32_16x16x32_bf16 v[184:187], v[152:155], v[204:207], 0
    v_mfma_f32_16x16x32_bf16 v[184:187], v[156:159], v[208:211], v[184:187]
    s_waitcnt lgkmcnt(2)
    v_mfma_f32_16x16x32_bf16 v[188:191], v[152:155], v[212:215], 0
    v_mfma_f32_16x16x32_bf16 v[188:191], v[156:159], v[216:219], v[188:191]
    s_waitcnt lgkmcnt(0)
    v_mfma_f32_16x16x32_bf16 v[192:195], v[152:155], v[220:223], 0
    v_mfma_f32_16x16x32_bf16 v[192:195], v[156:159], v[224:227], v[192:195]
    s_nop 4
    v_cvt_pk_bf16_f32 v65, v180, v188
    v_cvt_pk_bf16_f32 v73, v181, v189
    s_nop 0
    v_cvt_pk_bf16_f32 v69, v184, v192
    v_cvt_pk_bf16_f32 v77, v185, v193
    s_mov_b32 exec_lo, 0
    s_mov_b32 exec_hi, 65535
    v_cvt_pk_bf16_f32 v161, v182, v190
    s_mov_b64 exec, -1
    s_waitcnt vmcnt(11)
    s_barrier
    v_add_u32_dpp v5, v2, v1 row_newbcast:6 row_mask:0xf bank_mask:0x3
    s_nop 1
    v_add_u32_dpp v5, v2, v1 row_newbcast:14 row_mask:0xf bank_mask:0xc
    s_add_u32 m0, s60, 98304
    s_nop 0
    buffer_load_dwordx4 v5, s[12:15], 0 offen lds
    ds_read_b128 v[196:199], v10 offset:57344
    ds_read_b128 v[200:203], v12 offset:57344
    ds_read_b128 v[204:207], v11 offset:57344
    ds_read_b128 v[208:211], v13 offset:57344
    ds_read_b128 v[212:215], v10 offset:61440
    ds_read_b128 v[216:219], v12 offset:61440
    ds_read_b128 v[220:223], v11 offset:61440
    ds_read_b128 v[224:227], v13 offset:61440
    s_waitcnt lgkmcnt(6)
    v_mfma_f32_16x16x32_bf16 v[180:183], v[152:155], v[196:199], 0
    v_mfma_f32_16x16x32_bf16 v[180:183], v[156:159], v[200:203], v[180:183]
    s_waitcnt lgkmcnt(4)
    v_mfma_f32_16x16x32_bf16 v[184:187], v[152:155], v[204:207], 0
    v_mfma_f32_16x16x32_bf16 v[184:187], v[156:159], v[208:211], v[184:187]
    s_waitcnt lgkmcnt(2)
    v_mfma_f32_16x16x32_bf16 v[188:191], v[152:155], v[212:215], 0
    v_mfma_f32_16x16x32_bf16 v[188:191], v[156:159], v[216:219], v[188:191]
    s_waitcnt lgkmcnt(0)
    v_mfma_f32_16x16x32_bf16 v[192:195], v[152:155], v[220:223], 0
    v_mfma_f32_16x16x32_bf16 v[192:195], v[156:159], v[224:227], v[192:195]
    ds_read_b128 v[112:115], v14 offset:32768
    ds_read_b128 v[116:119], v15 offset:32768
    ds_read_b128 v[120:123], v14 offset:36864
    ds_read_b128 v[124:127], v15 offset:36864
    s_nop 0
    v_cvt_pk_bf16_f32 v81, v180, v188
    v_cvt_pk_bf16_f32 v89, v181, v189
    s_nop 0
    v_cvt_pk_bf16_f32 v85, v184, v192
    v_cvt_pk_bf16_f32 v93, v185, v193
    s_mov_b32 exec_lo, 0
    s_mov_b32 exec_hi, 4294901760
    v_cvt_pk_bf16_f32 v161, v182, v190
    s_mov_b64 exec, -1
    v_permlane32_swap_b32 v33, v65
    v_permlane32_swap_b32 v49, v81
    v_permlane32_swap_b32 v41, v73
    v_permlane32_swap_b32 v57, v89
    v_permlane32_swap_b32 v37, v69
    v_permlane32_swap_b32 v53, v85
    v_permlane32_swap_b32 v45, v77
    v_permlane32_swap_b32 v61, v93
    v_permlane16_swap_b32 v33, v49
    v_permlane16_swap_b32 v65, v81
    v_permlane16_swap_b32 v41, v57
    v_permlane16_swap_b32 v73, v89
    v_permlane16_swap_b32 v37, v53
    v_permlane16_swap_b32 v69, v85
    v_permlane16_swap_b32 v45, v61
    v_permlane16_swap_b32 v77, v93
    s_waitcnt lgkmcnt(0)
    s_waitcnt vmcnt(10)
    s_barrier
    s_add_u32 m0, s61, 106496
    s_nop 0
    buffer_load_dwordx4 v22, s[20:23], 0 offen lds
    v_add_u32 v10, 0x10000, v10
    v_add_u32 v11, 0x10000, v11
    v_add_u32 v12, 0x10000, v12
    v_add_u32 v13, 0x10000, v13
    v_add_u32 v14, 0x10000, v14
    v_add_u32 v15, 0x10000, v15
    ds_read_b128 v[196:199], v10 offset:0
    ds_read_b128 v[200:203], v12 offset:0
    ds_read_b128 v[204:207], v11 offset:0
    ds_read_b128 v[208:211], v13 offset:0
    ds_read_b128 v[212:215], v10 offset:4096
    ds_read_b128 v[216:219], v12 offset:4096
    ds_read_b128 v[220:223], v11 offset:4096
    ds_read_b128 v[224:227], v13 offset:4096
    s_waitcnt lgkmcnt(6)
    v_mfma_f32_16x16x32_bf16 v[180:183], v[152:155], v[196:199], 0
    v_mfma_f32_16x16x32_bf16 v[180:183], v[156:159], v[200:203], v[180:183]
    s_waitcnt lgkmcnt(4)
    v_mfma_f32_16x16x32_bf16 v[184:187], v[152:155], v[204:207], 0
    v_mfma_f32_16x16x32_bf16 v[184:187], v[156:159], v[208:211], v[184:187]
    s_waitcnt lgkmcnt(2)
    v_mfma_f32_16x16x32_bf16 v[188:191], v[152:155], v[212:215], 0
    v_mfma_f32_16x16x32_bf16 v[188:191], v[156:159], v[216:219], v[188:191]
    s_waitcnt lgkmcnt(0)
    v_mfma_f32_16x16x32_bf16 v[192:195], v[152:155], v[220:223], 0
    v_mfma_f32_16x16x32_bf16 v[192:195], v[156:159], v[224:227], v[192:195]
    s_nop 4
    v_cvt_pk_bf16_f32 v34, v180, v188
    v_cvt_pk_bf16_f32 v42, v181, v189
    s_nop 0
    v_cvt_pk_bf16_f32 v38, v184, v192
    v_cvt_pk_bf16_f32 v46, v185, v193
    s_mov_b32 exec_lo, 65535
    s_mov_b32 exec_hi, 0
    v_cvt_pk_bf16_f32 v162, v182, v190
    s_mov_b64 exec, -1
    s_waitcnt vmcnt(9)
    s_barrier
    s_add_u32 m0, s61, 114688
    s_nop 0
    buffer_load_dwordx4 v23, s[20:23], 0 offen lds
    ds_read_b128 v[196:199], v10 offset:8192
    ds_read_b128 v[200:203], v12 offset:8192
    ds_read_b128 v[204:207], v11 offset:8192
    ds_read_b128 v[208:211], v13 offset:8192
    ds_read_b128 v[212:215], v10 offset:12288
    ds_read_b128 v[216:219], v12 offset:12288
    ds_read_b128 v[220:223], v11 offset:12288
    ds_read_b128 v[224:227], v13 offset:12288
    s_waitcnt lgkmcnt(6)
    v_mfma_f32_16x16x32_bf16 v[180:183], v[152:155], v[196:199], 0
    v_mfma_f32_16x16x32_bf16 v[180:183], v[156:159], v[200:203], v[180:183]
    s_waitcnt lgkmcnt(4)
    v_mfma_f32_16x16x32_bf16 v[184:187], v[152:155], v[204:207], 0
    v_mfma_f32_16x16x32_bf16 v[184:187], v[156:159], v[208:211], v[184:187]
    s_waitcnt lgkmcnt(2)
    v_mfma_f32_16x16x32_bf16 v[188:191], v[152:155], v[212:215], 0
    v_mfma_f32_16x16x32_bf16 v[188:191], v[156:159], v[216:219], v[188:191]
    s_waitcnt lgkmcnt(0)
    v_mfma_f32_16x16x32_bf16 v[192:195], v[152:155], v[220:223], 0
    v_mfma_f32_16x16x32_bf16 v[192:195], v[156:159], v[224:227], v[192:195]
    s_nop 4
    v_cvt_pk_bf16_f32 v50, v180, v188
    v_cvt_pk_bf16_f32 v58, v181, v189
    s_nop 0
    v_cvt_pk_bf16_f32 v54, v184, v192
    v_cvt_pk_bf16_f32 v62, v185, v193
    s_mov_b32 exec_lo, 4294901760
    s_mov_b32 exec_hi, 0
    v_cvt_pk_bf16_f32 v162, v182, v190
    s_mov_b64 exec, -1
    s_waitcnt vmcnt(8)
    s_barrier
    s_add_u32 m0, s61, 122880
    s_nop 0
    buffer_load_dwordx4 v24, s[20:23], 0 offen lds
    ds_read_b128 v[196:199], v10 offset:16384
    ds_read_b128 v[200:203], v12 offset:16384
    ds_read_b128 v[204:207], v11 offset:16384
    ds_read_b128 v[208:211], v13 offset:16384
    ds_read_b128 v[212:215], v10 offset:20480
    ds_read_b128 v[216:219], v12 offset:20480
    ds_read_b128 v[220:223], v11 offset:20480
    ds_read_b128 v[224:227], v13 offset:20480
    s_waitcnt lgkmcnt(6)
    v_mfma_f32_16x16x32_bf16 v[180:183], v[152:155], v[196:199], 0
    v_mfma_f32_16x16x32_bf16 v[180:183], v[156:159], v[200:203], v[180:183]
    s_waitcnt lgkmcnt(4)
    v_mfma_f32_16x16x32_bf16 v[184:187], v[152:155], v[204:207], 0
    v_mfma_f32_16x16x32_bf16 v[184:187], v[156:159], v[208:211], v[184:187]
    s_waitcnt lgkmcnt(2)
    v_mfma_f32_16x16x32_bf16 v[188:191], v[152:155], v[212:215], 0
    v_mfma_f32_16x16x32_bf16 v[188:191], v[156:159], v[216:219], v[188:191]
    s_waitcnt lgkmcnt(0)
    v_mfma_f32_16x16x32_bf16 v[192:195], v[152:155], v[220:223], 0
    v_mfma_f32_16x16x32_bf16 v[192:195], v[156:159], v[224:227], v[192:195]
    s_nop 4
    v_cvt_pk_bf16_f32 v66, v180, v188
    v_cvt_pk_bf16_f32 v74, v181, v189
    s_nop 0
    v_cvt_pk_bf16_f32 v70, v184, v192
    v_cvt_pk_bf16_f32 v78, v185, v193
    s_mov_b32 exec_lo, 0
    s_mov_b32 exec_hi, 65535
    v_cvt_pk_bf16_f32 v162, v182, v190
    s_mov_b64 exec, -1
    s_waitcnt vmcnt(7)
    s_barrier
    s_add_u32 m0, s61, 131072
    s_nop 0
    buffer_load_dwordx4 v25, s[20:23], 0 offen lds
    ds_read_b128 v[196:199], v10 offset:24576
    ds_read_b128 v[200:203], v12 offset:24576
    ds_read_b128 v[204:207], v11 offset:24576
    ds_read_b128 v[208:211], v13 offset:24576
    ds_read_b128 v[212:215], v10 offset:28672
    ds_read_b128 v[216:219], v12 offset:28672
    ds_read_b128 v[220:223], v11 offset:28672
    ds_read_b128 v[224:227], v13 offset:28672
    s_waitcnt lgkmcnt(6)
    v_mfma_f32_16x16x32_bf16 v[180:183], v[152:155], v[196:199], 0
    v_mfma_f32_16x16x32_bf16 v[180:183], v[156:159], v[200:203], v[180:183]
    s_waitcnt lgkmcnt(4)
    v_mfma_f32_16x16x32_bf16 v[184:187], v[152:155], v[204:207], 0
    v_mfma_f32_16x16x32_bf16 v[184:187], v[156:159], v[208:211], v[184:187]
    s_waitcnt lgkmcnt(2)
    v_mfma_f32_16x16x32_bf16 v[188:191], v[152:155], v[212:215], 0
    v_mfma_f32_16x16x32_bf16 v[188:191], v[156:159], v[216:219], v[188:191]
    s_waitcnt lgkmcnt(0)
    v_mfma_f32_16x16x32_bf16 v[192:195], v[152:155], v[220:223], 0
    v_mfma_f32_16x16x32_bf16 v[192:195], v[156:159], v[224:227], v[192:195]
    ds_read_b128 v[128:131], v14 offset:0
    ds_read_b128 v[132:135], v15 offset:0
    ds_read_b128 v[136:139], v14 offset:4096
    ds_read_b128 v[140:143], v15 offset:4096
    s_nop 0
    v_cvt_pk_bf16_f32 v82, v180, v188
    v_cvt_pk_bf16_f32 v90, v181, v189
    s_nop 0
    v_cvt_pk_bf16_f32 v86, v184, v192
    v_cvt_pk_bf16_f32 v94, v185, v193
    s_mov_b32 exec_lo, 0
    s_mov_b32 exec_hi, 4294901760
    v_cvt_pk_bf16_f32 v162, v182, v190
    s_mov_b64 exec, -1
    v_permlane32_swap_b32 v34, v66
    v_permlane32_swap_b32 v50, v82
    v_permlane32_swap_b32 v42, v74
    v_permlane32_swap_b32 v58, v90
    v_permlane32_swap_b32 v38, v70
    v_permlane32_swap_b32 v54, v86
    v_permlane32_swap_b32 v46, v78
    v_permlane32_swap_b32 v62, v94
    v_permlane16_swap_b32 v34, v50
    v_permlane16_swap_b32 v66, v82
    v_permlane16_swap_b32 v42, v58
    v_permlane16_swap_b32 v74, v90
    v_permlane16_swap_b32 v38, v54
    v_permlane16_swap_b32 v70, v86
    v_permlane16_swap_b32 v46, v62
    v_permlane16_swap_b32 v78, v94
    s_waitcnt lgkmcnt(0)
    s_waitcnt vmcnt(4)
    s_barrier
    s_add_u32 m0, s61, 139264
    s_nop 0
    buffer_load_dwordx4 v26, s[20:23], 0 offen lds
    ds_read_b128 v[196:199], v10 offset:32768
    ds_read_b128 v[200:203], v12 offset:32768
    ds_read_b128 v[204:207], v11 offset:32768
    ds_read_b128 v[208:211], v13 offset:32768
    ds_read_b128 v[212:215], v10 offset:36864
    ds_read_b128 v[216:219], v12 offset:36864
    ds_read_b128 v[220:223], v11 offset:36864
    ds_read_b128 v[224:227], v13 offset:36864
    s_waitcnt lgkmcnt(6)
    v_mfma_f32_16x16x32_bf16 v[180:183], v[152:155], v[196:199], 0
    v_mfma_f32_16x16x32_bf16 v[180:183], v[156:159], v[200:203], v[180:183]
    s_waitcnt lgkmcnt(4)
    v_mfma_f32_16x16x32_bf16 v[184:187], v[152:155], v[204:207], 0
    v_mfma_f32_16x16x32_bf16 v[184:187], v[156:159], v[208:211], v[184:187]
    s_waitcnt lgkmcnt(2)
    v_mfma_f32_16x16x32_bf16 v[188:191], v[152:155], v[212:215], 0
    v_mfma_f32_16x16x32_bf16 v[188:191], v[156:159], v[216:219], v[188:191]
    s_waitcnt lgkmcnt(0)
    v_mfma_f32_16x16x32_bf16 v[192:195], v[152:155], v[220:223], 0
    v_mfma_f32_16x16x32_bf16 v[192:195], v[156:159], v[224:227], v[192:195]
    s_mov_b32 exec_hi, 0
    ds_read_b128 v[144:147], v16
    ds_read_b128 v[148:151], v17
    s_mov_b64 exec, -1
    s_mov_b64 exec, 0xffff
    v_cvt_pk_bf16_f32 v163, v182, 0
    s_mov_b32 exec_lo, 0xffff0000
    v_cvt_pk_bf16_f32 v163, v190, 0
    s_mov_b64 exec, -1
    v_cvt_pk_bf16_f32 v35, v180, 0
    v_cvt_pk_bf16_f32 v43, v181, 0
    v_cvt_pk_bf16_f32 v51, v188, 0
    v_cvt_pk_bf16_f32 v59, v189, 0
    v_cvt_pk_bf16_f32 v39, v184, 0
    v_cvt_pk_bf16_f32 v47, v185, 0
    v_cvt_pk_bf16_f32 v55, v192, 0
    v_cvt_pk_bf16_f32 v63, v193, 0
    s_add_u32 m0, s61, 0
    s_mov_b32 s56, 0
    buffer_load_dwordx4 v27, s[20:23], s56 offen lds
    s_cmp_ge_u32 s52, 4
    s_cbranch_scc1 L_nosenet
    v_mfma_f32_16x16x32_bf16 v[196:199], v[164:167], v[160:163], 0
    v_mov_b32 v216, s66
    s_nop 6
    v_cvt_pk_bf16_f32 v204, v196, v197
    v_cvt_pk_bf16_f32 v205, v198, v199
    v_lshlrev_b32 v196, 16, v204
    v_and_b32 v197, s68, v204
    v_lshlrev_b32 v198, 16, v205
    v_and_b32 v199, s68, v205
    v_mul_f32 v208, v196, v196
    v_mul_f32 v209, v197, v197
    v_mul_f32 v210, v198, v198
    v_mul_f32 v211, v199, v199
    v_fma_f32 v208, v208, s67, v216
    v_fma_f32 v209, v209, s67, v216
    v_fma_f32 v210, v210, s67, v216
    v_fma_f32 v211, v211, s67, v216
    v_mul_f32 v208, v208, v196
    v_mul_f32 v209, v209, v197
    v_mul_f32 v210, v210, v198
    v_mul_f32 v211, v211, v199
    v_exp_f32 v208, v208
    v_exp_f32 v209, v209
    v_exp_f32 v210, v210
    v_exp_f32 v211, v211
    v_add_f32 v208, 1.0, v208
    v_add_f32 v209, 1.0, v209
    v_add_f32 v210, 1.0, v210
    v_add_f32 v211, 1.0, v211
    v_rcp_f32 v208, v208
    v_rcp_f32 v209, v209
    v_rcp_f32 v210, v210
    v_rcp_f32 v211, v211
    v_mul_f32 v200, v196, v208
    v_mul_f32 v201, v197, v209
    v_mul_f32 v202, v198, v210
    v_mul_f32 v203, v199, v211
    v_cvt_pk_bf16_f32 v206, v200, v201
    v_cvt_pk_bf16_f32 v207, v202, v203
    s_nop 1
    v_mfma_f32_16x16x16_bf16 v[212:215], v[168:169], v[206:207], 0
    s_nop 7
    v_cvt_pk_bf16_f32 v204, v212, v213
    v_cvt_pk_bf16_f32 v205, v214, v215
    v_lshlrev_b32 v196, 16, v204
    v_and_b32 v197, s68, v204
    v_lshlrev_b32 v198, 16, v205
    v_and_b32 v199, s68, v205
    v_mul_f32 v196, s69, v196
    v_mul_f32 v197, s69, v197
    v_mul_f32 v198, s69, v198
    v_mul_f32 v199, s69, v199
    v_exp_f32 v196, v196
    v_exp_f32 v197, v197
    v_exp_f32 v198, v198
    v_exp_f32 v199, v199
    v_add_f32 v196, 1.0, v196
    v_add_f32 v197, 1.0, v197
    v_add_f32 v198, 1.0, v198
    v_add_f32 v199, 1.0, v199
    v_rcp_f32 v196, v196
    v_rcp_f32 v197, v197
    v_rcp_f32 v198, v198
    v_rcp_f32 v199, v199
    v_cvt_pk_bf16_f32 v200, v196, 0
    v_cvt_pk_bf16_f32 v201, 0, v197
    v_cvt_pk_bf16_f32 v202, v198, 0
    v_cvt_pk_bf16_f32 v203, 0, v199
    ds_write_b128 v28, v[200:203]
L_nosenet:
    s_nop 1
    v_permlane32_swap_b32 v35, v67
    v_permlane32_swap_b32 v51, v83
    v_permlane32_swap_b32 v43, v75
    v_permlane32_swap_b32 v59, v91
    v_permlane32_swap_b32 v39, v71
    v_permlane32_swap_b32 v55, v87
    v_permlane32_swap_b32 v47, v79
    v_permlane32_swap_b32 v63, v95
    v_permlane16_swap_b32 v35, v51
    v_permlane16_swap_b32 v67, v83
    v_permlane16_swap_b32 v43, v59
    v_permlane16_swap_b32 v75, v91
    v_permlane16_swap_b32 v39, v55
    v_permlane16_swap_b32 v71, v87
    v_permlane16_swap_b32 v47, v63
    v_permlane16_swap_b32 v79, v95
    s_add_u32 m0, s61, 8192
    s_mov_b32 s56, 13312
    buffer_load_dwordx4 v27, s[20:23], s56 offen lds
    v_mov_b32 v1, 0
    v_mov_b32 v2, 0
    v_mov_b32 v3, 0
    v_mov_b32 v4, 0
    v_mov_b32 v5, 0
    v_mov_b32 v6, 0
    v_mov_b32 v7, 0
    v_mov_b32 v8, 0
    v_mov_b32 v10, 0
    v_mov_b32 v11, 0
    v_mov_b32 v12, 0
    v_mov_b32 v13, 0
    v_mov_b32 v14, 0
    v_mov_b32 v15, 0
    s_add_u32 m0, s61, 16384
    s_mov_b32 s56, 26624
    buffer_load_dwordx4 v27, s[20:23], s56 offen lds
    s_waitcnt lgkmcnt(0)
    s_waitcnt vmcnt(3)
    s_barrier
    ds_read_b128 v[152:155], v20 offset:0
    ds_read_b128 v[156:159], v20 offset:1280
    ds_read_b128 v[160:163], v20 offset:10240
    ds_read_b128 v[164:167], v20 offset:11520
    ds_read_b128 v[168:171], v20 offset:20480
    ds_read_b128 v[172:175], v20 offset:21760
    ds_read_b128 v[176:179], v21
    s_add_u32 m0, s61, 24576
    s_mov_b32 s56, 39936
    buffer_load_dwordx4 v27, s[20:23], s56 offen lds
    s_waitcnt lgkmcnt(0)
    v_perm_b32 v180, v156, v152, s64
    v_perm_b32 v184, v156, v152, s65
    v_perm_b32 v181, v164, v160, s64
    v_perm_b32 v185, v164, v160, s65
    v_perm_b32 v182, v172, v168, s64
    v_perm_b32 v186, v172, v168, s65
    v_mov_b32 v183, v176
    v_lshrrev_b32 v187, 16, v176
    s_nop 0
    v_mfma_f32_16x16x32_bf16 v[196:199], v[180:183], v[32:35], 0
    v_mfma_f32_16x16x32_bf16 v[204:207], v[184:187], v[40:43], 0
    v_mfma_f32_16x16x32_bf16 v[200:203], v[180:183], v[36:39], 0
    v_mfma_f32_16x16x32_bf16 v[208:211], v[184:187], v[44:47], 0
    s_add_u32 m0, s61, 32768
    s_mov_b32 s56, 53248
    buffer_load_dwordx4 v27, s[20:23], s56 offen lds
    v_perm_b32 v188, v157, v153, s64
    v_perm_b32 v192, v157, v153, s65
    v_perm_b32 v189, v165, v161, s64
    v_perm_b32 v193, v165, v161, s65
    v_perm_b32 v190, v173, v169, s64
    v_perm_b32 v194, v173, v169, s65
    v_mov_b32 v191, v177
    v_lshrrev_b32 v195, 16, v177
    s_nop 0
    v_mfma_f32_16x16x32_bf16 v[212:215], v[188:191], v[48:51], 0
    v_mfma_f32_16x16x32_bf16 v[220:223], v[192:195], v[56:59], 0
    v_mfma_f32_16x16x32_bf16 v[216:219], v[188:191], v[52:55], 0
    v_mfma_f32_16x16x32_bf16 v[224:227], v[192:195], v[60:63], 0
    s_add_u32 m0, s61, 40960
    s_mov_b32 s56, 66560
    buffer_load_dwordx4 v27, s[20:23], s56 offen lds
    v_cvt_pk_bf16_f32 v228, v196, v204
    v_cvt_pk_bf16_f32 v229, v197, v205
    v_cvt_pk_bf16_f32 v230, v198, v206
    v_cvt_pk_bf16_f32 v232, v200, v208
    v_cvt_pk_bf16_f32 v233, v201, v209
    v_cvt_pk_bf16_f32 v234, v202, v210
    v_dot2c_f32_bf16 v252, v228, v128
    v_dot2c_f32_bf16 v253, v229, v136
    v_dot2c_f32_bf16 v252, v230, v144
    v_dot2c_f32_bf16 v254, v232, v132
    v_dot2c_f32_bf16 v255, v233, v140
    v_dot2c_f32_bf16 v254, v234, v148
    s_add_u32 m0, s63, 0
    s_add_u32 s56, s62, 0
    buffer_load_dwordx4 v27, s[20:23], s56 offen lds
    v_perm_b32 v180, v158, v154, s64
    v_perm_b32 v184, v158, v154, s65
    v_perm_b32 v181, v166, v162, s64
    v_perm_b32 v185, v166, v162, s65
    v_perm_b32 v182, v174, v170, s64
    v_perm_b32 v186, v174, v170, s65
    v_mov_b32 v183, v178
    v_lshrrev_b32 v187, 16, v178
    s_nop 0
    v_mfma_f32_16x16x32_bf16 v[196:199], v[180:183], v[64:67], 0
    v_mfma_f32_16x16x32_bf16 v[204:207], v[184:187], v[72:75], 0
    v_mfma_f32_16x16x32_bf16 v[200:203], v[180:183], v[68:71], 0
    v_mfma_f32_16x16x32_bf16 v[208:211], v[184:187], v[76:79], 0
    s_add_u32 m0, s61, 53248
    s_mov_b32 s56, 86528
    buffer_load_dwordx4 v27, s[20:23], s56 offen lds
    v_cvt_pk_bf16_f32 v228, v212, v220
    v_cvt_pk_bf16_f32 v229, v213, v221
    v_cvt_pk_bf16_f32 v230, v214, v222
    v_cvt_pk_bf16_f32 v232, v216, v224
    v_cvt_pk_bf16_f32 v233, v217, v225
    v_cvt_pk_bf16_f32 v234, v218, v226
    v_dot2c_f32_bf16 v252, v228, v129
    v_dot2c_f32_bf16 v253, v229, v137
    v_dot2c_f32_bf16 v252, v230, v145
    v_dot2c_f32_bf16 v254, v232, v133
    v_dot2c_f32_bf16 v255, v233, v141
    v_dot2c_f32_bf16 v254, v234, v149
    s_add_u32 m0, s61, 61440
    s_mov_b32 s56, 99840
    buffer_load_dwordx4 v27, s[20:23], s56 offen lds
    v_perm_b32 v188, v159, v155, s64
    v_perm_b32 v192, v159, v155, s65
    v_perm_b32 v189, v167, v163, s64
    v_perm_b32 v193, v167, v163, s65
    v_perm_b32 v190, v175, v171, s64
    v_perm_b32 v194, v175, v171, s65
    v_mov_b32 v191, v179
    v_lshrrev_b32 v195, 16, v179
    s_nop 0
    v_mfma_f32_16x16x32_bf16 v[212:215], v[188:191], v[80:83], 0
    v_mfma_f32_16x16x32_bf16 v[220:223], v[192:195], v[88:91], 0
    v_mfma_f32_16x16x32_bf16 v[216:219], v[188:191], v[84:87], 0
    v_mfma_f32_16x16x32_bf16 v[224:227], v[192:195], v[92:95], 0
    s_add_u32 m0, s61, 69632
    s_mov_b32 s56, 113152
    buffer_load_dwordx4 v27, s[20:23], s56 offen lds
    v_cvt_pk_bf16_f32 v228, v196, v204
    v_cvt_pk_bf16_f32 v229, v197, v205
    v_cvt_pk_bf16_f32 v230, v198, v206
    v_cvt_pk_bf16_f32 v232, v200, v208
    v_cvt_pk_bf16_f32 v233, v201, v209
    v_cvt_pk_bf16_f32 v234, v202, v210
    v_dot2c_f32_bf16 v252, v228, v130
    v_dot2c_f32_bf16 v253, v229, v138
    v_dot2c_f32_bf16 v252, v230, v146
    v_dot2c_f32_bf16 v254, v232, v134
    v_dot2c_f32_bf16 v255, v233, v142
    v_dot2c_f32_bf16 v254, v234, v150
    s_add_u32 m0, s61, 77824
    s_mov_b32 s56, 126464
    buffer_load_dwordx4 v27, s[20:23], s56 offen lds
    v_cvt_pk_bf16_f32 v228, v212, v220
    v_cvt_pk_bf16_f32 v229, v213, v221
    v_cvt_pk_bf16_f32 v230, v214, v222
    v_cvt_pk_bf16_f32 v232, v216, v224
    v_cvt_pk_bf16_f32 v233, v217, v225
    v_cvt_pk_bf16_f32 v234, v218, v226
    v_dot2c_f32_bf16 v252, v228, v131
    v_dot2c_f32_bf16 v253, v229, v139
    v_dot2c_f32_bf16 v252, v230, v147
    v_dot2c_f32_bf16 v254, v232, v135
    v_dot2c_f32_bf16 v255, v233, v143
    v_dot2c_f32_bf16 v254, v234, v151
    s_waitcnt lgkmcnt(0)
    s_waitcnt vmcnt(4)
    s_barrier
    ds_read_b128 v[152:155], v18 offset:0
    ds_read_b128 v[156:159], v18 offset:2048
    ds_read_b128 v[160:163], v18 offset:16384
    ds_read_b128 v[164:167], v18 offset:18432
    ds_read_b128 v[168:171], v18 offset:32768
    ds_read_b128 v[172:175], v18 offset:34816
    ds_read_b128 v[176:179], v19
    ds_read_b128 v[236:239], v29 offset:0
    ds_read_b128 v[240:243], v29 offset:16
    ds_read_b128 v[244:247], v30 offset:0
    ds_read_b128 v[248:251], v30 offset:16
    v_add_u32 v18, 53248, v18
    v_add_u32 v19, 53248, v19
    s_add_u32 m0, s61, 86016
    s_mov_b32 s56, 139776
    buffer_load_dwordx4 v27, s[20:23], s56 offen lds
    s_waitcnt lgkmcnt(4)
    v_perm_b32 v180, v156, v152, s64
    v_perm_b32 v184, v156, v152, s65
    v_perm_b32 v181, v164, v160, s64
    v_perm_b32 v185, v164, v160, s65
    v_perm_b32 v182, v172, v168, s64
    v_perm_b32 v186, v172, v168, s65
    v_mov_b32 v183, v176
    v_lshrrev_b32 v187, 16, v176
    s_nop 0
    v_mfma_f32_16x16x32_bf16 v[196:199], v[180:183], v[32:35], 0
    v_mfma_f32_16x16x32_bf16 v[204:207], v[184:187], v[40:43], 0
    v_mfma_f32_16x16x32_bf16 v[200:203], v[180:183], v[36:39], 0
    v_mfma_f32_16x16x32_bf16 v[208:211], v[184:187], v[44:47], 0
    s_add_u32 m0, s61, 94208
    s_mov_b32 s56, 153088
    buffer_load_dwordx4 v27, s[20:23], s56 offen lds
    v_perm_b32 v188, v157, v153, s64
    v_perm_b32 v192, v157, v153, s65
    v_perm_b32 v189, v165, v161, s64
    v_perm_b32 v193, v165, v161, s65
    v_perm_b32 v190, v173, v169, s64
    v_perm_b32 v194, v173, v169, s65
    v_mov_b32 v191, v177
    v_lshrrev_b32 v195, 16, v177
    s_nop 0
    v_mfma_f32_16x16x32_bf16 v[212:215], v[188:191], v[48:51], 0
    v_mfma_f32_16x16x32_bf16 v[220:223], v[192:195], v[56:59], 0
    v_mfma_f32_16x16x32_bf16 v[216:219], v[188:191], v[52:55], 0
    v_mfma_f32_16x16x32_bf16 v[224:227], v[192:195], v[60:63], 0
    s_add_u32 m0, s63, 53248
    s_add_u32 s56, s62, 86528
    buffer_load_dwordx4 v27, s[20:23], s56 offen lds
    v_cvt_pk_bf16_f32 v228, v196, v204
    v_cvt_pk_bf16_f32 v229, v197, v205
    v_cvt_pk_bf16_f32 v230, v198, v206
    v_cvt_pk_bf16_f32 v231, v199, v207
    v_cvt_pk_bf16_f32 v232, v200, v208
    v_cvt_pk_bf16_f32 v233, v201, v209
    v_cvt_pk_bf16_f32 v234, v202, v210
    v_cvt_pk_bf16_f32 v235, v203, v211
    v_dot2c_f32_bf16 v252, v228, v96
    v_dot2c_f32_bf16 v253, v229, v104
    v_dot2c_f32_bf16 v252, v230, v112
    v_dot2c_f32_bf16 v253, v231, v120
    v_dot2c_f32_bf16 v254, v232, v100
    v_dot2c_f32_bf16 v255, v233, v108
    v_dot2c_f32_bf16 v254, v234, v116
    v_dot2c_f32_bf16 v255, v235, v124
    s_add_u32 m0, s61, 106496
    s_mov_b32 s56, 86528
    buffer_load_dwordx4 v22, s[20:23], s56 offen lds
    v_perm_b32 v180, v158, v154, s64
    v_perm_b32 v184, v158, v154, s65
    v_perm_b32 v181, v166, v162, s64
    v_perm_b32 v185, v166, v162, s65
    v_perm_b32 v182, v174, v170, s64
    v_perm_b32 v186, v174, v170, s65
    v_mov_b32 v183, v178
    v_lshrrev_b32 v187, 16, v178
    s_nop 0
    v_mfma_f32_16x16x32_bf16 v[196:199], v[180:183], v[64:67], 0
    v_mfma_f32_16x16x32_bf16 v[204:207], v[184:187], v[72:75], 0
    v_mfma_f32_16x16x32_bf16 v[200:203], v[180:183], v[68:71], 0
    v_mfma_f32_16x16x32_bf16 v[208:211], v[184:187], v[76:79], 0
    s_add_u32 m0, s61, 114688
    s_mov_b32 s56, 86528
    buffer_load_dwordx4 v23, s[20:23], s56 offen lds
    v_cvt_pk_bf16_f32 v228, v212, v220
    v_cvt_pk_bf16_f32 v229, v213, v221
    v_cvt_pk_bf16_f32 v230, v214, v222
    v_cvt_pk_bf16_f32 v231, v215, v223
    v_cvt_pk_bf16_f32 v232, v216, v224
    v_cvt_pk_bf16_f32 v233, v217, v225
    v_cvt_pk_bf16_f32 v234, v218, v226
    v_cvt_pk_bf16_f32 v235, v219, v227
    v_dot2c_f32_bf16 v252, v228, v97
    v_dot2c_f32_bf16 v253, v229, v105
    v_dot2c_f32_bf16 v252, v230, v113
    v_dot2c_f32_bf16 v253, v231, v121
    v_dot2c_f32_bf16 v254, v232, v101
    v_dot2c_f32_bf16 v255, v233, v109
    v_dot2c_f32_bf16 v254, v234, v117
    v_dot2c_f32_bf16 v255, v235, v125
    s_add_u32 m0, s61, 122880
    s_mov_b32 s56, 86528
    buffer_load_dwordx4 v24, s[20:23], s56 offen lds
    v_perm_b32 v188, v159, v155, s64
    v_perm_b32 v192, v159, v155, s65
    v_perm_b32 v189, v167, v163, s64
    v_perm_b32 v193, v167, v163, s65
    v_perm_b32 v190, v175, v171, s64
    v_perm_b32 v194, v175, v171, s65
    v_mov_b32 v191, v179
    v_lshrrev_b32 v195, 16, v179
    s_nop 0
    v_mfma_f32_16x16x32_bf16 v[212:215], v[188:191], v[80:83], 0
    v_mfma_f32_16x16x32_bf16 v[220:223], v[192:195], v[88:91], 0
    v_mfma_f32_16x16x32_bf16 v[216:219], v[188:191], v[84:87], 0
    v_mfma_f32_16x16x32_bf16 v[224:227], v[192:195], v[92:95], 0
    s_add_u32 m0, s61, 131072
    s_mov_b32 s56, 86528
    buffer_load_dwordx4 v25, s[20:23], s56 offen lds
    v_cvt_pk_bf16_f32 v228, v196, v204
    v_cvt_pk_bf16_f32 v229, v197, v205
    v_cvt_pk_bf16_f32 v230, v198, v206
    v_cvt_pk_bf16_f32 v231, v199, v207
    v_cvt_pk_bf16_f32 v232, v200, v208
    v_cvt_pk_bf16_f32 v233, v201, v209
    v_cvt_pk_bf16_f32 v234, v202, v210
    v_cvt_pk_bf16_f32 v235, v203, v211
    v_dot2c_f32_bf16 v252, v228, v98
    v_dot2c_f32_bf16 v253, v229, v106
    v_dot2c_f32_bf16 v252, v230, v114
    v_dot2c_f32_bf16 v253, v231, v122
    v_dot2c_f32_bf16 v254, v232, v102
    v_dot2c_f32_bf16 v255, v233, v110
    v_dot2c_f32_bf16 v254, v234, v118
    v_dot2c_f32_bf16 v255, v235, v126
    s_add_u32 m0, s61, 139264
    s_mov_b32 s56, 86528
    buffer_load_dwordx4 v26, s[20:23], s56 offen lds
    v_cvt_pk_bf16_f32 v228, v212, v220
    v_cvt_pk_bf16_f32 v229, v213, v221
    v_cvt_pk_bf16_f32 v230, v214, v222
    v_cvt_pk_bf16_f32 v231, v215, v223
    v_cvt_pk_bf16_f32 v232, v216, v224
    v_cvt_pk_bf16_f32 v233, v217, v225
    v_cvt_pk_bf16_f32 v234, v218, v226
    v_cvt_pk_bf16_f32 v235, v219, v227
    v_dot2c_f32_bf16 v252, v228, v99
    v_dot2c_f32_bf16 v253, v229, v107
    v_dot2c_f32_bf16 v252, v230, v115
    v_dot2c_f32_bf16 v253, v231, v123
    v_dot2c_f32_bf16 v254, v232, v103
    v_dot2c_f32_bf16 v255, v233, v111
    v_dot2c_f32_bf16 v254, v234, v119
    v_dot2c_f32_bf16 v255, v235, v127
    s_waitcnt lgkmcnt(0)
    s_waitcnt vmcnt(5)
    s_barrier
    ds_read_b128 v[152:155], v18 offset:0
    ds_read_b128 v[156:159], v18 offset:2048
    ds_read_b128 v[160:163], v18 offset:16384
    ds_read_b128 v[164:167], v18 offset:18432
    ds_read_b128 v[168:171], v18 offset:32768
    ds_read_b128 v[172:175], v18 offset:34816
    ds_read_b128 v[176:179], v19
    v_dot2_f32_bf16 v228, v32, v236, 0
    v_dot2_f32_bf16 v229, v32, v237, 0
    v_dot2_f32_bf16 v230, v33, v238, 0
    v_dot2_f32_bf16 v231, v33, v239, 0
    v_dot2_f32_bf16 v232, v34, v240, 0
    v_dot2_f32_bf16 v233, v34, v241, 0
    v_dot2_f32_bf16 v234, v35, v242, 0
    v_cvt_pk_bf16_f32 v32, v228, v229
    v_cvt_pk_bf16_f32 v33, v230, v231
    v_cvt_pk_bf16_f32 v34, v232, v233
    v_cvt_pk_bf16_f32 v35, v234, 0
    v_dot2_f32_bf16 v228, v36, v244, 0
    v_dot2_f32_bf16 v229, v36, v245, 0
    v_dot2_f32_bf16 v230, v37, v246, 0
    v_dot2_f32_bf16 v231, v37, v247, 0
    v_dot2_f32_bf16 v232, v38, v248, 0
    v_dot2_f32_bf16 v233, v38, v249, 0
    v_dot2_f32_bf16 v234, v39, v250, 0
    v_cvt_pk_bf16_f32 v36, v228, v229
    v_cvt_pk_bf16_f32 v37, v230, v231
    v_cvt_pk_bf16_f32 v38, v232, v233
    v_cvt_pk_bf16_f32 v39, v234, 0
    v_dot2_f32_bf16 v228, v40, v236, 0
    v_dot2_f32_bf16 v229, v40, v237, 0
    v_dot2_f32_bf16 v230, v41, v238, 0
    v_dot2_f32_bf16 v231, v41, v239, 0
    v_dot2_f32_bf16 v232, v42, v240, 0
    v_dot2_f32_bf16 v233, v42, v241, 0
    v_dot2_f32_bf16 v234, v43, v242, 0
    v_cvt_pk_bf16_f32 v40, v228, v229
    v_cvt_pk_bf16_f32 v41, v230, v231
    v_cvt_pk_bf16_f32 v42, v232, v233
    v_cvt_pk_bf16_f32 v43, v234, 0
    v_dot2_f32_bf16 v228, v44, v244, 0
    v_dot2_f32_bf16 v229, v44, v245, 0
    v_dot2_f32_bf16 v230, v45, v246, 0
    v_dot2_f32_bf16 v231, v45, v247, 0
    v_dot2_f32_bf16 v232, v46, v248, 0
    v_dot2_f32_bf16 v233, v46, v249, 0
    v_dot2_f32_bf16 v234, v47, v250, 0
    v_cvt_pk_bf16_f32 v44, v228, v229
    v_cvt_pk_bf16_f32 v45, v230, v231
    v_cvt_pk_bf16_f32 v46, v232, v233
    v_cvt_pk_bf16_f32 v47, v234, 0
    s_waitcnt lgkmcnt(0)
    v_perm_b32 v180, v156, v152, s64
    v_perm_b32 v184, v156, v152, s65
    v_perm_b32 v181, v164, v160, s64
    v_perm_b32 v185, v164, v160, s65
    v_perm_b32 v182, v172, v168, s64
    v_perm_b32 v186, v172, v168, s65
    v_mov_b32 v183, v176
    v_lshrrev_b32 v187, 16, v176
    s_nop 0
    v_mfma_f32_16x16x32_bf16 v[196:199], v[180:183], v[32:35], 0
    v_mfma_f32_16x16x32_bf16 v[204:207], v[184:187], v[40:43], 0
    v_mfma_f32_16x16x32_bf16 v[200:203], v[180:183], v[36:39], 0
    v_mfma_f32_16x16x32_bf16 v[208:211], v[184:187], v[44:47], 0
    v_dot2_f32_bf16 v228, v48, v236, 0
    v_dot2_f32_bf16 v229, v48, v237, 0
    v_dot2_f32_bf16 v230, v49, v238, 0
    v_dot2_f32_bf16 v231, v49, v239, 0
    v_dot2_f32_bf16 v232, v50, v240, 0
    v_dot2_f32_bf16 v233, v50, v241, 0
    v_dot2_f32_bf16 v234, v51, v242, 0
    v_cvt_pk_bf16_f32 v48, v228, v229
    v_cvt_pk_bf16_f32 v49, v230, v231
    v_cvt_pk_bf16_f32 v50, v232, v233
    v_cvt_pk_bf16_f32 v51, v234, 0
    v_dot2_f32_bf16 v228, v52, v244, 0
    v_dot2_f32_bf16 v229, v52, v245, 0
    v_dot2_f32_bf16 v230, v53, v246, 0
    v_dot2_f32_bf16 v231, v53, v247, 0
    v_dot2_f32_bf16 v232, v54, v248, 0
    v_dot2_f32_bf16 v233, v54, v249, 0
    v_dot2_f32_bf16 v234, v55, v250, 0
    v_cvt_pk_bf16_f32 v52, v228, v229
    v_cvt_pk_bf16_f32 v53, v230, v231
    v_cvt_pk_bf16_f32 v54, v232, v233
    v_cvt_pk_bf16_f32 v55, v234, 0
    v_dot2_f32_bf16 v228, v56, v236, 0
    v_dot2_f32_bf16 v229, v56, v237, 0
    v_dot2_f32_bf16 v230, v57, v238, 0
    v_dot2_f32_bf16 v231, v57, v239, 0
    v_dot2_f32_bf16 v232, v58, v240, 0
    v_dot2_f32_bf16 v233, v58, v241, 0
    v_dot2_f32_bf16 v234, v59, v242, 0
    v_cvt_pk_bf16_f32 v56, v228, v229
    v_cvt_pk_bf16_f32 v57, v230, v231
    v_cvt_pk_bf16_f32 v58, v232, v233
    v_cvt_pk_bf16_f32 v59, v234, 0
    v_dot2_f32_bf16 v228, v60, v244, 0
    v_dot2_f32_bf16 v229, v60, v245, 0
    v_dot2_f32_bf16 v230, v61, v246, 0
    v_dot2_f32_bf16 v231, v61, v247, 0
    v_dot2_f32_bf16 v232, v62, v248, 0
    v_dot2_f32_bf16 v233, v62, v249, 0
    v_dot2_f32_bf16 v234, v63, v250, 0
    v_cvt_pk_bf16_f32 v60, v228, v229
    v_cvt_pk_bf16_f32 v61, v230, v231
    v_cvt_pk_bf16_f32 v62, v232, v233
    v_cvt_pk_bf16_f32 v63, v234, 0
    v_perm_b32 v188, v157, v153, s64
    v_perm_b32 v192, v157, v153, s65
    v_perm_b32 v189, v165, v161, s64
    v_perm_b32 v193, v165, v161, s65
    v_perm_b32 v190, v173, v169, s64
    v_perm_b32 v194, v173, v169, s65
    v_mov_b32 v191, v177
    v_lshrrev_b32 v195, 16, v177
    s_nop 0
    v_mfma_f32_16x16x32_bf16 v[212:215], v[188:191], v[48:51], 0
    v_mfma_f32_16x16x32_bf16 v[220:223], v[192:195], v[56:59], 0
    v_mfma_f32_16x16x32_bf16 v[216:219], v[188:191], v[52:55], 0
    v_mfma_f32_16x16x32_bf16 v[224:227], v[192:195], v[60:63], 0
    v_cvt_pk_bf16_f32 v228, v196, v204
    v_cvt_pk_bf16_f32 v229, v197, v205
    v_cvt_pk_bf16_f32 v230, v198, v206
    v_cvt_pk_bf16_f32 v231, v199, v207
    v_cvt_pk_bf16_f32 v232, v200, v208
    v_cvt_pk_bf16_f32 v233, v201, v209
    v_cvt_pk_bf16_f32 v234, v202, v210
    v_cvt_pk_bf16_f32 v235, v203, v211
    v_dot2c_f32_bf16 v1, v228, v96
    v_dot2c_f32_bf16 v3, v229, v104
    v_dot2c_f32_bf16 v5, v230, v112
    v_dot2c_f32_bf16 v7, v231, v120
    v_dot2c_f32_bf16 v2, v232, v100
    v_dot2c_f32_bf16 v4, v233, v108
    v_dot2c_f32_bf16 v6, v234, v116
    v_dot2c_f32_bf16 v8, v235, v124
    v_dot2_f32_bf16 v228, v64, v236, 0
    v_dot2_f32_bf16 v229, v64, v237, 0
    v_dot2_f32_bf16 v230, v65, v238, 0
    v_dot2_f32_bf16 v231, v65, v239, 0
    v_dot2_f32_bf16 v232, v66, v240, 0
    v_dot2_f32_bf16 v233, v66, v241, 0
    v_dot2_f32_bf16 v234, v67, v242, 0
    v_cvt_pk_bf16_f32 v64, v228, v229
    v_cvt_pk_bf16_f32 v65, v230, v231
    v_cvt_pk_bf16_f32 v66, v232, v233
    v_cvt_pk_bf16_f32 v67, v234, 0
    v_dot2_f32_bf16 v228, v68, v244, 0
    v_dot2_f32_bf16 v229, v68, v245, 0
    v_dot2_f32_bf16 v230, v69, v246, 0
    v_dot2_f32_bf16 v231, v69, v247, 0
    v_dot2_f32_bf16 v232, v70, v248, 0
    v_dot2_f32_bf16 v233, v70, v249, 0
    v_dot2_f32_bf16 v234, v71, v250, 0
    v_cvt_pk_bf16_f32 v68, v228, v229
    v_cvt_pk_bf16_f32 v69, v230, v231
    v_cvt_pk_bf16_f32 v70, v232, v233
    v_cvt_pk_bf16_f32 v71, v234, 0
    v_dot2_f32_bf16 v228, v72, v236, 0
    v_dot2_f32_bf16 v229, v72, v237, 0
    v_dot2_f32_bf16 v230, v73, v238, 0
    v_dot2_f32_bf16 v231, v73, v239, 0
    v_dot2_f32_bf16 v232, v74, v240, 0
    v_dot2_f32_bf16 v233, v74, v241, 0
    v_dot2_f32_bf16 v234, v75, v242, 0
    v_cvt_pk_bf16_f32 v72, v228, v229
    v_cvt_pk_bf16_f32 v73, v230, v231
    v_cvt_pk_bf16_f32 v74, v232, v233
    v_cvt_pk_bf16_f32 v75, v234, 0
    v_dot2_f32_bf16 v228, v76, v244, 0
    v_dot2_f32_bf16 v229, v76, v245, 0
    v_dot2_f32_bf16 v230, v77, v246, 0
    v_dot2_f32_bf16 v231, v77, v247, 0
    v_dot2_f32_bf16 v232, v78, v248, 0
    v_dot2_f32_bf16 v233, v78, v249, 0
    v_dot2_f32_bf16 v234, v79, v250, 0
    v_cvt_pk_bf16_f32 v76, v228, v229
    v_cvt_pk_bf16_f32 v77, v230, v231
    v_cvt_pk_bf16_f32 v78, v232, v233
    v_cvt_pk_bf16_f32 v79, v234, 0
    v_perm_b32 v180, v158, v154, s64
    v_perm_b32 v184, v158, v154, s65
    v_perm_b32 v181, v166, v162, s64
    v_perm_b32 v185, v166, v162, s65
    v_perm_b32 v182, v174, v170, s64
    v_perm_b32 v186, v174, v170, s65
    v_mov_b32 v183, v178
    v_lshrrev_b32 v187, 16, v178
    s_nop 0
    v_mfma_f32_16x16x32_bf16 v[196:199], v[180:183], v[64:67], 0
    v_mfma_f32_16x16x32_bf16 v[204:207], v[184:187], v[72:75], 0
    v_mfma_f32_16x16x32_bf16 v[200:203], v[180:183], v[68:71], 0
    v_mfma_f32_16x16x32_bf16 v[208:211], v[184:187], v[76:79], 0
    v_cvt_pk_bf16_f32 v228, v212, v220
    v_cvt_pk_bf16_f32 v229, v213, v221
    v_cvt_pk_bf16_f32 v230, v214, v222
    v_cvt_pk_bf16_f32 v231, v215, v223
    v_cvt_pk_bf16_f32 v232, v216, v224
    v_cvt_pk_bf16_f32 v233, v217, v225
    v_cvt_pk_bf16_f32 v234, v218, v226
    v_cvt_pk_bf16_f32 v235, v219, v227
    v_dot2c_f32_bf16 v1, v228, v97
    v_dot2c_f32_bf16 v3, v229, v105
    v_dot2c_f32_bf16 v5, v230, v113
    v_dot2c_f32_bf16 v7, v231, v121
    v_dot2c_f32_bf16 v2, v232, v101
    v_dot2c_f32_bf16 v4, v233, v109
    v_dot2c_f32_bf16 v6, v234, v117
    v_dot2c_f32_bf16 v8, v235, v125
    v_dot2_f32_bf16 v228, v80, v236, 0
    v_dot2_f32_bf16 v229, v80, v237, 0
    v_dot2_f32_bf16 v230, v81, v238, 0
    v_dot2_f32_bf16 v231, v81, v239, 0
    v_dot2_f32_bf16 v232, v82, v240, 0
    v_dot2_f32_bf16 v233, v82, v241, 0
    v_dot2_f32_bf16 v234, v83, v242, 0
    v_cvt_pk_bf16_f32 v80, v228, v229
    v_cvt_pk_bf16_f32 v81, v230, v231
    v_cvt_pk_bf16_f32 v82, v232, v233
    v_cvt_pk_bf16_f32 v83, v234, 0
    v_dot2_f32_bf16 v228, v84, v244, 0
    v_dot2_f32_bf16 v229, v84, v245, 0
    v_dot2_f32_bf16 v230, v85, v246, 0
    v_dot2_f32_bf16 v231, v85, v247, 0
    v_dot2_f32_bf16 v232, v86, v248, 0
    v_dot2_f32_bf16 v233, v86, v249, 0
    v_dot2_f32_bf16 v234, v87, v250, 0
    v_cvt_pk_bf16_f32 v84, v228, v229
    v_cvt_pk_bf16_f32 v85, v230, v231
    v_cvt_pk_bf16_f32 v86, v232, v233
    v_cvt_pk_bf16_f32 v87, v234, 0
    v_dot2_f32_bf16 v228, v88, v236, 0
    v_dot2_f32_bf16 v229, v88, v237, 0
    v_dot2_f32_bf16 v230, v89, v238, 0
    v_dot2_f32_bf16 v231, v89, v239, 0
    v_dot2_f32_bf16 v232, v90, v240, 0
    v_dot2_f32_bf16 v233, v90, v241, 0
    v_dot2_f32_bf16 v234, v91, v242, 0
    v_cvt_pk_bf16_f32 v88, v228, v229
    v_cvt_pk_bf16_f32 v89, v230, v231
    v_cvt_pk_bf16_f32 v90, v232, v233
    v_cvt_pk_bf16_f32 v91, v234, 0
    v_dot2_f32_bf16 v228, v92, v244, 0
    v_dot2_f32_bf16 v229, v92, v245, 0
    v_dot2_f32_bf16 v230, v93, v246, 0
    v_dot2_f32_bf16 v231, v93, v247, 0
    v_dot2_f32_bf16 v232, v94, v248, 0
    v_dot2_f32_bf16 v233, v94, v249, 0
    v_dot2_f32_bf16 v234, v95, v250, 0
    v_cvt_pk_bf16_f32 v92, v228, v229
    v_cvt_pk_bf16_f32 v93, v230, v231
    v_cvt_pk_bf16_f32 v94, v232, v233
    v_cvt_pk_bf16_f32 v95, v234, 0
    v_perm_b32 v188, v159, v155, s64
    v_perm_b32 v192, v159, v155, s65
    v_perm_b32 v189, v167, v163, s64
    v_perm_b32 v193, v167, v163, s65
    v_perm_b32 v190, v175, v171, s64
    v_perm_b32 v194, v175, v171, s65
    v_mov_b32 v191, v179
    v_lshrrev_b32 v195, 16, v179
    s_nop 0
    v_mfma_f32_16x16x32_bf16 v[212:215], v[188:191], v[80:83], 0
    v_mfma_f32_16x16x32_bf16 v[220:223], v[192:195], v[88:91], 0
    v_mfma_f32_16x16x32_bf16 v[216:219], v[188:191], v[84:87], 0
    v_mfma_f32_16x16x32_bf16 v[224:227], v[192:195], v[92:95], 0
    v_cvt_pk_bf16_f32 v228, v196, v204
    v_cvt_pk_bf16_f32 v229, v197, v205
    v_cvt_pk_bf16_f32 v230, v198, v206
    v_cvt_pk_bf16_f32 v231, v199, v207
    v_cvt_pk_bf16_f32 v232, v200, v208
    v_cvt_pk_bf16_f32 v233, v201, v209
    v_cvt_pk_bf16_f32 v234, v202, v210
    v_cvt_pk_bf16_f32 v235, v203, v211
    v_dot2c_f32_bf16 v1, v228, v98
    v_dot2c_f32_bf16 v3, v229, v106
    v_dot2c_f32_bf16 v5, v230, v114
    v_dot2c_f32_bf16 v7, v231, v122
    v_dot2c_f32_bf16 v2, v232, v102
    v_dot2c_f32_bf16 v4, v233, v110
    v_dot2c_f32_bf16 v6, v234, v118
    v_dot2c_f32_bf16 v8, v235, v126
    v_cvt_pk_bf16_f32 v228, v212, v220
    v_cvt_pk_bf16_f32 v229, v213, v221
    v_cvt_pk_bf16_f32 v230, v214, v222
    v_cvt_pk_bf16_f32 v231, v215, v223
    v_cvt_pk_bf16_f32 v232, v216, v224
    v_cvt_pk_bf16_f32 v233, v217, v225
    v_cvt_pk_bf16_f32 v234, v218, v226
    v_cvt_pk_bf16_f32 v235, v219, v227
    v_dot2c_f32_bf16 v1, v228, v99
    v_dot2c_f32_bf16 v3, v229, v107
    v_dot2c_f32_bf16 v5, v230, v115
    v_dot2c_f32_bf16 v7, v231, v123
    v_dot2c_f32_bf16 v2, v232, v103
    v_dot2c_f32_bf16 v4, v233, v111
    v_dot2c_f32_bf16 v6, v234, v119
    v_dot2c_f32_bf16 v8, v235, v127
    s_waitcnt lgkmcnt(0)
    s_waitcnt vmcnt(0)
    s_barrier
    ds_read_b128 v[152:155], v20 offset:0
    ds_read_b128 v[156:159], v20 offset:1280
    ds_read_b128 v[160:163], v20 offset:10240
    ds_read_b128 v[164:167], v20 offset:11520
    ds_read_b128 v[168:171], v20 offset:20480
    ds_read_b128 v[172:175], v20 offset:21760
    ds_read_b128 v[176:179], v21
    s_waitcnt lgkmcnt(0)
    v_perm_b32 v180, v156, v152, s64
    v_perm_b32 v184, v156, v152, s65
    v_perm_b32 v181, v164, v160, s64
    v_perm_b32 v185, v164, v160, s65
    v_perm_b32 v182, v172, v168, s64
    v_perm_b32 v186, v172, v168, s65
    v_mov_b32 v183, v176
    v_lshrrev_b32 v187, 16, v176
    s_nop 0
    v_mfma_f32_16x16x32_bf16 v[196:199], v[180:183], v[32:35], 0
    v_mfma_f32_16x16x32_bf16 v[204:207], v[184:187], v[40:43], 0
    v_mfma_f32_16x16x32_bf16 v[200:203], v[180:183], v[36:39], 0
    v_mfma_f32_16x16x32_bf16 v[208:211], v[184:187], v[44:47], 0
    v_perm_b32 v188, v157, v153, s64
    v_perm_b32 v192, v157, v153, s65
    v_perm_b32 v189, v165, v161, s64
    v_perm_b32 v193, v165, v161, s65
    v_perm_b32 v190, v173, v169, s64
    v_perm_b32 v194, v173, v169, s65
    v_mov_b32 v191, v177
    v_lshrrev_b32 v195, 16, v177
    s_nop 0
    v_mfma_f32_16x16x32_bf16 v[212:215], v[188:191], v[48:51], 0
    v_mfma_f32_16x16x32_bf16 v[220:223], v[192:195], v[56:59], 0
    v_mfma_f32_16x16x32_bf16 v[216:219], v[188:191], v[52:55], 0
    v_mfma_f32_16x16x32_bf16 v[224:227], v[192:195], v[60:63], 0
    v_cvt_pk_bf16_f32 v228, v196, v204
    v_cvt_pk_bf16_f32 v229, v197, v205
    v_cvt_pk_bf16_f32 v230, v198, v206
    v_cvt_pk_bf16_f32 v232, v200, v208
    v_cvt_pk_bf16_f32 v233, v201, v209
    v_cvt_pk_bf16_f32 v234, v202, v210
    v_dot2c_f32_bf16 v10, v228, v128
    v_dot2c_f32_bf16 v12, v229, v136
    v_dot2c_f32_bf16 v14, v230, v144
    v_dot2c_f32_bf16 v11, v232, v132
    v_dot2c_f32_bf16 v13, v233, v140
    v_dot2c_f32_bf16 v15, v234, v148
    v_perm_b32 v180, v158, v154, s64
    v_perm_b32 v184, v158, v154, s65
    v_perm_b32 v181, v166, v162, s64
    v_perm_b32 v185, v166, v162, s65
    v_perm_b32 v182, v174, v170, s64
    v_perm_b32 v186, v174, v170, s65
    v_mov_b32 v183, v178
    v_lshrrev_b32 v187, 16, v178
    s_nop 0
    v_mfma_f32_16x16x32_bf16 v[196:199], v[180:183], v[64:67], 0
    v_mfma_f32_16x16x32_bf16 v[204:207], v[184:187], v[72:75], 0
    v_mfma_f32_16x16x32_bf16 v[200:203], v[180:183], v[68:71], 0
    v_mfma_f32_16x16x32_bf16 v[208:211], v[184:187], v[76:79], 0
    v_cvt_pk_bf16_f32 v228, v212, v220
    v_cvt_pk_bf16_f32 v229, v213, v221
    v_cvt_pk_bf16_f32 v230, v214, v222
    v_cvt_pk_bf16_f32 v232, v216, v224
    v_cvt_pk_bf16_f32 v233, v217, v225
    v_cvt_pk_bf16_f32 v234, v218, v226
    v_dot2c_f32_bf16 v10, v228, v129
    v_dot2c_f32_bf16 v12, v229, v137
    v_dot2c_f32_bf16 v14, v230, v145
    v_dot2c_f32_bf16 v11, v232, v133
    v_dot2c_f32_bf16 v13, v233, v141
    v_dot2c_f32_bf16 v15, v234, v149
    v_perm_b32 v188, v159, v155, s64
    v_perm_b32 v192, v159, v155, s65
    v_perm_b32 v189, v167, v163, s64
    v_perm_b32 v193, v167, v163, s65
    v_perm_b32 v190, v175, v171, s64
    v_perm_b32 v194, v175, v171, s65
    v_mov_b32 v191, v179
    v_lshrrev_b32 v195, 16, v179
    s_nop 0
    v_mfma_f32_16x16x32_bf16 v[212:215], v[188:191], v[80:83], 0
    v_mfma_f32_16x16x32_bf16 v[220:223], v[192:195], v[88:91], 0
    v_mfma_f32_16x16x32_bf16 v[216:219], v[188:191], v[84:87], 0
    v_mfma_f32_16x16x32_bf16 v[224:227], v[192:195], v[92:95], 0
    v_cvt_pk_bf16_f32 v228, v196, v204
    v_cvt_pk_bf16_f32 v229, v197, v205
    v_cvt_pk_bf16_f32 v230, v198, v206
    v_cvt_pk_bf16_f32 v232, v200, v208
    v_cvt_pk_bf16_f32 v233, v201, v209
    v_cvt_pk_bf16_f32 v234, v202, v210
    v_dot2c_f32_bf16 v10, v228, v130
    v_dot2c_f32_bf16 v12, v229, v138
    v_dot2c_f32_bf16 v14, v230, v146
    v_dot2c_f32_bf16 v11, v232, v134
    v_dot2c_f32_bf16 v13, v233, v142
    v_dot2c_f32_bf16 v15, v234, v150
    v_cvt_pk_bf16_f32 v228, v212, v220
    v_cvt_pk_bf16_f32 v229, v213, v221
    v_cvt_pk_bf16_f32 v230, v214, v222
    v_cvt_pk_bf16_f32 v232, v216, v224
    v_cvt_pk_bf16_f32 v233, v217, v225
    v_cvt_pk_bf16_f32 v234, v218, v226
    v_dot2c_f32_bf16 v10, v228, v131
    v_dot2c_f32_bf16 v12, v229, v139
    v_dot2c_f32_bf16 v14, v230, v147
    v_dot2c_f32_bf16 v11, v232, v135
    v_dot2c_f32_bf16 v13, v233, v143
    v_dot2c_f32_bf16 v15, v234, v151
    s_waitcnt lgkmcnt(0)
    v_lshlrev_b32 v236, 16, v236
    v_lshlrev_b32 v238, 16, v238
    v_lshlrev_b32 v240, 16, v240
    v_lshlrev_b32 v242, 16, v242
    v_lshlrev_b32 v244, 16, v244
    v_lshlrev_b32 v246, 16, v246
    v_lshlrev_b32 v248, 16, v248
    v_lshlrev_b32 v250, 16, v250
    v_fmac_f32 v252, v236, v1
    v_fmac_f32 v253, v237, v3
    v_fmac_f32 v252, v238, v5
    v_fmac_f32 v253, v239, v7
    v_fmac_f32 v252, v240, v10
    v_fmac_f32 v253, v241, v12
    v_fmac_f32 v252, v242, v14
    v_fmac_f32 v254, v244, v2
    v_fmac_f32 v255, v245, v4
    v_fmac_f32 v254, v246, v6
    v_fmac_f32 v255, v247, v8
    v_fmac_f32 v254, v248, v11
    v_fmac_f32 v255, v249, v13
    v_fmac_f32 v254, v250, v15
    v_add_f32 v252, v252, v253
    ds_write_b32 v31, v252
    v_add_f32 v254, v254, v255
    ds_write_b32 v9, v254
    s_waitcnt lgkmcnt(0)
    s_barrier
    s_cmp_lg_u32 s52, 0
    s_cbranch_scc1 L_end
    v_and_b32 v1, 31, v0
    v_mul_u32_u24 v2, 144, v1
    v_lshrrev_b32 v3, 5, v0
    v_lshl_add_u32 v2, v3, 6, v2
    v_add_u32 v2, 147456, v2
    ds_read_b128 v[16:19], v2 offset:0
    ds_read_b128 v[20:23], v2 offset:16
    ds_read_b128 v[24:27], v2 offset:32
    ds_read_b128 v[28:31], v2 offset:48
    s_lshl_b32 s56, s54, 7
    s_add_u32 s56, s56, 512
    v_lshl_add_u32 v5, v1, 2, s56
    s_waitcnt lgkmcnt(0)
    v_add_f32 v16, v16, v24
    v_add_f32 v17, v17, v25
    v_add_f32 v18, v18, v26
    v_add_f32 v19, v19, v27
    v_add_f32 v20, v20, v28
    v_add_f32 v21, v21, v29
    v_add_f32 v22, v22, v30
    v_add_f32 v23, v23, v31
    v_add_f32 v16, v16, v20
    v_add_f32 v17, v17, v21
    v_add_f32 v18, v18, v22
    v_add_f32 v19, v19, v23
    v_add_f32 v16, v16, v18
    v_add_f32 v17, v17, v19
    v_add_f32 v16, v16, v17
    v_mov_b32 v17, v16
    s_nop 1
    v_permlane32_swap_b32 v16, v17
    v_add_f32 v4, v16, v17
    s_branch L_fin
L_B:
    s_cmp_lt_u32 s52, 4
    s_cbranch_scc1 L_Bc
    v_bfe_u32 v14, v0, 4, 4
    v_lshlrev_b32 v14, 9, v14
    v_bfe_u32 v15, v0, 4, 2
    v_lshlrev_b32 v15, 2, v15
    v_xor_b32 v15, v15, v0
    v_and_b32 v15, 15, v15
    v_lshl_add_u32 v14, v15, 4, v14
    s_lshl_b32 s56, s54, 8
    v_add_u32 v1, s56, v14
    s_and_b32 s60, s52, 3
    s_lshl_b32 s60, s60, 10
    v_bfe_u32 v14, v0, 3, 5
    v_mul_u32_u24 v14, 104, v14
    v_and_b32 v15, 7, v0
    v_lshl_add_u32 v14, v15, 4, v14
    s_mul_i32 s57, s53, 6656
    v_lshrrev_b32 v15, 4, v0
    v_xor_b32 v15, v15, v0
    v_and_b32 v15, 7, v15
    v_lshlrev_b32 v2, 4, v15
    s_waitcnt lgkmcnt(0)
    s_add_u32 m0, s60, 0
    s_mov_b32 s56, 0
    buffer_load_dwordx4 v1, s[16:19], s56 offen lds
    s_add_u32 m0, s60, 4096
    s_mov_b32 s56, 8192
    buffer_load_dwordx4 v1, s[16:19], s56 offen lds
    s_add_u32 m0, s60, 8192
    s_mov_b32 s56, 16384
    buffer_load_dwordx4 v1, s[16:19], s56 offen lds
    s_add_u32 m0, s60, 12288
    s_mov_b32 s56, 24576
    buffer_load_dwordx4 v1, s[16:19], s56 offen lds
    buffer_load_dwordx4 v[4:7], v14, s[8:11], s57 offen
    buffer_load_dwordx4 v[8:11], v14, s[8:11], s57 offen offset:3328
    s_add_u32 m0, s60, 16384
    s_mov_b32 s56, 32768
    buffer_load_dwordx4 v1, s[16:19], s56 offen lds
    s_add_u32 m0, s60, 20480
    s_mov_b32 s56, 40960
    buffer_load_dwordx4 v1, s[16:19], s56 offen lds
    s_add_u32 m0, s60, 24576
    s_mov_b32 s56, 49152
    buffer_load_dwordx4 v1, s[16:19], s56 offen lds
    s_add_u32 m0, s60, 28672
    s_mov_b32 s56, 57344
    buffer_load_dwordx4 v1, s[16:19], s56 offen lds
    s_add_u32 m0, s60, 32768
    s_mov_b32 s56, 65536
    buffer_load_dwordx4 v1, s[16:19], s56 offen lds
    s_add_u32 m0, s60, 36864
    s_mov_b32 s56, 73728
    buffer_load_dwordx4 v1, s[16:19], s56 offen lds
    s_add_u32 m0, s60, 40960
    s_mov_b32 s56, 81920
    buffer_load_dwordx4 v1, s[16:19], s56 offen lds
    s_add_u32 m0, s60, 45056
    s_mov_b32 s56, 90112
    buffer_load_dwordx4 v1, s[16:19], s56 offen lds
    s_add_u32 m0, s60, 49152
    s_mov_b32 s56, 98304
    buffer_load_dwordx4 v1, s[16:19], s56 offen lds
    s_add_u32 m0, s60, 53248
    s_mov_b32 s56, 106496
    buffer_load_dwordx4 v1, s[16:19], s56 offen lds
    s_add_u32 m0, s60, 57344
    s_mov_b32 s56, 114688
    buffer_load_dwordx4 v1, s[16:19], s56 offen lds
    s_add_u32 m0, s60, 61440
    s_mov_b32 s56, 122880
    buffer_load_dwordx4 v1, s[16:19], s56 offen lds
    s_add_u32 m0, s60, 65536
    s_mov_b32 s56, 131072
    buffer_load_dwordx4 v1, s[16:19], s56 offen lds
    s_add_u32 m0, s60, 69632
    s_mov_b32 s56, 139264
    buffer_load_dwordx4 v1, s[16:19], s56 offen lds
    s_add_u32 m0, s60, 73728
    s_mov_b32 s56, 147456
    buffer_load_dwordx4 v1, s[16:19], s56 offen lds
    s_add_u32 m0, s60, 77824
    s_mov_b32 s56, 155648
    buffer_load_dwordx4 v1, s[16:19], s56 offen lds
    s_add_u32 m0, s60, 81920
    s_mov_b32 s56, 163840
    buffer_load_dwordx4 v1, s[16:19], s56 offen lds
    s_add_u32 m0, s60, 86016
    s_mov_b32 s56, 172032
    buffer_load_dwordx4 v1, s[16:19], s56 offen lds
    s_add_u32 m0, s60, 90112
    s_mov_b32 s56, 180224
    buffer_load_dwordx4 v1, s[16:19], s56 offen lds
    s_add_u32 m0, s60, 94208
    s_mov_b32 s56, 188416
    buffer_load_dwordx4 v1, s[16:19], s56 offen lds
    s_add_u32 m0, s60, 98304
    s_mov_b32 s56, 196608
    buffer_load_dwordx4 v1, s[16:19], s56 offen lds
    s_add_u32 m0, s60, 102400
    s_mov_b32 s56, 204800
    buffer_load_dwordx4 v1, s[16:19], s56 offen lds
    s_add_u32 m0, s60, 106496
    s_mov_b32 s56, 212992
    buffer_load_dwordx4 v1, s[16:19], s56 offen lds
    s_add_u32 m0, s60, 110592
    s_mov_b32 s56, 221184
    buffer_load_dwordx4 v1, s[16:19], s56 offen lds
    s_add_u32 m0, s60, 114688
    s_mov_b32 s56, 229376
    buffer_load_dwordx4 v1, s[16:19], s56 offen lds
    s_add_u32 m0, s60, 118784
    s_mov_b32 s56, 237568
    buffer_load_dwordx4 v1, s[16:19], s56 offen lds
    s_add_u32 m0, s60, 122880
    s_mov_b32 s56, 245760
    buffer_load_dwordx4 v1, s[16:19], s56 offen lds
    s_add_u32 m0, s60, 126976
    s_mov_b32 s56, 253952
    buffer_load_dwordx4 v1, s[16:19], s56 offen lds
    s_waitcnt vmcnt(28)
    v_lshlrev_b32 v4, 7, v4
    v_lshlrev_b32 v5, 7, v5
    v_lshlrev_b32 v6, 7, v6
    v_lshlrev_b32 v7, 7, v7
    v_lshlrev_b32 v8, 7, v8
    v_lshlrev_b32 v9, 7, v9
    v_lshlrev_b32 v10, 7, v10
    v_lshlrev_b32 v11, 7, v11
    v_add_u32_dpp v12, v4, v2 row_newbcast:0 row_mask:0xf bank_mask:0x3
    s_nop 1
    v_add_u32_dpp v12, v4, v2 row_newbcast:8 row_mask:0xf bank_mask:0xc
    s_add_u32 m0, s60, 131072
    s_nop 0
    buffer_load_dwordx4 v12, s[12:15], 0 offen lds
    v_add_u32_dpp v13, v8, v2 row_newbcast:0 row_mask:0xf bank_mask:0x3
    s_nop 1
    v_add_u32_dpp v13, v8, v2 row_newbcast:8 row_mask:0xf bank_mask:0xc
    s_add_u32 m0, s60, 135168
    s_nop 0
    buffer_load_dwordx4 v13, s[12:15], 0 offen lds
    v_add_u32_dpp v12, v5, v2 row_newbcast:0 row_mask:0xf bank_mask:0x3
    s_nop 1
    v_add_u32_dpp v12, v5, v2 row_newbcast:8 row_mask:0xf bank_mask:0xc
    s_add_u32 m0, s60, 139264
    s_nop 0
    buffer_load_dwordx4 v12, s[12:15], 0 offen lds
    v_add_u32_dpp v13, v9, v2 row_newbcast:0 row_mask:0xf bank_mask:0x3
    s_nop 1
    v_add_u32_dpp v13, v9, v2 row_newbcast:8 row_mask:0xf bank_mask:0xc
    s_add_u32 m0, s60, 143360
    s_nop 0
    buffer_load_dwordx4 v13, s[12:15], 0 offen lds
    v_add_u32_dpp v12, v6, v2 row_newbcast:0 row_mask:0xf bank_mask:0x3
    s_nop 1
    v_add_u32_dpp v12, v6, v2 row_newbcast:8 row_mask:0xf bank_mask:0xc
    s_add_u32 m0, s60, 147456
    s_nop 0
    buffer_load_dwordx4 v12, s[12:15], 0 offen lds
    v_add_u32_dpp v13, v10, v2 row_newbcast:0 row_mask:0xf bank_mask:0x3
    s_nop 1
    v_add_u32_dpp v13, v10, v2 row_newbcast:8 row_mask:0xf bank_mask:0xc
    s_add_u32 m0, s60, 151552
    s_nop 0
    buffer_load_dwordx4 v13, s[12:15], 0 offen lds
    v_add_u32_dpp v12, v7, v2 row_newbcast:0 row_mask:0xf bank_mask:0x3
    s_nop 1
    v_add_u32_dpp v12, v7, v2 row_newbcast:8 row_mask:0xf bank_mask:0xc
    s_add_u32 m0, s60, 155648
    s_nop 0
    buffer_load_dwordx4 v12, s[12:15], 0 offen lds
    v_add_u32_dpp v13, v11, v2 row_newbcast:0 row_mask:0xf bank_mask:0x3
    s_nop 1
    v_add_u32_dpp v13, v11, v2 row_newbcast:8 row_mask:0xf bank_mask:0xc
    s_add_u32 m0, s60, 159744
    s_nop 0
    buffer_load_dwordx4 v13, s[12:15], 0 offen lds
    s_waitcnt vmcnt(6)
    s_barrier
    s_waitcnt vmcnt(4)
    s_barrier
    s_add_u32 m0, s60, 0
    s_mov_b32 s56, 262144
    buffer_load_dwordx4 v1, s[16:19], s56 offen lds
    s_add_u32 m0, s60, 4096
    s_mov_b32 s56, 270336
    buffer_load_dwordx4 v1, s[16:19], s56 offen lds
    s_add_u32 m0, s60, 8192
    s_mov_b32 s56, 278528
    buffer_load_dwordx4 v1, s[16:19], s56 offen lds
    v_add_u32_dpp v12, v4, v2 row_newbcast:1 row_mask:0xf bank_mask:0x3
    s_nop 1
    v_add_u32_dpp v12, v4, v2 row_newbcast:9 row_mask:0xf bank_mask:0xc
    s_add_u32 m0, s60, 131072
    s_nop 0
    buffer_load_dwordx4 v12, s[12:15], 0 offen lds
    v_add_u32_dpp v13, v8, v2 row_newbcast:1 row_mask:0xf bank_mask:0x3
    s_nop 1
    v_add_u32_dpp v13, v8, v2 row_newbcast:9 row_mask:0xf bank_mask:0xc
    s_add_u32 m0, s60, 135168
    s_nop 0
    buffer_load_dwordx4 v13, s[12:15], 0 offen lds
    s_waitcnt vmcnt(7)
    s_barrier
    s_add_u32 m0, s60, 12288
    s_mov_b32 s56, 286720
    buffer_load_dwordx4 v1, s[16:19], s56 offen lds
    s_add_u32 m0, s60, 16384
    s_mov_b32 s56, 294912
    buffer_load_dwordx4 v1, s[16:19], s56 offen lds
    s_add_u32 m0, s60, 20480
    s_mov_b32 s56, 303104
    buffer_load_dwordx4 v1, s[16:19], s56 offen lds
    v_add_u32_dpp v12, v5, v2 row_newbcast:1 row_mask:0xf bank_mask:0x3
    s_nop 1
    v_add_u32_dpp v12, v5, v2 row_newbcast:9 row_mask:0xf bank_mask:0xc
    s_add_u32 m0, s60, 139264
    s_nop 0
    buffer_load_dwordx4 v12, s[12:15], 0 offen lds
    v_add_u32_dpp v13, v9, v2 row_newbcast:1 row_mask:0xf bank_mask:0x3
    s_nop 1
    v_add_u32_dpp v13, v9, v2 row_newbcast:9 row_mask:0xf bank_mask:0xc
    s_add_u32 m0, s60, 143360
    s_nop 0
    buffer_load_dwordx4 v13, s[12:15], 0 offen lds
    s_waitcnt vmcnt(10)
    s_barrier
    s_add_u32 m0, s60, 24576
    s_mov_b32 s56, 311296
    buffer_load_dwordx4 v1, s[16:19], s56 offen lds
    s_add_u32 m0, s60, 28672
    s_mov_b32 s56, 319488
    buffer_load_dwordx4 v1, s[16:19], s56 offen lds
    s_add_u32 m0, s60, 32768
    s_mov_b32 s56, 327680
    buffer_load_dwordx4 v1, s[16:19], s56 offen lds
    v_add_u32_dpp v12, v6, v2 row_newbcast:1 row_mask:0xf bank_mask:0x3
    s_nop 1
    v_add_u32_dpp v12, v6, v2 row_newbcast:9 row_mask:0xf bank_mask:0xc
    s_add_u32 m0, s60, 147456
    s_nop 0
    buffer_load_dwordx4 v12, s[12:15], 0 offen lds
    v_add_u32_dpp v13, v10, v2 row_newbcast:1 row_mask:0xf bank_mask:0x3
    s_nop 1
    v_add_u32_dpp v13, v10, v2 row_newbcast:9 row_mask:0xf bank_mask:0xc
    s_add_u32 m0, s60, 151552
    s_nop 0
    buffer_load_dwordx4 v13, s[12:15], 0 offen lds
    s_waitcnt vmcnt(10)
    s_barrier
    s_add_u32 m0, s60, 36864
    s_mov_b32 s56, 335872
    buffer_load_dwordx4 v1, s[16:19], s56 offen lds
    s_add_u32 m0, s60, 40960
    s_mov_b32 s56, 344064
    buffer_load_dwordx4 v1, s[16:19], s56 offen lds
    s_add_u32 m0, s60, 45056
    s_mov_b32 s56, 352256
    buffer_load_dwordx4 v1, s[16:19], s56 offen lds
    s_add_u32 m0, s60, 49152
    s_mov_b32 s56, 360448
    buffer_load_dwordx4 v1, s[16:19], s56 offen lds
    v_add_u32_dpp v12, v7, v2 row_newbcast:1 row_mask:0xf bank_mask:0x3
    s_nop 1
    v_add_u32_dpp v12, v7, v2 row_newbcast:9 row_mask:0xf bank_mask:0xc
    s_add_u32 m0, s60, 155648
    s_nop 0
    buffer_load_dwordx4 v12, s[12:15], 0 offen lds
    v_add_u32_dpp v13, v11, v2 row_newbcast:1 row_mask:0xf bank_mask:0x3
    s_nop 1
    v_add_u32_dpp v13, v11, v2 row_newbcast:9 row_mask:0xf bank_mask:0xc
    s_add_u32 m0, s60, 159744
    s_nop 0
    buffer_load_dwordx4 v13, s[12:15], 0 offen lds
    s_waitcnt vmcnt(11)
    s_barrier
    s_add_u32 m0, s60, 53248
    s_mov_b32 s56, 368640
    buffer_load_dwordx4 v1, s[16:19], s56 offen lds
    s_add_u32 m0, s60, 57344
    s_mov_b32 s56, 376832
    buffer_load_dwordx4 v1, s[16:19], s56 offen lds
    s_add_u32 m0, s60, 61440
    s_mov_b32 s56, 385024
    buffer_load_dwordx4 v1, s[16:19], s56 offen lds
    v_add_u32_dpp v12, v4, v2 row_newbcast:2 row_mask:0xf bank_mask:0x3
    s_nop 1
    v_add_u32_dpp v12, v4, v2 row_newbcast:10 row_mask:0xf bank_mask:0xc
    s_add_u32 m0, s60, 131072
    s_nop 0
    buffer_load_dwordx4 v12, s[12:15], 0 offen lds
    v_add_u32_dpp v13, v8, v2 row_newbcast:2 row_mask:0xf bank_mask:0x3
    s_nop 1
    v_add_u32_dpp v13, v8, v2 row_newbcast:10 row_mask:0xf bank_mask:0xc
    s_add_u32 m0, s60, 135168
    s_nop 0
    buffer_load_dwordx4 v13, s[12:15], 0 offen lds
    s_waitcnt vmcnt(11)
    s_barrier
    s_add_u32 m0, s60, 65536
    s_mov_b32 s56, 393216
    buffer_load_dwordx4 v1, s[16:19], s56 offen lds
    s_add_u32 m0, s60, 69632
    s_mov_b32 s56, 401408
    buffer_load_dwordx4 v1, s[16:19], s56 offen lds
    s_add_u32 m0, s60, 73728
    s_mov_b32 s56, 409600
    buffer_load_dwordx4 v1, s[16:19], s56 offen lds
    v_add_u32_dpp v12, v5, v2 row_newbcast:2 row_mask:0xf bank_mask:0x3
    s_nop 1
    v_add_u32_dpp v12, v5, v2 row_newbcast:10 row_mask:0xf bank_mask:0xc
    s_add_u32 m0, s60, 139264
    s_nop 0
    buffer_load_dwordx4 v12, s[12:15], 0 offen lds
    v_add_u32_dpp v13, v9, v2 row_newbcast:2 row_mask:0xf bank_mask:0x3
    s_nop 1
    v_add_u32_dpp v13, v9, v2 row_newbcast:10 row_mask:0xf bank_mask:0xc
    s_add_u32 m0, s60, 143360
    s_nop 0
    buffer_load_dwordx4 v13, s[12:15], 0 offen lds
    s_waitcnt vmcnt(10)
    s_barrier
    s_add_u32 m0, s60, 77824
    s_mov_b32 s56, 417792
    buffer_load_dwordx4 v1, s[16:19], s56 offen lds
    s_add_u32 m0, s60, 81920
    s_mov_b32 s56, 425984
    buffer_load_dwordx4 v1, s[16:19], s56 offen lds
    s_add_u32 m0, s60, 86016
    s_mov_b32 s56, 434176
    buffer_load_dwordx4 v1, s[16:19], s56 offen lds
    v_add_u32_dpp v12, v6, v2 row_newbcast:2 row_mask:0xf bank_mask:0x3
    s_nop 1
    v_add_u32_dpp v12, v6, v2 row_newbcast:10 row_mask:0xf bank_mask:0xc
    s_add_u32 m0, s60, 147456
    s_nop 0
    buffer_load_dwordx4 v12, s[12:15], 0 offen lds
    v_add_u32_dpp v13, v10, v2 row_newbcast:2 row_mask:0xf bank_mask:0x3
    s_nop 1
    v_add_u32_dpp v13, v10, v2 row_newbcast:10 row_mask:0xf bank_mask:0xc
    s_add_u32 m0, s60, 151552
    s_nop 0
    buffer_load_dwordx4 v13, s[12:15], 0 offen lds
    s_waitcnt vmcnt(10)
    s_barrier
    s_add_u32 m0, s60, 90112
    s_mov_b32 s56, 442368
    buffer_load_dwordx4 v1, s[16:19], s56 offen lds
    s_add_u32 m0, s60, 94208
    s_mov_b32 s56, 450560
    buffer_load_dwordx4 v1, s[16:19], s56 offen lds
    s_add_u32 m0, s60, 98304
    s_mov_b32 s56, 458752
    buffer_load_dwordx4 v1, s[16:19], s56 offen lds
    s_add_u32 m0, s60, 102400
    s_mov_b32 s56, 466944
    buffer_load_dwordx4 v1, s[16:19], s56 offen lds
    v_add_u32_dpp v12, v7, v2 row_newbcast:2 row_mask:0xf bank_mask:0x3
    s_nop 1
    v_add_u32_dpp v12, v7, v2 row_newbcast:10 row_mask:0xf bank_mask:0xc
    s_add_u32 m0, s60, 155648
    s_nop 0
    buffer_load_dwordx4 v12, s[12:15], 0 offen lds
    v_add_u32_dpp v13, v11, v2 row_newbcast:2 row_mask:0xf bank_mask:0x3
    s_nop 1
    v_add_u32_dpp v13, v11, v2 row_newbcast:10 row_mask:0xf bank_mask:0xc
    s_add_u32 m0, s60, 159744
    s_nop 0
    buffer_load_dwordx4 v13, s[12:15], 0 offen lds
    s_waitcnt vmcnt(11)
    s_barrier
    s_add_u32 m0, s60, 106496
    s_mov_b32 s56, 475136
    buffer_load_dwordx4 v1, s[16:19], s56 offen lds
    s_add_u32 m0, s60, 110592
    s_mov_b32 s56, 483328
    buffer_load_dwordx4 v1, s[16:19], s56 offen lds
    s_add_u32 m0, s60, 114688
    s_mov_b32 s56, 491520
    buffer_load_dwordx4 v1, s[16:19], s56 offen lds
    v_add_u32_dpp v12, v4, v2 row_newbcast:3 row_mask:0xf bank_mask:0x3
    s_nop 1
    v_add_u32_dpp v12, v4, v2 row_newbcast:11 row_mask:0xf bank_mask:0xc
    s_add_u32 m0, s60, 131072
    s_nop 0
    buffer_load_dwordx4 v12, s[12:15], 0 offen lds
    v_add_u32_dpp v13, v8, v2 row_newbcast:3 row_mask:0xf bank_mask:0x3
    s_nop 1
    v_add_u32_dpp v13, v8, v2 row_newbcast:11 row_mask:0xf bank_mask:0xc
    s_add_u32 m0, s60, 135168
    s_nop 0
    buffer_load_dwordx4 v13, s[12:15], 0 offen lds
    s_waitcnt vmcnt(11)
    s_barrier
    s_add_u32 m0, s60, 118784
    s_mov_b32 s56, 499712
    buffer_load_dwordx4 v1, s[16:19], s56 offen lds
    s_add_u32 m0, s60, 122880
    s_mov_b32 s56, 507904
    buffer_load_dwordx4 v1, s[16:19], s56 offen lds
    s_add_u32 m0, s60, 126976
    s_mov_b32 s56, 516096
    buffer_load_dwordx4 v1, s[16:19], s56 offen lds
    v_add_u32_dpp v12, v5, v2 row_newbcast:3 row_mask:0xf bank_mask:0x3
    s_nop 1
    v_add_u32_dpp v12, v5, v2 row_newbcast:11 row_mask:0xf bank_mask:0xc
    s_add_u32 m0, s60, 139264
    s_nop 0
    buffer_load_dwordx4 v12, s[12:15], 0 offen lds
    v_add_u32_dpp v13, v9, v2 row_newbcast:3 row_mask:0xf bank_mask:0x3
    s_nop 1
    v_add_u32_dpp v13, v9, v2 row_newbcast:11 row_mask:0xf bank_mask:0xc
    s_add_u32 m0, s60, 143360
    s_nop 0
    buffer_load_dwordx4 v13, s[12:15], 0 offen lds
    s_waitcnt vmcnt(10)
    s_barrier
    s_add_u32 m0, s60, 0
    s_mov_b32 s56, 524288
    buffer_load_dwordx4 v1, s[16:19], s56 offen lds
    s_add_u32 m0, s60, 4096
    s_mov_b32 s56, 532480
    buffer_load_dwordx4 v1, s[16:19], s56 offen lds
    s_add_u32 m0, s60, 8192
    s_mov_b32 s56, 540672
    buffer_load_dwordx4 v1, s[16:19], s56 offen lds
    s_add_u32 m0, s60, 12288
    s_mov_b32 s56, 548864
    buffer_load_dwordx4 v1, s[16:19], s56 offen lds
    v_add_u32_dpp v12, v6, v2 row_newbcast:3 row_mask:0xf bank_mask:0x3
    s_nop 1
    v_add_u32_dpp v12, v6, v2 row_newbcast:11 row_mask:0xf bank_mask:0xc
    s_add_u32 m0, s60, 147456
    s_nop 0
    buffer_load_dwordx4 v12, s[12:15], 0 offen lds
    v_add_u32_dpp v13, v10, v2 row_newbcast:3 row_mask:0xf bank_mask:0x3
    s_nop 1
    v_add_u32_dpp v13, v10, v2 row_newbcast:11 row_mask:0xf bank_mask:0xc
    s_add_u32 m0, s60, 151552
    s_nop 0
    buffer_load_dwordx4 v13, s[12:15], 0 offen lds
    s_waitcnt vmcnt(11)
    s_barrier
    s_add_u32 m0, s60, 16384
    s_mov_b32 s56, 557056
    buffer_load_dwordx4 v1, s[16:19], s56 offen lds
    s_add_u32 m0, s60, 20480
    s_mov_b32 s56, 565248
    buffer_load_dwordx4 v1, s[16:19], s56 offen lds
    s_add_u32 m0, s60, 24576
    s_mov_b32 s56, 573440
    buffer_load_dwordx4 v1, s[16:19], s56 offen lds
    v_add_u32_dpp v12, v7, v2 row_newbcast:3 row_mask:0xf bank_mask:0x3
    s_nop 1
    v_add_u32_dpp v12, v7, v2 row_newbcast:11 row_mask:0xf bank_mask:0xc
    s_add_u32 m0, s60, 155648
    s_nop 0
    buffer_load_dwordx4 v12, s[12:15], 0 offen lds
    v_add_u32_dpp v13, v11, v2 row_newbcast:3 row_mask:0xf bank_mask:0x3
    s_nop 1
    v_add_u32_dpp v13, v11, v2 row_newbcast:11 row_mask:0xf bank_mask:0xc
    s_add_u32 m0, s60, 159744
    s_nop 0
    buffer_load_dwordx4 v13, s[12:15], 0 offen lds
    s_waitcnt vmcnt(11)
    s_barrier
    s_add_u32 m0, s60, 28672
    s_mov_b32 s56, 581632
    buffer_load_dwordx4 v1, s[16:19], s56 offen lds
    s_add_u32 m0, s60, 32768
    s_mov_b32 s56, 589824
    buffer_load_dwordx4 v1, s[16:19], s56 offen lds
    s_add_u32 m0, s60, 36864
    s_mov_b32 s56, 598016
    buffer_load_dwordx4 v1, s[16:19], s56 offen lds
    v_add_u32_dpp v12, v4, v2 row_newbcast:4 row_mask:0xf bank_mask:0x3
    s_nop 1
    v_add_u32_dpp v12, v4, v2 row_newbcast:12 row_mask:0xf bank_mask:0xc
    s_add_u32 m0, s60, 131072
    s_nop 0
    buffer_load_dwordx4 v12, s[12:15], 0 offen lds
    v_add_u32_dpp v13, v8, v2 row_newbcast:4 row_mask:0xf bank_mask:0x3
    s_nop 1
    v_add_u32_dpp v13, v8, v2 row_newbcast:12 row_mask:0xf bank_mask:0xc
    s_add_u32 m0, s60, 135168
    s_nop 0
    buffer_load_dwordx4 v13, s[12:15], 0 offen lds
    s_waitcnt vmcnt(10)
    s_barrier
    s_add_u32 m0, s60, 40960
    s_mov_b32 s56, 606208
    buffer_load_dwordx4 v1, s[16:19], s56 offen lds
    s_add_u32 m0, s60, 45056
    s_mov_b32 s56, 614400
    buffer_load_dwordx4 v1, s[16:19], s56 offen lds
    s_add_u32 m0, s60, 49152
    s_mov_b32 s56, 622592
    buffer_load_dwordx4 v1, s[16:19], s56 offen lds
    v_add_u32_dpp v12, v5, v2 row_newbcast:4 row_mask:0xf bank_mask:0x3
    s_nop 1
    v_add_u32_dpp v12, v5, v2 row_newbcast:12 row_mask:0xf bank_mask:0xc
    s_add_u32 m0, s60, 139264
    s_nop 0
    buffer_load_dwordx4 v12, s[12:15], 0 offen lds
    v_add_u32_dpp v13, v9, v2 row_newbcast:4 row_mask:0xf bank_mask:0x3
    s_nop 1
    v_add_u32_dpp v13, v9, v2 row_newbcast:12 row_mask:0xf bank_mask:0xc
    s_add_u32 m0, s60, 143360
    s_nop 0
    buffer_load_dwordx4 v13, s[12:15], 0 offen lds
    s_waitcnt vmcnt(10)
    s_barrier
    s_add_u32 m0, s60, 53248
    s_mov_b32 s56, 630784
    buffer_load_dwordx4 v1, s[16:19], s56 offen lds
    s_add_u32 m0, s60, 57344
    s_mov_b32 s56, 638976
    buffer_load_dwordx4 v1, s[16:19], s56 offen lds
    s_add_u32 m0, s60, 61440
    s_mov_b32 s56, 647168
    buffer_load_dwordx4 v1, s[16:19], s56 offen lds
    s_add_u32 m0, s60, 65536
    s_mov_b32 s56, 655360
    buffer_load_dwordx4 v1, s[16:19], s56 offen lds
    v_add_u32_dpp v12, v6, v2 row_newbcast:4 row_mask:0xf bank_mask:0x3
    s_nop 1
    v_add_u32_dpp v12, v6, v2 row_newbcast:12 row_mask:0xf bank_mask:0xc
    s_add_u32 m0, s60, 147456
    s_nop 0
    buffer_load_dwordx4 v12, s[12:15], 0 offen lds
    v_add_u32_dpp v13, v10, v2 row_newbcast:4 row_mask:0xf bank_mask:0x3
    s_nop 1
    v_add_u32_dpp v13, v10, v2 row_newbcast:12 row_mask:0xf bank_mask:0xc
    s_add_u32 m0, s60, 151552
    s_nop 0
    buffer_load_dwordx4 v13, s[12:15], 0 offen lds
    s_waitcnt vmcnt(11)
    s_barrier
    s_add_u32 m0, s60, 69632
    s_mov_b32 s56, 663552
    buffer_load_dwordx4 v1, s[16:19], s56 offen lds
    s_add_u32 m0, s60, 73728
    s_mov_b32 s56, 671744
    buffer_load_dwordx4 v1, s[16:19], s56 offen lds
    s_add_u32 m0, s60, 77824
    s_mov_b32 s56, 679936
    buffer_load_dwordx4 v1, s[16:19], s56 offen lds
    v_add_u32_dpp v12, v7, v2 row_newbcast:4 row_mask:0xf bank_mask:0x3
    s_nop 1
    v_add_u32_dpp v12, v7, v2 row_newbcast:12 row_mask:0xf bank_mask:0xc
    s_add_u32 m0, s60, 155648
    s_nop 0
    buffer_load_dwordx4 v12, s[12:15], 0 offen lds
    v_add_u32_dpp v13, v11, v2 row_newbcast:4 row_mask:0xf bank_mask:0x3
    s_nop 1
    v_add_u32_dpp v13, v11, v2 row_newbcast:12 row_mask:0xf bank_mask:0xc
    s_add_u32 m0, s60, 159744
    s_nop 0
    buffer_load_dwordx4 v13, s[12:15], 0 offen lds
    s_waitcnt vmcnt(11)
    s_barrier
    s_add_u32 m0, s60, 81920
    s_mov_b32 s56, 688128
    buffer_load_dwordx4 v1, s[16:19], s56 offen lds
    s_add_u32 m0, s60, 86016
    s_mov_b32 s56, 696320
    buffer_load_dwordx4 v1, s[16:19], s56 offen lds
    s_add_u32 m0, s60, 90112
    s_mov_b32 s56, 704512
    buffer_load_dwordx4 v1, s[16:19], s56 offen lds
    v_add_u32_dpp v12, v4, v2 row_newbcast:5 row_mask:0xf bank_mask:0x3
    s_nop 1
    v_add_u32_dpp v12, v4, v2 row_newbcast:13 row_mask:0xf bank_mask:0xc
    s_add_u32 m0, s60, 131072
    s_nop 0
    buffer_load_dwordx4 v12, s[12:15], 0 offen lds
    v_add_u32_dpp v13, v8, v2 row_newbcast:5 row_mask:0xf bank_mask:0x3
    s_nop 1
    v_add_u32_dpp v13, v8, v2 row_newbcast:13 row_mask:0xf bank_mask:0xc
    s_add_u32 m0, s60, 135168
    s_nop 0
    buffer_load_dwordx4 v13, s[12:15], 0 offen lds
    s_waitcnt vmcnt(10)
    s_barrier
    s_add_u32 m0, s60, 94208
    s_mov_b32 s56, 712704
    buffer_load_dwordx4 v1, s[16:19], s56 offen lds
    s_add_u32 m0, s60, 98304
    s_mov_b32 s56, 720896
    buffer_load_dwordx4 v1, s[16:19], s56 offen lds
    s_add_u32 m0, s60, 102400
    s_mov_b32 s56, 729088
    buffer_load_dwordx4 v1, s[16:19], s56 offen lds
    v_add_u32_dpp v12, v5, v2 row_newbcast:5 row_mask:0xf bank_mask:0x3
    s_nop 1
    v_add_u32_dpp v12, v5, v2 row_newbcast:13 row_mask:0xf bank_mask:0xc
    s_add_u32 m0, s60, 139264
    s_nop 0
    buffer_load_dwordx4 v12, s[12:15], 0 offen lds
    v_add_u32_dpp v13, v9, v2 row_newbcast:5 row_mask:0xf bank_mask:0x3
    s_nop 1
    v_add_u32_dpp v13, v9, v2 row_newbcast:13 row_mask:0xf bank_mask:0xc
    s_add_u32 m0, s60, 143360
    s_nop 0
    buffer_load_dwordx4 v13, s[12:15], 0 offen lds
    s_waitcnt vmcnt(10)
    s_barrier
    s_add_u32 m0, s60, 106496
    s_mov_b32 s56, 737280
    buffer_load_dwordx4 v1, s[16:19], s56 offen lds
    s_add_u32 m0, s60, 110592
    s_mov_b32 s56, 745472
    buffer_load_dwordx4 v1, s[16:19], s56 offen lds
    s_add_u32 m0, s60, 114688
    s_mov_b32 s56, 753664
    buffer_load_dwordx4 v1, s[16:19], s56 offen lds
    s_add_u32 m0, s60, 118784
    s_mov_b32 s56, 761856
    buffer_load_dwordx4 v1, s[16:19], s56 offen lds
    v_add_u32_dpp v12, v6, v2 row_newbcast:5 row_mask:0xf bank_mask:0x3
    s_nop 1
    v_add_u32_dpp v12, v6, v2 row_newbcast:13 row_mask:0xf bank_mask:0xc
    s_add_u32 m0, s60, 147456
    s_nop 0
    buffer_load_dwordx4 v12, s[12:15], 0 offen lds
    v_add_u32_dpp v13, v10, v2 row_newbcast:5 row_mask:0xf bank_mask:0x3
    s_nop 1
    v_add_u32_dpp v13, v10, v2 row_newbcast:13 row_mask:0xf bank_mask:0xc
    s_add_u32 m0, s60, 151552
    s_nop 0
    buffer_load_dwordx4 v13, s[12:15], 0 offen lds
    s_waitcnt vmcnt(11)
    s_barrier
    s_add_u32 m0, s60, 122880
    s_mov_b32 s56, 770048
    buffer_load_dwordx4 v1, s[16:19], s56 offen lds
    s_add_u32 m0, s60, 126976
    s_mov_b32 s56, 778240
    buffer_load_dwordx4 v1, s[16:19], s56 offen lds
    s_add_u32 m0, s60, 0
    s_mov_b32 s56, 786432
    buffer_load_dwordx4 v1, s[16:19], s56 offen lds
    v_add_u32_dpp v12, v7, v2 row_newbcast:5 row_mask:0xf bank_mask:0x3
    s_nop 1
    v_add_u32_dpp v12, v7, v2 row_newbcast:13 row_mask:0xf bank_mask:0xc
    s_add_u32 m0, s60, 155648
    s_nop 0
    buffer_load_dwordx4 v12, s[12:15], 0 offen lds
    v_add_u32_dpp v13, v11, v2 row_newbcast:5 row_mask:0xf bank_mask:0x3
    s_nop 1
    v_add_u32_dpp v13, v11, v2 row_newbcast:13 row_mask:0xf bank_mask:0xc
    s_add_u32 m0, s60, 159744
    s_nop 0
    buffer_load_dwordx4 v13, s[12:15], 0 offen lds
    s_waitcnt vmcnt(15)
    s_waitcnt vmcnt(11)
    s_barrier
    s_add_u32 m0, s60, 4096
    s_mov_b32 s56, 794624
    buffer_load_dwordx4 v1, s[16:19], s56 offen lds
    s_add_u32 m0, s60, 8192
    s_mov_b32 s56, 802816
    buffer_load_dwordx4 v1, s[16:19], s56 offen lds
    s_add_u32 m0, s60, 12288
    s_mov_b32 s56, 811008
    buffer_load_dwordx4 v1, s[16:19], s56 offen lds
    v_add_u32_dpp v12, v4, v2 row_newbcast:6 row_mask:0xf bank_mask:0x3
    s_nop 1
    v_add_u32_dpp v12, v4, v2 row_newbcast:14 row_mask:0xf bank_mask:0xc
    s_add_u32 m0, s60, 131072
    s_nop 0
    buffer_load_dwordx4 v12, s[12:15], 0 offen lds
    v_add_u32_dpp v13, v8, v2 row_newbcast:6 row_mask:0xf bank_mask:0x3
    s_nop 1
    v_add_u32_dpp v13, v8, v2 row_newbcast:14 row_mask:0xf bank_mask:0xc
    s_add_u32 m0, s60, 135168
    s_nop 0
    buffer_load_dwordx4 v13, s[12:15], 0 offen lds
    s_waitcnt vmcnt(14)
    s_waitcnt vmcnt(10)
    s_barrier
    s_add_u32 m0, s60, 16384
    s_mov_b32 s56, 819200
    buffer_load_dwordx4 v1, s[16:19], s56 offen lds
    s_add_u32 m0, s60, 20480
    s_mov_b32 s56, 827392
    buffer_load_dwordx4 v1, s[16:19], s56 offen lds
    s_add_u32 m0, s60, 24576
    s_mov_b32 s56, 835584
    buffer_load_dwordx4 v1, s[16:19], s56 offen lds
    s_add_u32 m0, s60, 28672
    s_mov_b32 s56, 843776
    buffer_load_dwordx4 v1, s[16:19], s56 offen lds
    v_add_u32_dpp v12, v5, v2 row_newbcast:6 row_mask:0xf bank_mask:0x3
    s_nop 1
    v_add_u32_dpp v12, v5, v2 row_newbcast:14 row_mask:0xf bank_mask:0xc
    s_add_u32 m0, s60, 139264
    s_nop 0
    buffer_load_dwordx4 v12, s[12:15], 0 offen lds
    v_add_u32_dpp v13, v9, v2 row_newbcast:6 row_mask:0xf bank_mask:0x3
    s_nop 1
    v_add_u32_dpp v13, v9, v2 row_newbcast:14 row_mask:0xf bank_mask:0xc
    s_add_u32 m0, s60, 143360
    s_nop 0
    buffer_load_dwordx4 v13, s[12:15], 0 offen lds
    s_waitcnt vmcnt(14)
    s_waitcnt vmcnt(11)
    s_barrier
    s_waitcnt vmcnt(8)
    s_waitcnt vmcnt(6)
    s_barrier
    s_waitcnt vmcnt(2)
    s_waitcnt vmcnt(0)
    s_barrier
    s_branch L_end
L_Bc:
    s_mov_b32 s30, 676
    s_mov_b32 s31, 0x00020000
    s_mov_b32 s34, 676
    s_mov_b32 s35, 0x00020000
    s_mov_b32 s26, 8192
    s_mov_b32 s27, 0x00020000
    s_mov_b32 s22, 173056
    s_mov_b32 s23, 0x00020000
    s_mov_b32 s38, 512
    s_mov_b32 s39, 0x00020000
    s_mov_b32 s42, 8192
    s_mov_b32 s43, 0x00020000
    s_mov_b32 s46, 256
    s_mov_b32 s47, 0x00020000
    s_mov_b32 s50, 268435456
    s_mov_b32 s51, 0x00020000
    s_mov_b32 s64, 0x05040100
    s_mov_b32 s65, 0x07060302
    s_mov_b32 s66, 0xc0135761
    s_mov_b32 s67, 0xbdd2d3e8
    s_mov_b32 s68, 0xffff0000
    s_mov_b32 s69, 0xbfb8aa3b
    v_and_b32 v8, 31, v0
    v_bfe_u32 v9, v0, 5, 1
    v_bfe_u32 v10, v0, 1, 3
    v_xor_b32 v10, v10, v9
    v_lshlrev_b32 v10, 4, v10
    v_lshl_add_u32 v10, v8, 7, v10
    v_add_u32 v1, 131072, v10
    v_xor_b32 v2, 32, v1
    v_xor_b32 v3, 64, v1
    v_xor_b32 v4, 96, v1
    v_bfe_u32 v8, v0, 2, 2
    v_lshl_add_u32 v10, v9, 3, v8
    v_lshlrev_b32 v10, 8, v10
    v_xor_b32 v8, s52, v8
    v_lshl_add_u32 v10, v8, 6, v10
    v_bfe_u32 v8, v0, 4, 1
    v_lshl_add_u32 v10, v8, 5, v10
    v_and_b32 v8, 3, v0
    v_lshl_add_u32 v5, v8, 3, v10
    v_add_u32 v6, 0x10000, v5
    s_lshl_b32 s56, s54, 8
    s_lshl_b32 s57, s52, 6
    s_add_u32 s56, s56, s57
    v_lshlrev_b32 v9, 3, v9
    s_waitcnt lgkmcnt(0)
    s_mov_b64 s[28:29], s[84:85]
    s_mov_b64 s[32:33], s[86:87]
    s_mov_b64 s[24:25], s[88:89]
    s_mov_b64 s[20:21], s[90:91]
    s_mov_b64 s[36:37], s[92:93]
    s_mov_b64 s[40:41], s[94:95]
    s_mov_b64 s[44:45], s[96:97]
    s_mov_b64 s[48:49], s[98:99]
    buffer_load_dwordx2 v[64:65], v9, s[36:39], s56 offen offset:0
    buffer_load_dwordx2 v[66:67], v9, s[36:39], s56 offen offset:16
    buffer_load_dwordx2 v[68:69], v9, s[36:39], s56 offen offset:32
    buffer_load_dwordx2 v[70:71], v9, s[36:39], s56 offen offset:48
    s_mov_b64 exec, 1
    v_mov_b32 v8, 0
    buffer_load_dword v11, v8, s[40:43], 0 offen
    buffer_load_dword v11, v8, s[44:47], 0 offen
    buffer_load_dword v11, v8, s[48:51], 0 offen
    s_mov_b64 exec, -1
    v_mov_b32 v32, 0
    v_mov_b32 v33, 0
    v_mov_b32 v34, 0
    v_mov_b32 v35, 0
    v_mov_b32 v36, 0
    v_mov_b32 v37, 0
    v_mov_b32 v38, 0
    v_mov_b32 v39, 0
    v_mov_b32 v40, 0
    v_mov_b32 v41, 0
    v_mov_b32 v42, 0
    v_mov_b32 v43, 0
    v_mov_b32 v44, 0
    v_mov_b32 v45, 0
    v_mov_b32 v46, 0
    v_mov_b32 v47, 0
    v_mov_b32 v48, 0
    v_mov_b32 v49, 0
    v_mov_b32 v50, 0
    v_mov_b32 v51, 0
    v_mov_b32 v52, 0
    v_mov_b32 v53, 0
    v_mov_b32 v54, 0
    v_mov_b32 v55, 0
    v_mov_b32 v56, 0
    v_mov_b32 v57, 0
    v_mov_b32 v58, 0
    v_mov_b32 v59, 0
    v_mov_b32 v60, 0
    v_mov_b32 v61, 0
    v_mov_b32 v62, 0
    v_mov_b32 v63, 0
    s_waitcnt vmcnt(0)
    v_lshlrev_b32 v16, 16, v64
    v_and_b32 v17, s68, v64
    v_lshlrev_b32 v18, 16, v65
    v_and_b32 v19, s68, v65
    v_lshlrev_b32 v20, 16, v66
    v_and_b32 v21, s68, v66
    v_lshlrev_b32 v22, 16, v67
    v_and_b32 v23, s68, v67
    v_lshlrev_b32 v24, 16, v68
    v_and_b32 v25, s68, v68
    v_lshlrev_b32 v26, 16, v69
    v_and_b32 v27, s68, v69
    v_lshlrev_b32 v28, 16, v70
    v_and_b32 v29, s68, v70
    v_lshlrev_b32 v30, 16, v71
    v_and_b32 v31, s68, v71
    s_barrier
    ds_read_b64_tr_b16 v[128:129], v5 offset:0
    ds_read_b64_tr_b16 v[130:131], v5 offset:1024
    ds_read_b128 v[64:67], v1 offset:0
    ds_read_b128 v[80:83], v1 offset:4096
    ds_read_b64_tr_b16 v[132:133], v5 offset:4096
    ds_read_b64_tr_b16 v[134:135], v5 offset:5120
    ds_read_b128 v[68:71], v2 offset:0
    ds_read_b128 v[84:87], v2 offset:4096
    ds_read_b64_tr_b16 v[136:137], v5 offset:8192
    ds_read_b64_tr_b16 v[138:139], v5 offset:9216
    ds_read_b128 v[72:75], v3 offset:0
    ds_read_b128 v[88:91], v3 offset:4096
    s_waitcnt lgkmcnt(8)
    ds_read_b64_tr_b16 v[140:141], v5 offset:12288
    ds_read_b64_tr_b16 v[142:143], v5 offset:13312
    ds_read_b128 v[76:79], v4 offset:0
    ds_read_b128 v[92:95], v4 offset:4096
    v_mfma_f32_32x32x16_bf16 v[32:47], v[128:131], v[64:67], v[32:47]
    v_mfma_f32_32x32x16_bf16 v[48:63], v[128:131], v[80:83], v[48:63]
    s_waitcnt lgkmcnt(8)
    v_mfma_f32_32x32x16_bf16 v[32:47], v[132:135], v[68:71], v[32:47]
    v_mfma_f32_32x32x16_bf16 v[48:63], v[132:135], v[84:87], v[48:63]
    s_waitcnt lgkmcnt(0)
    s_barrier
    ds_read_b64_tr_b16 v[144:145], v5 offset:16384
    ds_read_b64_tr_b16 v[146:147], v5 offset:17408
    ds_read_b128 v[96:99], v1 offset:8192
    ds_read_b128 v[112:115], v1 offset:12288
    ds_read_b64_tr_b16 v[148:149], v5 offset:20480
    ds_read_b64_tr_b16 v[150:151], v5 offset:21504
    ds_read_b128 v[100:103], v2 offset:8192
    ds_read_b128 v[116:119], v2 offset:12288
    v_mfma_f32_32x32x16_bf16 v[32:47], v[136:139], v[72:75], v[32:47]
    v_mfma_f32_32x32x16_bf16 v[48:63], v[136:139], v[88:91], v[48:63]
    ds_read_b64_tr_b16 v[152:153], v5 offset:24576
    ds_read_b64_tr_b16 v[154:155], v5 offset:25600
    ds_read_b128 v[104:107], v3 offset:8192
    ds_read_b128 v[120:123], v3 offset:12288
    v_mfma_f32_32x32x16_bf16 v[32:47], v[140:143], v[76:79], v[32:47]
    v_mfma_f32_32x32x16_bf16 v[48:63], v[140:143], v[92:95], v[48:63]
    s_waitcnt lgkmcnt(8)
    ds_read_b64_tr_b16 v[156:157], v5 offset:28672
    ds_read_b64_tr_b16 v[158:159], v5 offset:29696
    ds_read_b128 v[108:111], v4 offset:8192
    ds_read_b128 v[124:127], v4 offset:12288
    v_mfma_f32_32x32x16_bf16 v[32:47], v[144:147], v[96:99], v[32:47]
    v_mfma_f32_32x32x16_bf16 v[48:63], v[144:147], v[112:115], v[48:63]
    s_waitcnt lgkmcnt(8)
    v_mfma_f32_32x32x16_bf16 v[32:47], v[148:151], v[100:103], v[32:47]
    v_mfma_f32_32x32x16_bf16 v[48:63], v[148:151], v[116:119], v[48:63]
    s_waitcnt lgkmcnt(0)
    s_barrier
    ds_read_b64_tr_b16 v[128:129], v5 offset:32768
    ds_read_b64_tr_b16 v[130:131], v5 offset:33792
    ds_read_b128 v[64:67], v1 offset:16384
    ds_read_b128 v[80:83], v1 offset:20480
    ds_read_b64_tr_b16 v[132:133], v5 offset:36864
    ds_read_b64_tr_b16 v[134:135], v5 offset:37888
    ds_read_b128 v[68:71], v2 offset:16384
    ds_read_b128 v[84:87], v2 offset:20480
    v_mfma_f32_32x32x16_bf16 v[32:47], v[152:155], v[104:107], v[32:47]
    v_mfma_f32_32x32x16_bf16 v[48:63], v[152:155], v[120:123], v[48:63]
    ds_read_b64_tr_b16 v[136:137], v5 offset:40960
    ds_read_b64_tr_b16 v[138:139], v5 offset:41984
    ds_read_b128 v[72:75], v3 offset:16384
    ds_read_b128 v[88:91], v3 offset:20480
    v_mfma_f32_32x32x16_bf16 v[32:47], v[156:159], v[108:111], v[32:47]
    v_mfma_f32_32x32x16_bf16 v[48:63], v[156:159], v[124:127], v[48:63]
    s_waitcnt lgkmcnt(8)
    ds_read_b64_tr_b16 v[140:141], v5 offset:45056
    ds_read_b64_tr_b16 v[142:143], v5 offset:46080
    ds_read_b128 v[76:79], v4 offset:16384
    ds_read_b128 v[92:95], v4 offset:20480
    v_mfma_f32_32x32x16_bf16 v[32:47], v[128:131], v[64:67], v[32:47]
    v_mfma_f32_32x32x16_bf16 v[48:63], v[128:131], v[80:83], v[48:63]
    s_waitcnt lgkmcnt(8)
    v_mfma_f32_32x32x16_bf16 v[32:47], v[132:135], v[68:71], v[32:47]
    v_mfma_f32_32x32x16_bf16 v[48:63], v[132:135], v[84:87], v[48:63]
    s_waitcnt lgkmcnt(0)
    s_barrier
    ds_read_b64_tr_b16 v[144:145], v5 offset:49152
    ds_read_b64_tr_b16 v[146:147], v5 offset:50176
    ds_read_b128 v[96:99], v1 offset:24576
    ds_read_b128 v[112:115], v1 offset:28672
    ds_read_b64_tr_b16 v[148:149], v5 offset:53248
    ds_read_b64_tr_b16 v[150:151], v5 offset:54272
    ds_read_b128 v[100:103], v2 offset:24576
    ds_read_b128 v[116:119], v2 offset:28672
    v_mfma_f32_32x32x16_bf16 v[32:47], v[136:139], v[72:75], v[32:47]
    v_mfma_f32_32x32x16_bf16 v[48:63], v[136:139], v[88:91], v[48:63]
    ds_read_b64_tr_b16 v[152:153], v5 offset:57344
    ds_read_b64_tr_b16 v[154:155], v5 offset:58368
    ds_read_b128 v[104:107], v3 offset:24576
    ds_read_b128 v[120:123], v3 offset:28672
    v_mfma_f32_32x32x16_bf16 v[32:47], v[140:143], v[76:79], v[32:47]
    v_mfma_f32_32x32x16_bf16 v[48:63], v[140:143], v[92:95], v[48:63]
    s_waitcnt lgkmcnt(8)
    ds_read_b64_tr_b16 v[156:157], v5 offset:61440
    ds_read_b64_tr_b16 v[158:159], v5 offset:62464
    ds_read_b128 v[108:111], v4 offset:24576
    ds_read_b128 v[124:127], v4 offset:28672
    v_mfma_f32_32x32x16_bf16 v[32:47], v[144:147], v[96:99], v[32:47]
    v_mfma_f32_32x32x16_bf16 v[48:63], v[144:147], v[112:115], v[48:63]
    s_waitcnt lgkmcnt(8)
    v_mfma_f32_32x32x16_bf16 v[32:47], v[148:151], v[100:103], v[32:47]
    v_mfma_f32_32x32x16_bf16 v[48:63], v[148:151], v[116:119], v[48:63]
    s_waitcnt lgkmcnt(0)
    s_barrier
    ds_read_b64_tr_b16 v[128:129], v6 offset:0
    ds_read_b64_tr_b16 v[130:131], v6 offset:1024
    ds_read_b128 v[64:67], v1 offset:0
    ds_read_b128 v[80:83], v1 offset:4096
    ds_read_b64_tr_b16 v[132:133], v6 offset:4096
    ds_read_b64_tr_b16 v[134:135], v6 offset:5120
    ds_read_b128 v[68:71], v2 offset:0
    ds_read_b128 v[84:87], v2 offset:4096
    v_mfma_f32_32x32x16_bf16 v[32:47], v[152:155], v[104:107], v[32:47]
    v_mfma_f32_32x32x16_bf16 v[48:63], v[152:155], v[120:123], v[48:63]
    ds_read_b64_tr_b16 v[136:137], v6 offset:8192
    ds_read_b64_tr_b16 v[138:139], v6 offset:9216
    ds_read_b128 v[72:75], v3 offset:0
    ds_read_b128 v[88:91], v3 offset:4096
    v_mfma_f32_32x32x16_bf16 v[32:47], v[156:159], v[108:111], v[32:47]
    v_mfma_f32_32x32x16_bf16 v[48:63], v[156:159], v[124:127], v[48:63]
    s_waitcnt lgkmcnt(8)
    ds_read_b64_tr_b16 v[140:141], v6 offset:12288
    ds_read_b64_tr_b16 v[142:143], v6 offset:13312
    ds_read_b128 v[76:79], v4 offset:0
    ds_read_b128 v[92:95], v4 offset:4096
    v_mfma_f32_32x32x16_bf16 v[32:47], v[128:131], v[64:67], v[32:47]
    v_mfma_f32_32x32x16_bf16 v[48:63], v[128:131], v[80:83], v[48:63]
    s_waitcnt lgkmcnt(8)
    v_mfma_f32_32x32x16_bf16 v[32:47], v[132:135], v[68:71], v[32:47]
    v_mfma_f32_32x32x16_bf16 v[48:63], v[132:135], v[84:87], v[48:63]
    s_waitcnt lgkmcnt(0)
    s_barrier
    ds_read_b64_tr_b16 v[144:145], v6 offset:16384
    ds_read_b64_tr_b16 v[146:147], v6 offset:17408
    ds_read_b128 v[96:99], v1 offset:8192
    ds_read_b128 v[112:115], v1 offset:12288
    ds_read_b64_tr_b16 v[148:149], v6 offset:20480
    ds_read_b64_tr_b16 v[150:151], v6 offset:21504
    ds_read_b128 v[100:103], v2 offset:8192
    ds_read_b128 v[116:119], v2 offset:12288
    v_mfma_f32_32x32x16_bf16 v[32:47], v[136:139], v[72:75], v[32:47]
    v_mfma_f32_32x32x16_bf16 v[48:63], v[136:139], v[88:91], v[48:63]
    ds_read_b64_tr_b16 v[152:153], v6 offset:24576
    ds_read_b64_tr_b16 v[154:155], v6 offset:25600
    ds_read_b128 v[104:107], v3 offset:8192
    ds_read_b128 v[120:123], v3 offset:12288
    v_mfma_f32_32x32x16_bf16 v[32:47], v[140:143], v[76:79], v[32:47]
    v_mfma_f32_32x32x16_bf16 v[48:63], v[140:143], v[92:95], v[48:63]
    s_waitcnt lgkmcnt(8)
    ds_read_b64_tr_b16 v[156:157], v6 offset:28672
    ds_read_b64_tr_b16 v[158:159], v6 offset:29696
    ds_read_b128 v[108:111], v4 offset:8192
    ds_read_b128 v[124:127], v4 offset:12288
    v_mfma_f32_32x32x16_bf16 v[32:47], v[144:147], v[96:99], v[32:47]
    v_mfma_f32_32x32x16_bf16 v[48:63], v[144:147], v[112:115], v[48:63]
    s_waitcnt lgkmcnt(8)
    v_mfma_f32_32x32x16_bf16 v[32:47], v[148:151], v[100:103], v[32:47]
    v_mfma_f32_32x32x16_bf16 v[48:63], v[148:151], v[116:119], v[48:63]
    s_waitcnt lgkmcnt(0)
    s_barrier
    ds_read_b64_tr_b16 v[128:129], v6 offset:32768
    ds_read_b64_tr_b16 v[130:131], v6 offset:33792
    ds_read_b128 v[64:67], v1 offset:16384
    ds_read_b128 v[80:83], v1 offset:20480
    ds_read_b64_tr_b16 v[132:133], v6 offset:36864
    ds_read_b64_tr_b16 v[134:135], v6 offset:37888
    ds_read_b128 v[68:71], v2 offset:16384
    ds_read_b128 v[84:87], v2 offset:20480
    v_mfma_f32_32x32x16_bf16 v[32:47], v[152:155], v[104:107], v[32:47]
    v_mfma_f32_32x32x16_bf16 v[48:63], v[152:155], v[120:123], v[48:63]
    ds_read_b64_tr_b16 v[136:137], v6 offset:40960
    ds_read_b64_tr_b16 v[138:139], v6 offset:41984
    ds_read_b128 v[72:75], v3 offset:16384
    ds_read_b128 v[88:91], v3 offset:20480
    v_mfma_f32_32x32x16_bf16 v[32:47], v[156:159], v[108:111], v[32:47]
    v_mfma_f32_32x32x16_bf16 v[48:63], v[156:159], v[124:127], v[48:63]
    s_waitcnt lgkmcnt(8)
    ds_read_b64_tr_b16 v[140:141], v6 offset:45056
    ds_read_b64_tr_b16 v[142:143], v6 offset:46080
    ds_read_b128 v[76:79], v4 offset:16384
    ds_read_b128 v[92:95], v4 offset:20480
    v_mfma_f32_32x32x16_bf16 v[32:47], v[128:131], v[64:67], v[32:47]
    v_mfma_f32_32x32x16_bf16 v[48:63], v[128:131], v[80:83], v[48:63]
    s_waitcnt lgkmcnt(8)
    v_mfma_f32_32x32x16_bf16 v[32:47], v[132:135], v[68:71], v[32:47]
    v_mfma_f32_32x32x16_bf16 v[48:63], v[132:135], v[84:87], v[48:63]
    s_waitcnt lgkmcnt(0)
    s_barrier
    ds_read_b64_tr_b16 v[144:145], v6 offset:49152
    ds_read_b64_tr_b16 v[146:147], v6 offset:50176
    ds_read_b128 v[96:99], v1 offset:24576
    ds_read_b128 v[112:115], v1 offset:28672
    ds_read_b64_tr_b16 v[148:149], v6 offset:53248
    ds_read_b64_tr_b16 v[150:151], v6 offset:54272
    ds_read_b128 v[100:103], v2 offset:24576
    ds_read_b128 v[116:119], v2 offset:28672
    v_mfma_f32_32x32x16_bf16 v[32:47], v[136:139], v[72:75], v[32:47]
    v_mfma_f32_32x32x16_bf16 v[48:63], v[136:139], v[88:91], v[48:63]
    ds_read_b64_tr_b16 v[152:153], v6 offset:57344
    ds_read_b64_tr_b16 v[154:155], v6 offset:58368
    ds_read_b128 v[104:107], v3 offset:24576
    ds_read_b128 v[120:123], v3 offset:28672
    v_mfma_f32_32x32x16_bf16 v[32:47], v[140:143], v[76:79], v[32:47]
    v_mfma_f32_32x32x16_bf16 v[48:63], v[140:143], v[92:95], v[48:63]
    s_waitcnt lgkmcnt(8)
    ds_read_b64_tr_b16 v[156:157], v6 offset:61440
    ds_read_b64_tr_b16 v[158:159], v6 offset:62464
    ds_read_b128 v[108:111], v4 offset:24576
    ds_read_b128 v[124:127], v4 offset:28672
    v_mfma_f32_32x32x16_bf16 v[32:47], v[144:147], v[96:99], v[32:47]
    v_mfma_f32_32x32x16_bf16 v[48:63], v[144:147], v[112:115], v[48:63]
    s_waitcnt lgkmcnt(8)
    v_mfma_f32_32x32x16_bf16 v[32:47], v[148:151], v[100:103], v[32:47]
    v_mfma_f32_32x32x16_bf16 v[48:63], v[148:151], v[116:119], v[48:63]
    s_waitcnt lgkmcnt(0)
    s_barrier
    ds_read_b64_tr_b16 v[128:129], v5 offset:0
    ds_read_b64_tr_b16 v[130:131], v5 offset:1024
    ds_read_b128 v[64:67], v1 offset:0
    ds_read_b128 v[80:83], v1 offset:4096
    ds_read_b64_tr_b16 v[132:133], v5 offset:4096
    ds_read_b64_tr_b16 v[134:135], v5 offset:5120
    ds_read_b128 v[68:71], v2 offset:0
    ds_read_b128 v[84:87], v2 offset:4096
    v_mfma_f32_32x32x16_bf16 v[32:47], v[152:155], v[104:107], v[32:47]
    v_mfma_f32_32x32x16_bf16 v[48:63], v[152:155], v[120:123], v[48:63]
    ds_read_b64_tr_b16 v[136:137], v5 offset:8192
    ds_read_b64_tr_b16 v[138:139], v5 offset:9216
    ds_read_b128 v[72:75], v3 offset:0
    ds_read_b128 v[88:91], v3 offset:4096
    v_mfma_f32_32x32x16_bf16 v[32:47], v[156:159], v[108:111], v[32:47]
    v_mfma_f32_32x32x16_bf16 v[48:63], v[156:159], v[124:127], v[48:63]
    s_waitcnt lgkmcnt(8)
    ds_read_b64_tr_b16 v[140:141], v5 offset:12288
    ds_read_b64_tr_b16 v[142:143], v5 offset:13312
    ds_read_b128 v[76:79], v4 offset:0
    ds_read_b128 v[92:95], v4 offset:4096
    v_mfma_f32_32x32x16_bf16 v[32:47], v[128:131], v[64:67], v[32:47]
    v_mfma_f32_32x32x16_bf16 v[48:63], v[128:131], v[80:83], v[48:63]
    s_waitcnt lgkmcnt(8)
    v_mfma_f32_32x32x16_bf16 v[32:47], v[132:135], v[68:71], v[32:47]
    v_mfma_f32_32x32x16_bf16 v[48:63], v[132:135], v[84:87], v[48:63]
    s_waitcnt lgkmcnt(0)
    s_barrier
    ds_read_b64_tr_b16 v[144:145], v5 offset:16384
    ds_read_b64_tr_b16 v[146:147], v5 offset:17408
    ds_read_b128 v[96:99], v1 offset:8192
    ds_read_b128 v[112:115], v1 offset:12288
    ds_read_b64_tr_b16 v[148:149], v5 offset:20480
    ds_read_b64_tr_b16 v[150:151], v5 offset:21504
    ds_read_b128 v[100:103], v2 offset:8192
    ds_read_b128 v[116:119], v2 offset:12288
    v_mfma_f32_32x32x16_bf16 v[32:47], v[136:139], v[72:75], v[32:47]
    v_mfma_f32_32x32x16_bf16 v[48:63], v[136:139], v[88:91], v[48:63]
    ds_read_b64_tr_b16 v[152:153], v5 offset:24576
    ds_read_b64_tr_b16 v[154:155], v5 offset:25600
    ds_read_b128 v[104:107], v3 offset:8192
    ds_read_b128 v[120:123], v3 offset:12288
    v_mfma_f32_32x32x16_bf16 v[32:47], v[140:143], v[76:79], v[32:47]
    v_mfma_f32_32x32x16_bf16 v[48:63], v[140:143], v[92:95], v[48:63]
    s_waitcnt lgkmcnt(8)
    ds_read_b64_tr_b16 v[156:157], v5 offset:28672
    ds_read_b64_tr_b16 v[158:159], v5 offset:29696
    ds_read_b128 v[108:111], v4 offset:8192
    ds_read_b128 v[124:127], v4 offset:12288
    v_mfma_f32_32x32x16_bf16 v[32:47], v[144:147], v[96:99], v[32:47]
    v_mfma_f32_32x32x16_bf16 v[48:63], v[144:147], v[112:115], v[48:63]
    s_waitcnt lgkmcnt(8)
    v_mfma_f32_32x32x16_bf16 v[32:47], v[148:151], v[100:103], v[32:47]
    v_mfma_f32_32x32x16_bf16 v[48:63], v[148:151], v[116:119], v[48:63]
    s_waitcnt lgkmcnt(0)
    s_barrier
    ds_read_b64_tr_b16 v[128:129], v5 offset:32768
    ds_read_b64_tr_b16 v[130:131], v5 offset:33792
    ds_read_b128 v[64:67], v1 offset:16384
    ds_read_b128 v[80:83], v1 offset:20480
    ds_read_b64_tr_b16 v[132:133], v5 offset:36864
    ds_read_b64_tr_b16 v[134:135], v5 offset:37888
    ds_read_b128 v[68:71], v2 offset:16384
    ds_read_b128 v[84:87], v2 offset:20480
    v_mfma_f32_32x32x16_bf16 v[32:47], v[152:155], v[104:107], v[32:47]
    v_mfma_f32_32x32x16_bf16 v[48:63], v[152:155], v[120:123], v[48:63]
    ds_read_b64_tr_b16 v[136:137], v5 offset:40960
    ds_read_b64_tr_b16 v[138:139], v5 offset:41984
    ds_read_b128 v[72:75], v3 offset:16384
    ds_read_b128 v[88:91], v3 offset:20480
    v_mfma_f32_32x32x16_bf16 v[32:47], v[156:159], v[108:111], v[32:47]
    v_mfma_f32_32x32x16_bf16 v[48:63], v[156:159], v[124:127], v[48:63]
    s_waitcnt lgkmcnt(8)
    ds_read_b64_tr_b16 v[140:141], v5 offset:45056
    ds_read_b64_tr_b16 v[142:143], v5 offset:46080
    ds_read_b128 v[76:79], v4 offset:16384
    ds_read_b128 v[92:95], v4 offset:20480
    v_mfma_f32_32x32x16_bf16 v[32:47], v[128:131], v[64:67], v[32:47]
    v_mfma_f32_32x32x16_bf16 v[48:63], v[128:131], v[80:83], v[48:63]
    s_waitcnt lgkmcnt(8)
    v_mfma_f32_32x32x16_bf16 v[32:47], v[132:135], v[68:71], v[32:47]
    v_mfma_f32_32x32x16_bf16 v[48:63], v[132:135], v[84:87], v[48:63]
    s_waitcnt lgkmcnt(0)
    s_barrier
    ds_read_b64_tr_b16 v[144:145], v5 offset:49152
    ds_read_b64_tr_b16 v[146:147], v5 offset:50176
    ds_read_b128 v[96:99], v1 offset:24576
    ds_read_b128 v[112:115], v1 offset:28672
    ds_read_b64_tr_b16 v[148:149], v5 offset:53248
    ds_read_b64_tr_b16 v[150:151], v5 offset:54272
    ds_read_b128 v[100:103], v2 offset:24576
    ds_read_b128 v[116:119], v2 offset:28672
    v_mfma_f32_32x32x16_bf16 v[32:47], v[136:139], v[72:75], v[32:47]
    v_mfma_f32_32x32x16_bf16 v[48:63], v[136:139], v[88:91], v[48:63]
    ds_read_b64_tr_b16 v[152:153], v5 offset:57344
    ds_read_b64_tr_b16 v[154:155], v5 offset:58368
    ds_read_b128 v[104:107], v3 offset:24576
    ds_read_b128 v[120:123], v3 offset:28672
    v_mfma_f32_32x32x16_bf16 v[32:47], v[140:143], v[76:79], v[32:47]
    v_mfma_f32_32x32x16_bf16 v[48:63], v[140:143], v[92:95], v[48:63]
    s_waitcnt lgkmcnt(8)
    ds_read_b64_tr_b16 v[156:157], v5 offset:61440
    ds_read_b64_tr_b16 v[158:159], v5 offset:62464
    ds_read_b128 v[108:111], v4 offset:24576
    ds_read_b128 v[124:127], v4 offset:28672
    v_mfma_f32_32x32x16_bf16 v[32:47], v[144:147], v[96:99], v[32:47]
    v_mfma_f32_32x32x16_bf16 v[48:63], v[144:147], v[112:115], v[48:63]
    s_waitcnt lgkmcnt(8)
    v_mfma_f32_32x32x16_bf16 v[32:47], v[148:151], v[100:103], v[32:47]
    v_mfma_f32_32x32x16_bf16 v[48:63], v[148:151], v[116:119], v[48:63]
    s_waitcnt lgkmcnt(0)
    s_barrier
    ds_read_b64_tr_b16 v[128:129], v6 offset:0
    ds_read_b64_tr_b16 v[130:131], v6 offset:1024
    ds_read_b128 v[64:67], v1 offset:0
    ds_read_b128 v[80:83], v1 offset:4096
    ds_read_b64_tr_b16 v[132:133], v6 offset:4096
    ds_read_b64_tr_b16 v[134:135], v6 offset:5120
    ds_read_b128 v[68:71], v2 offset:0
    ds_read_b128 v[84:87], v2 offset:4096
    v_mfma_f32_32x32x16_bf16 v[32:47], v[152:155], v[104:107], v[32:47]
    v_mfma_f32_32x32x16_bf16 v[48:63], v[152:155], v[120:123], v[48:63]
    ds_read_b64_tr_b16 v[136:137], v6 offset:8192
    ds_read_b64_tr_b16 v[138:139], v6 offset:9216
    ds_read_b128 v[72:75], v3 offset:0
    ds_read_b128 v[88:91], v3 offset:4096
    v_mfma_f32_32x32x16_bf16 v[32:47], v[156:159], v[108:111], v[32:47]
    v_mfma_f32_32x32x16_bf16 v[48:63], v[156:159], v[124:127], v[48:63]
    s_waitcnt lgkmcnt(8)
    ds_read_b64_tr_b16 v[140:141], v6 offset:12288
    ds_read_b64_tr_b16 v[142:143], v6 offset:13312
    ds_read_b128 v[76:79], v4 offset:0
    ds_read_b128 v[92:95], v4 offset:4096
    v_mfma_f32_32x32x16_bf16 v[32:47], v[128:131], v[64:67], v[32:47]
    v_mfma_f32_32x32x16_bf16 v[48:63], v[128:131], v[80:83], v[48:63]
    s_waitcnt lgkmcnt(8)
    v_mfma_f32_32x32x16_bf16 v[32:47], v[132:135], v[68:71], v[32:47]
    v_mfma_f32_32x32x16_bf16 v[48:63], v[132:135], v[84:87], v[48:63]
    s_waitcnt lgkmcnt(0)
    s_barrier
    ds_read_b64_tr_b16 v[144:145], v6 offset:16384
    ds_read_b64_tr_b16 v[146:147], v6 offset:17408
    ds_read_b128 v[96:99], v1 offset:8192
    ds_read_b128 v[112:115], v1 offset:12288
    ds_read_b64_tr_b16 v[148:149], v6 offset:20480
    ds_read_b64_tr_b16 v[150:151], v6 offset:21504
    ds_read_b128 v[100:103], v2 offset:8192
    ds_read_b128 v[116:119], v2 offset:12288
    v_mfma_f32_32x32x16_bf16 v[32:47], v[136:139], v[72:75], v[32:47]
    v_mfma_f32_32x32x16_bf16 v[48:63], v[136:139], v[88:91], v[48:63]
    ds_read_b64_tr_b16 v[152:153], v6 offset:24576
    ds_read_b64_tr_b16 v[154:155], v6 offset:25600
    ds_read_b128 v[104:107], v3 offset:8192
    ds_read_b128 v[120:123], v3 offset:12288
    v_mfma_f32_32x32x16_bf16 v[32:47], v[140:143], v[76:79], v[32:47]
    v_mfma_f32_32x32x16_bf16 v[48:63], v[140:143], v[92:95], v[48:63]
    s_waitcnt lgkmcnt(8)
    ds_read_b64_tr_b16 v[156:157], v6 offset:28672
    ds_read_b64_tr_b16 v[158:159], v6 offset:29696
    ds_read_b128 v[108:111], v4 offset:8192
    ds_read_b128 v[124:127], v4 offset:12288
    v_mfma_f32_32x32x16_bf16 v[32:47], v[144:147], v[96:99], v[32:47]
    v_mfma_f32_32x32x16_bf16 v[48:63], v[144:147], v[112:115], v[48:63]
    s_waitcnt lgkmcnt(8)
    v_mfma_f32_32x32x16_bf16 v[32:47], v[148:151], v[100:103], v[32:47]
    v_mfma_f32_32x32x16_bf16 v[48:63], v[148:151], v[116:119], v[48:63]
    s_waitcnt lgkmcnt(0)
    s_barrier
    ds_read_b64_tr_b16 v[128:129], v6 offset:32768
    ds_read_b64_tr_b16 v[130:131], v6 offset:33792
    ds_read_b128 v[64:67], v1 offset:16384
    ds_read_b128 v[80:83], v1 offset:20480
    ds_read_b64_tr_b16 v[132:133], v6 offset:36864
    ds_read_b64_tr_b16 v[134:135], v6 offset:37888
    ds_read_b128 v[68:71], v2 offset:16384
    ds_read_b128 v[84:87], v2 offset:20480
    v_mfma_f32_32x32x16_bf16 v[32:47], v[152:155], v[104:107], v[32:47]
    v_mfma_f32_32x32x16_bf16 v[48:63], v[152:155], v[120:123], v[48:63]
    ds_read_b64_tr_b16 v[136:137], v6 offset:40960
    ds_read_b64_tr_b16 v[138:139], v6 offset:41984
    ds_read_b128 v[72:75], v3 offset:16384
    ds_read_b128 v[88:91], v3 offset:20480
    v_mfma_f32_32x32x16_bf16 v[32:47], v[156:159], v[108:111], v[32:47]
    v_mfma_f32_32x32x16_bf16 v[48:63], v[156:159], v[124:127], v[48:63]
    s_waitcnt lgkmcnt(8)
    ds_read_b64_tr_b16 v[140:141], v6 offset:45056
    ds_read_b64_tr_b16 v[142:143], v6 offset:46080
    ds_read_b128 v[76:79], v4 offset:16384
    ds_read_b128 v[92:95], v4 offset:20480
    v_mfma_f32_32x32x16_bf16 v[32:47], v[128:131], v[64:67], v[32:47]
    v_mfma_f32_32x32x16_bf16 v[48:63], v[128:131], v[80:83], v[48:63]
    s_waitcnt lgkmcnt(8)
    v_mfma_f32_32x32x16_bf16 v[32:47], v[132:135], v[68:71], v[32:47]
    v_mfma_f32_32x32x16_bf16 v[48:63], v[132:135], v[84:87], v[48:63]
    s_waitcnt lgkmcnt(0)
    s_barrier
    ds_read_b64_tr_b16 v[144:145], v6 offset:49152
    ds_read_b64_tr_b16 v[146:147], v6 offset:50176
    ds_read_b128 v[96:99], v1 offset:24576
    ds_read_b128 v[112:115], v1 offset:28672
    ds_read_b64_tr_b16 v[148:149], v6 offset:53248
    ds_read_b64_tr_b16 v[150:151], v6 offset:54272
    ds_read_b128 v[100:103], v2 offset:24576
    ds_read_b128 v[116:119], v2 offset:28672
    v_mfma_f32_32x32x16_bf16 v[32:47], v[136:139], v[72:75], v[32:47]
    v_mfma_f32_32x32x16_bf16 v[48:63], v[136:139], v[88:91], v[48:63]
    ds_read_b64_tr_b16 v[152:153], v6 offset:57344
    ds_read_b64_tr_b16 v[154:155], v6 offset:58368
    ds_read_b128 v[104:107], v3 offset:24576
    ds_read_b128 v[120:123], v3 offset:28672
    v_mfma_f32_32x32x16_bf16 v[32:47], v[140:143], v[76:79], v[32:47]
    v_mfma_f32_32x32x16_bf16 v[48:63], v[140:143], v[92:95], v[48:63]
    s_waitcnt lgkmcnt(8)
    ds_read_b64_tr_b16 v[156:157], v6 offset:61440
    ds_read_b64_tr_b16 v[158:159], v6 offset:62464
    ds_read_b128 v[108:111], v4 offset:24576
    ds_read_b128 v[124:127], v4 offset:28672
    v_mfma_f32_32x32x16_bf16 v[32:47], v[144:147], v[96:99], v[32:47]
    v_mfma_f32_32x32x16_bf16 v[48:63], v[144:147], v[112:115], v[48:63]
    s_waitcnt lgkmcnt(8)
    v_mfma_f32_32x32x16_bf16 v[32:47], v[148:151], v[100:103], v[32:47]
    v_mfma_f32_32x32x16_bf16 v[48:63], v[148:151], v[116:119], v[48:63]
    s_waitcnt lgkmcnt(0)
    s_barrier
    ds_read_b64_tr_b16 v[128:129], v5 offset:0
    ds_read_b64_tr_b16 v[130:131], v5 offset:1024
    ds_read_b128 v[64:67], v1 offset:0
    ds_read_b128 v[80:83], v1 offset:4096
    ds_read_b64_tr_b16 v[132:133], v5 offset:4096
    ds_read_b64_tr_b16 v[134:135], v5 offset:5120
    ds_read_b128 v[68:71], v2 offset:0
    ds_read_b128 v[84:87], v2 offset:4096
    v_mfma_f32_32x32x16_bf16 v[32:47], v[152:155], v[104:107], v[32:47]
    v_mfma_f32_32x32x16_bf16 v[48:63], v[152:155], v[120:123], v[48:63]
    ds_read_b64_tr_b16 v[136:137], v5 offset:8192
    ds_read_b64_tr_b16 v[138:139], v5 offset:9216
    ds_read_b128 v[72:75], v3 offset:0
    ds_read_b128 v[88:91], v3 offset:4096
    v_mfma_f32_32x32x16_bf16 v[32:47], v[156:159], v[108:111], v[32:47]
    v_mfma_f32_32x32x16_bf16 v[48:63], v[156:159], v[124:127], v[48:63]
    s_waitcnt lgkmcnt(8)
    ds_read_b64_tr_b16 v[140:141], v5 offset:12288
    ds_read_b64_tr_b16 v[142:143], v5 offset:13312
    ds_read_b128 v[76:79], v4 offset:0
    ds_read_b128 v[92:95], v4 offset:4096
    v_mfma_f32_32x32x16_bf16 v[32:47], v[128:131], v[64:67], v[32:47]
    v_mfma_f32_32x32x16_bf16 v[48:63], v[128:131], v[80:83], v[48:63]
    s_waitcnt lgkmcnt(8)
    v_mfma_f32_32x32x16_bf16 v[32:47], v[132:135], v[68:71], v[32:47]
    v_mfma_f32_32x32x16_bf16 v[48:63], v[132:135], v[84:87], v[48:63]
    s_waitcnt lgkmcnt(0)
    s_barrier
    ds_read_b64_tr_b16 v[144:145], v5 offset:16384
    ds_read_b64_tr_b16 v[146:147], v5 offset:17408
    ds_read_b128 v[96:99], v1 offset:8192
    ds_read_b128 v[112:115], v1 offset:12288
    ds_read_b64_tr_b16 v[148:149], v5 offset:20480
    ds_read_b64_tr_b16 v[150:151], v5 offset:21504
    ds_read_b128 v[100:103], v2 offset:8192
    ds_read_b128 v[116:119], v2 offset:12288
    v_mfma_f32_32x32x16_bf16 v[32:47], v[136:139], v[72:75], v[32:47]
    v_mfma_f32_32x32x16_bf16 v[48:63], v[136:139], v[88:91], v[48:63]
    ds_read_b64_tr_b16 v[152:153], v5 offset:24576
    ds_read_b64_tr_b16 v[154:155], v5 offset:25600
    ds_read_b128 v[104:107], v3 offset:8192
    ds_read_b128 v[120:123], v3 offset:12288
    v_mfma_f32_32x32x16_bf16 v[32:47], v[140:143], v[76:79], v[32:47]
    v_mfma_f32_32x32x16_bf16 v[48:63], v[140:143], v[92:95], v[48:63]
    s_waitcnt lgkmcnt(8)
    ds_read_b64_tr_b16 v[156:157], v5 offset:28672
    ds_read_b64_tr_b16 v[158:159], v5 offset:29696
    ds_read_b128 v[108:111], v4 offset:8192
    ds_read_b128 v[124:127], v4 offset:12288
    v_mfma_f32_32x32x16_bf16 v[32:47], v[144:147], v[96:99], v[32:47]
    v_mfma_f32_32x32x16_bf16 v[48:63], v[144:147], v[112:115], v[48:63]
    s_waitcnt lgkmcnt(8)
    v_mfma_f32_32x32x16_bf16 v[32:47], v[148:151], v[100:103], v[32:47]
    v_mfma_f32_32x32x16_bf16 v[48:63], v[148:151], v[116:119], v[48:63]
    s_waitcnt lgkmcnt(0)
    s_barrier
    ds_read_b64_tr_b16 v[128:129], v5 offset:32768
    ds_read_b64_tr_b16 v[130:131], v5 offset:33792
    ds_read_b128 v[64:67], v1 offset:16384
    ds_read_b128 v[80:83], v1 offset:20480
    ds_read_b64_tr_b16 v[132:133], v5 offset:36864
    ds_read_b64_tr_b16 v[134:135], v5 offset:37888
    ds_read_b128 v[68:71], v2 offset:16384
    ds_read_b128 v[84:87], v2 offset:20480
    v_mfma_f32_32x32x16_bf16 v[32:47], v[152:155], v[104:107], v[32:47]
    v_mfma_f32_32x32x16_bf16 v[48:63], v[152:155], v[120:123], v[48:63]
    ds_read_b64_tr_b16 v[136:137], v5 offset:40960
    ds_read_b64_tr_b16 v[138:139], v5 offset:41984
    ds_read_b128 v[72:75], v3 offset:16384
    ds_read_b128 v[88:91], v3 offset:20480
    v_mfma_f32_32x32x16_bf16 v[32:47], v[156:159], v[108:111], v[32:47]
    v_mfma_f32_32x32x16_bf16 v[48:63], v[156:159], v[124:127], v[48:63]
    s_waitcnt lgkmcnt(8)
    ds_read_b64_tr_b16 v[140:141], v5 offset:45056
    ds_read_b64_tr_b16 v[142:143], v5 offset:46080
    ds_read_b128 v[76:79], v4 offset:16384
    ds_read_b128 v[92:95], v4 offset:20480
    v_mfma_f32_32x32x16_bf16 v[32:47], v[128:131], v[64:67], v[32:47]
    v_mfma_f32_32x32x16_bf16 v[48:63], v[128:131], v[80:83], v[48:63]
    s_waitcnt lgkmcnt(8)
    v_mfma_f32_32x32x16_bf16 v[32:47], v[132:135], v[68:71], v[32:47]
    v_mfma_f32_32x32x16_bf16 v[48:63], v[132:135], v[84:87], v[48:63]
    s_waitcnt lgkmcnt(0)
    s_barrier
    ds_read_b64_tr_b16 v[144:145], v5 offset:49152
    ds_read_b64_tr_b16 v[146:147], v5 offset:50176
    ds_read_b128 v[96:99], v1 offset:24576
    ds_read_b128 v[112:115], v1 offset:28672
    ds_read_b64_tr_b16 v[148:149], v5 offset:53248
    ds_read_b64_tr_b16 v[150:151], v5 offset:54272
    ds_read_b128 v[100:103], v2 offset:24576
    ds_read_b128 v[116:119], v2 offset:28672
    v_mfma_f32_32x32x16_bf16 v[32:47], v[136:139], v[72:75], v[32:47]
    v_mfma_f32_32x32x16_bf16 v[48:63], v[136:139], v[88:91], v[48:63]
    ds_read_b64_tr_b16 v[152:153], v5 offset:57344
    ds_read_b64_tr_b16 v[154:155], v5 offset:58368
    ds_read_b128 v[104:107], v3 offset:24576
    ds_read_b128 v[120:123], v3 offset:28672
    v_mfma_f32_32x32x16_bf16 v[32:47], v[140:143], v[76:79], v[32:47]
    v_mfma_f32_32x32x16_bf16 v[48:63], v[140:143], v[92:95], v[48:63]
    s_waitcnt lgkmcnt(8)
    ds_read_b64_tr_b16 v[156:157], v5 offset:61440
    ds_read_b64_tr_b16 v[158:159], v5 offset:62464
    ds_read_b128 v[108:111], v4 offset:24576
    ds_read_b128 v[124:127], v4 offset:28672
    v_mfma_f32_32x32x16_bf16 v[32:47], v[144:147], v[96:99], v[32:47]
    v_mfma_f32_32x32x16_bf16 v[48:63], v[144:147], v[112:115], v[48:63]
    s_waitcnt lgkmcnt(8)
    v_mfma_f32_32x32x16_bf16 v[32:47], v[148:151], v[100:103], v[32:47]
    v_mfma_f32_32x32x16_bf16 v[48:63], v[148:151], v[116:119], v[48:63]
    s_waitcnt lgkmcnt(0)
    s_barrier
    ds_read_b64_tr_b16 v[128:129], v6 offset:0
    ds_read_b64_tr_b16 v[130:131], v6 offset:1024
    ds_read_b128 v[64:67], v1 offset:0
    ds_read_b128 v[80:83], v1 offset:4096
    ds_read_b64_tr_b16 v[132:133], v6 offset:4096
    ds_read_b64_tr_b16 v[134:135], v6 offset:5120
    ds_read_b128 v[68:71], v2 offset:0
    ds_read_b128 v[84:87], v2 offset:4096
    v_mfma_f32_32x32x16_bf16 v[32:47], v[152:155], v[104:107], v[32:47]
    v_mfma_f32_32x32x16_bf16 v[48:63], v[152:155], v[120:123], v[48:63]
    ds_read_b64_tr_b16 v[136:137], v6 offset:8192
    ds_read_b64_tr_b16 v[138:139], v6 offset:9216
    ds_read_b128 v[72:75], v3 offset:0
    ds_read_b128 v[88:91], v3 offset:4096
    v_mfma_f32_32x32x16_bf16 v[32:47], v[156:159], v[108:111], v[32:47]
    v_mfma_f32_32x32x16_bf16 v[48:63], v[156:159], v[124:127], v[48:63]
    s_waitcnt lgkmcnt(8)
    ds_read_b64_tr_b16 v[140:141], v6 offset:12288
    ds_read_b64_tr_b16 v[142:143], v6 offset:13312
    ds_read_b128 v[76:79], v4 offset:0
    ds_read_b128 v[92:95], v4 offset:4096
    v_mfma_f32_32x32x16_bf16 v[32:47], v[128:131], v[64:67], v[32:47]
    v_mfma_f32_32x32x16_bf16 v[48:63], v[128:131], v[80:83], v[48:63]
    s_waitcnt lgkmcnt(8)
    v_mfma_f32_32x32x16_bf16 v[32:47], v[132:135], v[68:71], v[32:47]
    v_mfma_f32_32x32x16_bf16 v[48:63], v[132:135], v[84:87], v[48:63]
    s_waitcnt lgkmcnt(0)
    s_barrier
    ds_read_b64_tr_b16 v[144:145], v6 offset:16384
    ds_read_b64_tr_b16 v[146:147], v6 offset:17408
    ds_read_b128 v[96:99], v1 offset:8192
    ds_read_b128 v[112:115], v1 offset:12288
    ds_read_b64_tr_b16 v[148:149], v6 offset:20480
    ds_read_b64_tr_b16 v[150:151], v6 offset:21504
    ds_read_b128 v[100:103], v2 offset:8192
    ds_read_b128 v[116:119], v2 offset:12288
    v_mfma_f32_32x32x16_bf16 v[32:47], v[136:139], v[72:75], v[32:47]
    v_mfma_f32_32x32x16_bf16 v[48:63], v[136:139], v[88:91], v[48:63]
    ds_read_b64_tr_b16 v[152:153], v6 offset:24576
    ds_read_b64_tr_b16 v[154:155], v6 offset:25600
    ds_read_b128 v[104:107], v3 offset:8192
    ds_read_b128 v[120:123], v3 offset:12288
    v_mfma_f32_32x32x16_bf16 v[32:47], v[140:143], v[76:79], v[32:47]
    v_mfma_f32_32x32x16_bf16 v[48:63], v[140:143], v[92:95], v[48:63]
    s_waitcnt lgkmcnt(8)
    ds_read_b64_tr_b16 v[156:157], v6 offset:28672
    ds_read_b64_tr_b16 v[158:159], v6 offset:29696
    ds_read_b128 v[108:111], v4 offset:8192
    ds_read_b128 v[124:127], v4 offset:12288
    v_mfma_f32_32x32x16_bf16 v[32:47], v[144:147], v[96:99], v[32:47]
    v_mfma_f32_32x32x16_bf16 v[48:63], v[144:147], v[112:115], v[48:63]
    s_waitcnt lgkmcnt(8)
    v_mfma_f32_32x32x16_bf16 v[32:47], v[148:151], v[100:103], v[32:47]
    v_mfma_f32_32x32x16_bf16 v[48:63], v[148:151], v[116:119], v[48:63]
    s_waitcnt lgkmcnt(0)
    s_barrier
    ds_read_b64_tr_b16 v[128:129], v6 offset:32768
    ds_read_b64_tr_b16 v[130:131], v6 offset:33792
    ds_read_b128 v[64:67], v1 offset:16384
    ds_read_b128 v[80:83], v1 offset:20480
    ds_read_b64_tr_b16 v[132:133], v6 offset:36864
    ds_read_b64_tr_b16 v[134:135], v6 offset:37888
    ds_read_b128 v[68:71], v2 offset:16384
    ds_read_b128 v[84:87], v2 offset:20480
    v_mfma_f32_32x32x16_bf16 v[32:47], v[152:155], v[104:107], v[32:47]
    v_mfma_f32_32x32x16_bf16 v[48:63], v[152:155], v[120:123], v[48:63]
    ds_read_b64_tr_b16 v[136:137], v6 offset:40960
    ds_read_b64_tr_b16 v[138:139], v6 offset:41984
    ds_read_b128 v[72:75], v3 offset:16384
    ds_read_b128 v[88:91], v3 offset:20480
    v_mfma_f32_32x32x16_bf16 v[32:47], v[156:159], v[108:111], v[32:47]
    v_mfma_f32_32x32x16_bf16 v[48:63], v[156:159], v[124:127], v[48:63]
    s_waitcnt lgkmcnt(8)
    ds_read_b64_tr_b16 v[140:141], v6 offset:45056
    ds_read_b64_tr_b16 v[142:143], v6 offset:46080
    ds_read_b128 v[76:79], v4 offset:16384
    ds_read_b128 v[92:95], v4 offset:20480
    v_mfma_f32_32x32x16_bf16 v[32:47], v[128:131], v[64:67], v[32:47]
    v_mfma_f32_32x32x16_bf16 v[48:63], v[128:131], v[80:83], v[48:63]
    s_waitcnt lgkmcnt(8)
    v_mfma_f32_32x32x16_bf16 v[32:47], v[132:135], v[68:71], v[32:47]
    v_mfma_f32_32x32x16_bf16 v[48:63], v[132:135], v[84:87], v[48:63]
    s_waitcnt lgkmcnt(0)
    s_barrier
    ds_read_b64_tr_b16 v[144:145], v6 offset:49152
    ds_read_b64_tr_b16 v[146:147], v6 offset:50176
    ds_read_b128 v[96:99], v1 offset:24576
    ds_read_b128 v[112:115], v1 offset:28672
    ds_read_b64_tr_b16 v[148:149], v6 offset:53248
    ds_read_b64_tr_b16 v[150:151], v6 offset:54272
    ds_read_b128 v[100:103], v2 offset:24576
    ds_read_b128 v[116:119], v2 offset:28672
    v_mfma_f32_32x32x16_bf16 v[32:47], v[136:139], v[72:75], v[32:47]
    v_mfma_f32_32x32x16_bf16 v[48:63], v[136:139], v[88:91], v[48:63]
    ds_read_b64_tr_b16 v[152:153], v6 offset:57344
    ds_read_b64_tr_b16 v[154:155], v6 offset:58368
    ds_read_b128 v[104:107], v3 offset:24576
    ds_read_b128 v[120:123], v3 offset:28672
    v_mfma_f32_32x32x16_bf16 v[32:47], v[140:143], v[76:79], v[32:47]
    v_mfma_f32_32x32x16_bf16 v[48:63], v[140:143], v[92:95], v[48:63]
    s_waitcnt lgkmcnt(8)
    ds_read_b64_tr_b16 v[156:157], v6 offset:61440
    ds_read_b64_tr_b16 v[158:159], v6 offset:62464
    ds_read_b128 v[108:111], v4 offset:24576
    ds_read_b128 v[124:127], v4 offset:28672
    v_mfma_f32_32x32x16_bf16 v[32:47], v[144:147], v[96:99], v[32:47]
    v_mfma_f32_32x32x16_bf16 v[48:63], v[144:147], v[112:115], v[48:63]
    s_waitcnt lgkmcnt(8)
    v_mfma_f32_32x32x16_bf16 v[32:47], v[148:151], v[100:103], v[32:47]
    v_mfma_f32_32x32x16_bf16 v[48:63], v[148:151], v[116:119], v[48:63]
    s_waitcnt lgkmcnt(0)
    s_barrier
    ds_read_b64_tr_b16 v[128:129], v5 offset:0
    ds_read_b64_tr_b16 v[130:131], v5 offset:1024
    ds_read_b128 v[64:67], v1 offset:0
    ds_read_b128 v[80:83], v1 offset:4096
    ds_read_b64_tr_b16 v[132:133], v5 offset:4096
    ds_read_b64_tr_b16 v[134:135], v5 offset:5120
    ds_read_b128 v[68:71], v2 offset:0
    ds_read_b128 v[84:87], v2 offset:4096
    v_mfma_f32_32x32x16_bf16 v[32:47], v[152:155], v[104:107], v[32:47]
    v_mfma_f32_32x32x16_bf16 v[48:63], v[152:155], v[120:123], v[48:63]
    ds_read_b64_tr_b16 v[136:137], v5 offset:8192
    ds_read_b64_tr_b16 v[138:139], v5 offset:9216
    ds_read_b128 v[72:75], v3 offset:0
    ds_read_b128 v[88:91], v3 offset:4096
    v_mfma_f32_32x32x16_bf16 v[32:47], v[156:159], v[108:111], v[32:47]
    v_mfma_f32_32x32x16_bf16 v[48:63], v[156:159], v[124:127], v[48:63]
    s_waitcnt lgkmcnt(8)
    ds_read_b64_tr_b16 v[140:141], v5 offset:12288
    ds_read_b64_tr_b16 v[142:143], v5 offset:13312
    ds_read_b128 v[76:79], v4 offset:0
    ds_read_b128 v[92:95], v4 offset:4096
    v_mfma_f32_32x32x16_bf16 v[32:47], v[128:131], v[64:67], v[32:47]
    v_mfma_f32_32x32x16_bf16 v[48:63], v[128:131], v[80:83], v[48:63]
    s_waitcnt lgkmcnt(8)
    v_mfma_f32_32x32x16_bf16 v[32:47], v[132:135], v[68:71], v[32:47]
    v_mfma_f32_32x32x16_bf16 v[48:63], v[132:135], v[84:87], v[48:63]
    s_waitcnt lgkmcnt(0)
    s_barrier
    ds_read_b64_tr_b16 v[144:145], v5 offset:16384
    ds_read_b64_tr_b16 v[146:147], v5 offset:17408
    ds_read_b128 v[96:99], v1 offset:8192
    ds_read_b128 v[112:115], v1 offset:12288
    ds_read_b64_tr_b16 v[148:149], v5 offset:20480
    ds_read_b64_tr_b16 v[150:151], v5 offset:21504
    ds_read_b128 v[100:103], v2 offset:8192
    ds_read_b128 v[116:119], v2 offset:12288
    v_mfma_f32_32x32x16_bf16 v[32:47], v[136:139], v[72:75], v[32:47]
    v_mfma_f32_32x32x16_bf16 v[48:63], v[136:139], v[88:91], v[48:63]
    ds_read_b64_tr_b16 v[152:153], v5 offset:24576
    ds_read_b64_tr_b16 v[154:155], v5 offset:25600
    ds_read_b128 v[104:107], v3 offset:8192
    ds_read_b128 v[120:123], v3 offset:12288
    v_mfma_f32_32x32x16_bf16 v[32:47], v[140:143], v[76:79], v[32:47]
    v_mfma_f32_32x32x16_bf16 v[48:63], v[140:143], v[92:95], v[48:63]
    s_waitcnt lgkmcnt(8)
    ds_read_b64_tr_b16 v[156:157], v5 offset:28672
    ds_read_b64_tr_b16 v[158:159], v5 offset:29696
    ds_read_b128 v[108:111], v4 offset:8192
    ds_read_b128 v[124:127], v4 offset:12288
    v_mfma_f32_32x32x16_bf16 v[32:47], v[144:147], v[96:99], v[32:47]
    v_mfma_f32_32x32x16_bf16 v[48:63], v[144:147], v[112:115], v[48:63]
    s_waitcnt lgkmcnt(8)
    v_mfma_f32_32x32x16_bf16 v[32:47], v[148:151], v[100:103], v[32:47]
    v_mfma_f32_32x32x16_bf16 v[48:63], v[148:151], v[116:119], v[48:63]
    s_waitcnt lgkmcnt(0)
    v_mfma_f32_32x32x16_bf16 v[32:47], v[152:155], v[104:107], v[32:47]
    v_mfma_f32_32x32x16_bf16 v[48:63], v[152:155], v[120:123], v[48:63]
    v_mfma_f32_32x32x16_bf16 v[32:47], v[156:159], v[108:111], v[32:47]
    v_mfma_f32_32x32x16_bf16 v[48:63], v[156:159], v[124:127], v[48:63]
    v_mov_b32 v12, s66
    v_mov_b32 v13, s66
    v_mov_b32 v14, s67
    v_mov_b32 v15, s67
    s_nop 6
    v_pk_mul_f32 v[64:65], v[32:33], v[32:33]
    v_pk_mul_f32 v[66:67], v[34:35], v[34:35]
    v_pk_mul_f32 v[68:69], v[36:37], v[36:37]
    v_pk_mul_f32 v[70:71], v[38:39], v[38:39]
    v_pk_mul_f32 v[72:73], v[40:41], v[40:41]
    v_pk_mul_f32 v[74:75], v[42:43], v[42:43]
    v_pk_mul_f32 v[76:77], v[44:45], v[44:45]
    v_pk_mul_f32 v[78:79], v[46:47], v[46:47]
    v_pk_fma_f32 v[64:65], v[64:65], v[14:15], v[12:13]
    v_pk_fma_f32 v[66:67], v[66:67], v[14:15], v[12:13]
    v_pk_fma_f32 v[68:69], v[68:69], v[14:15], v[12:13]
    v_pk_fma_f32 v[70:71], v[70:71], v[14:15], v[12:13]
    v_pk_fma_f32 v[72:73], v[72:73], v[14:15], v[12:13]
    v_pk_fma_f32 v[74:75], v[74:75], v[14:15], v[12:13]
    v_pk_fma_f32 v[76:77], v[76:77], v[14:15], v[12:13]
    v_pk_fma_f32 v[78:79], v[78:79], v[14:15], v[12:13]
    v_pk_mul_f32 v[64:65], v[64:65], v[32:33]
    v_pk_mul_f32 v[66:67], v[66:67], v[34:35]
    v_pk_mul_f32 v[68:69], v[68:69], v[36:37]
    v_pk_mul_f32 v[70:71], v[70:71], v[38:39]
    v_pk_mul_f32 v[72:73], v[72:73], v[40:41]
    v_pk_mul_f32 v[74:75], v[74:75], v[42:43]
    v_pk_mul_f32 v[76:77], v[76:77], v[44:45]
    v_pk_mul_f32 v[78:79], v[78:79], v[46:47]
    v_exp_f32 v64, v64
    v_exp_f32 v66, v66
    v_exp_f32 v68, v68
    v_exp_f32 v70, v70
    v_exp_f32 v72, v72
    v_exp_f32 v74, v74
    v_exp_f32 v76, v76
    v_exp_f32 v78, v78
    v_exp_f32 v65, v65
    v_exp_f32 v67, v67
    v_exp_f32 v69, v69
    v_exp_f32 v71, v71
    v_exp_f32 v73, v73
    v_exp_f32 v75, v75
    v_exp_f32 v77, v77
    v_exp_f32 v79, v79
    v_pk_mul_f32 v[32:33], v[32:33], v[16:17]
    v_pk_mul_f32 v[34:35], v[34:35], v[18:19]
    v_pk_mul_f32 v[36:37], v[36:37], v[20:21]
    v_pk_mul_f32 v[38:39], v[38:39], v[22:23]
    v_pk_mul_f32 v[40:41], v[40:41], v[24:25]
    v_pk_mul_f32 v[42:43], v[42:43], v[26:27]
    v_pk_mul_f32 v[44:45], v[44:45], v[28:29]
    v_pk_mul_f32 v[46:47], v[46:47], v[30:31]
    v_pk_add_f32 v[64:65], v[64:65], 1.0 op_sel_hi:[1,0]
    v_pk_add_f32 v[66:67], v[66:67], 1.0 op_sel_hi:[1,0]
    v_pk_add_f32 v[68:69], v[68:69], 1.0 op_sel_hi:[1,0]
    v_pk_add_f32 v[70:71], v[70:71], 1.0 op_sel_hi:[1,0]
    v_pk_add_f32 v[72:73], v[72:73], 1.0 op_sel_hi:[1,0]
    v_pk_add_f32 v[74:75], v[74:75], 1.0 op_sel_hi:[1,0]
    v_pk_add_f32 v[76:77], v[76:77], 1.0 op_sel_hi:[1,0]
    v_pk_add_f32 v[78:79], v[78:79], 1.0 op_sel_hi:[1,0]
    v_rcp_f32 v64, v64
    v_rcp_f32 v66, v66
    v_rcp_f32 v68, v68
    v_rcp_f32 v70, v70
    v_rcp_f32 v72, v72
    v_rcp_f32 v74, v74
    v_rcp_f32 v76, v76
    v_rcp_f32 v78, v78
    v_rcp_f32 v65, v65
    v_rcp_f32 v67, v67
    v_rcp_f32 v69, v69
    v_rcp_f32 v71, v71
    v_rcp_f32 v73, v73
    v_rcp_f32 v75, v75
    v_rcp_f32 v77, v77
    v_rcp_f32 v79, v79
    v_pk_mul_f32 v[8:9], v[32:33], v[64:65]
    v_pk_fma_f32 v[8:9], v[34:35], v[66:67], v[8:9]
    v_pk_fma_f32 v[8:9], v[36:37], v[68:69], v[8:9]
    v_pk_fma_f32 v[8:9], v[38:39], v[70:71], v[8:9]
    v_pk_fma_f32 v[8:9], v[40:41], v[72:73], v[8:9]
    v_pk_fma_f32 v[8:9], v[42:43], v[74:75], v[8:9]
    v_pk_fma_f32 v[8:9], v[44:45], v[76:77], v[8:9]
    v_pk_fma_f32 v[8:9], v[46:47], v[78:79], v[8:9]
    v_pk_mul_f32 v[64:65], v[48:49], v[48:49]
    v_pk_mul_f32 v[66:67], v[50:51], v[50:51]
    v_pk_mul_f32 v[68:69], v[52:53], v[52:53]
    v_pk_mul_f32 v[70:71], v[54:55], v[54:55]
    v_pk_mul_f32 v[72:73], v[56:57], v[56:57]
    v_pk_mul_f32 v[74:75], v[58:59], v[58:59]
    v_pk_mul_f32 v[76:77], v[60:61], v[60:61]
    v_pk_mul_f32 v[78:79], v[62:63], v[62:63]
    v_pk_fma_f32 v[64:65], v[64:65], v[14:15], v[12:13]
    v_pk_fma_f32 v[66:67], v[66:67], v[14:15], v[12:13]
    v_pk_fma_f32 v[68:69], v[68:69], v[14:15], v[12:13]
    v_pk_fma_f32 v[70:71], v[70:71], v[14:15], v[12:13]
    v_pk_fma_f32 v[72:73], v[72:73], v[14:15], v[12:13]
    v_pk_fma_f32 v[74:75], v[74:75], v[14:15], v[12:13]
    v_pk_fma_f32 v[76:77], v[76:77], v[14:15], v[12:13]
    v_pk_fma_f32 v[78:79], v[78:79], v[14:15], v[12:13]
    v_pk_mul_f32 v[64:65], v[64:65], v[48:49]
    v_pk_mul_f32 v[66:67], v[66:67], v[50:51]
    v_pk_mul_f32 v[68:69], v[68:69], v[52:53]
    v_pk_mul_f32 v[70:71], v[70:71], v[54:55]
    v_pk_mul_f32 v[72:73], v[72:73], v[56:57]
    v_pk_mul_f32 v[74:75], v[74:75], v[58:59]
    v_pk_mul_f32 v[76:77], v[76:77], v[60:61]
    v_pk_mul_f32 v[78:79], v[78:79], v[62:63]
    v_exp_f32 v64, v64
    v_exp_f32 v66, v66
    v_exp_f32 v68, v68
    v_exp_f32 v70, v70
    v_exp_f32 v72, v72
    v_exp_f32 v74, v74
    v_exp_f32 v76, v76
    v_exp_f32 v78, v78
    v_exp_f32 v65, v65
    v_exp_f32 v67, v67
    v_exp_f32 v69, v69
    v_exp_f32 v71, v71
    v_exp_f32 v73, v73
    v_exp_f32 v75, v75
    v_exp_f32 v77, v77
    v_exp_f32 v79, v79
    v_pk_mul_f32 v[48:49], v[48:49], v[16:17]
    v_pk_mul_f32 v[50:51], v[50:51], v[18:19]
    v_pk_mul_f32 v[52:53], v[52:53], v[20:21]
    v_pk_mul_f32 v[54:55], v[54:55], v[22:23]
    v_pk_mul_f32 v[56:57], v[56:57], v[24:25]
    v_pk_mul_f32 v[58:59], v[58:59], v[26:27]
    v_pk_mul_f32 v[60:61], v[60:61], v[28:29]
    v_pk_mul_f32 v[62:63], v[62:63], v[30:31]
    v_pk_add_f32 v[64:65], v[64:65], 1.0 op_sel_hi:[1,0]
    v_pk_add_f32 v[66:67], v[66:67], 1.0 op_sel_hi:[1,0]
    v_pk_add_f32 v[68:69], v[68:69], 1.0 op_sel_hi:[1,0]
    v_pk_add_f32 v[70:71], v[70:71], 1.0 op_sel_hi:[1,0]
    v_pk_add_f32 v[72:73], v[72:73], 1.0 op_sel_hi:[1,0]
    v_pk_add_f32 v[74:75], v[74:75], 1.0 op_sel_hi:[1,0]
    v_pk_add_f32 v[76:77], v[76:77], 1.0 op_sel_hi:[1,0]
    v_pk_add_f32 v[78:79], v[78:79], 1.0 op_sel_hi:[1,0]
    v_rcp_f32 v64, v64
    v_rcp_f32 v66, v66
    v_rcp_f32 v68, v68
    v_rcp_f32 v70, v70
    v_rcp_f32 v72, v72
    v_rcp_f32 v74, v74
    v_rcp_f32 v76, v76
    v_rcp_f32 v78, v78
    v_rcp_f32 v65, v65
    v_rcp_f32 v67, v67
    v_rcp_f32 v69, v69
    v_rcp_f32 v71, v71
    v_rcp_f32 v73, v73
    v_rcp_f32 v75, v75
    v_rcp_f32 v77, v77
    v_rcp_f32 v79, v79
    v_pk_mul_f32 v[10:11], v[48:49], v[64:65]
    v_pk_fma_f32 v[10:11], v[50:51], v[66:67], v[10:11]
    v_pk_fma_f32 v[10:11], v[52:53], v[68:69], v[10:11]
    v_pk_fma_f32 v[10:11], v[54:55], v[70:71], v[10:11]
    v_pk_fma_f32 v[10:11], v[56:57], v[72:73], v[10:11]
    v_pk_fma_f32 v[10:11], v[58:59], v[74:75], v[10:11]
    v_pk_fma_f32 v[10:11], v[60:61], v[76:77], v[10:11]
    v_pk_fma_f32 v[10:11], v[62:63], v[78:79], v[10:11]
    v_add_f32 v8, v8, v9
    v_add_f32 v10, v10, v11
    v_lshlrev_b32 v1, 2, v0
    v_add_u32 v1, 65536, v1
    v_permlane32_swap_b32 v8, v10
    v_add_f32 v8, v8, v10
    ds_write_b32 v1, v8
    s_waitcnt lgkmcnt(0)
    s_barrier
    s_cmp_lg_u32 s52, 0
    s_cbranch_scc1 L_end
    ds_read_b32 v17, v1 offset:256
    ds_read_b32 v18, v1 offset:512
    ds_read_b32 v19, v1 offset:768
    s_lshl_b32 s56, s54, 8
    v_lshl_add_u32 v5, v0, 2, s56
    s_waitcnt lgkmcnt(0)
    v_add_f32 v8, v8, v17
    v_add_f32 v18, v18, v19
    v_add_f32 v4, v8, v18
L_fin:
    s_mul_i32 s56, s53, 768
    buffer_store_dword v4, v5, s[48:51], s56 offen sc1
    v_mov_b32 v6, 1
    s_lshl_b32 s57, s53, 2
    v_mov_b32 v7, s57
    v_lshlrev_b32 v8, 2, v0
    s_waitcnt vmcnt(0)
    s_mov_b64 exec, 1
    buffer_atomic_add v6, v7, s[44:47], 0 offen sc0 sc1
    s_waitcnt vmcnt(0)
    v_readfirstlane_b32 s58, v6
    s_mov_b64 exec, -1
    s_cmp_lg_u32 s58, 3
    s_cbranch_scc1 L_end
    buffer_load_dword v10, v8, s[48:51], s56 offen offset:0 sc1
    buffer_load_dword v11, v8, s[48:51], s56 offen offset:256 sc1
    buffer_load_dword v12, v8, s[48:51], s56 offen offset:512 sc1
    s_lshl_b32 s56, s53, 7
    v_lshlrev_b32 v9, 1, v0
    s_waitcnt vmcnt(0)
    v_add_f32 v10, v10, v11
    v_add_f32 v10, v10, v12
    v_cvt_pk_bf16_f32 v10, v10, v10
    buffer_store_short v10, v9, s[40:43], s56 offen
L_end:
L_exit:
    s_endpgm
.section .rodata,"a"
.p2align 6
.amdhsa_kernel standalone__deep_cross_fibinet__recsys_kernel
  .amdhsa_next_free_vgpr 256
  .amdhsa_next_free_sgpr 102
  .amdhsa_accum_offset 256
  .amdhsa_group_segment_fixed_size 0
  .amdhsa_kernarg_size 88
  .amdhsa_user_sgpr_count 2
  .amdhsa_user_sgpr_kernarg_segment_ptr 1
  .amdhsa_system_sgpr_workgroup_id_x 1
.end_amdhsa_kernel
```

```asm
; @launch grid=(256,1,1) block=(512,1,1) lds=163840
.amdgcn_target "amdgcn-amd-amdhsa--gfx950"
.text
.globl standalone__deep_cross_fibinet__recsys_kernel
.p2align 12
.type standalone__deep_cross_fibinet__recsys_kernel,@function
standalone__deep_cross_fibinet__recsys_kernel:
    s_cmp_ge_u32 s2, 256
    s_cbranch_scc1 L_exit
    s_load_dwordx2 s[8:9], s[0:1], 0
    s_load_dwordx2 s[16:17], s[0:1], 48
    s_load_dwordx2 s[12:13], s[0:1], 8
    s_load_dwordx8 s[84:91], s[0:1], 16
    s_load_dwordx8 s[92:99], s[0:1], 56
    v_lshrrev_b32 v1, 6, v0
    s_lshr_b32 s56, s2, 5
    v_readfirstlane_b32 s52, v1
    s_and_b32 s57, s2, 7
    s_lshl3_add_u32 s53, s56, s57
    s_bfe_u32 s54, s2, 0x10003
    s_getpc_b64 s[20:21]
L_pc:
    s_mov_b32 s22, L_codeend-L_pc
    s_mov_b32 s23, 0x00020000
    s_andn2_b32 s56, s2, 7
    s_add_u32 s56, s56, s52
    s_lshl_b32 s56, s56, 7
    s_mov_b64 exec, 1
    buffer_load_dword v8, off, s[20:23], s56
    s_mov_b64 exec, -1
    s_mov_b32 s10, 425984
    s_mov_b32 s11, 0x00020000
    s_mov_b32 s18, 851968
    s_mov_b32 s19, 0x00020000
    s_mov_b32 s14, 12800000
    s_mov_b32 s15, 0x00020000
    s_bitcmp1_b32 s2, 4
    s_cbranch_scc1 L_B
    v_bfe_u32 v228, v0, 3, 5
    v_mul_u32_u24 v228, 104, v228
    v_and_b32 v229, 7, v0
    v_lshl_add_u32 v228, v229, 4, v228
    v_lshrrev_b32 v230, 8, v0
    v_lshl_add_u32 v228, v230, 4, v228
    v_mul_u32_u24 v230, 12, v230
    s_mov_b32 exec_lo, 0x40404040
    s_mov_b32 exec_hi, 0x40404040
    v_sub_u32 v228, v228, v230
    s_mov_b64 exec, -1
    s_lshl1_add_u32 s58, s53, s54
    s_mul_i32 s58, s58, 3328
    s_lshl_b32 s60, s52, 10
    s_and_b32 s79, s53, 3
    s_bfe_u32 s63, s53, 0x20002
    s_bfe_u32 s55, s53, 0x10004
    v_bfe_u32 v229, v0, 3, 1
    v_bfe_u32 v230, v0, 2, 1
    v_lshl_add_u32 v229, v229, 3, v230
    s_lshl3_add_u32 s56, s55, s79
    s_lshl_b32 s56, s56, 1
    v_add_u32 v229, s56, v229
    s_add_u32 s56, s79, 24
    v_min_u32 v229, s56, v229
    v_and_b32 v230, 3, v0
    v_lshl_add_u32 v229, v229, 3, v230
    v_lshlrev_b32 v229, 4, v229
    s_lshr_b32 s56, s52, 1
    s_lshl2_add_u32 s56, s56, s63
    s_min_u32 s56, s56, 12
    s_and_b32 s57, s52, 1
    s_lshl1_add_u32 s56, s56, s57
    s_lshr_b32 s57, s53, 5
    s_mul_i32 s57, s57, 26
    s_add_u32 s56, s56, s57
    s_mul_i32 s56, s56, 3328
    s_lshl_b32 s57, s54, 6
    s_add_u32 s3, s56, s57
    s_mov_b32 s34, 173056
    s_mov_b32 s35, 0x00020000
    s_lshr_b32 s57, s60, 2
    s_add_u32 m0, s57, 106496
    s_lshr_b32 s6, s2, 5
    s_lshl1_add_u32 s6, s6, s54
    s_waitcnt lgkmcnt(0)
    buffer_load_dwordx4 v[2:5], v228, s[8:11], s58 offen
    s_mov_b64 s[32:33], s[90:91]
    s_mov_b64 exec, 0xffff
    buffer_load_dwordx4 v229, s[32:35], s3 offen lds
    s_mov_b64 exec, -1
    s_mov_b32 s26, 8192
    s_mov_b32 s27, 0x00020000
    s_mov_b64 s[24:25], s[88:89]
    v_lshlrev_b32 v231, 4, v0
    s_add_u32 m0, s60, 139264
    s_lshl_b32 s56, s6, 13
    buffer_load_dwordx4 v231, s[24:27], 0 offen lds
    s_addk_i32 m0, 0x2000
    v_and_b32 v230, 63, v0
    buffer_load_dwordx4 v231, s[24:27], 4 offen lds
    v_lshl_add_u32 v7, v230, 7, s56
    s_sub_u32 s57, s52, 6
    s_lshl_b32 s57, s57, 17
    s_add_u32 s57, s57, s56
    s_add_u32 s57, s57, 262144
    s_cmp_lt_u32 s52, 6
    s_cselect_b32 s57, 0x7f000000, s57
    s_cmp_eq_u32 s52, 0
    s_cselect_b64 s[28:29], s[84:85], s[86:87]
    s_min_u32 s56, s60, 2048
    s_add_u32 m0, s56, 155648
    s_cmp_lt_u32 s52, 2
    s_cselect_b64 s[28:29], s[28:29], s[16:17]
    s_cselect_b32 s30, 676, s18
    s_cselect_b32 s57, 0, s57
    s_cselect_b32 s59, 4, 7
    s_mov_b32 s31, 0x00020000
    v_lshlrev_b32 v232, s59, v230
    buffer_load_dwordx4 v232, s[28:31], s57 offen lds
    s_branch L_A2
L_B:
    s_cmp_lt_u32 s52, 4
    s_cbranch_scc1 L_Bc
    s_setprio 3
    v_bfe_u32 v14, v0, 4, 4
    v_lshlrev_b32 v14, 9, v14
    v_bfe_u32 v15, v0, 4, 2
    v_lshlrev_b32 v15, 2, v15
    s_and_b32 s56, s52, 2
    v_xor_b32 v15, v15, v0
    v_xor_b32 v15, s56, v15
    v_and_b32 v15, 15, v15
    v_lshl_add_u32 v14, v15, 4, v14
    s_lshl_b32 s56, s54, 8
    v_add_u32 v1, s56, v14
    s_and_b32 s60, s52, 3
    s_lshl_b32 s60, s60, 10
    v_bfe_u32 v14, v0, 3, 5
    v_mul_u32_u24 v14, 104, v14
    v_and_b32 v15, 7, v0
    v_lshl_add_u32 v14, v15, 4, v14
    s_mul_i32 s57, s53, 6656
    s_lshr_b32 s58, s2, 5
    s_lshl_b32 s56, s58, 15
    s_mov_b32 s59, 0
    s_waitcnt lgkmcnt(0)
    buffer_load_dwordx4 v[4:7], v14, s[8:11], s57 offen
    buffer_load_dwordx4 v[8:11], v14, s[8:11], s57 offen offset:3328
L_lead:
    s_lshr_b32 s58, s56, 1
    s_add_u32 m0, s58, s60
    s_add_u32 s59, s59, 1
    buffer_load_dwordx4 v1, s[16:19], s56 offen lds
    s_addk_i32 m0, 0x1000
    s_addk_i32 s56, 0x2000
    buffer_load_dwordx4 v1, s[16:19], s56 offen lds
    s_addk_i32 m0, 0x1000
    s_addk_i32 s56, 0x2000
    buffer_load_dwordx4 v1, s[16:19], s56 offen lds
    s_addk_i32 m0, 0x1000
    s_addk_i32 s56, 0x2000
    buffer_load_dwordx4 v1, s[16:19], s56 offen lds
    s_addk_i32 s56, 0x2000
    s_and_b32 s56, s56, 262143
    s_cmp_lt_u32 s59, 8
    s_cbranch_scc1 L_lead
    s_branch L_Bl2
L_A2:
    s_and_b32 s56, s60, 0x1000
    s_mul_i32 s56, s56, 3
    s_add_u32 s78, s60, s56
    v_lshrrev_b32 v229, 4, v0
    v_xor_b32 v229, v229, v0
    v_and_b32 v229, 7, v229
    v_lshlrev_b32 v1, 4, v229
    v_and_b32 v147, 15, v0
    v_bfe_u32 v148, v0, 4, 2
    v_bfe_u32 v228, v0, 1, 3
    s_and_b32 s56, s60, 0x400
    s_lshl_b32 s56, s56, 1
    v_lshl_add_u32 v15, v147, 7, s56
    v_xor_b32 v230, v148, v228
    v_lshl_add_u32 v10, v230, 4, v15
    v_xor_b32 v12, 64, v10
    v_xor_b32 v11, 0x800, v10
    v_xor_b32 v13, 0x800, v12
    v_bfe_u32 v150, v0, 2, 2
    v_lshl_add_u32 v231, v148, 3, v150
    v_and_b32 v229, 1, v0
    v_lshl_add_u32 v231, v229, 6, v231
    v_bfe_u32 v232, v0, 1, 1
    v_lshlrev_b32 v233, 3, v232
    v_lshl_add_u32 v231, v231, 7, v233
    s_lshl_b32 s56, s52, 4
    s_add_u32 s56, s56, 139264
    v_add_u32 v149, s56, v231
    v_lshl_add_u32 v229, v150, 1, v229
    v_add_u32 v151, v233, v229
    v_and_b32 v232, 3, v0
    v_lshl_add_u32 v231, v232, 5, v150
    s_lshl_b32 s56, s52, 3
    s_add_u32 s56, s56, 106496
    v_lshl_add_u32 v96, v231, 1, s56
    v_mul_u32_u24 v231, 3328, v150
    v_lshl_add_u32 v97, v232, 4, v231
    v_mov_b32 v103, 0
    s_lshl2_add_u32 s57, s63, s79
    s_lshl_b32 s57, s57, 2
    s_mul_i32 s56, s79, 3
    s_min_u32 s56, s56, 8
    s_mul_i32 s58, s63, 10
    s_add_u32 s56, s56, s58
    s_add_u32 s56, s56, 64
    s_cmp_lt_u32 s79, 2
    s_movk_i32 s79, 0x3333
    s_cselect_b32 s79, 0x7777, s79
    s_cmp_eq_u32 s55, 0
    s_cselect_b32 s56, s57, s56
    s_cselect_b32 s79, 0xffff, s79
    s_lshr_b32 s57, s53, 5
    s_mul_i32 s57, s57, 104
    s_add_u32 s56, s56, s57
    s_lshl_b32 s56, s56, 4
    s_lshl3_add_u32 s57, s54, s52
    s_mul_i32 s57, s57, 13312
    s_add_u32 s56, s56, s57
    s_add_u32 s62, s56, 262144
    s_and_b32 s56, s63, 1
    s_lshl_b32 s56, s56, 3
    s_lshl_b32 s55, 0xff, s56
    s_lshr_b32 s56, s63, 1
    s_xor_b32 s56, s56, s52
    s_bitcmp1_b32 s56, 0
    s_cselect_b32 s55, 0x10000, s55
    s_mov_b32 s50, 268435456
    s_mov_b32 s51, 0x00020000
    s_mov_b64 s[48:49], s[98:99]
    v_and_b32 v231, 31, v0
    v_bfe_u32 v232, v0, 5, 1
    v_lshl_add_u32 v231, v232, 6, v231
    s_lshl2_add_u32 s56, s53, s54
    s_lshl_b32 s56, s56, 8
    v_lshl_add_u32 v20, v231, 3, s56
    s_waitcnt vmcnt(4)
    v_lshlrev_b32 v2, 7, v2
    v_lshlrev_b32 v3, 7, v3
    v_lshlrev_b32 v4, 7, v4
    v_lshlrev_b32 v5, 7, v5
    v_add_u32_dpp v6, v2, v1 row_newbcast:0 row_mask:0xf bank_mask:0x3
    s_add_u32 m0, s78, 0
    v_add_u32_dpp v6, v2, v1 row_newbcast:8 row_mask:0xf bank_mask:0xc
    buffer_load_dwordx4 v6, s[12:15], 0 offen lds
    v_add_u32_dpp v9, v3, v1 row_newbcast:0 row_mask:0xf bank_mask:0x3
    s_add_u32 m0, s78, 4096
    v_add_u32_dpp v9, v3, v1 row_newbcast:8 row_mask:0xf bank_mask:0xc
    buffer_load_dwordx4 v9, s[12:15], 0 offen lds
    v_add_u32_dpp v6, v4, v1 row_newbcast:0 row_mask:0xf bank_mask:0x3
    s_add_u32 m0, s78, 8192
    v_add_u32_dpp v6, v4, v1 row_newbcast:8 row_mask:0xf bank_mask:0xc
    buffer_load_dwordx4 v6, s[12:15], 0 offen lds
    v_add_u32_dpp v9, v5, v1 row_newbcast:0 row_mask:0xf bank_mask:0x3
    s_add_u32 m0, s78, 12288
    v_add_u32_dpp v9, v5, v1 row_newbcast:8 row_mask:0xf bank_mask:0xc
    buffer_load_dwordx4 v9, s[12:15], 0 offen lds
    v_add_u32_dpp v6, v2, v1 row_newbcast:2 row_mask:0xf bank_mask:0x3
    s_add_u32 m0, s78, 32768
    v_add_u32_dpp v6, v2, v1 row_newbcast:10 row_mask:0xf bank_mask:0xc
    buffer_load_dwordx4 v6, s[12:15], 0 offen lds
    s_waitcnt vmcnt(6)
    s_barrier
    ds_read_u16 v108, v96 offset:0
    ds_read_u16 v109, v96 offset:256
    ds_read_u16 v110, v96 offset:512
    ds_read_u16 v111, v96 offset:768
    ds_read_u16 v112, v96 offset:1024
    ds_read_u16 v113, v96 offset:1280
    ds_read_u16 v114, v96 offset:1536
    ds_read_u16 v115, v96 offset:1792
    ds_read_b64_tr_b16 v[152:153], v149 offset:0
    ds_read_b64_tr_b16 v[154:155], v149 offset:512
    ds_read_b64_tr_b16 v[156:157], v149 offset:4096
    ds_read_b64_tr_b16 v[158:159], v149 offset:4608
    s_lshl_b32 s56, s52, 28
    buffer_load_dword v21, v20, s[48:51], s56 offen offset:4 sc1
    s_add_u32 s56, s56, 0x10000
    buffer_load_dword v26, v20, s[48:51], s56 offen offset:4 sc1
    s_waitcnt lgkmcnt(4)
    v_lshl_or_b32 v100, v109, 16, v108
    v_lshl_or_b32 v101, v111, 16, v110
    v_lshl_or_b32 v102, v113, 16, v112
    s_mov_b32 exec_hi, 0
    s_mov_b32 exec_lo, s55
    v_lshl_or_b32 v103, v115, 16, v114
    s_mov_b32 exec_lo, s79
    buffer_store_dwordx4 v[100:103], v97, s[48:51], s62 offen sc1
    s_mov_b64 exec, -1
    s_waitcnt lgkmcnt(0)
    v_mov_b32 v233, 0x3c803c80
    s_mov_b32 exec_lo, 0x44444444
    s_mov_b32 exec_hi, 0x44444444
    v_mov_b32 v152, v233
    v_mov_b32 v153, v233
    v_mov_b32 v154, v233
    v_mov_b32 v155, v233
    v_mov_b32 v156, v233
    v_mov_b32 v157, v233
    v_mov_b32 v158, v233
    v_mov_b32 v159, v233
    s_mov_b64 exec, -1
    v_add_u32_dpp v9, v3, v1 row_newbcast:2 row_mask:0xf bank_mask:0x3
    s_add_u32 m0, s78, 36864
    v_add_u32_dpp v9, v3, v1 row_newbcast:10 row_mask:0xf bank_mask:0xc
    buffer_load_dwordx4 v9, s[12:15], 0 offen lds
    v_add_u32_dpp v6, v4, v1 row_newbcast:2 row_mask:0xf bank_mask:0x3
    v_add_u32_dpp v6, v4, v1 row_newbcast:10 row_mask:0xf bank_mask:0xc
    s_cmp_ge_u32 s52, 4
    s_cbranch_scc1 L_nw0
    s_waitcnt vmcnt(5)
L_nw0:
    s_barrier
    ds_read_b128 v[196:199], v10 offset:0
    ds_read_b128 v[200:203], v12 offset:0
    ds_read_b128 v[204:207], v10 offset:4096
    ds_read_b128 v[208:211], v12 offset:4096
    ds_read_b128 v[212:215], v11 offset:0
    ds_read_b128 v[216:219], v13 offset:0
    ds_read_b128 v[220:223], v11 offset:4096
    ds_read_b128 v[224:227], v13 offset:4096
    s_add_u32 m0, s78, 40960
    s_nop 0
    buffer_load_dwordx4 v6, s[12:15], 0 offen lds
    v_bfe_u32 v98, v0, 1, 3
    v_xor_b32 v98, s52, v98
    v_lshl_add_u32 v98, v98, 4, v15
    v_lshl_add_u32 v14, v148, 13, v98
    v_xor_b32 v15, 0x800, v14
    v_min_u32 v99, 1, v148
    v_add_u32 v99, 24, v99
    v_lshl_add_u32 v16, v99, 12, v98
    v_xor_b32 v17, 0x800, v16
    s_and_b32 s57, s52, 2
    s_lshl_b32 s57, s57, 3
    v_add_u32 v98, s57, v151
    v_add_u32 v99, 24, v150
    v_min_u32 v98, v98, v99
    v_mov_b32 v149, 155648
    s_movk_i32 s59, 208
    v_mad_u32_u24 v99, v148, s59, v149
    v_lshl_add_u32 v146, v98, 1, v99
    v_lshl_add_u32 v149, v147, 1, v149
    v_mad_u32_u24 v145, v148, 26, v149
    v_mad_u32_u24 v144, v148, 52, v149
    v_and_b32 v98, 63, v0
    v_lshlrev_b32 v18, 4, v98
    s_lshl3_add_u32 s56, s6, s52
    s_mul_i32 s56, s56, 1664
    s_add_u32 s56, s56, 262144
    v_lshl_add_u32 v23, v98, 7, s56
    v_mul_u32_u24 v98, 3, v150
    v_min_u32 v98, 8, v98
    v_mad_u32_u24 v98, v148, 10, v98
    v_and_b32 v99, 3, v0
    v_bfrev_b32 v19, 2
    s_mov_b32 exec_lo, 0x33773377
    s_mov_b32 exec_hi, 0x33773377
    v_add_lshl_u32 v19, v98, v99, 4
    s_mov_b64 exec, -1
    s_mul_i32 s61, s52, 26624
    s_add_u32 s61, s61, 262144
    s_and_b32 s56, s52, 1
    s_mul_i32 s58, s56, 2304
    s_sub_u32 s59, 160000, s58
    s_add_u32 s58, s58, 157696
    v_mul_u32_u24 v98, 144, v147
    v_lshl_add_u32 v98, v148, 5, v98
    v_add_u32 v29, s58, v98
    v_add_u32 v30, s59, v98
    v_add_u32 v28, s57, v29
    s_lshl_b32 s7, s52, 11
    s_add_u32 s7, s7, 106496
    v_add_u32 v31, s7, v18
    s_mov_b32 s42, 8192
    s_mov_b32 s43, 0x00020000
    s_mov_b32 s46, 256
    s_mov_b32 s47, 0x00020000
    s_mov_b64 s[40:41], s[94:95]
    s_mov_b64 s[44:45], s[96:97]
    s_mov_b32 s66, 0xc0135761
    s_mov_b32 s67, 0xbdd2d3e8
    s_mov_b32 s68, 0xffff0000
    s_mov_b32 s69, 0xbfb8aa3b
    v_mov_b32 v163, 0
    s_waitcnt lgkmcnt(6)
    v_mfma_f32_16x16x32_bf16 v[180:183], v[152:155], v[196:199], 0
    ds_read_b128 v[236:239], v10 offset:8192
    v_add_u32_dpp v9, v5, v1 row_newbcast:2 row_mask:0xf bank_mask:0x3
    v_mfma_f32_16x16x32_bf16 v[180:183], v[156:159], v[200:203], v[180:183]
    ds_read_b128 v[240:243], v12 offset:8192
    v_add_u32_dpp v9, v5, v1 row_newbcast:10 row_mask:0xf bank_mask:0xc
    s_waitcnt lgkmcnt(6)
    v_mfma_f32_16x16x32_bf16 v[188:191], v[152:155], v[204:207], 0
    ds_read_b128 v[244:247], v10 offset:12288
    v_add_u32_dpp v6, v2, v1 row_newbcast:4 row_mask:0xf bank_mask:0x3
    v_mfma_f32_16x16x32_bf16 v[188:191], v[156:159], v[208:211], v[188:191]
    ds_read_b128 v[248:251], v12 offset:12288
    v_add_u32_dpp v6, v2, v1 row_newbcast:12 row_mask:0xf bank_mask:0xc
    s_waitcnt lgkmcnt(6)
    v_mfma_f32_16x16x32_bf16 v[184:187], v[152:155], v[212:215], 0
    ds_read_b128 v[228:231], v11 offset:8192
    v_mfma_f32_16x16x32_bf16 v[184:187], v[156:159], v[216:219], v[184:187]
    ds_read_b128 v[232:235], v13 offset:8192
    s_waitcnt lgkmcnt(6)
    v_mfma_f32_16x16x32_bf16 v[192:195], v[152:155], v[220:223], 0
    ds_read_b128 v[252:255], v11 offset:12288
    v_cvt_pk_bf16_f32 v32, v180, v188
    v_cvt_pk_bf16_f32 v40, v181, v189
    v_mfma_f32_16x16x32_bf16 v[192:195], v[156:159], v[224:227], v[192:195]
    ds_read_b128 v[172:175], v13 offset:12288
    s_mov_b32 exec_lo, 65535
    s_mov_b32 exec_hi, 0
    v_cvt_pk_bf16_f32 v160, v182, v190
    s_mov_b64 exec, -1
    s_add_u32 m0, s78, 45056
    s_nop 0
    buffer_load_dwordx4 v9, s[12:15], 0 offen lds
    v_cvt_pk_bf16_f32 v36, v184, v192
    v_cvt_pk_bf16_f32 v44, v185, v193
    s_waitcnt vmcnt(7)
    s_waitcnt vmcnt(3)
    s_barrier
    s_waitcnt lgkmcnt(6)
    v_mfma_f32_16x16x32_bf16 v[128:131], v[152:155], v[236:239], 0
    ds_read_b128 v[196:199], v10 offset:16384
    v_mfma_f32_16x16x32_bf16 v[128:131], v[156:159], v[240:243], v[128:131]
    ds_read_b128 v[200:203], v12 offset:16384
    s_waitcnt lgkmcnt(6)
    v_mfma_f32_16x16x32_bf16 v[136:139], v[152:155], v[244:247], 0
    ds_read_b128 v[204:207], v10 offset:20480
    v_mfma_f32_16x16x32_bf16 v[136:139], v[156:159], v[248:251], v[136:139]
    ds_read_b128 v[208:211], v12 offset:20480
    s_waitcnt lgkmcnt(6)
    v_mfma_f32_16x16x32_bf16 v[132:135], v[152:155], v[228:231], 0
    ds_read_b128 v[212:215], v11 offset:16384
    v_mfma_f32_16x16x32_bf16 v[132:135], v[156:159], v[232:235], v[132:135]
    ds_read_b128 v[216:219], v13 offset:16384
    s_waitcnt lgkmcnt(6)
    v_mfma_f32_16x16x32_bf16 v[140:143], v[152:155], v[252:255], 0
    ds_read_b128 v[220:223], v11 offset:20480
    v_mfma_f32_16x16x32_bf16 v[140:143], v[156:159], v[172:175], v[140:143]
    ds_read_b128 v[224:227], v13 offset:20480
    s_add_u32 m0, s78, 65536
    s_nop 0
    buffer_load_dwordx4 v6, s[12:15], 0 offen lds
    s_lshl_b32 s56, s54, 4
    s_lshl_b32 s56, 0x100, s56
    v_mov_b32 v22, s56
    s_lshl_b32 s56, s52, 6
    s_add_u32 s56, s56, s53
    s_lshl_b32 s56, s56, 2
    s_mov_b64 exec, 1
    buffer_atomic_or v22, off, s[44:47], s56 sc1
    s_mov_b64 exec, -1
    ds_read_u16 v116, v144 offset:0
    ds_read_u16 v117, v144 offset:26
    ds_read_u16 v118, v144 offset:208
    ds_read_u16 v119, v144 offset:234
    ds_read_u16 v120, v144 offset:416
    ds_read_u16 v121, v144 offset:442
    ds_read_u16 v167, v145 offset:624
    s_waitcnt lgkmcnt(13)
    v_mfma_f32_16x16x32_bf16 v[180:183], v[152:155], v[196:199], 0
    ds_read_b128 v[236:239], v10 offset:24576
    v_cvt_pk_bf16_f32 v48, v128, v136
    v_cvt_pk_bf16_f32 v56, v129, v137
    v_mfma_f32_16x16x32_bf16 v[180:183], v[156:159], v[200:203], v[180:183]
    ds_read_b128 v[240:243], v12 offset:24576
    v_cvt_pk_bf16_f32 v52, v132, v140
    v_cvt_pk_bf16_f32 v60, v133, v141
    s_waitcnt lgkmcnt(13)
    v_mfma_f32_16x16x32_bf16 v[188:191], v[152:155], v[204:207], 0
    ds_read_b128 v[244:247], v10 offset:28672
    v_add_u32_dpp v9, v3, v1 row_newbcast:4 row_mask:0xf bank_mask:0x3
    v_mfma_f32_16x16x32_bf16 v[188:191], v[156:159], v[208:211], v[188:191]
    ds_read_b128 v[248:251], v12 offset:28672
    v_add_u32_dpp v9, v3, v1 row_newbcast:12 row_mask:0xf bank_mask:0xc
    s_waitcnt lgkmcnt(13)
    v_mfma_f32_16x16x32_bf16 v[184:187], v[152:155], v[212:215], 0
    ds_read_b128 v[228:231], v11 offset:24576
    v_add_u32_dpp v6, v4, v1 row_newbcast:4 row_mask:0xf bank_mask:0x3
    v_mfma_f32_16x16x32_bf16 v[184:187], v[156:159], v[216:219], v[184:187]
    ds_read_b128 v[232:235], v13 offset:24576
    v_add_u32_dpp v6, v4, v1 row_newbcast:12 row_mask:0xf bank_mask:0xc
    s_mov_b32 exec_lo, 4294901760
    s_mov_b32 exec_hi, 0
    v_cvt_pk_bf16_f32 v160, v130, v138
    s_mov_b64 exec, -1
    s_waitcnt lgkmcnt(13)
    v_mfma_f32_16x16x32_bf16 v[192:195], v[152:155], v[220:223], 0
    ds_read_b128 v[252:255], v11 offset:28672
    v_cvt_pk_bf16_f32 v64, v180, v188
    v_cvt_pk_bf16_f32 v72, v181, v189
    v_mfma_f32_16x16x32_bf16 v[192:195], v[156:159], v[224:227], v[192:195]
    ds_read_b128 v[172:175], v13 offset:28672
    s_mov_b32 exec_lo, 0
    s_mov_b32 exec_hi, 65535
    v_cvt_pk_bf16_f32 v160, v182, v190
    s_mov_b64 exec, -1
    s_add_u32 m0, s78, 69632
    s_nop 0
    buffer_load_dwordx4 v9, s[12:15], 0 offen lds
    s_waitcnt lgkmcnt(8)
    ds_read_u16 v124, v146 offset:1024
    ds_read_u16 v125, v146 offset:1076
    ds_read_u16 v126, v146 offset:1128
    ds_read_u16 v127, v146 offset:1180
    v_cvt_pk_bf16_f32 v68, v184, v192
    v_cvt_pk_bf16_f32 v76, v185, v193
    s_cmp_ge_u32 s52, 4
    s_cbranch_scc1 L_nw4
    s_waitcnt vmcnt(3)
L_nw4:
    s_barrier
    s_waitcnt lgkmcnt(10)
    v_mfma_f32_16x16x32_bf16 v[128:131], v[152:155], v[236:239], 0
    ds_read_b128 v[196:199], v10 offset:32768
    v_mfma_f32_16x16x32_bf16 v[128:131], v[156:159], v[240:243], v[128:131]
    ds_read_b128 v[200:203], v12 offset:32768
    s_waitcnt lgkmcnt(10)
    v_mfma_f32_16x16x32_bf16 v[136:139], v[152:155], v[244:247], 0
    ds_read_b128 v[204:207], v10 offset:36864
    v_mfma_f32_16x16x32_bf16 v[136:139], v[156:159], v[248:251], v[136:139]
    ds_read_b128 v[208:211], v12 offset:36864
    s_waitcnt lgkmcnt(10)
    v_mfma_f32_16x16x32_bf16 v[132:135], v[152:155], v[228:231], 0
    ds_read_b128 v[212:215], v11 offset:32768
    v_mfma_f32_16x16x32_bf16 v[132:135], v[156:159], v[232:235], v[132:135]
    ds_read_b128 v[216:219], v13 offset:32768
    s_waitcnt lgkmcnt(10)
    v_mfma_f32_16x16x32_bf16 v[140:143], v[152:155], v[252:255], 0
    ds_read_b128 v[220:223], v11 offset:36864
    v_mfma_f32_16x16x32_bf16 v[140:143], v[156:159], v[172:175], v[140:143]
    ds_read_b128 v[224:227], v13 offset:36864
    s_add_u32 m0, s78, 73728
    s_nop 0
    buffer_load_dwordx4 v6, s[12:15], 0 offen lds
    s_waitcnt lgkmcnt(6)
    v_mfma_f32_16x16x32_bf16 v[180:183], v[152:155], v[196:199], 0
    ds_read_b128 v[236:239], v10 offset:40960
    v_cvt_pk_bf16_f32 v80, v128, v136
    v_cvt_pk_bf16_f32 v88, v129, v137
    v_cvt_pk_bf16_f32 v84, v132, v140
    v_mfma_f32_16x16x32_bf16 v[180:183], v[156:159], v[200:203], v[180:183]
    ds_read_b128 v[240:243], v12 offset:40960
    v_cvt_pk_bf16_f32 v92, v133, v141
    v_add_u32_dpp v9, v5, v1 row_newbcast:4 row_mask:0xf bank_mask:0x3
    v_add_u32_dpp v9, v5, v1 row_newbcast:12 row_mask:0xf bank_mask:0xc
    s_waitcnt lgkmcnt(6)
    v_mfma_f32_16x16x32_bf16 v[188:191], v[152:155], v[204:207], 0
    ds_read_b128 v[244:247], v10 offset:45056
    v_add_u32_dpp v6, v2, v1 row_newbcast:6 row_mask:0xf bank_mask:0x3
    v_add_u32_dpp v6, v2, v1 row_newbcast:14 row_mask:0xf bank_mask:0xc
    v_permlane32_swap_b32 v32, v64
    v_mfma_f32_16x16x32_bf16 v[188:191], v[156:159], v[208:211], v[188:191]
    ds_read_b128 v[248:251], v12 offset:45056
    v_permlane32_swap_b32 v48, v80
    v_permlane32_swap_b32 v40, v72
    v_permlane32_swap_b32 v56, v88
    s_waitcnt lgkmcnt(6)
    v_mfma_f32_16x16x32_bf16 v[184:187], v[152:155], v[212:215], 0
    ds_read_b128 v[228:231], v11 offset:40960
    v_permlane16_swap_b32 v32, v48
    v_permlane16_swap_b32 v64, v80
    v_mfma_f32_16x16x32_bf16 v[184:187], v[156:159], v[216:219], v[184:187]
    ds_read_b128 v[232:235], v13 offset:40960
    v_permlane16_swap_b32 v40, v56
    v_permlane16_swap_b32 v72, v88
    s_mov_b32 exec_lo, 0
    s_mov_b32 exec_hi, 4294901760
    v_cvt_pk_bf16_f32 v160, v130, v138
    s_mov_b64 exec, -1
    s_waitcnt lgkmcnt(6)
    v_mfma_f32_16x16x32_bf16 v[192:195], v[152:155], v[220:223], 0
    ds_read_b128 v[252:255], v11 offset:45056
    v_cvt_pk_bf16_f32 v33, v180, v188
    v_cvt_pk_bf16_f32 v41, v181, v189
    v_mfma_f32_16x16x32_bf16 v[192:195], v[156:159], v[224:227], v[192:195]
    ds_read_b128 v[172:175], v13 offset:45056
    s_mov_b32 exec_lo, 65535
    s_mov_b32 exec_hi, 0
    v_cvt_pk_bf16_f32 v161, v182, v190
    s_mov_b64 exec, -1
    s_add_u32 m0, s78, 77824
    s_nop 0
    buffer_load_dwordx4 v9, s[12:15], 0 offen lds
    v_lshl_or_b32 v164, v117, 16, v116
    v_lshl_or_b32 v165, v119, 16, v118
    v_lshl_or_b32 v166, v121, 16, v120
    v_lshl_or_b32 v168, v125, 16, v124
    v_lshl_or_b32 v169, v127, 16, v126
    v_cvt_pk_bf16_f32 v37, v184, v192
    v_cvt_pk_bf16_f32 v45, v185, v193
    s_waitcnt vmcnt(5)
    s_barrier
    s_waitcnt lgkmcnt(6)
    v_mfma_f32_16x16x32_bf16 v[128:131], v[152:155], v[236:239], 0
    ds_read_b128 v[196:199], v10 offset:49152
    v_mfma_f32_16x16x32_bf16 v[128:131], v[156:159], v[240:243], v[128:131]
    ds_read_b128 v[200:203], v12 offset:49152
    s_waitcnt lgkmcnt(6)
    v_mfma_f32_16x16x32_bf16 v[136:139], v[152:155], v[244:247], 0
    ds_read_b128 v[204:207], v10 offset:53248
    v_mfma_f32_16x16x32_bf16 v[136:139], v[156:159], v[248:251], v[136:139]
    ds_read_b128 v[208:211], v12 offset:53248
    s_waitcnt lgkmcnt(6)
    v_mfma_f32_16x16x32_bf16 v[132:135], v[152:155], v[228:231], 0
    ds_read_b128 v[212:215], v11 offset:49152
    v_mfma_f32_16x16x32_bf16 v[132:135], v[156:159], v[232:235], v[132:135]
    ds_read_b128 v[216:219], v13 offset:49152
    s_waitcnt lgkmcnt(6)
    v_mfma_f32_16x16x32_bf16 v[140:143], v[152:155], v[252:255], 0
    ds_read_b128 v[220:223], v11 offset:53248
    v_mfma_f32_16x16x32_bf16 v[140:143], v[156:159], v[172:175], v[140:143]
    ds_read_b128 v[224:227], v13 offset:53248
    s_add_u32 m0, s60, 98304
    s_nop 0
    buffer_load_dwordx4 v6, s[12:15], 0 offen lds
    s_waitcnt lgkmcnt(6)
    v_mfma_f32_16x16x32_bf16 v[180:183], v[152:155], v[196:199], 0
    ds_read_b128 v[236:239], v10 offset:57344
    v_cvt_pk_bf16_f32 v49, v128, v136
    v_cvt_pk_bf16_f32 v57, v129, v137
    v_mfma_f32_16x16x32_bf16 v[180:183], v[156:159], v[200:203], v[180:183]
    ds_read_b128 v[240:243], v12 offset:57344
    v_cvt_pk_bf16_f32 v53, v132, v140
    v_cvt_pk_bf16_f32 v61, v133, v141
    s_waitcnt lgkmcnt(6)
    v_mfma_f32_16x16x32_bf16 v[188:191], v[152:155], v[204:207], 0
    ds_read_b128 v[244:247], v10 offset:61440
    v_permlane32_swap_b32 v36, v68
    v_permlane32_swap_b32 v52, v84
    v_mfma_f32_16x16x32_bf16 v[188:191], v[156:159], v[208:211], v[188:191]
    ds_read_b128 v[248:251], v12 offset:61440
    v_permlane32_swap_b32 v44, v76
    v_permlane32_swap_b32 v60, v92
    s_waitcnt lgkmcnt(6)
    v_mfma_f32_16x16x32_bf16 v[184:187], v[152:155], v[212:215], 0
    ds_read_b128 v[228:231], v11 offset:57344
    v_permlane16_swap_b32 v36, v52
    v_permlane16_swap_b32 v68, v84
    v_mfma_f32_16x16x32_bf16 v[184:187], v[156:159], v[216:219], v[184:187]
    ds_read_b128 v[232:235], v13 offset:57344
    v_permlane16_swap_b32 v44, v60
    v_permlane16_swap_b32 v76, v92
    s_mov_b32 exec_lo, 4294901760
    s_mov_b32 exec_hi, 0
    v_cvt_pk_bf16_f32 v161, v130, v138
    s_mov_b64 exec, -1
    s_waitcnt lgkmcnt(6)
    v_mfma_f32_16x16x32_bf16 v[192:195], v[152:155], v[220:223], 0
    ds_read_b128 v[252:255], v11 offset:61440
    v_cvt_pk_bf16_f32 v65, v180, v188
    v_cvt_pk_bf16_f32 v73, v181, v189
    v_mfma_f32_16x16x32_bf16 v[192:195], v[156:159], v[224:227], v[192:195]
    ds_read_b128 v[172:175], v13 offset:61440
    s_mov_b32 exec_lo, 0
    s_mov_b32 exec_hi, 65535
    v_cvt_pk_bf16_f32 v161, v182, v190
    s_mov_b64 exec, -1
    s_lshl_b32 s57, s52, 17
    s_add_u32 s57, s57, 524288
    buffer_load_dword v8, v7, s[16:19], s57 offen
    v_add_u32 v10, 0x10000, v10
    v_add_u32 v11, 0x10000, v11
    v_add_u32 v12, 0x10000, v12
    v_add_u32 v13, 0x10000, v13
    v_cvt_pk_bf16_f32 v69, v184, v192
    v_cvt_pk_bf16_f32 v77, v185, v193
    s_cmp_ge_u32 s52, 4
    s_cbranch_scc1 L_nw8
    s_waitcnt vmcnt(2)
L_nw8:
    s_barrier
    s_waitcnt lgkmcnt(6)
    v_mfma_f32_16x16x32_bf16 v[128:131], v[152:155], v[236:239], 0
    ds_read_b128 v[196:199], v10 offset:0
    v_mfma_f32_16x16x32_bf16 v[128:131], v[156:159], v[240:243], v[128:131]
    ds_read_b128 v[200:203], v12 offset:0
    s_waitcnt lgkmcnt(6)
    v_mfma_f32_16x16x32_bf16 v[136:139], v[152:155], v[244:247], 0
    ds_read_b128 v[204:207], v10 offset:4096
    v_mfma_f32_16x16x32_bf16 v[136:139], v[156:159], v[248:251], v[136:139]
    ds_read_b128 v[208:211], v12 offset:4096
    s_waitcnt lgkmcnt(6)
    v_mfma_f32_16x16x32_bf16 v[132:135], v[152:155], v[228:231], 0
    ds_read_b128 v[212:215], v11 offset:0
    v_mfma_f32_16x16x32_bf16 v[132:135], v[156:159], v[232:235], v[132:135]
    ds_read_b128 v[216:219], v13 offset:0
    s_waitcnt lgkmcnt(6)
    v_mfma_f32_16x16x32_bf16 v[140:143], v[152:155], v[252:255], 0
    ds_read_b128 v[220:223], v11 offset:4096
    v_mfma_f32_16x16x32_bf16 v[140:143], v[156:159], v[172:175], v[140:143]
    ds_read_b128 v[224:227], v13 offset:4096
    s_waitcnt lgkmcnt(6)
    v_mfma_f32_16x16x32_bf16 v[180:183], v[152:155], v[196:199], 0
    ds_read_b128 v[236:239], v10 offset:8192
    v_cvt_pk_bf16_f32 v81, v128, v136
    v_cvt_pk_bf16_f32 v89, v129, v137
    v_mfma_f32_16x16x32_bf16 v[180:183], v[156:159], v[200:203], v[180:183]
    ds_read_b128 v[240:243], v12 offset:8192
    v_cvt_pk_bf16_f32 v85, v132, v140
    v_cvt_pk_bf16_f32 v93, v133, v141
    s_waitcnt lgkmcnt(6)
    v_mfma_f32_16x16x32_bf16 v[188:191], v[152:155], v[204:207], 0
    ds_read_b128 v[244:247], v10 offset:12288
    v_permlane32_swap_b32 v33, v65
    v_permlane32_swap_b32 v49, v81
    v_mfma_f32_16x16x32_bf16 v[188:191], v[156:159], v[208:211], v[188:191]
    ds_read_b128 v[248:251], v12 offset:12288
    v_permlane32_swap_b32 v41, v73
    v_permlane32_swap_b32 v57, v89
    s_waitcnt lgkmcnt(6)
    v_mfma_f32_16x16x32_bf16 v[184:187], v[152:155], v[212:215], 0
    ds_read_b128 v[228:231], v11 offset:8192
    v_permlane16_swap_b32 v33, v49
    v_permlane16_swap_b32 v65, v81
    v_mfma_f32_16x16x32_bf16 v[184:187], v[156:159], v[216:219], v[184:187]
    ds_read_b128 v[232:235], v13 offset:8192
    v_permlane16_swap_b32 v41, v57
    v_permlane16_swap_b32 v73, v89
    s_mov_b32 exec_lo, 0
    s_mov_b32 exec_hi, 4294901760
    v_cvt_pk_bf16_f32 v161, v130, v138
    s_mov_b64 exec, -1
    s_waitcnt lgkmcnt(6)
    v_mfma_f32_16x16x32_bf16 v[192:195], v[152:155], v[220:223], 0
    ds_read_b128 v[252:255], v11 offset:12288
    v_cvt_pk_bf16_f32 v34, v180, v188
    v_cvt_pk_bf16_f32 v42, v181, v189
    v_mfma_f32_16x16x32_bf16 v[192:195], v[156:159], v[224:227], v[192:195]
    ds_read_b128 v[172:175], v13 offset:12288
    s_mov_b32 exec_lo, 65535
    s_mov_b32 exec_hi, 0
    v_cvt_pk_bf16_f32 v162, v182, v190
    s_mov_b64 exec, -1
    v_lshrrev_b32 v22, 2, v18
    s_lshl_b32 s56, s52, 8
    buffer_load_dword v22, v22, s[44:47], s56 offen sc1
    v_cvt_pk_bf16_f32 v38, v184, v192
    v_cvt_pk_bf16_f32 v46, v185, v193
    s_waitcnt vmcnt(3)
    s_barrier
    s_waitcnt lgkmcnt(6)
    v_mfma_f32_16x16x32_bf16 v[128:131], v[152:155], v[236:239], 0
    ds_read_b128 v[196:199], v10 offset:16384
    v_mfma_f32_16x16x32_bf16 v[128:131], v[156:159], v[240:243], v[128:131]
    ds_read_b128 v[200:203], v12 offset:16384
    s_waitcnt lgkmcnt(6)
    v_mfma_f32_16x16x32_bf16 v[136:139], v[152:155], v[244:247], 0
    ds_read_b128 v[204:207], v10 offset:20480
    v_mfma_f32_16x16x32_bf16 v[136:139], v[156:159], v[248:251], v[136:139]
    ds_read_b128 v[208:211], v12 offset:20480
    s_waitcnt lgkmcnt(6)
    v_mfma_f32_16x16x32_bf16 v[132:135], v[152:155], v[228:231], 0
    ds_read_b128 v[212:215], v11 offset:16384
    v_mfma_f32_16x16x32_bf16 v[132:135], v[156:159], v[232:235], v[132:135]
    ds_read_b128 v[216:219], v13 offset:16384
    s_waitcnt lgkmcnt(6)
    v_mfma_f32_16x16x32_bf16 v[140:143], v[152:155], v[252:255], 0
    ds_read_b128 v[220:223], v11 offset:20480
    v_mfma_f32_16x16x32_bf16 v[140:143], v[156:159], v[172:175], v[140:143]
    ds_read_b128 v[224:227], v13 offset:20480
    s_waitcnt lgkmcnt(6)
    v_mfma_f32_16x16x32_bf16 v[180:183], v[152:155], v[196:199], 0
    ds_read_b128 v[236:239], v10 offset:24576
    v_cvt_pk_bf16_f32 v50, v128, v136
    v_cvt_pk_bf16_f32 v58, v129, v137
    v_mfma_f32_16x16x32_bf16 v[180:183], v[156:159], v[200:203], v[180:183]
    ds_read_b128 v[240:243], v12 offset:24576
    v_cvt_pk_bf16_f32 v54, v132, v140
    v_cvt_pk_bf16_f32 v62, v133, v141
    s_waitcnt lgkmcnt(6)
    v_mfma_f32_16x16x32_bf16 v[188:191], v[152:155], v[204:207], 0
    ds_read_b128 v[244:247], v10 offset:28672
    v_permlane32_swap_b32 v37, v69
    v_permlane32_swap_b32 v53, v85
    v_mfma_f32_16x16x32_bf16 v[188:191], v[156:159], v[208:211], v[188:191]
    ds_read_b128 v[248:251], v12 offset:28672
    v_permlane32_swap_b32 v45, v77
    v_permlane32_swap_b32 v61, v93
    s_waitcnt lgkmcnt(6)
    v_mfma_f32_16x16x32_bf16 v[184:187], v[152:155], v[212:215], 0
    ds_read_b128 v[228:231], v11 offset:24576
    v_permlane16_swap_b32 v37, v53
    v_permlane16_swap_b32 v69, v85
    v_mfma_f32_16x16x32_bf16 v[184:187], v[156:159], v[216:219], v[184:187]
    ds_read_b128 v[232:235], v13 offset:24576
    v_permlane16_swap_b32 v45, v61
    v_permlane16_swap_b32 v77, v93
    s_mov_b32 exec_lo, 4294901760
    s_mov_b32 exec_hi, 0
    v_cvt_pk_bf16_f32 v162, v130, v138
    s_mov_b64 exec, -1
    s_waitcnt lgkmcnt(6)
    v_mfma_f32_16x16x32_bf16 v[192:195], v[152:155], v[220:223], 0
    ds_read_b128 v[252:255], v11 offset:28672
    v_cvt_pk_bf16_f32 v66, v180, v188
    v_cvt_pk_bf16_f32 v74, v181, v189
    v_mfma_f32_16x16x32_bf16 v[192:195], v[156:159], v[224:227], v[192:195]
    ds_read_b128 v[172:175], v13 offset:28672
    s_mov_b32 exec_lo, 0
    s_mov_b32 exec_hi, 65535
    v_cvt_pk_bf16_f32 v162, v182, v190
    s_mov_b64 exec, -1
    s_nop 2
    v_cvt_pk_bf16_f32 v70, v184, v192
    v_cvt_pk_bf16_f32 v78, v185, v193
    s_waitcnt vmcnt(2)
    s_waitcnt vmcnt(0)
    s_cmp_lg_u32 s52, 0
    s_cbranch_scc1 L_flok
L_flp:
    v_and_b32 v22, 0x01000100, v22
    v_cmp_ne_u32 vcc, 0x01000100, v22
    s_cbranch_vccz L_flok
    s_sleep 8
    v_lshrrev_b32 v22, 2, v18
    buffer_load_dword v22, v22, s[44:47], 0 offen sc1
    s_waitcnt vmcnt(0)
    s_branch L_flp
L_flok:
    s_barrier
    s_mov_b64 exec, 0x1fff
    buffer_load_dword v8, v23, s[48:51], 0 offen sc1
    s_mov_b64 exec, -1
    s_waitcnt lgkmcnt(6)
    v_mfma_f32_16x16x32_bf16 v[128:131], v[152:155], v[236:239], 0
    ds_read_b128 v[196:199], v10 offset:32768
    v_add_u32 v22, 0x10000, v14
    v_mfma_f32_16x16x32_bf16 v[128:131], v[156:159], v[240:243], v[128:131]
    ds_read_b128 v[200:203], v12 offset:32768
    v_add_u32 v23, 0x10000, v15
    s_waitcnt lgkmcnt(6)
    v_mfma_f32_16x16x32_bf16 v[136:139], v[152:155], v[244:247], 0
    ds_read_b128 v[204:207], v10 offset:36864
    v_mfma_f32_16x16x32_bf16 v[136:139], v[156:159], v[248:251], v[136:139]
    ds_read_b128 v[208:211], v12 offset:36864
    s_waitcnt lgkmcnt(6)
    v_mfma_f32_16x16x32_bf16 v[132:135], v[152:155], v[228:231], 0
    ds_read_b128 v[212:215], v11 offset:32768
    v_mfma_f32_16x16x32_bf16 v[132:135], v[156:159], v[232:235], v[132:135]
    ds_read_b128 v[216:219], v13 offset:32768
    s_waitcnt lgkmcnt(6)
    v_mfma_f32_16x16x32_bf16 v[140:143], v[152:155], v[252:255], 0
    ds_read_b128 v[220:223], v11 offset:36864
    v_mfma_f32_16x16x32_bf16 v[140:143], v[156:159], v[172:175], v[140:143]
    ds_read_b128 v[224:227], v13 offset:36864
    s_mov_b32 exec_lo, 0
    s_mov_b32 exec_hi, 4294901760
    v_cvt_pk_bf16_f32 v162, v130, v138
    s_mov_b64 exec, -1
    s_waitcnt lgkmcnt(6)
    v_mfma_f32_16x16x32_bf16 v[180:183], v[152:155], v[196:199], 0
    v_mfma_f32_16x16x32_bf16 v[180:183], v[156:159], v[200:203], v[180:183]
    s_waitcnt lgkmcnt(4)
    v_mfma_f32_16x16x32_bf16 v[188:191], v[152:155], v[204:207], 0
    v_mfma_f32_16x16x32_bf16 v[188:191], v[156:159], v[208:211], v[188:191]
    s_waitcnt lgkmcnt(2)
    v_mfma_f32_16x16x32_bf16 v[184:187], v[152:155], v[212:215], 0
    v_mfma_f32_16x16x32_bf16 v[184:187], v[156:159], v[216:219], v[184:187]
    s_waitcnt lgkmcnt(0)
    v_mfma_f32_16x16x32_bf16 v[192:195], v[152:155], v[220:223], 0
    v_mfma_f32_16x16x32_bf16 v[192:195], v[156:159], v[224:227], v[192:195]
    s_cmp_ge_u32 s52, 4
    s_cbranch_scc1 L_nosenet
    s_mov_b64 exec, 0xffff
    v_cvt_pk_bf16_f32 v163, v182, 0
    s_mov_b32 exec_lo, 0xffff0000
    v_cvt_pk_bf16_f32 v163, v190, 0
    s_mov_b64 exec, -1
    s_nop 0
    v_mfma_f32_16x16x32_bf16 v[228:231], v[164:167], v[160:163], 0
    v_mov_b32 v248, s66
    s_nop 6
    v_cvt_pk_bf16_f32 v236, v228, v229
    v_cvt_pk_bf16_f32 v237, v230, v231
    v_lshlrev_b32 v228, 16, v236
    v_and_b32 v229, s68, v236
    v_lshlrev_b32 v230, 16, v237
    v_and_b32 v231, s68, v237
    v_mul_f32 v240, v228, v228
    v_mul_f32 v241, v229, v229
    v_mul_f32 v242, v230, v230
    v_mul_f32 v243, v231, v231
    v_fma_f32 v240, v240, s67, v248
    v_fma_f32 v241, v241, s67, v248
    v_fma_f32 v242, v242, s67, v248
    v_fma_f32 v243, v243, s67, v248
    v_mul_f32 v240, v240, v228
    v_mul_f32 v241, v241, v229
    v_mul_f32 v242, v242, v230
    v_mul_f32 v243, v243, v231
    v_exp_f32 v240, v240
    v_exp_f32 v241, v241
    v_exp_f32 v242, v242
    v_exp_f32 v243, v243
    v_add_f32 v240, 1.0, v240
    v_add_f32 v241, 1.0, v241
    v_add_f32 v242, 1.0, v242
    v_add_f32 v243, 1.0, v243
    v_rcp_f32 v240, v240
    v_rcp_f32 v241, v241
    v_rcp_f32 v242, v242
    v_rcp_f32 v243, v243
    v_mul_f32 v232, v228, v240
    v_mul_f32 v233, v229, v241
    v_mul_f32 v234, v230, v242
    v_mul_f32 v235, v231, v243
    v_cvt_pk_bf16_f32 v238, v232, v233
    v_cvt_pk_bf16_f32 v239, v234, v235
    s_nop 1
    v_mfma_f32_16x16x16_bf16 v[244:247], v[168:169], v[238:239], 0
    s_nop 7
    v_cvt_pk_bf16_f32 v236, v244, v245
    v_cvt_pk_bf16_f32 v237, v246, v247
    v_lshlrev_b32 v228, 16, v236
    v_and_b32 v229, s68, v236
    v_lshlrev_b32 v230, 16, v237
    v_and_b32 v231, s68, v237
    v_mul_f32 v228, s69, v228
    v_mul_f32 v229, s69, v229
    v_mul_f32 v230, s69, v230
    v_mul_f32 v231, s69, v231
    v_exp_f32 v228, v228
    v_exp_f32 v229, v229
    v_exp_f32 v230, v230
    v_exp_f32 v231, v231
    v_add_f32 v228, 1.0, v228
    v_add_f32 v229, 1.0, v229
    v_add_f32 v230, 1.0, v230
    v_add_f32 v231, 1.0, v231
    v_rcp_f32 v228, v228
    v_rcp_f32 v229, v229
    v_rcp_f32 v230, v230
    v_rcp_f32 v231, v231
    v_cvt_pk_bf16_f32 v232, 0, v228
    v_cvt_pk_bf16_f32 v233, 0, v229
    v_cvt_pk_bf16_f32 v234, 0, v230
    v_cvt_pk_bf16_f32 v235, 0, v231
    ds_write_b128 v28, v[232:235]
    s_waitcnt lgkmcnt(0)
    s_barrier
    v_cvt_pk_bf16_f32 v82, v128, v136
    v_cvt_pk_bf16_f32 v90, v129, v137
    v_cvt_pk_bf16_f32 v86, v132, v140
    v_cvt_pk_bf16_f32 v94, v133, v141
    s_add_u32 s56, s61, 0
    buffer_load_dwordx4 v[96:99], v18, s[48:51], s56 offen offset:0 sc1
    s_add_u32 s56, s61, 3328
    buffer_load_dwordx4 v[100:103], v18, s[48:51], s56 offen offset:0 sc1
    s_add_u32 s56, s61, 0
    buffer_load_dwordx4 v[104:107], v18, s[48:51], s56 offen offset:1664 sc1
    s_add_u32 s56, s61, 3328
    buffer_load_dwordx4 v[108:111], v18, s[48:51], s56 offen offset:1664 sc1
    s_add_u32 s56, s61, 0
    buffer_load_dwordx4 v[112:115], v19, s[48:51], s56 offen offset:1024 sc1
    s_add_u32 s56, s61, 3328
    buffer_load_dwordx4 v[116:119], v19, s[48:51], s56 offen offset:1024 sc1
    s_add_u32 s56, s61, 0
    buffer_load_dwordx4 v[172:175], v19, s[48:51], s56 offen offset:2688 sc1
    s_add_u32 s56, s61, 3328
    buffer_load_dwordx4 v[176:179], v19, s[48:51], s56 offen offset:2688 sc1
    v_cvt_pk_bf16_f32 v35, v180, v188
    v_cvt_pk_bf16_f32 v43, v181, v189
    v_cvt_pk_bf16_f32 v51, v180, v188
    v_cvt_pk_bf16_f32 v59, v181, v189
    v_cvt_pk_bf16_f32 v67, v180, v188
    v_cvt_pk_bf16_f32 v75, v181, v189
    v_cvt_pk_bf16_f32 v83, v180, v188
    v_cvt_pk_bf16_f32 v91, v181, v189
    v_mov_b32 v2, v180
    v_mov_b32 v3, v181
    v_mov_b32 v4, v188
    v_mov_b32 v5, v189
    v_cvt_pk_bf16_f32 v39, v184, v192
    v_cvt_pk_bf16_f32 v47, v185, v193
    v_cvt_pk_bf16_f32 v55, v184, v192
    v_cvt_pk_bf16_f32 v63, v185, v193
    v_cvt_pk_bf16_f32 v71, v184, v192
    v_cvt_pk_bf16_f32 v79, v185, v193
    v_cvt_pk_bf16_f32 v87, v184, v192
    v_cvt_pk_bf16_f32 v95, v185, v193
    v_mov_b32 v10, v184
    v_mov_b32 v11, v185
    v_mov_b32 v12, v192
    v_mov_b32 v13, v193
    v_permlane32_swap_b32 v34, v66
    v_permlane32_swap_b32 v50, v82
    v_permlane32_swap_b32 v42, v74
    v_permlane32_swap_b32 v58, v90
    v_permlane32_swap_b32 v38, v70
    v_permlane32_swap_b32 v54, v86
    v_permlane32_swap_b32 v46, v78
    v_permlane32_swap_b32 v62, v94
    v_permlane16_swap_b32 v34, v50
    v_permlane16_swap_b32 v66, v82
    v_permlane16_swap_b32 v42, v58
    v_permlane16_swap_b32 v74, v90
    v_permlane16_swap_b32 v38, v54
    v_permlane16_swap_b32 v70, v86
    v_permlane16_swap_b32 v46, v62
    v_permlane16_swap_b32 v78, v94
    v_mov_b32 v134, 0
    v_mov_b32 v135, 0
    v_mov_b32 v150, 0
    v_mov_b32 v151, 0
    s_branch L_post
L_nosenet:
    s_nop 7
    v_cvt_pk_bf16_f32 v82, v128, v136
    v_cvt_pk_bf16_f32 v90, v129, v137
    v_cvt_pk_bf16_f32 v86, v132, v140
    v_cvt_pk_bf16_f32 v94, v133, v141
    s_add_u32 s56, s61, 0
    buffer_load_dwordx4 v[96:99], v18, s[48:51], s56 offen offset:0 sc1
    s_add_u32 s56, s61, 3328
    buffer_load_dwordx4 v[100:103], v18, s[48:51], s56 offen offset:0 sc1
    s_add_u32 s56, s61, 0
    buffer_load_dwordx4 v[104:107], v18, s[48:51], s56 offen offset:1664 sc1
    s_add_u32 s56, s61, 3328
    buffer_load_dwordx4 v[108:111], v18, s[48:51], s56 offen offset:1664 sc1
    s_add_u32 s56, s61, 0
    buffer_load_dwordx4 v[112:115], v19, s[48:51], s56 offen offset:1024 sc1
    s_add_u32 s56, s61, 3328
    buffer_load_dwordx4 v[116:119], v19, s[48:51], s56 offen offset:1024 sc1
    s_add_u32 s56, s61, 0
    buffer_load_dwordx4 v[172:175], v19, s[48:51], s56 offen offset:2688 sc1
    s_add_u32 s56, s61, 3328
    buffer_load_dwordx4 v[176:179], v19, s[48:51], s56 offen offset:2688 sc1
    v_cvt_pk_bf16_f32 v35, v180, v188
    v_cvt_pk_bf16_f32 v43, v181, v189
    v_cvt_pk_bf16_f32 v51, v180, v188
    v_cvt_pk_bf16_f32 v59, v181, v189
    v_cvt_pk_bf16_f32 v67, v180, v188
    v_cvt_pk_bf16_f32 v75, v181, v189
    v_cvt_pk_bf16_f32 v83, v180, v188
    v_cvt_pk_bf16_f32 v91, v181, v189
    v_mov_b32 v2, v180
    v_mov_b32 v3, v181
    v_mov_b32 v4, v188
    v_mov_b32 v5, v189
    v_cvt_pk_bf16_f32 v39, v184, v192
    v_cvt_pk_bf16_f32 v47, v185, v193
    v_cvt_pk_bf16_f32 v55, v184, v192
    v_cvt_pk_bf16_f32 v63, v185, v193
    v_cvt_pk_bf16_f32 v71, v184, v192
    v_cvt_pk_bf16_f32 v79, v185, v193
    v_cvt_pk_bf16_f32 v87, v184, v192
    v_cvt_pk_bf16_f32 v95, v185, v193
    v_mov_b32 v10, v184
    v_mov_b32 v11, v185
    v_mov_b32 v12, v192
    v_mov_b32 v13, v193
    v_permlane32_swap_b32 v34, v66
    v_permlane32_swap_b32 v50, v82
    v_permlane32_swap_b32 v42, v74
    v_permlane32_swap_b32 v58, v90
    v_permlane32_swap_b32 v38, v70
    v_permlane32_swap_b32 v54, v86
    v_permlane32_swap_b32 v46, v78
    v_permlane32_swap_b32 v62, v94
    v_permlane16_swap_b32 v34, v50
    v_permlane16_swap_b32 v66, v82
    v_permlane16_swap_b32 v42, v58
    v_permlane16_swap_b32 v74, v90
    v_permlane16_swap_b32 v38, v54
    v_permlane16_swap_b32 v70, v86
    v_permlane16_swap_b32 v46, v62
    v_permlane16_swap_b32 v78, v94
    v_mov_b32 v134, 0
    v_mov_b32 v135, 0
    v_mov_b32 v150, 0
    v_mov_b32 v151, 0
    s_barrier
L_post:
    ds_read_b128 v[180:183], v29 offset:0
    ds_read_b128 v[184:187], v29 offset:16
    ds_read_b128 v[188:191], v30 offset:0
    ds_read_b128 v[192:195], v30 offset:16
    v_bfe_u32 v152, v0, 4, 2
    v_lshlrev_b32 v152, 5, v152
    v_sub_u32 v29, v29, v152
    ds_read2_b32 v[156:157], v29 offset0:6 offset1:14
    v_sub_u32 v30, v30, v152
    ds_read2_b32 v[158:159], v30 offset0:6 offset1:14
    s_waitcnt vmcnt(6)
    v_mfma_f32_16x16x32_bf16 v[196:199], v[96:99], v[32:35], 0
    v_mfma_f32_16x16x32_bf16 v[200:203], v[96:99], v[36:39], 0
    v_mfma_f32_16x16x32_bf16 v[204:207], v[100:103], v[40:43], 0
    v_mfma_f32_16x16x32_bf16 v[208:211], v[100:103], v[44:47], 0
    s_waitcnt lgkmcnt(0)
    v_lshrrev_b32 v1, 16, v180
    v_lshrrev_b32 v6, 16, v182
    v_lshrrev_b32 v7, 16, v184
    v_mul_f32 v2, v2, v156
    v_mul_f32 v3, v3, v156
    v_mul_f32 v4, v4, v157
    v_mul_f32 v5, v5, v157
    v_lshrrev_b32 v8, 16, v188
    v_lshrrev_b32 v9, 16, v190
    v_lshrrev_b32 v27, 16, v192
    v_mul_f32 v10, v10, v158
    v_mul_f32 v11, v11, v158
    v_mul_f32 v12, v12, v159
    v_mul_f32 v13, v13, v159
    v_dot2_f32_bf16 v212, v32, v1, 0
    v_dot2_f32_bf16 v213, v32, v181, 0
    v_dot2_f32_bf16 v214, v33, v6, 0
    v_dot2_f32_bf16 v215, v33, v183, 0
    v_dot2_f32_bf16 v216, v34, v7, 0
    v_dot2_f32_bf16 v217, v34, v185, 0
    v_dot2_f32_bf16 v218, v36, v8, 0
    v_dot2_f32_bf16 v219, v36, v189, 0
    v_dot2_f32_bf16 v220, v37, v9, 0
    v_dot2_f32_bf16 v221, v37, v191, 0
    v_dot2_f32_bf16 v222, v38, v27, 0
    v_dot2_f32_bf16 v223, v38, v193, 0
    v_cvt_pk_bf16_f32 v155, v2, v4
    v_cvt_pk_bf16_f32 v152, v212, v213
    v_cvt_pk_bf16_f32 v153, v214, v215
    v_cvt_pk_bf16_f32 v154, v216, v217
    v_cvt_pk_bf16_f32 v159, v10, v12
    v_cvt_pk_bf16_f32 v156, v218, v219
    v_cvt_pk_bf16_f32 v157, v220, v221
    v_cvt_pk_bf16_f32 v158, v222, v223
    v_dot2_f32_bf16 v212, v40, v1, 0
    v_dot2_f32_bf16 v213, v40, v181, 0
    v_dot2_f32_bf16 v214, v41, v6, 0
    v_dot2_f32_bf16 v215, v41, v183, 0
    v_dot2_f32_bf16 v216, v42, v7, 0
    v_dot2_f32_bf16 v217, v42, v185, 0
    v_dot2_f32_bf16 v218, v44, v8, 0
    v_dot2_f32_bf16 v219, v44, v189, 0
    v_dot2_f32_bf16 v220, v45, v9, 0
    v_dot2_f32_bf16 v221, v45, v191, 0
    v_dot2_f32_bf16 v222, v46, v27, 0
    v_dot2_f32_bf16 v223, v46, v193, 0
    v_cvt_pk_bf16_f32 v163, v3, v5
    v_cvt_pk_bf16_f32 v160, v212, v213
    v_cvt_pk_bf16_f32 v161, v214, v215
    v_cvt_pk_bf16_f32 v162, v216, v217
    v_cvt_pk_bf16_f32 v167, v11, v13
    v_cvt_pk_bf16_f32 v164, v218, v219
    v_cvt_pk_bf16_f32 v165, v220, v221
    v_cvt_pk_bf16_f32 v166, v222, v223
    s_waitcnt vmcnt(4)
    v_mfma_f32_16x16x32_bf16 v[212:215], v[104:107], v[152:155], 0
    v_mfma_f32_16x16x32_bf16 v[216:219], v[104:107], v[156:159], 0
    v_mfma_f32_16x16x32_bf16 v[220:223], v[108:111], v[160:163], 0
    v_mfma_f32_16x16x32_bf16 v[224:227], v[108:111], v[164:167], 0
    s_add_u32 s56, s61, 6656
    buffer_load_dwordx4 v[96:99], v18, s[48:51], s56 offen offset:0 sc1
    s_add_u32 s56, s61, 9984
    buffer_load_dwordx4 v[100:103], v18, s[48:51], s56 offen offset:0 sc1
    s_add_u32 s56, s61, 6656
    buffer_load_dwordx4 v[104:107], v18, s[48:51], s56 offen offset:1664 sc1
    s_add_u32 s56, s61, 9984
    buffer_load_dwordx4 v[108:111], v18, s[48:51], s56 offen offset:1664 sc1
    s_waitcnt vmcnt(6)
    v_mfma_f32_16x16x32_bf16 v[228:231], v[112:115], v[32:35], 0
    v_fmac_f32 v196, v212, v180
    v_fmac_f32 v197, v213, v181
    v_fmac_f32 v198, v214, v182
    v_mfma_f32_16x16x32_bf16 v[232:235], v[112:115], v[36:39], 0
    v_fmac_f32 v199, v215, v183
    v_fmac_f32 v204, v220, v180
    v_fmac_f32 v205, v221, v181
    v_mfma_f32_16x16x32_bf16 v[236:239], v[116:119], v[40:43], 0
    v_fmac_f32 v206, v222, v182
    v_fmac_f32 v207, v223, v183
    v_cvt_pk_bf16_f32 v120, v196, v204
    v_mfma_f32_16x16x32_bf16 v[240:243], v[116:119], v[44:47], 0
    v_cvt_pk_bf16_f32 v122, v197, v205
    v_cvt_pk_bf16_f32 v124, v198, v206
    v_cvt_pk_bf16_f32 v126, v199, v207
    s_waitcnt vmcnt(4)
    v_mfma_f32_16x16x32_bf16 v[244:247], v[172:175], v[152:155], 0
    v_fmac_f32 v200, v216, v188
    v_fmac_f32 v201, v217, v189
    v_fmac_f32 v202, v218, v190
    v_mfma_f32_16x16x32_bf16 v[248:251], v[172:175], v[156:159], 0
    v_fmac_f32 v203, v219, v191
    v_fmac_f32 v208, v224, v188
    v_fmac_f32 v209, v225, v189
    v_mfma_f32_16x16x32_bf16 v[252:255], v[176:179], v[160:163], 0
    v_fmac_f32 v210, v226, v190
    v_fmac_f32 v211, v227, v191
    v_cvt_pk_bf16_f32 v136, v200, v208
    v_mfma_f32_16x16x32_bf16 v[168:171], v[176:179], v[164:167], 0
    v_cvt_pk_bf16_f32 v138, v201, v209
    v_cvt_pk_bf16_f32 v140, v202, v210
    v_cvt_pk_bf16_f32 v142, v203, v211
    s_add_u32 s56, s61, 6656
    buffer_load_dwordx4 v[112:115], v19, s[48:51], s56 offen offset:1024 sc1
    s_add_u32 s56, s61, 9984
    buffer_load_dwordx4 v[116:119], v19, s[48:51], s56 offen offset:1024 sc1
    s_add_u32 s56, s61, 6656
    buffer_load_dwordx4 v[172:175], v19, s[48:51], s56 offen offset:2688 sc1
    s_add_u32 s56, s61, 9984
    buffer_load_dwordx4 v[176:179], v19, s[48:51], s56 offen offset:2688 sc1
    v_dot2_f32_bf16 v212, v48, v1, 0
    v_dot2_f32_bf16 v213, v48, v181, 0
    v_dot2_f32_bf16 v214, v49, v6, 0
    v_dot2_f32_bf16 v215, v49, v183, 0
    v_dot2_f32_bf16 v216, v50, v7, 0
    v_dot2_f32_bf16 v217, v50, v185, 0
    v_dot2_f32_bf16 v218, v52, v8, 0
    v_dot2_f32_bf16 v219, v52, v189, 0
    v_dot2_f32_bf16 v220, v53, v9, 0
    v_dot2_f32_bf16 v221, v53, v191, 0
    v_dot2_f32_bf16 v222, v54, v27, 0
    v_dot2_f32_bf16 v223, v54, v193, 0
    v_cvt_pk_bf16_f32 v152, v212, v213
    v_cvt_pk_bf16_f32 v153, v214, v215
    v_cvt_pk_bf16_f32 v154, v216, v217
    v_cvt_pk_bf16_f32 v156, v218, v219
    v_cvt_pk_bf16_f32 v157, v220, v221
    v_cvt_pk_bf16_f32 v158, v222, v223
    v_dot2_f32_bf16 v212, v56, v1, 0
    v_dot2_f32_bf16 v213, v56, v181, 0
    v_dot2_f32_bf16 v214, v57, v6, 0
    v_dot2_f32_bf16 v215, v57, v183, 0
    v_dot2_f32_bf16 v216, v58, v7, 0
    v_dot2_f32_bf16 v217, v58, v185, 0
    v_dot2_f32_bf16 v218, v60, v8, 0
    v_dot2_f32_bf16 v219, v60, v189, 0
    v_dot2_f32_bf16 v220, v61, v9, 0
    v_dot2_f32_bf16 v221, v61, v191, 0
    v_dot2_f32_bf16 v222, v62, v27, 0
    v_dot2_f32_bf16 v223, v62, v193, 0
    v_cvt_pk_bf16_f32 v160, v212, v213
    v_cvt_pk_bf16_f32 v161, v214, v215
    v_cvt_pk_bf16_f32 v162, v216, v217
    v_cvt_pk_bf16_f32 v164, v218, v219
    v_cvt_pk_bf16_f32 v165, v220, v221
    v_cvt_pk_bf16_f32 v166, v222, v223
    s_waitcnt vmcnt(6)
    v_mfma_f32_16x16x32_bf16 v[196:199], v[96:99], v[48:51], 0
    v_fmac_f32 v228, v244, v184
    v_fmac_f32 v229, v245, v185
    v_mfma_f32_16x16x32_bf16 v[200:203], v[96:99], v[52:55], 0
    v_fmac_f32 v230, v246, v186
    v_fmac_f32 v236, v252, v184
    v_mfma_f32_16x16x32_bf16 v[204:207], v[100:103], v[56:59], 0
    v_fmac_f32 v237, v253, v185
    v_fmac_f32 v238, v254, v186
    v_mfma_f32_16x16x32_bf16 v[208:211], v[100:103], v[60:63], 0
    v_cvt_pk_bf16_f32 v128, v228, v236
    v_cvt_pk_bf16_f32 v130, v229, v237
    v_cvt_pk_bf16_f32 v132, v230, v238
    s_waitcnt vmcnt(4)
    v_mfma_f32_16x16x32_bf16 v[212:215], v[104:107], v[152:155], 0
    v_fmac_f32 v232, v248, v192
    v_fmac_f32 v233, v249, v193
    v_mfma_f32_16x16x32_bf16 v[216:219], v[104:107], v[156:159], 0
    v_fmac_f32 v234, v250, v194
    v_fmac_f32 v240, v168, v192
    v_mfma_f32_16x16x32_bf16 v[220:223], v[108:111], v[160:163], 0
    v_fmac_f32 v241, v169, v193
    v_fmac_f32 v242, v170, v194
    v_mfma_f32_16x16x32_bf16 v[224:227], v[108:111], v[164:167], 0
    v_cvt_pk_bf16_f32 v144, v232, v240
    v_cvt_pk_bf16_f32 v146, v233, v241
    v_cvt_pk_bf16_f32 v148, v234, v242
    s_add_u32 s56, s61, 13312
    buffer_load_dwordx4 v[96:99], v18, s[48:51], s56 offen offset:0 sc1
    s_add_u32 s56, s61, 16640
    buffer_load_dwordx4 v[100:103], v18, s[48:51], s56 offen offset:0 sc1
    s_add_u32 s56, s61, 13312
    buffer_load_dwordx4 v[104:107], v18, s[48:51], s56 offen offset:1664 sc1
    s_add_u32 s56, s61, 16640
    buffer_load_dwordx4 v[108:111], v18, s[48:51], s56 offen offset:1664 sc1
    s_waitcnt vmcnt(6)
    v_mfma_f32_16x16x32_bf16 v[228:231], v[112:115], v[48:51], 0
    v_fmac_f32 v196, v212, v180
    v_fmac_f32 v197, v213, v181
    v_fmac_f32 v198, v214, v182
    v_mfma_f32_16x16x32_bf16 v[232:235], v[112:115], v[52:55], 0
    v_fmac_f32 v199, v215, v183
    v_fmac_f32 v204, v220, v180
    v_fmac_f32 v205, v221, v181
    v_mfma_f32_16x16x32_bf16 v[236:239], v[116:119], v[56:59], 0
    v_fmac_f32 v206, v222, v182
    v_fmac_f32 v207, v223, v183
    v_cvt_pk_bf16_f32 v121, v196, v204
    v_mfma_f32_16x16x32_bf16 v[240:243], v[116:119], v[60:63], 0
    v_cvt_pk_bf16_f32 v123, v197, v205
    v_cvt_pk_bf16_f32 v125, v198, v206
    v_cvt_pk_bf16_f32 v127, v199, v207
    s_waitcnt vmcnt(4)
    v_mfma_f32_16x16x32_bf16 v[244:247], v[172:175], v[152:155], 0
    v_fmac_f32 v200, v216, v188
    v_fmac_f32 v201, v217, v189
    v_fmac_f32 v202, v218, v190
    v_mfma_f32_16x16x32_bf16 v[248:251], v[172:175], v[156:159], 0
    v_fmac_f32 v203, v219, v191
    v_fmac_f32 v208, v224, v188
    v_fmac_f32 v209, v225, v189
    v_mfma_f32_16x16x32_bf16 v[252:255], v[176:179], v[160:163], 0
    v_fmac_f32 v210, v226, v190
    v_fmac_f32 v211, v227, v191
    v_cvt_pk_bf16_f32 v137, v200, v208
    v_mfma_f32_16x16x32_bf16 v[168:171], v[176:179], v[164:167], 0
    v_cvt_pk_bf16_f32 v139, v201, v209
    v_cvt_pk_bf16_f32 v141, v202, v210
    v_cvt_pk_bf16_f32 v143, v203, v211
    s_add_u32 s56, s61, 13312
    buffer_load_dwordx4 v[112:115], v19, s[48:51], s56 offen offset:1024 sc1
    s_add_u32 s56, s61, 16640
    buffer_load_dwordx4 v[116:119], v19, s[48:51], s56 offen offset:1024 sc1
    s_add_u32 s56, s61, 13312
    buffer_load_dwordx4 v[172:175], v19, s[48:51], s56 offen offset:2688 sc1
    s_add_u32 s56, s61, 16640
    buffer_load_dwordx4 v[176:179], v19, s[48:51], s56 offen offset:2688 sc1
    ds_read_b64 v[32:33], v14 offset:0
    ds_read_b64 v[34:35], v14 offset:4096
    ds_read_b64 v[36:37], v14 offset:32768
    ds_read_b64 v[38:39], v14 offset:36864
    ds_read_b64 v[40:41], v22 offset:0
    ds_read_b64 v[42:43], v22 offset:4096
    ds_read_b64 v[44:45], v16 offset:0
    ds_read_b64 v[48:49], v15 offset:0
    ds_read_b64 v[50:51], v15 offset:4096
    ds_read_b64 v[52:53], v15 offset:32768
    ds_read_b64 v[54:55], v15 offset:36864
    ds_read_b64 v[56:57], v23 offset:0
    ds_read_b64 v[58:59], v23 offset:4096
    ds_read_b64 v[60:61], v17 offset:0
    v_dot2_f32_bf16 v212, v64, v1, 0
    v_dot2_f32_bf16 v213, v64, v181, 0
    v_dot2_f32_bf16 v214, v65, v6, 0
    v_dot2_f32_bf16 v215, v65, v183, 0
    v_dot2_f32_bf16 v216, v66, v7, 0
    v_dot2_f32_bf16 v217, v66, v185, 0
    v_dot2_f32_bf16 v218, v68, v8, 0
    v_dot2_f32_bf16 v219, v68, v189, 0
    v_dot2_f32_bf16 v220, v69, v9, 0
    v_dot2_f32_bf16 v221, v69, v191, 0
    v_dot2_f32_bf16 v222, v70, v27, 0
    v_dot2_f32_bf16 v223, v70, v193, 0
    v_cvt_pk_bf16_f32 v152, v212, v213
    v_cvt_pk_bf16_f32 v153, v214, v215
    v_cvt_pk_bf16_f32 v154, v216, v217
    v_cvt_pk_bf16_f32 v156, v218, v219
    v_cvt_pk_bf16_f32 v157, v220, v221
    v_cvt_pk_bf16_f32 v158, v222, v223
    v_dot2_f32_bf16 v212, v72, v1, 0
    v_dot2_f32_bf16 v213, v72, v181, 0
    v_dot2_f32_bf16 v214, v73, v6, 0
    v_dot2_f32_bf16 v215, v73, v183, 0
    v_dot2_f32_bf16 v216, v74, v7, 0
    v_dot2_f32_bf16 v217, v74, v185, 0
    v_dot2_f32_bf16 v218, v76, v8, 0
    v_dot2_f32_bf16 v219, v76, v189, 0
    v_dot2_f32_bf16 v220, v77, v9, 0
    v_dot2_f32_bf16 v221, v77, v191, 0
    v_dot2_f32_bf16 v222, v78, v27, 0
    v_dot2_f32_bf16 v223, v78, v193, 0
    v_cvt_pk_bf16_f32 v160, v212, v213
    v_cvt_pk_bf16_f32 v161, v214, v215
    v_cvt_pk_bf16_f32 v162, v216, v217
    v_cvt_pk_bf16_f32 v164, v218, v219
    v_cvt_pk_bf16_f32 v165, v220, v221
    v_cvt_pk_bf16_f32 v166, v222, v223
    s_waitcnt vmcnt(6)
    v_mfma_f32_16x16x32_bf16 v[196:199], v[96:99], v[64:67], 0
    v_fmac_f32 v228, v244, v184
    v_fmac_f32 v229, v245, v185
    v_mfma_f32_16x16x32_bf16 v[200:203], v[96:99], v[68:71], 0
    v_fmac_f32 v230, v246, v186
    v_fmac_f32 v236, v252, v184
    v_mfma_f32_16x16x32_bf16 v[204:207], v[100:103], v[72:75], 0
    v_fmac_f32 v237, v253, v185
    v_fmac_f32 v238, v254, v186
    v_mfma_f32_16x16x32_bf16 v[208:211], v[100:103], v[76:79], 0
    v_cvt_pk_bf16_f32 v129, v228, v236
    v_cvt_pk_bf16_f32 v131, v229, v237
    v_cvt_pk_bf16_f32 v133, v230, v238
    s_waitcnt vmcnt(4)
    v_mfma_f32_16x16x32_bf16 v[212:215], v[104:107], v[152:155], 0
    v_fmac_f32 v232, v248, v192
    v_fmac_f32 v233, v249, v193
    v_mfma_f32_16x16x32_bf16 v[216:219], v[104:107], v[156:159], 0
    v_fmac_f32 v234, v250, v194
    v_fmac_f32 v240, v168, v192
    v_mfma_f32_16x16x32_bf16 v[220:223], v[108:111], v[160:163], 0
    v_fmac_f32 v241, v169, v193
    v_fmac_f32 v242, v170, v194
    v_mfma_f32_16x16x32_bf16 v[224:227], v[108:111], v[164:167], 0
    v_cvt_pk_bf16_f32 v145, v232, v240
    v_cvt_pk_bf16_f32 v147, v233, v241
    v_cvt_pk_bf16_f32 v149, v234, v242
    s_add_u32 s56, s61, 19968
    buffer_load_dwordx4 v[96:99], v18, s[48:51], s56 offen offset:0 sc1
    s_add_u32 s56, s61, 23296
    buffer_load_dwordx4 v[100:103], v18, s[48:51], s56 offen offset:0 sc1
    s_add_u32 s56, s61, 19968
    buffer_load_dwordx4 v[104:107], v18, s[48:51], s56 offen offset:1664 sc1
    s_add_u32 s56, s61, 23296
    buffer_load_dwordx4 v[108:111], v18, s[48:51], s56 offen offset:1664 sc1
    s_waitcnt lgkmcnt(0)
    v_mfma_f32_16x16x32_bf16 v[2:5], v[120:123], v[32:35], 0
    v_mfma_f32_16x16x32_bf16 v[10:13], v[136:139], v[48:51], 0
    v_mfma_f32_16x16x32_bf16 v[2:5], v[124:127], v[36:39], v[2:5]
    v_mfma_f32_16x16x32_bf16 v[10:13], v[140:143], v[52:55], v[10:13]
    v_mfma_f32_16x16x32_bf16 v[2:5], v[128:131], v[40:43], v[2:5]
    v_mfma_f32_16x16x32_bf16 v[10:13], v[144:147], v[56:59], v[10:13]
    v_mfma_f32_16x16x32_bf16 v[2:5], v[132:135], v[44:47], v[2:5]
    v_mfma_f32_16x16x32_bf16 v[10:13], v[148:151], v[60:63], v[10:13]
    s_waitcnt vmcnt(6)
    v_mfma_f32_16x16x32_bf16 v[228:231], v[112:115], v[64:67], 0
    v_fmac_f32 v196, v212, v180
    v_fmac_f32 v197, v213, v181
    v_fmac_f32 v198, v214, v182
    v_mfma_f32_16x16x32_bf16 v[232:235], v[112:115], v[68:71], 0
    v_fmac_f32 v199, v215, v183
    v_fmac_f32 v204, v220, v180
    v_fmac_f32 v205, v221, v181
    v_mfma_f32_16x16x32_bf16 v[236:239], v[116:119], v[72:75], 0
    v_fmac_f32 v206, v222, v182
    v_fmac_f32 v207, v223, v183
    v_cvt_pk_bf16_f32 v120, v196, v204
    v_mfma_f32_16x16x32_bf16 v[240:243], v[116:119], v[76:79], 0
    v_cvt_pk_bf16_f32 v122, v197, v205
    v_cvt_pk_bf16_f32 v124, v198, v206
    v_cvt_pk_bf16_f32 v126, v199, v207
    s_waitcnt vmcnt(4)
    v_mfma_f32_16x16x32_bf16 v[244:247], v[172:175], v[152:155], 0
    v_fmac_f32 v200, v216, v188
    v_fmac_f32 v201, v217, v189
    v_fmac_f32 v202, v218, v190
    v_mfma_f32_16x16x32_bf16 v[248:251], v[172:175], v[156:159], 0
    v_fmac_f32 v203, v219, v191
    v_fmac_f32 v208, v224, v188
    v_fmac_f32 v209, v225, v189
    v_mfma_f32_16x16x32_bf16 v[252:255], v[176:179], v[160:163], 0
    v_fmac_f32 v210, v226, v190
    v_fmac_f32 v211, v227, v191
    v_cvt_pk_bf16_f32 v136, v200, v208
    v_mfma_f32_16x16x32_bf16 v[168:171], v[176:179], v[164:167], 0
    v_cvt_pk_bf16_f32 v138, v201, v209
    v_cvt_pk_bf16_f32 v140, v202, v210
    v_cvt_pk_bf16_f32 v142, v203, v211
    s_add_u32 s56, s61, 19968
    buffer_load_dwordx4 v[112:115], v19, s[48:51], s56 offen offset:1024 sc1
    s_add_u32 s56, s61, 23296
    buffer_load_dwordx4 v[116:119], v19, s[48:51], s56 offen offset:1024 sc1
    s_add_u32 s56, s61, 19968
    buffer_load_dwordx4 v[172:175], v19, s[48:51], s56 offen offset:2688 sc1
    s_add_u32 s56, s61, 23296
    buffer_load_dwordx4 v[176:179], v19, s[48:51], s56 offen offset:2688 sc1
    ds_read_b64 v[32:33], v14 offset:8
    ds_read_b64 v[34:35], v14 offset:4104
    ds_read_b64 v[36:37], v14 offset:32776
    ds_read_b64 v[38:39], v14 offset:36872
    ds_read_b64 v[40:41], v22 offset:8
    ds_read_b64 v[42:43], v22 offset:4104
    ds_read_b64 v[44:45], v16 offset:8
    ds_read_b64 v[48:49], v15 offset:8
    ds_read_b64 v[50:51], v15 offset:4104
    ds_read_b64 v[52:53], v15 offset:32776
    ds_read_b64 v[54:55], v15 offset:36872
    ds_read_b64 v[56:57], v23 offset:8
    ds_read_b64 v[58:59], v23 offset:4104
    ds_read_b64 v[60:61], v17 offset:8
    v_dot2_f32_bf16 v212, v80, v1, 0
    v_dot2_f32_bf16 v213, v80, v181, 0
    v_dot2_f32_bf16 v214, v81, v6, 0
    v_dot2_f32_bf16 v215, v81, v183, 0
    v_dot2_f32_bf16 v216, v82, v7, 0
    v_dot2_f32_bf16 v217, v82, v185, 0
    v_dot2_f32_bf16 v218, v84, v8, 0
    v_dot2_f32_bf16 v219, v84, v189, 0
    v_dot2_f32_bf16 v220, v85, v9, 0
    v_dot2_f32_bf16 v221, v85, v191, 0
    v_dot2_f32_bf16 v222, v86, v27, 0
    v_dot2_f32_bf16 v223, v86, v193, 0
    v_cvt_pk_bf16_f32 v152, v212, v213
    v_cvt_pk_bf16_f32 v153, v214, v215
    v_cvt_pk_bf16_f32 v154, v216, v217
    v_cvt_pk_bf16_f32 v156, v218, v219
    v_cvt_pk_bf16_f32 v157, v220, v221
    v_cvt_pk_bf16_f32 v158, v222, v223
    v_dot2_f32_bf16 v212, v88, v1, 0
    v_dot2_f32_bf16 v213, v88, v181, 0
    v_dot2_f32_bf16 v214, v89, v6, 0
    v_dot2_f32_bf16 v215, v89, v183, 0
    v_dot2_f32_bf16 v216, v90, v7, 0
    v_dot2_f32_bf16 v217, v90, v185, 0
    v_dot2_f32_bf16 v218, v92, v8, 0
    v_dot2_f32_bf16 v219, v92, v189, 0
    v_dot2_f32_bf16 v220, v93, v9, 0
    v_dot2_f32_bf16 v221, v93, v191, 0
    v_dot2_f32_bf16 v222, v94, v27, 0
    v_dot2_f32_bf16 v223, v94, v193, 0
    v_cvt_pk_bf16_f32 v160, v212, v213
    v_cvt_pk_bf16_f32 v161, v214, v215
    v_cvt_pk_bf16_f32 v162, v216, v217
    v_cvt_pk_bf16_f32 v164, v218, v219
    v_cvt_pk_bf16_f32 v165, v220, v221
    v_cvt_pk_bf16_f32 v166, v222, v223
    s_waitcnt vmcnt(6)
    v_mfma_f32_16x16x32_bf16 v[196:199], v[96:99], v[80:83], 0
    v_fmac_f32 v228, v244, v184
    v_fmac_f32 v229, v245, v185
    v_mfma_f32_16x16x32_bf16 v[200:203], v[96:99], v[84:87], 0
    v_fmac_f32 v230, v246, v186
    v_fmac_f32 v236, v252, v184
    v_mfma_f32_16x16x32_bf16 v[204:207], v[100:103], v[88:91], 0
    v_fmac_f32 v237, v253, v185
    v_fmac_f32 v238, v254, v186
    v_mfma_f32_16x16x32_bf16 v[208:211], v[100:103], v[92:95], 0
    v_cvt_pk_bf16_f32 v128, v228, v236
    v_cvt_pk_bf16_f32 v130, v229, v237
    v_cvt_pk_bf16_f32 v132, v230, v238
    s_waitcnt vmcnt(4)
    v_mfma_f32_16x16x32_bf16 v[212:215], v[104:107], v[152:155], 0
    v_fmac_f32 v232, v248, v192
    v_fmac_f32 v233, v249, v193
    v_mfma_f32_16x16x32_bf16 v[216:219], v[104:107], v[156:159], 0
    v_fmac_f32 v234, v250, v194
    v_fmac_f32 v240, v168, v192
    v_mfma_f32_16x16x32_bf16 v[220:223], v[108:111], v[160:163], 0
    v_fmac_f32 v241, v169, v193
    v_fmac_f32 v242, v170, v194
    v_mfma_f32_16x16x32_bf16 v[224:227], v[108:111], v[164:167], 0
    v_cvt_pk_bf16_f32 v144, v232, v240
    v_cvt_pk_bf16_f32 v146, v233, v241
    v_cvt_pk_bf16_f32 v148, v234, v242
    s_waitcnt vmcnt(2)
    v_mfma_f32_16x16x32_bf16 v[228:231], v[112:115], v[80:83], 0
    v_fmac_f32 v196, v212, v180
    v_fmac_f32 v197, v213, v181
    v_fmac_f32 v198, v214, v182
    v_mfma_f32_16x16x32_bf16 v[232:235], v[112:115], v[84:87], 0
    v_fmac_f32 v199, v215, v183
    v_fmac_f32 v204, v220, v180
    v_fmac_f32 v205, v221, v181
    v_mfma_f32_16x16x32_bf16 v[236:239], v[116:119], v[88:91], 0
    v_fmac_f32 v206, v222, v182
    v_fmac_f32 v207, v223, v183
    v_cvt_pk_bf16_f32 v121, v196, v204
    v_mfma_f32_16x16x32_bf16 v[240:243], v[116:119], v[92:95], 0
    v_cvt_pk_bf16_f32 v123, v197, v205
    v_cvt_pk_bf16_f32 v125, v198, v206
    v_cvt_pk_bf16_f32 v127, v199, v207
    s_waitcnt vmcnt(0)
    v_mfma_f32_16x16x32_bf16 v[244:247], v[172:175], v[152:155], 0
    v_fmac_f32 v200, v216, v188
    v_fmac_f32 v201, v217, v189
    v_fmac_f32 v202, v218, v190
    v_mfma_f32_16x16x32_bf16 v[248:251], v[172:175], v[156:159], 0
    v_fmac_f32 v203, v219, v191
    v_fmac_f32 v208, v224, v188
    v_fmac_f32 v209, v225, v189
    v_mfma_f32_16x16x32_bf16 v[252:255], v[176:179], v[160:163], 0
    v_fmac_f32 v210, v226, v190
    v_fmac_f32 v211, v227, v191
    v_cvt_pk_bf16_f32 v137, v200, v208
    v_mfma_f32_16x16x32_bf16 v[168:171], v[176:179], v[164:167], 0
    v_cvt_pk_bf16_f32 v139, v201, v209
    v_cvt_pk_bf16_f32 v141, v202, v210
    v_cvt_pk_bf16_f32 v143, v203, v211
    s_lshl_b32 s56, s52, 28
    buffer_load_dwordx2 v[24:25], v20, s[48:51], s56 offen sc1
    v_fmac_f32 v228, v244, v184
    v_fmac_f32 v229, v245, v185
    v_fmac_f32 v230, v246, v186
    v_fmac_f32 v236, v252, v184
    v_fmac_f32 v237, v253, v185
    v_fmac_f32 v238, v254, v186
    v_cvt_pk_bf16_f32 v129, v228, v236
    v_cvt_pk_bf16_f32 v131, v229, v237
    v_cvt_pk_bf16_f32 v133, v230, v238
    v_fmac_f32 v232, v248, v192
    v_fmac_f32 v233, v249, v193
    v_fmac_f32 v234, v250, v194
    v_fmac_f32 v240, v168, v192
    v_fmac_f32 v241, v169, v193
    v_fmac_f32 v242, v170, v194
    v_cvt_pk_bf16_f32 v145, v232, v240
    v_cvt_pk_bf16_f32 v147, v233, v241
    v_cvt_pk_bf16_f32 v149, v234, v242
    s_waitcnt lgkmcnt(0)
    v_mfma_f32_16x16x32_bf16 v[2:5], v[120:123], v[32:35], v[2:5]
    v_mfma_f32_16x16x32_bf16 v[10:13], v[136:139], v[48:51], v[10:13]
    v_mfma_f32_16x16x32_bf16 v[2:5], v[124:127], v[36:39], v[2:5]
    v_mfma_f32_16x16x32_bf16 v[10:13], v[140:143], v[52:55], v[10:13]
    v_mfma_f32_16x16x32_bf16 v[2:5], v[128:131], v[40:43], v[2:5]
    v_mfma_f32_16x16x32_bf16 v[10:13], v[144:147], v[56:59], v[10:13]
    v_mfma_f32_16x16x32_bf16 v[2:5], v[132:135], v[44:47], v[2:5]
    v_mfma_f32_16x16x32_bf16 v[10:13], v[148:151], v[60:63], v[10:13]
    s_and_b32 s56, s60, 0x400
    v_add_u32 v31, s56, v31
    v_xor_b32 v29, 0x400, v31
    s_cmp_lg_u32 s52, 0
    s_nop 2
    ds_write_b128 v31, v[2:5]
    ds_write_b128 v29, v[10:13]
    s_cbranch_scc0 L_w0
    s_waitcnt lgkmcnt(0)
    s_barrier
    s_branch L_end
L_w0:
    buffer_load_dwordx2 v[40:41], v20, s[48:51], 0 offen sc1
    v_and_b32 v1, 31, v0
    v_and_b32 v6, 15, v0
    v_lshrrev_b32 v7, 2, v6
    v_lshl_add_u32 v7, v7, 4, v6
    v_lshlrev_b32 v7, 4, v7
    v_and_b32 v6, 3, v0
    v_lshl_add_u32 v7, v6, 2, v7
    v_bfe_u32 v6, v0, 4, 1
    v_lshl_add_u32 v7, v6, 10, v7
    v_bfe_u32 v6, v0, 5, 1
    v_lshl_add_u32 v7, v6, 13, v7
    v_add_u32 v7, 106496, v7
    s_lshl1_add_u32 s56, s53, s54
    s_lshl_b32 s56, s56, 6
    v_lshlrev_b32 v9, 1, v1
    s_lshl_b32 s57, s53, 2
    s_mov_b32 s59, 0
L_poll:
    s_waitcnt vmcnt(1)
    v_cmp_eq_u32 vcc, v25, v21
    s_cbranch_vccz L_got
    buffer_load_dwordx2 v[24:25], v20, s[48:51], 0 offen sc1
    s_waitcnt vmcnt(1)
    v_cmp_eq_u32 vcc, v41, v21
    s_cbranch_vccz L_got2
    buffer_load_dwordx2 v[40:41], v20, s[48:51], 0 offen sc1
    s_add_u32 s59, s59, 1
    s_and_b32 s58, s59, 15
    s_cbranch_scc1 L_poll
    s_mov_b64 exec, 1
    buffer_load_dword v27, off, s[44:47], s57 sc1
    s_waitcnt vmcnt(0)
    v_readfirstlane_b32 s58, v27
    s_mov_b64 exec, -1
    s_bitcmp1_b32 s58, 1
    s_cselect_b32 s6, 0, -1
    s_bitcmp1_b32 s58, 17
    s_cselect_b32 s7, 0, -1
    s_mov_b32 s58, 0x10000
    buffer_load_dwordx2 v[24:25], v20, s[48:51], s58 offen sc1
    s_waitcnt vmcnt(0)
    v_cmp_eq_u32 vcc, v25, v26
    s_nop 0
    s_and_b64 vcc, vcc, s[6:7]
    s_cbranch_scc0 L_got
    buffer_load_dwordx2 v[24:25], v20, s[48:51], 0 offen sc1
    buffer_load_dwordx2 v[40:41], v20, s[48:51], 0 offen sc1
    s_branch L_poll
L_got:
    v_mov_b32 v8, v24
    s_branch L_got3
L_got2:
    v_mov_b32 v8, v40
L_got3:
    s_waitcnt lgkmcnt(0)
    s_barrier
    ds_read_b32 v32, v7 offset:0
    ds_read_b32 v33, v7 offset:2048
    ds_read_b32 v34, v7 offset:4096
    ds_read_b32 v35, v7 offset:6144
    s_waitcnt lgkmcnt(2)
    v_add_f32 v32, v32, v33
    v_add_f32 v32, v32, v8
    s_waitcnt lgkmcnt(0)
    v_add_f32 v34, v34, v35
    v_add_f32 v32, v32, v34
    v_mov_b32 v33, v32
    s_nop 1
    v_permlane32_swap_b32 v32, v33
    v_add_f32 v4, v32, v33
    v_cvt_pk_bf16_f32 v4, v4, v4
    s_mov_b32 exec_hi, 0
    buffer_store_short v4, v9, s[40:43], s56 offen
    s_branch L_end
L_Bl2:
    v_lshrrev_b32 v15, 4, v0
    v_xor_b32 v15, v15, v0
    v_and_b32 v15, 7, v15
    v_lshlrev_b32 v2, 4, v15
    s_waitcnt vmcnt(32)
    v_lshlrev_b32 v4, 7, v4
    v_lshlrev_b32 v5, 7, v5
    v_lshlrev_b32 v6, 7, v6
    v_lshlrev_b32 v7, 7, v7
    v_lshlrev_b32 v8, 7, v8
    v_lshlrev_b32 v9, 7, v9
    v_lshlrev_b32 v10, 7, v10
    v_lshlrev_b32 v11, 7, v11
    v_add_u32_dpp v12, v4, v2 row_newbcast:0 row_mask:0xf bank_mask:0x3
    v_add_u32_dpp v13, v8, v2 row_newbcast:0 row_mask:0xf bank_mask:0x3
    s_add_u32 m0, s60, 131072
    v_add_u32_dpp v12, v4, v2 row_newbcast:8 row_mask:0xf bank_mask:0xc
    v_add_u32_dpp v13, v8, v2 row_newbcast:8 row_mask:0xf bank_mask:0xc
    buffer_load_dwordx4 v12, s[12:15], 0 offen lds
    s_addk_i32 m0, 0x1000
    s_nop 0
    buffer_load_dwordx4 v13, s[12:15], 0 offen lds
    v_add_u32_dpp v12, v5, v2 row_newbcast:0 row_mask:0xf bank_mask:0x3
    v_add_u32_dpp v13, v9, v2 row_newbcast:0 row_mask:0xf bank_mask:0x3
    s_add_u32 m0, s60, 139264
    v_add_u32_dpp v12, v5, v2 row_newbcast:8 row_mask:0xf bank_mask:0xc
    v_add_u32_dpp v13, v9, v2 row_newbcast:8 row_mask:0xf bank_mask:0xc
    buffer_load_dwordx4 v12, s[12:15], 0 offen lds
    s_addk_i32 m0, 0x1000
    s_nop 0
    buffer_load_dwordx4 v13, s[12:15], 0 offen lds
    v_add_u32_dpp v12, v6, v2 row_newbcast:0 row_mask:0xf bank_mask:0x3
    v_add_u32_dpp v13, v10, v2 row_newbcast:0 row_mask:0xf bank_mask:0x3
    s_add_u32 m0, s60, 147456
    v_add_u32_dpp v12, v6, v2 row_newbcast:8 row_mask:0xf bank_mask:0xc
    v_add_u32_dpp v13, v10, v2 row_newbcast:8 row_mask:0xf bank_mask:0xc
    buffer_load_dwordx4 v12, s[12:15], 0 offen lds
    s_addk_i32 m0, 0x1000
    s_nop 0
    buffer_load_dwordx4 v13, s[12:15], 0 offen lds
    v_add_u32_dpp v12, v7, v2 row_newbcast:0 row_mask:0xf bank_mask:0x3
    v_add_u32_dpp v13, v11, v2 row_newbcast:0 row_mask:0xf bank_mask:0x3
    s_add_u32 m0, s60, 155648
    v_add_u32_dpp v12, v7, v2 row_newbcast:8 row_mask:0xf bank_mask:0xc
    v_add_u32_dpp v13, v11, v2 row_newbcast:8 row_mask:0xf bank_mask:0xc
    buffer_load_dwordx4 v12, s[12:15], 0 offen lds
    s_addk_i32 m0, 0x1000
    s_nop 0
    buffer_load_dwordx4 v13, s[12:15], 0 offen lds
    s_waitcnt vmcnt(6)
    s_barrier
    s_waitcnt vmcnt(4)
    s_barrier
    s_add_u32 m0, s60, 0
    s_mov_b32 s56, 262144
    buffer_load_dwordx4 v1, s[16:19], s56 offen lds
    s_add_u32 m0, s60, 4096
    s_mov_b32 s56, 270336
    buffer_load_dwordx4 v1, s[16:19], s56 offen lds
    s_add_u32 m0, s60, 8192
    s_mov_b32 s56, 278528
    buffer_load_dwordx4 v1, s[16:19], s56 offen lds
    v_add_u32_dpp v12, v4, v2 row_newbcast:1 row_mask:0xf bank_mask:0x3
    v_add_u32_dpp v13, v8, v2 row_newbcast:1 row_mask:0xf bank_mask:0x3
    s_add_u32 m0, s60, 131072
    v_add_u32_dpp v12, v4, v2 row_newbcast:9 row_mask:0xf bank_mask:0xc
    v_add_u32_dpp v13, v8, v2 row_newbcast:9 row_mask:0xf bank_mask:0xc
    buffer_load_dwordx4 v12, s[12:15], 0 offen lds
    s_addk_i32 m0, 0x1000
    s_nop 0
    buffer_load_dwordx4 v13, s[12:15], 0 offen lds
    s_waitcnt vmcnt(7)
    s_barrier
    s_add_u32 m0, s60, 12288
    s_mov_b32 s56, 286720
    buffer_load_dwordx4 v1, s[16:19], s56 offen lds
    s_add_u32 m0, s60, 16384
    s_mov_b32 s56, 294912
    buffer_load_dwordx4 v1, s[16:19], s56 offen lds
    s_add_u32 m0, s60, 20480
    s_mov_b32 s56, 303104
    buffer_load_dwordx4 v1, s[16:19], s56 offen lds
    v_add_u32_dpp v12, v5, v2 row_newbcast:1 row_mask:0xf bank_mask:0x3
    v_add_u32_dpp v13, v9, v2 row_newbcast:1 row_mask:0xf bank_mask:0x3
    s_add_u32 m0, s60, 139264
    v_add_u32_dpp v12, v5, v2 row_newbcast:9 row_mask:0xf bank_mask:0xc
    v_add_u32_dpp v13, v9, v2 row_newbcast:9 row_mask:0xf bank_mask:0xc
    buffer_load_dwordx4 v12, s[12:15], 0 offen lds
    s_addk_i32 m0, 0x1000
    s_nop 0
    buffer_load_dwordx4 v13, s[12:15], 0 offen lds
    s_waitcnt vmcnt(10)
    s_barrier
    s_add_u32 m0, s60, 24576
    s_mov_b32 s56, 311296
    buffer_load_dwordx4 v1, s[16:19], s56 offen lds
    s_add_u32 m0, s60, 28672
    s_mov_b32 s56, 319488
    buffer_load_dwordx4 v1, s[16:19], s56 offen lds
    s_add_u32 m0, s60, 32768
    s_mov_b32 s56, 327680
    buffer_load_dwordx4 v1, s[16:19], s56 offen lds
    v_add_u32_dpp v12, v6, v2 row_newbcast:1 row_mask:0xf bank_mask:0x3
    v_add_u32_dpp v13, v10, v2 row_newbcast:1 row_mask:0xf bank_mask:0x3
    s_add_u32 m0, s60, 147456
    v_add_u32_dpp v12, v6, v2 row_newbcast:9 row_mask:0xf bank_mask:0xc
    v_add_u32_dpp v13, v10, v2 row_newbcast:9 row_mask:0xf bank_mask:0xc
    buffer_load_dwordx4 v12, s[12:15], 0 offen lds
    s_addk_i32 m0, 0x1000
    s_nop 0
    buffer_load_dwordx4 v13, s[12:15], 0 offen lds
    s_waitcnt vmcnt(10)
    s_barrier
    s_add_u32 m0, s60, 36864
    s_mov_b32 s56, 335872
    buffer_load_dwordx4 v1, s[16:19], s56 offen lds
    s_add_u32 m0, s60, 40960
    s_mov_b32 s56, 344064
    buffer_load_dwordx4 v1, s[16:19], s56 offen lds
    s_add_u32 m0, s60, 45056
    s_mov_b32 s56, 352256
    buffer_load_dwordx4 v1, s[16:19], s56 offen lds
    s_add_u32 m0, s60, 49152
    s_mov_b32 s56, 360448
    buffer_load_dwordx4 v1, s[16:19], s56 offen lds
    v_add_u32_dpp v12, v7, v2 row_newbcast:1 row_mask:0xf bank_mask:0x3
    v_add_u32_dpp v13, v11, v2 row_newbcast:1 row_mask:0xf bank_mask:0x3
    s_add_u32 m0, s60, 155648
    v_add_u32_dpp v12, v7, v2 row_newbcast:9 row_mask:0xf bank_mask:0xc
    v_add_u32_dpp v13, v11, v2 row_newbcast:9 row_mask:0xf bank_mask:0xc
    buffer_load_dwordx4 v12, s[12:15], 0 offen lds
    s_addk_i32 m0, 0x1000
    s_nop 0
    buffer_load_dwordx4 v13, s[12:15], 0 offen lds
    s_waitcnt vmcnt(11)
    s_barrier
    s_add_u32 m0, s60, 53248
    s_mov_b32 s56, 368640
    buffer_load_dwordx4 v1, s[16:19], s56 offen lds
    s_add_u32 m0, s60, 57344
    s_mov_b32 s56, 376832
    buffer_load_dwordx4 v1, s[16:19], s56 offen lds
    s_add_u32 m0, s60, 61440
    s_mov_b32 s56, 385024
    buffer_load_dwordx4 v1, s[16:19], s56 offen lds
    v_add_u32_dpp v12, v4, v2 row_newbcast:2 row_mask:0xf bank_mask:0x3
    v_add_u32_dpp v13, v8, v2 row_newbcast:2 row_mask:0xf bank_mask:0x3
    s_add_u32 m0, s60, 131072
    v_add_u32_dpp v12, v4, v2 row_newbcast:10 row_mask:0xf bank_mask:0xc
    v_add_u32_dpp v13, v8, v2 row_newbcast:10 row_mask:0xf bank_mask:0xc
    buffer_load_dwordx4 v12, s[12:15], 0 offen lds
    s_addk_i32 m0, 0x1000
    s_nop 0
    buffer_load_dwordx4 v13, s[12:15], 0 offen lds
    s_waitcnt vmcnt(11)
    s_barrier
    s_add_u32 m0, s60, 65536
    s_mov_b32 s56, 393216
    buffer_load_dwordx4 v1, s[16:19], s56 offen lds
    s_add_u32 m0, s60, 69632
    s_mov_b32 s56, 401408
    buffer_load_dwordx4 v1, s[16:19], s56 offen lds
    s_add_u32 m0, s60, 73728
    s_mov_b32 s56, 409600
    buffer_load_dwordx4 v1, s[16:19], s56 offen lds
    v_add_u32_dpp v12, v5, v2 row_newbcast:2 row_mask:0xf bank_mask:0x3
    v_add_u32_dpp v13, v9, v2 row_newbcast:2 row_mask:0xf bank_mask:0x3
    s_add_u32 m0, s60, 139264
    v_add_u32_dpp v12, v5, v2 row_newbcast:10 row_mask:0xf bank_mask:0xc
    v_add_u32_dpp v13, v9, v2 row_newbcast:10 row_mask:0xf bank_mask:0xc
    buffer_load_dwordx4 v12, s[12:15], 0 offen lds
    s_addk_i32 m0, 0x1000
    s_nop 0
    buffer_load_dwordx4 v13, s[12:15], 0 offen lds
    s_waitcnt vmcnt(10)
    s_barrier
    s_add_u32 m0, s60, 77824
    s_mov_b32 s56, 417792
    buffer_load_dwordx4 v1, s[16:19], s56 offen lds
    s_add_u32 m0, s60, 81920
    s_mov_b32 s56, 425984
    buffer_load_dwordx4 v1, s[16:19], s56 offen lds
    s_add_u32 m0, s60, 86016
    s_mov_b32 s56, 434176
    buffer_load_dwordx4 v1, s[16:19], s56 offen lds
    v_add_u32_dpp v12, v6, v2 row_newbcast:2 row_mask:0xf bank_mask:0x3
    v_add_u32_dpp v13, v10, v2 row_newbcast:2 row_mask:0xf bank_mask:0x3
    s_add_u32 m0, s60, 147456
    v_add_u32_dpp v12, v6, v2 row_newbcast:10 row_mask:0xf bank_mask:0xc
    v_add_u32_dpp v13, v10, v2 row_newbcast:10 row_mask:0xf bank_mask:0xc
    buffer_load_dwordx4 v12, s[12:15], 0 offen lds
    s_addk_i32 m0, 0x1000
    s_nop 0
    buffer_load_dwordx4 v13, s[12:15], 0 offen lds
    s_waitcnt vmcnt(10)
    s_barrier
    s_add_u32 m0, s60, 90112
    s_mov_b32 s56, 442368
    buffer_load_dwordx4 v1, s[16:19], s56 offen lds
    s_add_u32 m0, s60, 94208
    s_mov_b32 s56, 450560
    buffer_load_dwordx4 v1, s[16:19], s56 offen lds
    s_add_u32 m0, s60, 98304
    s_mov_b32 s56, 458752
    buffer_load_dwordx4 v1, s[16:19], s56 offen lds
    s_add_u32 m0, s60, 102400
    s_mov_b32 s56, 466944
    buffer_load_dwordx4 v1, s[16:19], s56 offen lds
    v_add_u32_dpp v12, v7, v2 row_newbcast:2 row_mask:0xf bank_mask:0x3
    v_add_u32_dpp v13, v11, v2 row_newbcast:2 row_mask:0xf bank_mask:0x3
    s_add_u32 m0, s60, 155648
    v_add_u32_dpp v12, v7, v2 row_newbcast:10 row_mask:0xf bank_mask:0xc
    v_add_u32_dpp v13, v11, v2 row_newbcast:10 row_mask:0xf bank_mask:0xc
    buffer_load_dwordx4 v12, s[12:15], 0 offen lds
    s_addk_i32 m0, 0x1000
    s_nop 0
    buffer_load_dwordx4 v13, s[12:15], 0 offen lds
    s_waitcnt vmcnt(11)
    s_barrier
    s_add_u32 m0, s60, 106496
    s_mov_b32 s56, 475136
    buffer_load_dwordx4 v1, s[16:19], s56 offen lds
    s_add_u32 m0, s60, 110592
    s_mov_b32 s56, 483328
    buffer_load_dwordx4 v1, s[16:19], s56 offen lds
    s_add_u32 m0, s60, 114688
    s_mov_b32 s56, 491520
    buffer_load_dwordx4 v1, s[16:19], s56 offen lds
    v_add_u32_dpp v12, v4, v2 row_newbcast:3 row_mask:0xf bank_mask:0x3
    v_add_u32_dpp v13, v8, v2 row_newbcast:3 row_mask:0xf bank_mask:0x3
    s_add_u32 m0, s60, 131072
    v_add_u32_dpp v12, v4, v2 row_newbcast:11 row_mask:0xf bank_mask:0xc
    v_add_u32_dpp v13, v8, v2 row_newbcast:11 row_mask:0xf bank_mask:0xc
    buffer_load_dwordx4 v12, s[12:15], 0 offen lds
    s_addk_i32 m0, 0x1000
    s_nop 0
    buffer_load_dwordx4 v13, s[12:15], 0 offen lds
    s_waitcnt vmcnt(11)
    s_barrier
    s_add_u32 m0, s60, 118784
    s_mov_b32 s56, 499712
    buffer_load_dwordx4 v1, s[16:19], s56 offen lds
    s_add_u32 m0, s60, 122880
    s_mov_b32 s56, 507904
    buffer_load_dwordx4 v1, s[16:19], s56 offen lds
    s_add_u32 m0, s60, 126976
    s_mov_b32 s56, 516096
    buffer_load_dwordx4 v1, s[16:19], s56 offen lds
    v_add_u32_dpp v12, v5, v2 row_newbcast:3 row_mask:0xf bank_mask:0x3
    v_add_u32_dpp v13, v9, v2 row_newbcast:3 row_mask:0xf bank_mask:0x3
    s_add_u32 m0, s60, 139264
    v_add_u32_dpp v12, v5, v2 row_newbcast:11 row_mask:0xf bank_mask:0xc
    v_add_u32_dpp v13, v9, v2 row_newbcast:11 row_mask:0xf bank_mask:0xc
    buffer_load_dwordx4 v12, s[12:15], 0 offen lds
    s_addk_i32 m0, 0x1000
    s_nop 0
    buffer_load_dwordx4 v13, s[12:15], 0 offen lds
    s_waitcnt vmcnt(10)
    s_barrier
    s_add_u32 m0, s60, 0
    s_mov_b32 s56, 524288
    buffer_load_dwordx4 v1, s[16:19], s56 offen lds
    s_add_u32 m0, s60, 4096
    s_mov_b32 s56, 532480
    buffer_load_dwordx4 v1, s[16:19], s56 offen lds
    s_add_u32 m0, s60, 8192
    s_mov_b32 s56, 540672
    buffer_load_dwordx4 v1, s[16:19], s56 offen lds
    s_add_u32 m0, s60, 12288
    s_mov_b32 s56, 548864
    buffer_load_dwordx4 v1, s[16:19], s56 offen lds
    v_add_u32_dpp v12, v6, v2 row_newbcast:3 row_mask:0xf bank_mask:0x3
    v_add_u32_dpp v13, v10, v2 row_newbcast:3 row_mask:0xf bank_mask:0x3
    s_add_u32 m0, s60, 147456
    v_add_u32_dpp v12, v6, v2 row_newbcast:11 row_mask:0xf bank_mask:0xc
    v_add_u32_dpp v13, v10, v2 row_newbcast:11 row_mask:0xf bank_mask:0xc
    buffer_load_dwordx4 v12, s[12:15], 0 offen lds
    s_addk_i32 m0, 0x1000
    s_nop 0
    buffer_load_dwordx4 v13, s[12:15], 0 offen lds
    s_waitcnt vmcnt(11)
    s_barrier
    s_add_u32 m0, s60, 16384
    s_mov_b32 s56, 557056
    buffer_load_dwordx4 v1, s[16:19], s56 offen lds
    s_add_u32 m0, s60, 20480
    s_mov_b32 s56, 565248
    buffer_load_dwordx4 v1, s[16:19], s56 offen lds
    s_add_u32 m0, s60, 24576
    s_mov_b32 s56, 573440
    buffer_load_dwordx4 v1, s[16:19], s56 offen lds
    v_add_u32_dpp v12, v7, v2 row_newbcast:3 row_mask:0xf bank_mask:0x3
    v_add_u32_dpp v13, v11, v2 row_newbcast:3 row_mask:0xf bank_mask:0x3
    s_add_u32 m0, s60, 155648
    v_add_u32_dpp v12, v7, v2 row_newbcast:11 row_mask:0xf bank_mask:0xc
    v_add_u32_dpp v13, v11, v2 row_newbcast:11 row_mask:0xf bank_mask:0xc
    buffer_load_dwordx4 v12, s[12:15], 0 offen lds
    s_addk_i32 m0, 0x1000
    s_nop 0
    buffer_load_dwordx4 v13, s[12:15], 0 offen lds
    s_waitcnt vmcnt(11)
    s_barrier
    s_add_u32 m0, s60, 28672
    s_mov_b32 s56, 581632
    buffer_load_dwordx4 v1, s[16:19], s56 offen lds
    s_add_u32 m0, s60, 32768
    s_mov_b32 s56, 589824
    buffer_load_dwordx4 v1, s[16:19], s56 offen lds
    s_add_u32 m0, s60, 36864
    s_mov_b32 s56, 598016
    buffer_load_dwordx4 v1, s[16:19], s56 offen lds
    v_add_u32_dpp v12, v4, v2 row_newbcast:4 row_mask:0xf bank_mask:0x3
    v_add_u32_dpp v13, v8, v2 row_newbcast:4 row_mask:0xf bank_mask:0x3
    s_add_u32 m0, s60, 131072
    v_add_u32_dpp v12, v4, v2 row_newbcast:12 row_mask:0xf bank_mask:0xc
    v_add_u32_dpp v13, v8, v2 row_newbcast:12 row_mask:0xf bank_mask:0xc
    buffer_load_dwordx4 v12, s[12:15], 0 offen lds
    s_addk_i32 m0, 0x1000
    s_nop 0
    buffer_load_dwordx4 v13, s[12:15], 0 offen lds
    s_waitcnt vmcnt(10)
    s_barrier
    s_add_u32 m0, s60, 40960
    s_mov_b32 s56, 606208
    buffer_load_dwordx4 v1, s[16:19], s56 offen lds
    s_add_u32 m0, s60, 45056
    s_mov_b32 s56, 614400
    buffer_load_dwordx4 v1, s[16:19], s56 offen lds
    s_add_u32 m0, s60, 49152
    s_mov_b32 s56, 622592
    buffer_load_dwordx4 v1, s[16:19], s56 offen lds
    v_add_u32_dpp v12, v5, v2 row_newbcast:4 row_mask:0xf bank_mask:0x3
    v_add_u32_dpp v13, v9, v2 row_newbcast:4 row_mask:0xf bank_mask:0x3
    s_add_u32 m0, s60, 139264
    v_add_u32_dpp v12, v5, v2 row_newbcast:12 row_mask:0xf bank_mask:0xc
    v_add_u32_dpp v13, v9, v2 row_newbcast:12 row_mask:0xf bank_mask:0xc
    buffer_load_dwordx4 v12, s[12:15], 0 offen lds
    s_addk_i32 m0, 0x1000
    s_nop 0
    buffer_load_dwordx4 v13, s[12:15], 0 offen lds
    s_waitcnt vmcnt(10)
    s_barrier
    s_add_u32 m0, s60, 53248
    s_mov_b32 s56, 630784
    buffer_load_dwordx4 v1, s[16:19], s56 offen lds
    s_add_u32 m0, s60, 57344
    s_mov_b32 s56, 638976
    buffer_load_dwordx4 v1, s[16:19], s56 offen lds
    s_add_u32 m0, s60, 61440
    s_mov_b32 s56, 647168
    buffer_load_dwordx4 v1, s[16:19], s56 offen lds
    s_add_u32 m0, s60, 65536
    s_mov_b32 s56, 655360
    buffer_load_dwordx4 v1, s[16:19], s56 offen lds
    v_add_u32_dpp v12, v6, v2 row_newbcast:4 row_mask:0xf bank_mask:0x3
    v_add_u32_dpp v13, v10, v2 row_newbcast:4 row_mask:0xf bank_mask:0x3
    s_add_u32 m0, s60, 147456
    v_add_u32_dpp v12, v6, v2 row_newbcast:12 row_mask:0xf bank_mask:0xc
    v_add_u32_dpp v13, v10, v2 row_newbcast:12 row_mask:0xf bank_mask:0xc
    buffer_load_dwordx4 v12, s[12:15], 0 offen lds
    s_addk_i32 m0, 0x1000
    s_nop 0
    buffer_load_dwordx4 v13, s[12:15], 0 offen lds
    s_waitcnt vmcnt(11)
    s_barrier
    s_add_u32 m0, s60, 69632
    s_mov_b32 s56, 663552
    buffer_load_dwordx4 v1, s[16:19], s56 offen lds
    s_add_u32 m0, s60, 73728
    s_mov_b32 s56, 671744
    buffer_load_dwordx4 v1, s[16:19], s56 offen lds
    s_add_u32 m0, s60, 77824
    s_mov_b32 s56, 679936
    buffer_load_dwordx4 v1, s[16:19], s56 offen lds
    v_add_u32_dpp v12, v7, v2 row_newbcast:4 row_mask:0xf bank_mask:0x3
    v_add_u32_dpp v13, v11, v2 row_newbcast:4 row_mask:0xf bank_mask:0x3
    s_add_u32 m0, s60, 155648
    v_add_u32_dpp v12, v7, v2 row_newbcast:12 row_mask:0xf bank_mask:0xc
    v_add_u32_dpp v13, v11, v2 row_newbcast:12 row_mask:0xf bank_mask:0xc
    buffer_load_dwordx4 v12, s[12:15], 0 offen lds
    s_addk_i32 m0, 0x1000
    s_nop 0
    buffer_load_dwordx4 v13, s[12:15], 0 offen lds
    s_waitcnt vmcnt(11)
    s_barrier
    s_add_u32 m0, s60, 81920
    s_mov_b32 s56, 688128
    buffer_load_dwordx4 v1, s[16:19], s56 offen lds
    s_add_u32 m0, s60, 86016
    s_mov_b32 s56, 696320
    buffer_load_dwordx4 v1, s[16:19], s56 offen lds
    s_add_u32 m0, s60, 90112
    s_mov_b32 s56, 704512
    buffer_load_dwordx4 v1, s[16:19], s56 offen lds
    v_add_u32_dpp v12, v4, v2 row_newbcast:5 row_mask:0xf bank_mask:0x3
    v_add_u32_dpp v13, v8, v2 row_newbcast:5 row_mask:0xf bank_mask:0x3
    s_add_u32 m0, s60, 131072
    v_add_u32_dpp v12, v4, v2 row_newbcast:13 row_mask:0xf bank_mask:0xc
    v_add_u32_dpp v13, v8, v2 row_newbcast:13 row_mask:0xf bank_mask:0xc
    buffer_load_dwordx4 v12, s[12:15], 0 offen lds
    s_addk_i32 m0, 0x1000
    s_nop 0
    buffer_load_dwordx4 v13, s[12:15], 0 offen lds
    s_waitcnt vmcnt(10)
    s_barrier
    s_add_u32 m0, s60, 94208
    s_mov_b32 s56, 712704
    buffer_load_dwordx4 v1, s[16:19], s56 offen lds
    s_add_u32 m0, s60, 98304
    s_mov_b32 s56, 720896
    buffer_load_dwordx4 v1, s[16:19], s56 offen lds
    s_add_u32 m0, s60, 102400
    s_mov_b32 s56, 729088
    buffer_load_dwordx4 v1, s[16:19], s56 offen lds
    v_add_u32_dpp v12, v5, v2 row_newbcast:5 row_mask:0xf bank_mask:0x3
    v_add_u32_dpp v13, v9, v2 row_newbcast:5 row_mask:0xf bank_mask:0x3
    s_add_u32 m0, s60, 139264
    v_add_u32_dpp v12, v5, v2 row_newbcast:13 row_mask:0xf bank_mask:0xc
    v_add_u32_dpp v13, v9, v2 row_newbcast:13 row_mask:0xf bank_mask:0xc
    buffer_load_dwordx4 v12, s[12:15], 0 offen lds
    s_addk_i32 m0, 0x1000
    s_nop 0
    buffer_load_dwordx4 v13, s[12:15], 0 offen lds
    s_waitcnt vmcnt(10)
    s_barrier
    s_add_u32 m0, s60, 106496
    s_mov_b32 s56, 737280
    buffer_load_dwordx4 v1, s[16:19], s56 offen lds
    s_add_u32 m0, s60, 110592
    s_mov_b32 s56, 745472
    buffer_load_dwordx4 v1, s[16:19], s56 offen lds
    s_add_u32 m0, s60, 114688
    s_mov_b32 s56, 753664
    buffer_load_dwordx4 v1, s[16:19], s56 offen lds
    s_add_u32 m0, s60, 118784
    s_mov_b32 s56, 761856
    buffer_load_dwordx4 v1, s[16:19], s56 offen lds
    v_add_u32_dpp v12, v6, v2 row_newbcast:5 row_mask:0xf bank_mask:0x3
    v_add_u32_dpp v13, v10, v2 row_newbcast:5 row_mask:0xf bank_mask:0x3
    s_add_u32 m0, s60, 147456
    v_add_u32_dpp v12, v6, v2 row_newbcast:13 row_mask:0xf bank_mask:0xc
    v_add_u32_dpp v13, v10, v2 row_newbcast:13 row_mask:0xf bank_mask:0xc
    buffer_load_dwordx4 v12, s[12:15], 0 offen lds
    s_addk_i32 m0, 0x1000
    s_nop 0
    buffer_load_dwordx4 v13, s[12:15], 0 offen lds
    s_waitcnt vmcnt(11)
    s_barrier
    s_add_u32 m0, s60, 122880
    s_mov_b32 s56, 770048
    buffer_load_dwordx4 v1, s[16:19], s56 offen lds
    s_add_u32 m0, s60, 126976
    s_mov_b32 s56, 778240
    buffer_load_dwordx4 v1, s[16:19], s56 offen lds
    s_add_u32 m0, s60, 0
    s_mov_b32 s56, 786432
    buffer_load_dwordx4 v1, s[16:19], s56 offen lds
    v_add_u32_dpp v12, v7, v2 row_newbcast:5 row_mask:0xf bank_mask:0x3
    v_add_u32_dpp v13, v11, v2 row_newbcast:5 row_mask:0xf bank_mask:0x3
    s_add_u32 m0, s60, 155648
    v_add_u32_dpp v12, v7, v2 row_newbcast:13 row_mask:0xf bank_mask:0xc
    v_add_u32_dpp v13, v11, v2 row_newbcast:13 row_mask:0xf bank_mask:0xc
    buffer_load_dwordx4 v12, s[12:15], 0 offen lds
    s_addk_i32 m0, 0x1000
    s_nop 0
    buffer_load_dwordx4 v13, s[12:15], 0 offen lds
    s_waitcnt vmcnt(11)
    s_barrier
    s_add_u32 m0, s60, 4096
    s_mov_b32 s56, 794624
    buffer_load_dwordx4 v1, s[16:19], s56 offen lds
    s_add_u32 m0, s60, 8192
    s_mov_b32 s56, 802816
    buffer_load_dwordx4 v1, s[16:19], s56 offen lds
    s_add_u32 m0, s60, 12288
    s_mov_b32 s56, 811008
    buffer_load_dwordx4 v1, s[16:19], s56 offen lds
    v_add_u32_dpp v12, v4, v2 row_newbcast:6 row_mask:0xf bank_mask:0x3
    v_add_u32_dpp v13, v8, v2 row_newbcast:6 row_mask:0xf bank_mask:0x3
    s_add_u32 m0, s60, 131072
    v_add_u32_dpp v12, v4, v2 row_newbcast:14 row_mask:0xf bank_mask:0xc
    v_add_u32_dpp v13, v8, v2 row_newbcast:14 row_mask:0xf bank_mask:0xc
    buffer_load_dwordx4 v12, s[12:15], 0 offen lds
    s_addk_i32 m0, 0x1000
    s_nop 0
    buffer_load_dwordx4 v13, s[12:15], 0 offen lds
    s_waitcnt vmcnt(10)
    s_barrier
    s_add_u32 m0, s60, 16384
    s_mov_b32 s56, 819200
    buffer_load_dwordx4 v1, s[16:19], s56 offen lds
    s_add_u32 m0, s60, 20480
    s_mov_b32 s56, 827392
    buffer_load_dwordx4 v1, s[16:19], s56 offen lds
    s_add_u32 m0, s60, 24576
    s_mov_b32 s56, 835584
    buffer_load_dwordx4 v1, s[16:19], s56 offen lds
    s_add_u32 m0, s60, 28672
    s_mov_b32 s56, 843776
    buffer_load_dwordx4 v1, s[16:19], s56 offen lds
    v_add_u32_dpp v12, v5, v2 row_newbcast:6 row_mask:0xf bank_mask:0x3
    v_add_u32_dpp v13, v9, v2 row_newbcast:6 row_mask:0xf bank_mask:0x3
    s_add_u32 m0, s60, 139264
    v_add_u32_dpp v12, v5, v2 row_newbcast:14 row_mask:0xf bank_mask:0xc
    v_add_u32_dpp v13, v9, v2 row_newbcast:14 row_mask:0xf bank_mask:0xc
    buffer_load_dwordx4 v12, s[12:15], 0 offen lds
    s_addk_i32 m0, 0x1000
    s_nop 0
    buffer_load_dwordx4 v13, s[12:15], 0 offen lds
    s_waitcnt vmcnt(11)
    s_barrier
    s_waitcnt vmcnt(6)
    s_barrier
    s_waitcnt vmcnt(0)
    s_barrier
    s_branch L_end
L_Bc:
    s_mov_b32 s30, 676
    s_mov_b32 s31, 0x00020000
    s_mov_b32 s34, 676
    s_mov_b32 s35, 0x00020000
    s_mov_b32 s26, 8192
    s_mov_b32 s27, 0x00020000
    s_mov_b32 s22, 173056
    s_mov_b32 s23, 0x00020000
    s_mov_b32 s38, 512
    s_mov_b32 s39, 0x00020000
    s_mov_b32 s42, 8192
    s_mov_b32 s43, 0x00020000
    s_mov_b32 s46, 256
    s_mov_b32 s47, 0x00020000
    s_mov_b32 s50, 268435456
    s_mov_b32 s51, 0x00020000
    s_mov_b32 s64, 0x05040100
    s_mov_b32 s65, 0x07060302
    s_mov_b32 s66, 0xc0135761
    s_mov_b32 s67, 0xbdd2d3e8
    s_mov_b32 s68, 0xffff0000
    s_mov_b32 s69, 0xbfb8aa3b
    v_and_b32 v7, 15, v0
    v_bfe_u32 v9, v0, 4, 2
    v_bfe_u32 v10, v0, 1, 3
    v_xor_b32 v10, v10, v9
    v_lshlrev_b32 v10, 4, v10
    v_lshl_add_u32 v10, v7, 7, v10
    v_add_u32 v1, 131072, v10
    v_xor_b32 v2, 64, v1
    v_bfe_u32 v7, v0, 2, 2
    v_lshl_add_u32 v10, v9, 3, v7
    v_lshlrev_b32 v10, 8, v10
    v_xor_b32 v7, s52, v7
    v_lshl_add_u32 v10, v7, 6, v10
    v_bfe_u32 v7, v0, 4, 1
    v_lshl_add_u32 v10, v7, 5, v10
    v_and_b32 v7, 3, v0
    v_lshl_add_u32 v3, v7, 3, v10
    v_xor_b32 v4, 32, v3
    v_add_u32 v5, 0x10000, v3
    v_add_u32 v6, 0x10000, v4
    s_lshl_b32 s56, s54, 8
    s_lshl_b32 s57, s52, 6
    s_add_u32 s56, s56, s57
    v_lshlrev_b32 v9, 3, v9
    s_waitcnt lgkmcnt(0)
    s_mov_b64 s[28:29], s[84:85]
    s_mov_b64 s[32:33], s[86:87]
    s_mov_b64 s[24:25], s[88:89]
    s_mov_b64 s[20:21], s[90:91]
    s_mov_b64 s[36:37], s[92:93]
    s_mov_b64 s[40:41], s[94:95]
    s_mov_b64 s[44:45], s[96:97]
    s_mov_b64 s[48:49], s[98:99]
    s_mov_b32 s58, s56
    v_mov_b32 v32, 0
    v_mov_b32 v33, 0
    v_mov_b32 v34, 0
    v_mov_b32 v35, 0
    v_mov_b32 v36, 0
    v_mov_b32 v37, 0
    v_mov_b32 v38, 0
    v_mov_b32 v39, 0
    v_mov_b32 v40, 0
    v_mov_b32 v41, 0
    v_mov_b32 v42, 0
    v_mov_b32 v43, 0
    v_mov_b32 v44, 0
    v_mov_b32 v45, 0
    v_mov_b32 v46, 0
    v_mov_b32 v47, 0
    v_mov_b32 v48, 0
    v_mov_b32 v49, 0
    v_mov_b32 v50, 0
    v_mov_b32 v51, 0
    v_mov_b32 v52, 0
    v_mov_b32 v53, 0
    v_mov_b32 v54, 0
    v_mov_b32 v55, 0
    v_mov_b32 v56, 0
    v_mov_b32 v57, 0
    v_mov_b32 v58, 0
    v_mov_b32 v59, 0
    v_mov_b32 v60, 0
    v_mov_b32 v61, 0
    v_mov_b32 v62, 0
    v_mov_b32 v63, 0
    v_mov_b32 v12, s66
    v_mov_b32 v13, s66
    v_mov_b32 v14, s67
    v_mov_b32 v15, s67
    v_lshlrev_b32 v172, 3, v0
    s_lshl1_add_u32 s59, s53, s54
    s_lshl_b32 s59, s59, 9
    s_lshl_b32 s56, s52, 28
    s_add_u32 s59, s59, s56
    s_barrier
    ds_read_b64_tr_b16 v[128:129], v3 offset:0
    ds_read_b64_tr_b16 v[130:131], v3 offset:1024
    ds_read_b64_tr_b16 v[132:133], v4 offset:0
    ds_read_b64_tr_b16 v[134:135], v4 offset:1024
    ds_read_b128 v[64:67], v1 offset:0
    ds_read_b128 v[68:71], v1 offset:2048
    ds_read_b128 v[72:75], v1 offset:4096
    ds_read_b128 v[76:79], v1 offset:6144
    ds_read_b64_tr_b16 v[136:137], v3 offset:8192
    ds_read_b64_tr_b16 v[138:139], v3 offset:9216
    ds_read_b64_tr_b16 v[140:141], v4 offset:8192
    ds_read_b64_tr_b16 v[142:143], v4 offset:9216
    s_waitcnt lgkmcnt(7)
    v_mfma_f32_16x16x32_bf16 v[32:35], v[128:131], v[64:67], v[32:35]
    ds_read_b128 v[80:83], v2 offset:0
    v_mfma_f32_16x16x32_bf16 v[36:39], v[132:135], v[64:67], v[36:39]
    ds_read_b128 v[84:87], v2 offset:2048
    s_waitcnt lgkmcnt(8)
    v_mfma_f32_16x16x32_bf16 v[40:43], v[128:131], v[68:71], v[40:43]
    ds_read_b128 v[88:91], v2 offset:4096
    v_mfma_f32_16x16x32_bf16 v[44:47], v[132:135], v[68:71], v[44:47]
    ds_read_b128 v[92:95], v2 offset:6144
    s_waitcnt lgkmcnt(9)
    v_mfma_f32_16x16x32_bf16 v[48:51], v[128:131], v[72:75], v[48:51]
    v_mfma_f32_16x16x32_bf16 v[52:55], v[132:135], v[72:75], v[52:55]
    s_waitcnt lgkmcnt(8)
    v_mfma_f32_16x16x32_bf16 v[56:59], v[128:131], v[76:79], v[56:59]
    v_mfma_f32_16x16x32_bf16 v[60:63], v[132:135], v[76:79], v[60:63]
    s_waitcnt lgkmcnt(0)
    s_barrier
    ds_read_b64_tr_b16 v[144:145], v3 offset:16384
    ds_read_b64_tr_b16 v[146:147], v3 offset:17408
    ds_read_b64_tr_b16 v[148:149], v4 offset:16384
    ds_read_b64_tr_b16 v[150:151], v4 offset:17408
    ds_read_b128 v[96:99], v1 offset:8192
    v_mfma_f32_16x16x32_bf16 v[32:35], v[136:139], v[80:83], v[32:35]
    ds_read_b128 v[100:103], v1 offset:10240
    v_mfma_f32_16x16x32_bf16 v[36:39], v[140:143], v[80:83], v[36:39]
    ds_read_b128 v[104:107], v1 offset:12288
    v_mfma_f32_16x16x32_bf16 v[40:43], v[136:139], v[84:87], v[40:43]
    ds_read_b128 v[108:111], v1 offset:14336
    v_mfma_f32_16x16x32_bf16 v[44:47], v[140:143], v[84:87], v[44:47]
    v_mfma_f32_16x16x32_bf16 v[48:51], v[136:139], v[88:91], v[48:51]
    ds_read_b64_tr_b16 v[152:153], v3 offset:24576
    v_mfma_f32_16x16x32_bf16 v[52:55], v[140:143], v[88:91], v[52:55]
    ds_read_b64_tr_b16 v[154:155], v3 offset:25600
    v_mfma_f32_16x16x32_bf16 v[56:59], v[136:139], v[92:95], v[56:59]
    ds_read_b64_tr_b16 v[156:157], v4 offset:24576
    v_mfma_f32_16x16x32_bf16 v[60:63], v[140:143], v[92:95], v[60:63]
    ds_read_b64_tr_b16 v[158:159], v4 offset:25600
    s_waitcnt lgkmcnt(7)
    v_mfma_f32_16x16x32_bf16 v[32:35], v[144:147], v[96:99], v[32:35]
    ds_read_b128 v[112:115], v2 offset:8192
    v_mfma_f32_16x16x32_bf16 v[36:39], v[148:151], v[96:99], v[36:39]
    ds_read_b128 v[116:119], v2 offset:10240
    s_waitcnt lgkmcnt(8)
    v_mfma_f32_16x16x32_bf16 v[40:43], v[144:147], v[100:103], v[40:43]
    ds_read_b128 v[120:123], v2 offset:12288
    v_mfma_f32_16x16x32_bf16 v[44:47], v[148:151], v[100:103], v[44:47]
    ds_read_b128 v[124:127], v2 offset:14336
    s_waitcnt lgkmcnt(9)
    v_mfma_f32_16x16x32_bf16 v[48:51], v[144:147], v[104:107], v[48:51]
    v_mfma_f32_16x16x32_bf16 v[52:55], v[148:151], v[104:107], v[52:55]
    s_waitcnt lgkmcnt(8)
    v_mfma_f32_16x16x32_bf16 v[56:59], v[144:147], v[108:111], v[56:59]
    v_mfma_f32_16x16x32_bf16 v[60:63], v[148:151], v[108:111], v[60:63]
    s_waitcnt lgkmcnt(0)
    s_barrier
    ds_read_b64_tr_b16 v[128:129], v3 offset:32768
    ds_read_b64_tr_b16 v[130:131], v3 offset:33792
    ds_read_b64_tr_b16 v[132:133], v4 offset:32768
    ds_read_b64_tr_b16 v[134:135], v4 offset:33792
    ds_read_b128 v[64:67], v1 offset:16384
    v_mfma_f32_16x16x32_bf16 v[32:35], v[152:155], v[112:115], v[32:35]
    ds_read_b128 v[68:71], v1 offset:18432
    v_mfma_f32_16x16x32_bf16 v[36:39], v[156:159], v[112:115], v[36:39]
    ds_read_b128 v[72:75], v1 offset:20480
    v_mfma_f32_16x16x32_bf16 v[40:43], v[152:155], v[116:119], v[40:43]
    ds_read_b128 v[76:79], v1 offset:22528
    v_mfma_f32_16x16x32_bf16 v[44:47], v[156:159], v[116:119], v[44:47]
    v_mfma_f32_16x16x32_bf16 v[48:51], v[152:155], v[120:123], v[48:51]
    ds_read_b64_tr_b16 v[136:137], v3 offset:40960
    v_mfma_f32_16x16x32_bf16 v[52:55], v[156:159], v[120:123], v[52:55]
    ds_read_b64_tr_b16 v[138:139], v3 offset:41984
    v_mfma_f32_16x16x32_bf16 v[56:59], v[152:155], v[124:127], v[56:59]
    ds_read_b64_tr_b16 v[140:141], v4 offset:40960
    v_mfma_f32_16x16x32_bf16 v[60:63], v[156:159], v[124:127], v[60:63]
    ds_read_b64_tr_b16 v[142:143], v4 offset:41984
    s_waitcnt lgkmcnt(7)
    v_mfma_f32_16x16x32_bf16 v[32:35], v[128:131], v[64:67], v[32:35]
    ds_read_b128 v[80:83], v2 offset:16384
    v_mfma_f32_16x16x32_bf16 v[36:39], v[132:135], v[64:67], v[36:39]
    ds_read_b128 v[84:87], v2 offset:18432
    s_waitcnt lgkmcnt(8)
    v_mfma_f32_16x16x32_bf16 v[40:43], v[128:131], v[68:71], v[40:43]
    ds_read_b128 v[88:91], v2 offset:20480
    v_mfma_f32_16x16x32_bf16 v[44:47], v[132:135], v[68:71], v[44:47]
    ds_read_b128 v[92:95], v2 offset:22528
    s_waitcnt lgkmcnt(9)
    v_mfma_f32_16x16x32_bf16 v[48:51], v[128:131], v[72:75], v[48:51]
    v_mfma_f32_16x16x32_bf16 v[52:55], v[132:135], v[72:75], v[52:55]
    s_waitcnt lgkmcnt(8)
    v_mfma_f32_16x16x32_bf16 v[56:59], v[128:131], v[76:79], v[56:59]
    v_mfma_f32_16x16x32_bf16 v[60:63], v[132:135], v[76:79], v[60:63]
    s_waitcnt lgkmcnt(0)
    s_barrier
    ds_read_b64_tr_b16 v[144:145], v3 offset:49152
    ds_read_b64_tr_b16 v[146:147], v3 offset:50176
    ds_read_b64_tr_b16 v[148:149], v4 offset:49152
    ds_read_b64_tr_b16 v[150:151], v4 offset:50176
    ds_read_b128 v[96:99], v1 offset:24576
    v_mfma_f32_16x16x32_bf16 v[32:35], v[136:139], v[80:83], v[32:35]
    ds_read_b128 v[100:103], v1 offset:26624
    v_mfma_f32_16x16x32_bf16 v[36:39], v[140:143], v[80:83], v[36:39]
    ds_read_b128 v[104:107], v1 offset:28672
    v_mfma_f32_16x16x32_bf16 v[40:43], v[136:139], v[84:87], v[40:43]
    ds_read_b128 v[108:111], v1 offset:30720
    v_mfma_f32_16x16x32_bf16 v[44:47], v[140:143], v[84:87], v[44:47]
    v_mfma_f32_16x16x32_bf16 v[48:51], v[136:139], v[88:91], v[48:51]
    ds_read_b64_tr_b16 v[152:153], v3 offset:57344
    v_mfma_f32_16x16x32_bf16 v[52:55], v[140:143], v[88:91], v[52:55]
    ds_read_b64_tr_b16 v[154:155], v3 offset:58368
    v_mfma_f32_16x16x32_bf16 v[56:59], v[136:139], v[92:95], v[56:59]
    ds_read_b64_tr_b16 v[156:157], v4 offset:57344
    v_mfma_f32_16x16x32_bf16 v[60:63], v[140:143], v[92:95], v[60:63]
    ds_read_b64_tr_b16 v[158:159], v4 offset:58368
    s_waitcnt lgkmcnt(7)
    v_mfma_f32_16x16x32_bf16 v[32:35], v[144:147], v[96:99], v[32:35]
    ds_read_b128 v[112:115], v2 offset:24576
    v_mfma_f32_16x16x32_bf16 v[36:39], v[148:151], v[96:99], v[36:39]
    ds_read_b128 v[116:119], v2 offset:26624
    s_waitcnt lgkmcnt(8)
    v_mfma_f32_16x16x32_bf16 v[40:43], v[144:147], v[100:103], v[40:43]
    ds_read_b128 v[120:123], v2 offset:28672
    v_mfma_f32_16x16x32_bf16 v[44:47], v[148:151], v[100:103], v[44:47]
    ds_read_b128 v[124:127], v2 offset:30720
    s_waitcnt lgkmcnt(9)
    v_mfma_f32_16x16x32_bf16 v[48:51], v[144:147], v[104:107], v[48:51]
    v_mfma_f32_16x16x32_bf16 v[52:55], v[148:151], v[104:107], v[52:55]
    s_waitcnt lgkmcnt(8)
    v_mfma_f32_16x16x32_bf16 v[56:59], v[144:147], v[108:111], v[56:59]
    v_mfma_f32_16x16x32_bf16 v[60:63], v[148:151], v[108:111], v[60:63]
    s_waitcnt lgkmcnt(0)
    s_barrier
    ds_read_b64_tr_b16 v[128:129], v5 offset:0
    ds_read_b64_tr_b16 v[130:131], v5 offset:1024
    ds_read_b64_tr_b16 v[132:133], v6 offset:0
    ds_read_b64_tr_b16 v[134:135], v6 offset:1024
    ds_read_b128 v[64:67], v1 offset:0
    v_mfma_f32_16x16x32_bf16 v[32:35], v[152:155], v[112:115], v[32:35]
    ds_read_b128 v[68:71], v1 offset:2048
    v_mfma_f32_16x16x32_bf16 v[36:39], v[156:159], v[112:115], v[36:39]
    ds_read_b128 v[72:75], v1 offset:4096
    v_mfma_f32_16x16x32_bf16 v[40:43], v[152:155], v[116:119], v[40:43]
    ds_read_b128 v[76:79], v1 offset:6144
    v_mfma_f32_16x16x32_bf16 v[44:47], v[156:159], v[116:119], v[44:47]
    v_mfma_f32_16x16x32_bf16 v[48:51], v[152:155], v[120:123], v[48:51]
    ds_read_b64_tr_b16 v[136:137], v5 offset:8192
    v_mfma_f32_16x16x32_bf16 v[52:55], v[156:159], v[120:123], v[52:55]
    ds_read_b64_tr_b16 v[138:139], v5 offset:9216
    v_mfma_f32_16x16x32_bf16 v[56:59], v[152:155], v[124:127], v[56:59]
    ds_read_b64_tr_b16 v[140:141], v6 offset:8192
    v_mfma_f32_16x16x32_bf16 v[60:63], v[156:159], v[124:127], v[60:63]
    ds_read_b64_tr_b16 v[142:143], v6 offset:9216
    s_waitcnt lgkmcnt(7)
    v_mfma_f32_16x16x32_bf16 v[32:35], v[128:131], v[64:67], v[32:35]
    ds_read_b128 v[80:83], v2 offset:0
    v_mfma_f32_16x16x32_bf16 v[36:39], v[132:135], v[64:67], v[36:39]
    ds_read_b128 v[84:87], v2 offset:2048
    s_waitcnt lgkmcnt(8)
    v_mfma_f32_16x16x32_bf16 v[40:43], v[128:131], v[68:71], v[40:43]
    ds_read_b128 v[88:91], v2 offset:4096
    v_mfma_f32_16x16x32_bf16 v[44:47], v[132:135], v[68:71], v[44:47]
    ds_read_b128 v[92:95], v2 offset:6144
    s_waitcnt lgkmcnt(9)
    v_mfma_f32_16x16x32_bf16 v[48:51], v[128:131], v[72:75], v[48:51]
    v_mfma_f32_16x16x32_bf16 v[52:55], v[132:135], v[72:75], v[52:55]
    s_waitcnt lgkmcnt(8)
    v_mfma_f32_16x16x32_bf16 v[56:59], v[128:131], v[76:79], v[56:59]
    v_mfma_f32_16x16x32_bf16 v[60:63], v[132:135], v[76:79], v[60:63]
    s_waitcnt lgkmcnt(0)
    s_barrier
    ds_read_b64_tr_b16 v[144:145], v5 offset:16384
    ds_read_b64_tr_b16 v[146:147], v5 offset:17408
    ds_read_b64_tr_b16 v[148:149], v6 offset:16384
    ds_read_b64_tr_b16 v[150:151], v6 offset:17408
    ds_read_b128 v[96:99], v1 offset:8192
    v_mfma_f32_16x16x32_bf16 v[32:35], v[136:139], v[80:83], v[32:35]
    ds_read_b128 v[100:103], v1 offset:10240
    v_mfma_f32_16x16x32_bf16 v[36:39], v[140:143], v[80:83], v[36:39]
    ds_read_b128 v[104:107], v1 offset:12288
    v_mfma_f32_16x16x32_bf16 v[40:43], v[136:139], v[84:87], v[40:43]
    ds_read_b128 v[108:111], v1 offset:14336
    v_mfma_f32_16x16x32_bf16 v[44:47], v[140:143], v[84:87], v[44:47]
    v_mfma_f32_16x16x32_bf16 v[48:51], v[136:139], v[88:91], v[48:51]
    ds_read_b64_tr_b16 v[152:153], v5 offset:24576
    v_mfma_f32_16x16x32_bf16 v[52:55], v[140:143], v[88:91], v[52:55]
    ds_read_b64_tr_b16 v[154:155], v5 offset:25600
    v_mfma_f32_16x16x32_bf16 v[56:59], v[136:139], v[92:95], v[56:59]
    ds_read_b64_tr_b16 v[156:157], v6 offset:24576
    v_mfma_f32_16x16x32_bf16 v[60:63], v[140:143], v[92:95], v[60:63]
    ds_read_b64_tr_b16 v[158:159], v6 offset:25600
    s_waitcnt lgkmcnt(7)
    v_mfma_f32_16x16x32_bf16 v[32:35], v[144:147], v[96:99], v[32:35]
    ds_read_b128 v[112:115], v2 offset:8192
    v_mfma_f32_16x16x32_bf16 v[36:39], v[148:151], v[96:99], v[36:39]
    ds_read_b128 v[116:119], v2 offset:10240
    s_waitcnt lgkmcnt(8)
    v_mfma_f32_16x16x32_bf16 v[40:43], v[144:147], v[100:103], v[40:43]
    ds_read_b128 v[120:123], v2 offset:12288
    v_mfma_f32_16x16x32_bf16 v[44:47], v[148:151], v[100:103], v[44:47]
    ds_read_b128 v[124:127], v2 offset:14336
    s_waitcnt lgkmcnt(9)
    v_mfma_f32_16x16x32_bf16 v[48:51], v[144:147], v[104:107], v[48:51]
    v_mfma_f32_16x16x32_bf16 v[52:55], v[148:151], v[104:107], v[52:55]
    s_waitcnt lgkmcnt(8)
    v_mfma_f32_16x16x32_bf16 v[56:59], v[144:147], v[108:111], v[56:59]
    v_mfma_f32_16x16x32_bf16 v[60:63], v[148:151], v[108:111], v[60:63]
    s_waitcnt lgkmcnt(0)
    s_barrier
    ds_read_b64_tr_b16 v[128:129], v5 offset:32768
    ds_read_b64_tr_b16 v[130:131], v5 offset:33792
    ds_read_b64_tr_b16 v[132:133], v6 offset:32768
    ds_read_b64_tr_b16 v[134:135], v6 offset:33792
    ds_read_b128 v[64:67], v1 offset:16384
    v_mfma_f32_16x16x32_bf16 v[32:35], v[152:155], v[112:115], v[32:35]
    ds_read_b128 v[68:71], v1 offset:18432
    v_mfma_f32_16x16x32_bf16 v[36:39], v[156:159], v[112:115], v[36:39]
    ds_read_b128 v[72:75], v1 offset:20480
    v_mfma_f32_16x16x32_bf16 v[40:43], v[152:155], v[116:119], v[40:43]
    ds_read_b128 v[76:79], v1 offset:22528
    v_mfma_f32_16x16x32_bf16 v[44:47], v[156:159], v[116:119], v[44:47]
    v_mfma_f32_16x16x32_bf16 v[48:51], v[152:155], v[120:123], v[48:51]
    ds_read_b64_tr_b16 v[136:137], v5 offset:40960
    v_mfma_f32_16x16x32_bf16 v[52:55], v[156:159], v[120:123], v[52:55]
    ds_read_b64_tr_b16 v[138:139], v5 offset:41984
    v_mfma_f32_16x16x32_bf16 v[56:59], v[152:155], v[124:127], v[56:59]
    ds_read_b64_tr_b16 v[140:141], v6 offset:40960
    v_mfma_f32_16x16x32_bf16 v[60:63], v[156:159], v[124:127], v[60:63]
    ds_read_b64_tr_b16 v[142:143], v6 offset:41984
    s_waitcnt lgkmcnt(7)
    v_mfma_f32_16x16x32_bf16 v[32:35], v[128:131], v[64:67], v[32:35]
    ds_read_b128 v[80:83], v2 offset:16384
    v_mfma_f32_16x16x32_bf16 v[36:39], v[132:135], v[64:67], v[36:39]
    ds_read_b128 v[84:87], v2 offset:18432
    s_waitcnt lgkmcnt(8)
    v_mfma_f32_16x16x32_bf16 v[40:43], v[128:131], v[68:71], v[40:43]
    ds_read_b128 v[88:91], v2 offset:20480
    v_mfma_f32_16x16x32_bf16 v[44:47], v[132:135], v[68:71], v[44:47]
    ds_read_b128 v[92:95], v2 offset:22528
    s_waitcnt lgkmcnt(9)
    v_mfma_f32_16x16x32_bf16 v[48:51], v[128:131], v[72:75], v[48:51]
    v_mfma_f32_16x16x32_bf16 v[52:55], v[132:135], v[72:75], v[52:55]
    s_waitcnt lgkmcnt(8)
    v_mfma_f32_16x16x32_bf16 v[56:59], v[128:131], v[76:79], v[56:59]
    v_mfma_f32_16x16x32_bf16 v[60:63], v[132:135], v[76:79], v[60:63]
    s_waitcnt lgkmcnt(0)
    s_barrier
    ds_read_b64_tr_b16 v[144:145], v5 offset:49152
    ds_read_b64_tr_b16 v[146:147], v5 offset:50176
    ds_read_b64_tr_b16 v[148:149], v6 offset:49152
    ds_read_b64_tr_b16 v[150:151], v6 offset:50176
    ds_read_b128 v[96:99], v1 offset:24576
    v_mfma_f32_16x16x32_bf16 v[32:35], v[136:139], v[80:83], v[32:35]
    ds_read_b128 v[100:103], v1 offset:26624
    v_mfma_f32_16x16x32_bf16 v[36:39], v[140:143], v[80:83], v[36:39]
    ds_read_b128 v[104:107], v1 offset:28672
    v_mfma_f32_16x16x32_bf16 v[40:43], v[136:139], v[84:87], v[40:43]
    ds_read_b128 v[108:111], v1 offset:30720
    v_mfma_f32_16x16x32_bf16 v[44:47], v[140:143], v[84:87], v[44:47]
    v_mfma_f32_16x16x32_bf16 v[48:51], v[136:139], v[88:91], v[48:51]
    ds_read_b64_tr_b16 v[152:153], v5 offset:57344
    v_mfma_f32_16x16x32_bf16 v[52:55], v[140:143], v[88:91], v[52:55]
    ds_read_b64_tr_b16 v[154:155], v5 offset:58368
    v_mfma_f32_16x16x32_bf16 v[56:59], v[136:139], v[92:95], v[56:59]
    ds_read_b64_tr_b16 v[156:157], v6 offset:57344
    v_mfma_f32_16x16x32_bf16 v[60:63], v[140:143], v[92:95], v[60:63]
    ds_read_b64_tr_b16 v[158:159], v6 offset:58368
    s_waitcnt lgkmcnt(7)
    v_mfma_f32_16x16x32_bf16 v[32:35], v[144:147], v[96:99], v[32:35]
    ds_read_b128 v[112:115], v2 offset:24576
    v_mfma_f32_16x16x32_bf16 v[36:39], v[148:151], v[96:99], v[36:39]
    ds_read_b128 v[116:119], v2 offset:26624
    s_waitcnt lgkmcnt(8)
    v_mfma_f32_16x16x32_bf16 v[40:43], v[144:147], v[100:103], v[40:43]
    ds_read_b128 v[120:123], v2 offset:28672
    v_mfma_f32_16x16x32_bf16 v[44:47], v[148:151], v[100:103], v[44:47]
    ds_read_b128 v[124:127], v2 offset:30720
    s_waitcnt lgkmcnt(9)
    v_mfma_f32_16x16x32_bf16 v[48:51], v[144:147], v[104:107], v[48:51]
    v_mfma_f32_16x16x32_bf16 v[52:55], v[148:151], v[104:107], v[52:55]
    s_waitcnt lgkmcnt(8)
    v_mfma_f32_16x16x32_bf16 v[56:59], v[144:147], v[108:111], v[56:59]
    v_mfma_f32_16x16x32_bf16 v[60:63], v[148:151], v[108:111], v[60:63]
    s_waitcnt lgkmcnt(0)
    s_barrier
    ds_read_b64_tr_b16 v[128:129], v3 offset:0
    ds_read_b64_tr_b16 v[130:131], v3 offset:1024
    ds_read_b64_tr_b16 v[132:133], v4 offset:0
    ds_read_b64_tr_b16 v[134:135], v4 offset:1024
    ds_read_b128 v[64:67], v1 offset:0
    v_mfma_f32_16x16x32_bf16 v[32:35], v[152:155], v[112:115], v[32:35]
    ds_read_b128 v[68:71], v1 offset:2048
    v_mfma_f32_16x16x32_bf16 v[36:39], v[156:159], v[112:115], v[36:39]
    ds_read_b128 v[72:75], v1 offset:4096
    v_mfma_f32_16x16x32_bf16 v[40:43], v[152:155], v[116:119], v[40:43]
    ds_read_b128 v[76:79], v1 offset:6144
    v_mfma_f32_16x16x32_bf16 v[44:47], v[156:159], v[116:119], v[44:47]
    v_mfma_f32_16x16x32_bf16 v[48:51], v[152:155], v[120:123], v[48:51]
    ds_read_b64_tr_b16 v[136:137], v3 offset:8192
    v_mfma_f32_16x16x32_bf16 v[52:55], v[156:159], v[120:123], v[52:55]
    ds_read_b64_tr_b16 v[138:139], v3 offset:9216
    v_mfma_f32_16x16x32_bf16 v[56:59], v[152:155], v[124:127], v[56:59]
    ds_read_b64_tr_b16 v[140:141], v4 offset:8192
    v_mfma_f32_16x16x32_bf16 v[60:63], v[156:159], v[124:127], v[60:63]
    ds_read_b64_tr_b16 v[142:143], v4 offset:9216
    s_waitcnt lgkmcnt(7)
    v_mfma_f32_16x16x32_bf16 v[32:35], v[128:131], v[64:67], v[32:35]
    ds_read_b128 v[80:83], v2 offset:0
    v_mfma_f32_16x16x32_bf16 v[36:39], v[132:135], v[64:67], v[36:39]
    ds_read_b128 v[84:87], v2 offset:2048
    s_waitcnt lgkmcnt(8)
    v_mfma_f32_16x16x32_bf16 v[40:43], v[128:131], v[68:71], v[40:43]
    ds_read_b128 v[88:91], v2 offset:4096
    v_mfma_f32_16x16x32_bf16 v[44:47], v[132:135], v[68:71], v[44:47]
    ds_read_b128 v[92:95], v2 offset:6144
    s_waitcnt lgkmcnt(9)
    v_mfma_f32_16x16x32_bf16 v[48:51], v[128:131], v[72:75], v[48:51]
    v_mfma_f32_16x16x32_bf16 v[52:55], v[132:135], v[72:75], v[52:55]
    s_waitcnt lgkmcnt(8)
    v_mfma_f32_16x16x32_bf16 v[56:59], v[128:131], v[76:79], v[56:59]
    v_mfma_f32_16x16x32_bf16 v[60:63], v[132:135], v[76:79], v[60:63]
    s_waitcnt lgkmcnt(0)
    s_barrier
    ds_read_b64_tr_b16 v[144:145], v3 offset:16384
    ds_read_b64_tr_b16 v[146:147], v3 offset:17408
    ds_read_b64_tr_b16 v[148:149], v4 offset:16384
    ds_read_b64_tr_b16 v[150:151], v4 offset:17408
    ds_read_b128 v[96:99], v1 offset:8192
    v_mfma_f32_16x16x32_bf16 v[32:35], v[136:139], v[80:83], v[32:35]
    ds_read_b128 v[100:103], v1 offset:10240
    v_mfma_f32_16x16x32_bf16 v[36:39], v[140:143], v[80:83], v[36:39]
    ds_read_b128 v[104:107], v1 offset:12288
    v_mfma_f32_16x16x32_bf16 v[40:43], v[136:139], v[84:87], v[40:43]
    ds_read_b128 v[108:111], v1 offset:14336
    v_mfma_f32_16x16x32_bf16 v[44:47], v[140:143], v[84:87], v[44:47]
    v_mfma_f32_16x16x32_bf16 v[48:51], v[136:139], v[88:91], v[48:51]
    ds_read_b64_tr_b16 v[152:153], v3 offset:24576
    v_mfma_f32_16x16x32_bf16 v[52:55], v[140:143], v[88:91], v[52:55]
    ds_read_b64_tr_b16 v[154:155], v3 offset:25600
    v_mfma_f32_16x16x32_bf16 v[56:59], v[136:139], v[92:95], v[56:59]
    ds_read_b64_tr_b16 v[156:157], v4 offset:24576
    v_mfma_f32_16x16x32_bf16 v[60:63], v[140:143], v[92:95], v[60:63]
    ds_read_b64_tr_b16 v[158:159], v4 offset:25600
    s_waitcnt lgkmcnt(7)
    v_mfma_f32_16x16x32_bf16 v[32:35], v[144:147], v[96:99], v[32:35]
    ds_read_b128 v[112:115], v2 offset:8192
    v_mfma_f32_16x16x32_bf16 v[36:39], v[148:151], v[96:99], v[36:39]
    ds_read_b128 v[116:119], v2 offset:10240
    s_waitcnt lgkmcnt(8)
    v_mfma_f32_16x16x32_bf16 v[40:43], v[144:147], v[100:103], v[40:43]
    ds_read_b128 v[120:123], v2 offset:12288
    v_mfma_f32_16x16x32_bf16 v[44:47], v[148:151], v[100:103], v[44:47]
    ds_read_b128 v[124:127], v2 offset:14336
    s_waitcnt lgkmcnt(9)
    v_mfma_f32_16x16x32_bf16 v[48:51], v[144:147], v[104:107], v[48:51]
    v_mfma_f32_16x16x32_bf16 v[52:55], v[148:151], v[104:107], v[52:55]
    s_waitcnt lgkmcnt(8)
    v_mfma_f32_16x16x32_bf16 v[56:59], v[144:147], v[108:111], v[56:59]
    v_mfma_f32_16x16x32_bf16 v[60:63], v[148:151], v[108:111], v[60:63]
    s_waitcnt lgkmcnt(0)
    s_barrier
    ds_read_b64_tr_b16 v[128:129], v3 offset:32768
    ds_read_b64_tr_b16 v[130:131], v3 offset:33792
    ds_read_b64_tr_b16 v[132:133], v4 offset:32768
    ds_read_b64_tr_b16 v[134:135], v4 offset:33792
    ds_read_b128 v[64:67], v1 offset:16384
    v_mfma_f32_16x16x32_bf16 v[32:35], v[152:155], v[112:115], v[32:35]
    ds_read_b128 v[68:71], v1 offset:18432
    v_mfma_f32_16x16x32_bf16 v[36:39], v[156:159], v[112:115], v[36:39]
    ds_read_b128 v[72:75], v1 offset:20480
    v_mfma_f32_16x16x32_bf16 v[40:43], v[152:155], v[116:119], v[40:43]
    ds_read_b128 v[76:79], v1 offset:22528
    v_mfma_f32_16x16x32_bf16 v[44:47], v[156:159], v[116:119], v[44:47]
    v_mfma_f32_16x16x32_bf16 v[48:51], v[152:155], v[120:123], v[48:51]
    ds_read_b64_tr_b16 v[136:137], v3 offset:40960
    v_mfma_f32_16x16x32_bf16 v[52:55], v[156:159], v[120:123], v[52:55]
    ds_read_b64_tr_b16 v[138:139], v3 offset:41984
    v_mfma_f32_16x16x32_bf16 v[56:59], v[152:155], v[124:127], v[56:59]
    ds_read_b64_tr_b16 v[140:141], v4 offset:40960
    v_mfma_f32_16x16x32_bf16 v[60:63], v[156:159], v[124:127], v[60:63]
    ds_read_b64_tr_b16 v[142:143], v4 offset:41984
    s_waitcnt lgkmcnt(7)
    v_mfma_f32_16x16x32_bf16 v[32:35], v[128:131], v[64:67], v[32:35]
    ds_read_b128 v[80:83], v2 offset:16384
    v_mfma_f32_16x16x32_bf16 v[36:39], v[132:135], v[64:67], v[36:39]
    ds_read_b128 v[84:87], v2 offset:18432
    s_waitcnt lgkmcnt(8)
    v_mfma_f32_16x16x32_bf16 v[40:43], v[128:131], v[68:71], v[40:43]
    ds_read_b128 v[88:91], v2 offset:20480
    v_mfma_f32_16x16x32_bf16 v[44:47], v[132:135], v[68:71], v[44:47]
    ds_read_b128 v[92:95], v2 offset:22528
    s_waitcnt lgkmcnt(9)
    v_mfma_f32_16x16x32_bf16 v[48:51], v[128:131], v[72:75], v[48:51]
    v_mfma_f32_16x16x32_bf16 v[52:55], v[132:135], v[72:75], v[52:55]
    s_waitcnt lgkmcnt(8)
    v_mfma_f32_16x16x32_bf16 v[56:59], v[128:131], v[76:79], v[56:59]
    v_mfma_f32_16x16x32_bf16 v[60:63], v[132:135], v[76:79], v[60:63]
    s_waitcnt lgkmcnt(0)
    s_barrier
    ds_read_b64_tr_b16 v[144:145], v3 offset:49152
    ds_read_b64_tr_b16 v[146:147], v3 offset:50176
    ds_read_b64_tr_b16 v[148:149], v4 offset:49152
    ds_read_b64_tr_b16 v[150:151], v4 offset:50176
    ds_read_b128 v[96:99], v1 offset:24576
    v_mfma_f32_16x16x32_bf16 v[32:35], v[136:139], v[80:83], v[32:35]
    ds_read_b128 v[100:103], v1 offset:26624
    v_mfma_f32_16x16x32_bf16 v[36:39], v[140:143], v[80:83], v[36:39]
    ds_read_b128 v[104:107], v1 offset:28672
    v_mfma_f32_16x16x32_bf16 v[40:43], v[136:139], v[84:87], v[40:43]
    ds_read_b128 v[108:111], v1 offset:30720
    v_mfma_f32_16x16x32_bf16 v[44:47], v[140:143], v[84:87], v[44:47]
    v_mfma_f32_16x16x32_bf16 v[48:51], v[136:139], v[88:91], v[48:51]
    ds_read_b64_tr_b16 v[152:153], v3 offset:57344
    v_mfma_f32_16x16x32_bf16 v[52:55], v[140:143], v[88:91], v[52:55]
    ds_read_b64_tr_b16 v[154:155], v3 offset:58368
    v_mfma_f32_16x16x32_bf16 v[56:59], v[136:139], v[92:95], v[56:59]
    ds_read_b64_tr_b16 v[156:157], v4 offset:57344
    v_mfma_f32_16x16x32_bf16 v[60:63], v[140:143], v[92:95], v[60:63]
    ds_read_b64_tr_b16 v[158:159], v4 offset:58368
    s_waitcnt lgkmcnt(7)
    v_mfma_f32_16x16x32_bf16 v[32:35], v[144:147], v[96:99], v[32:35]
    ds_read_b128 v[112:115], v2 offset:24576
    v_mfma_f32_16x16x32_bf16 v[36:39], v[148:151], v[96:99], v[36:39]
    ds_read_b128 v[116:119], v2 offset:26624
    s_waitcnt lgkmcnt(8)
    v_mfma_f32_16x16x32_bf16 v[40:43], v[144:147], v[100:103], v[40:43]
    ds_read_b128 v[120:123], v2 offset:28672
    v_mfma_f32_16x16x32_bf16 v[44:47], v[148:151], v[100:103], v[44:47]
    ds_read_b128 v[124:127], v2 offset:30720
    s_waitcnt lgkmcnt(9)
    v_mfma_f32_16x16x32_bf16 v[48:51], v[144:147], v[104:107], v[48:51]
    v_mfma_f32_16x16x32_bf16 v[52:55], v[148:151], v[104:107], v[52:55]
    s_waitcnt lgkmcnt(8)
    v_mfma_f32_16x16x32_bf16 v[56:59], v[144:147], v[108:111], v[56:59]
    v_mfma_f32_16x16x32_bf16 v[60:63], v[148:151], v[108:111], v[60:63]
    s_waitcnt lgkmcnt(0)
    s_barrier
    ds_read_b64_tr_b16 v[128:129], v5 offset:0
    ds_read_b64_tr_b16 v[130:131], v5 offset:1024
    ds_read_b64_tr_b16 v[132:133], v6 offset:0
    ds_read_b64_tr_b16 v[134:135], v6 offset:1024
    ds_read_b128 v[64:67], v1 offset:0
    v_mfma_f32_16x16x32_bf16 v[32:35], v[152:155], v[112:115], v[32:35]
    ds_read_b128 v[68:71], v1 offset:2048
    v_mfma_f32_16x16x32_bf16 v[36:39], v[156:159], v[112:115], v[36:39]
    ds_read_b128 v[72:75], v1 offset:4096
    v_mfma_f32_16x16x32_bf16 v[40:43], v[152:155], v[116:119], v[40:43]
    ds_read_b128 v[76:79], v1 offset:6144
    v_mfma_f32_16x16x32_bf16 v[44:47], v[156:159], v[116:119], v[44:47]
    v_mfma_f32_16x16x32_bf16 v[48:51], v[152:155], v[120:123], v[48:51]
    ds_read_b64_tr_b16 v[136:137], v5 offset:8192
    v_mfma_f32_16x16x32_bf16 v[52:55], v[156:159], v[120:123], v[52:55]
    ds_read_b64_tr_b16 v[138:139], v5 offset:9216
    v_mfma_f32_16x16x32_bf16 v[56:59], v[152:155], v[124:127], v[56:59]
    ds_read_b64_tr_b16 v[140:141], v6 offset:8192
    v_mfma_f32_16x16x32_bf16 v[60:63], v[156:159], v[124:127], v[60:63]
    ds_read_b64_tr_b16 v[142:143], v6 offset:9216
    s_waitcnt lgkmcnt(7)
    v_mfma_f32_16x16x32_bf16 v[32:35], v[128:131], v[64:67], v[32:35]
    ds_read_b128 v[80:83], v2 offset:0
    v_mfma_f32_16x16x32_bf16 v[36:39], v[132:135], v[64:67], v[36:39]
    ds_read_b128 v[84:87], v2 offset:2048
    s_waitcnt lgkmcnt(8)
    v_mfma_f32_16x16x32_bf16 v[40:43], v[128:131], v[68:71], v[40:43]
    ds_read_b128 v[88:91], v2 offset:4096
    v_mfma_f32_16x16x32_bf16 v[44:47], v[132:135], v[68:71], v[44:47]
    ds_read_b128 v[92:95], v2 offset:6144
    s_waitcnt lgkmcnt(9)
    v_mfma_f32_16x16x32_bf16 v[48:51], v[128:131], v[72:75], v[48:51]
    v_mfma_f32_16x16x32_bf16 v[52:55], v[132:135], v[72:75], v[52:55]
    s_waitcnt lgkmcnt(8)
    v_mfma_f32_16x16x32_bf16 v[56:59], v[128:131], v[76:79], v[56:59]
    v_mfma_f32_16x16x32_bf16 v[60:63], v[132:135], v[76:79], v[60:63]
    s_waitcnt lgkmcnt(0)
    s_barrier
    ds_read_b64_tr_b16 v[144:145], v5 offset:16384
    ds_read_b64_tr_b16 v[146:147], v5 offset:17408
    ds_read_b64_tr_b16 v[148:149], v6 offset:16384
    ds_read_b64_tr_b16 v[150:151], v6 offset:17408
    ds_read_b128 v[96:99], v1 offset:8192
    v_mfma_f32_16x16x32_bf16 v[32:35], v[136:139], v[80:83], v[32:35]
    ds_read_b128 v[100:103], v1 offset:10240
    v_mfma_f32_16x16x32_bf16 v[36:39], v[140:143], v[80:83], v[36:39]
    ds_read_b128 v[104:107], v1 offset:12288
    v_mfma_f32_16x16x32_bf16 v[40:43], v[136:139], v[84:87], v[40:43]
    ds_read_b128 v[108:111], v1 offset:14336
    v_mfma_f32_16x16x32_bf16 v[44:47], v[140:143], v[84:87], v[44:47]
    v_mfma_f32_16x16x32_bf16 v[48:51], v[136:139], v[88:91], v[48:51]
    ds_read_b64_tr_b16 v[152:153], v5 offset:24576
    v_mfma_f32_16x16x32_bf16 v[52:55], v[140:143], v[88:91], v[52:55]
    ds_read_b64_tr_b16 v[154:155], v5 offset:25600
    v_mfma_f32_16x16x32_bf16 v[56:59], v[136:139], v[92:95], v[56:59]
    ds_read_b64_tr_b16 v[156:157], v6 offset:24576
    v_mfma_f32_16x16x32_bf16 v[60:63], v[140:143], v[92:95], v[60:63]
    ds_read_b64_tr_b16 v[158:159], v6 offset:25600
    s_waitcnt lgkmcnt(7)
    v_mfma_f32_16x16x32_bf16 v[32:35], v[144:147], v[96:99], v[32:35]
    ds_read_b128 v[112:115], v2 offset:8192
    v_mfma_f32_16x16x32_bf16 v[36:39], v[148:151], v[96:99], v[36:39]
    ds_read_b128 v[116:119], v2 offset:10240
    s_waitcnt lgkmcnt(8)
    v_mfma_f32_16x16x32_bf16 v[40:43], v[144:147], v[100:103], v[40:43]
    ds_read_b128 v[120:123], v2 offset:12288
    v_mfma_f32_16x16x32_bf16 v[44:47], v[148:151], v[100:103], v[44:47]
    ds_read_b128 v[124:127], v2 offset:14336
    s_waitcnt lgkmcnt(9)
    v_mfma_f32_16x16x32_bf16 v[48:51], v[144:147], v[104:107], v[48:51]
    v_mfma_f32_16x16x32_bf16 v[52:55], v[148:151], v[104:107], v[52:55]
    s_waitcnt lgkmcnt(8)
    v_mfma_f32_16x16x32_bf16 v[56:59], v[144:147], v[108:111], v[56:59]
    v_mfma_f32_16x16x32_bf16 v[60:63], v[148:151], v[108:111], v[60:63]
    s_waitcnt lgkmcnt(0)
    s_barrier
    ds_read_b64_tr_b16 v[128:129], v5 offset:32768
    ds_read_b64_tr_b16 v[130:131], v5 offset:33792
    ds_read_b64_tr_b16 v[132:133], v6 offset:32768
    ds_read_b64_tr_b16 v[134:135], v6 offset:33792
    ds_read_b128 v[64:67], v1 offset:16384
    v_mfma_f32_16x16x32_bf16 v[32:35], v[152:155], v[112:115], v[32:35]
    ds_read_b128 v[68:71], v1 offset:18432
    v_mfma_f32_16x16x32_bf16 v[36:39], v[156:159], v[112:115], v[36:39]
    ds_read_b128 v[72:75], v1 offset:20480
    v_mfma_f32_16x16x32_bf16 v[40:43], v[152:155], v[116:119], v[40:43]
    ds_read_b128 v[76:79], v1 offset:22528
    v_mfma_f32_16x16x32_bf16 v[44:47], v[156:159], v[116:119], v[44:47]
    v_mfma_f32_16x16x32_bf16 v[48:51], v[152:155], v[120:123], v[48:51]
    ds_read_b64_tr_b16 v[136:137], v5 offset:40960
    v_mfma_f32_16x16x32_bf16 v[52:55], v[156:159], v[120:123], v[52:55]
    ds_read_b64_tr_b16 v[138:139], v5 offset:41984
    v_mfma_f32_16x16x32_bf16 v[56:59], v[152:155], v[124:127], v[56:59]
    ds_read_b64_tr_b16 v[140:141], v6 offset:40960
    v_mfma_f32_16x16x32_bf16 v[60:63], v[156:159], v[124:127], v[60:63]
    ds_read_b64_tr_b16 v[142:143], v6 offset:41984
    s_waitcnt lgkmcnt(7)
    v_mfma_f32_16x16x32_bf16 v[32:35], v[128:131], v[64:67], v[32:35]
    ds_read_b128 v[80:83], v2 offset:16384
    v_mfma_f32_16x16x32_bf16 v[36:39], v[132:135], v[64:67], v[36:39]
    ds_read_b128 v[84:87], v2 offset:18432
    s_waitcnt lgkmcnt(8)
    v_mfma_f32_16x16x32_bf16 v[40:43], v[128:131], v[68:71], v[40:43]
    ds_read_b128 v[88:91], v2 offset:20480
    v_mfma_f32_16x16x32_bf16 v[44:47], v[132:135], v[68:71], v[44:47]
    ds_read_b128 v[92:95], v2 offset:22528
    s_waitcnt lgkmcnt(9)
    v_mfma_f32_16x16x32_bf16 v[48:51], v[128:131], v[72:75], v[48:51]
    v_mfma_f32_16x16x32_bf16 v[52:55], v[132:135], v[72:75], v[52:55]
    s_waitcnt lgkmcnt(8)
    v_mfma_f32_16x16x32_bf16 v[56:59], v[128:131], v[76:79], v[56:59]
    v_mfma_f32_16x16x32_bf16 v[60:63], v[132:135], v[76:79], v[60:63]
    s_waitcnt lgkmcnt(0)
    s_barrier
    ds_read_b64_tr_b16 v[144:145], v5 offset:49152
    ds_read_b64_tr_b16 v[146:147], v5 offset:50176
    ds_read_b64_tr_b16 v[148:149], v6 offset:49152
    ds_read_b64_tr_b16 v[150:151], v6 offset:50176
    ds_read_b128 v[96:99], v1 offset:24576
    v_mfma_f32_16x16x32_bf16 v[32:35], v[136:139], v[80:83], v[32:35]
    ds_read_b128 v[100:103], v1 offset:26624
    v_mfma_f32_16x16x32_bf16 v[36:39], v[140:143], v[80:83], v[36:39]
    ds_read_b128 v[104:107], v1 offset:28672
    v_mfma_f32_16x16x32_bf16 v[40:43], v[136:139], v[84:87], v[40:43]
    ds_read_b128 v[108:111], v1 offset:30720
    v_mfma_f32_16x16x32_bf16 v[44:47], v[140:143], v[84:87], v[44:47]
    v_mfma_f32_16x16x32_bf16 v[48:51], v[136:139], v[88:91], v[48:51]
    ds_read_b64_tr_b16 v[152:153], v5 offset:57344
    v_mfma_f32_16x16x32_bf16 v[52:55], v[140:143], v[88:91], v[52:55]
    ds_read_b64_tr_b16 v[154:155], v5 offset:58368
    v_mfma_f32_16x16x32_bf16 v[56:59], v[136:139], v[92:95], v[56:59]
    ds_read_b64_tr_b16 v[156:157], v6 offset:57344
    v_mfma_f32_16x16x32_bf16 v[60:63], v[140:143], v[92:95], v[60:63]
    ds_read_b64_tr_b16 v[158:159], v6 offset:58368
    s_waitcnt lgkmcnt(7)
    v_mfma_f32_16x16x32_bf16 v[32:35], v[144:147], v[96:99], v[32:35]
    ds_read_b128 v[112:115], v2 offset:24576
    v_mfma_f32_16x16x32_bf16 v[36:39], v[148:151], v[96:99], v[36:39]
    ds_read_b128 v[116:119], v2 offset:26624
    s_waitcnt lgkmcnt(8)
    v_mfma_f32_16x16x32_bf16 v[40:43], v[144:147], v[100:103], v[40:43]
    ds_read_b128 v[120:123], v2 offset:28672
    v_mfma_f32_16x16x32_bf16 v[44:47], v[148:151], v[100:103], v[44:47]
    ds_read_b128 v[124:127], v2 offset:30720
    s_waitcnt lgkmcnt(9)
    v_mfma_f32_16x16x32_bf16 v[48:51], v[144:147], v[104:107], v[48:51]
    v_mfma_f32_16x16x32_bf16 v[52:55], v[148:151], v[104:107], v[52:55]
    s_waitcnt lgkmcnt(8)
    v_mfma_f32_16x16x32_bf16 v[56:59], v[144:147], v[108:111], v[56:59]
    v_mfma_f32_16x16x32_bf16 v[60:63], v[148:151], v[108:111], v[60:63]
    s_waitcnt lgkmcnt(0)
    s_barrier
    ds_read_b64_tr_b16 v[128:129], v3 offset:0
    ds_read_b64_tr_b16 v[130:131], v3 offset:1024
    ds_read_b64_tr_b16 v[132:133], v4 offset:0
    ds_read_b64_tr_b16 v[134:135], v4 offset:1024
    ds_read_b128 v[64:67], v1 offset:0
    v_mfma_f32_16x16x32_bf16 v[32:35], v[152:155], v[112:115], v[32:35]
    ds_read_b128 v[68:71], v1 offset:2048
    v_mfma_f32_16x16x32_bf16 v[36:39], v[156:159], v[112:115], v[36:39]
    ds_read_b128 v[72:75], v1 offset:4096
    v_mfma_f32_16x16x32_bf16 v[40:43], v[152:155], v[116:119], v[40:43]
    ds_read_b128 v[76:79], v1 offset:6144
    v_mfma_f32_16x16x32_bf16 v[44:47], v[156:159], v[116:119], v[44:47]
    v_mfma_f32_16x16x32_bf16 v[48:51], v[152:155], v[120:123], v[48:51]
    ds_read_b64_tr_b16 v[136:137], v3 offset:8192
    v_mfma_f32_16x16x32_bf16 v[52:55], v[156:159], v[120:123], v[52:55]
    ds_read_b64_tr_b16 v[138:139], v3 offset:9216
    v_mfma_f32_16x16x32_bf16 v[56:59], v[152:155], v[124:127], v[56:59]
    ds_read_b64_tr_b16 v[140:141], v4 offset:8192
    v_mfma_f32_16x16x32_bf16 v[60:63], v[156:159], v[124:127], v[60:63]
    ds_read_b64_tr_b16 v[142:143], v4 offset:9216
    s_waitcnt lgkmcnt(7)
    v_mfma_f32_16x16x32_bf16 v[32:35], v[128:131], v[64:67], v[32:35]
    ds_read_b128 v[80:83], v2 offset:0
    v_mfma_f32_16x16x32_bf16 v[36:39], v[132:135], v[64:67], v[36:39]
    ds_read_b128 v[84:87], v2 offset:2048
    s_waitcnt lgkmcnt(8)
    v_mfma_f32_16x16x32_bf16 v[40:43], v[128:131], v[68:71], v[40:43]
    ds_read_b128 v[88:91], v2 offset:4096
    v_mfma_f32_16x16x32_bf16 v[44:47], v[132:135], v[68:71], v[44:47]
    ds_read_b128 v[92:95], v2 offset:6144
    s_waitcnt lgkmcnt(9)
    v_mfma_f32_16x16x32_bf16 v[48:51], v[128:131], v[72:75], v[48:51]
    v_mfma_f32_16x16x32_bf16 v[52:55], v[132:135], v[72:75], v[52:55]
    s_waitcnt lgkmcnt(8)
    v_mfma_f32_16x16x32_bf16 v[56:59], v[128:131], v[76:79], v[56:59]
    v_mfma_f32_16x16x32_bf16 v[60:63], v[132:135], v[76:79], v[60:63]
    s_waitcnt lgkmcnt(0)
    s_barrier
    ds_read_b64_tr_b16 v[144:145], v3 offset:16384
    ds_read_b64_tr_b16 v[146:147], v3 offset:17408
    ds_read_b64_tr_b16 v[148:149], v4 offset:16384
    ds_read_b64_tr_b16 v[150:151], v4 offset:17408
    ds_read_b128 v[96:99], v1 offset:8192
    v_mfma_f32_16x16x32_bf16 v[32:35], v[136:139], v[80:83], v[32:35]
    ds_read_b128 v[100:103], v1 offset:10240
    v_mfma_f32_16x16x32_bf16 v[36:39], v[140:143], v[80:83], v[36:39]
    ds_read_b128 v[104:107], v1 offset:12288
    v_mfma_f32_16x16x32_bf16 v[40:43], v[136:139], v[84:87], v[40:43]
    ds_read_b128 v[108:111], v1 offset:14336
    v_mfma_f32_16x16x32_bf16 v[44:47], v[140:143], v[84:87], v[44:47]
    v_mfma_f32_16x16x32_bf16 v[48:51], v[136:139], v[88:91], v[48:51]
    ds_read_b64_tr_b16 v[152:153], v3 offset:24576
    v_mfma_f32_16x16x32_bf16 v[52:55], v[140:143], v[88:91], v[52:55]
    ds_read_b64_tr_b16 v[154:155], v3 offset:25600
    v_mfma_f32_16x16x32_bf16 v[56:59], v[136:139], v[92:95], v[56:59]
    ds_read_b64_tr_b16 v[156:157], v4 offset:24576
    v_mfma_f32_16x16x32_bf16 v[60:63], v[140:143], v[92:95], v[60:63]
    ds_read_b64_tr_b16 v[158:159], v4 offset:25600
    s_waitcnt lgkmcnt(7)
    v_mfma_f32_16x16x32_bf16 v[32:35], v[144:147], v[96:99], v[32:35]
    ds_read_b128 v[112:115], v2 offset:8192
    v_mfma_f32_16x16x32_bf16 v[36:39], v[148:151], v[96:99], v[36:39]
    ds_read_b128 v[116:119], v2 offset:10240
    s_waitcnt lgkmcnt(8)
    v_mfma_f32_16x16x32_bf16 v[40:43], v[144:147], v[100:103], v[40:43]
    ds_read_b128 v[120:123], v2 offset:12288
    v_mfma_f32_16x16x32_bf16 v[44:47], v[148:151], v[100:103], v[44:47]
    ds_read_b128 v[124:127], v2 offset:14336
    s_waitcnt lgkmcnt(9)
    v_mfma_f32_16x16x32_bf16 v[48:51], v[144:147], v[104:107], v[48:51]
    v_mfma_f32_16x16x32_bf16 v[52:55], v[148:151], v[104:107], v[52:55]
    s_waitcnt lgkmcnt(8)
    v_mfma_f32_16x16x32_bf16 v[56:59], v[144:147], v[108:111], v[56:59]
    v_mfma_f32_16x16x32_bf16 v[60:63], v[148:151], v[108:111], v[60:63]
    s_waitcnt lgkmcnt(0)
    s_barrier
    ds_read_b64_tr_b16 v[128:129], v3 offset:32768
    ds_read_b64_tr_b16 v[130:131], v3 offset:33792
    ds_read_b64_tr_b16 v[132:133], v4 offset:32768
    ds_read_b64_tr_b16 v[134:135], v4 offset:33792
    ds_read_b128 v[64:67], v1 offset:16384
    v_mfma_f32_16x16x32_bf16 v[32:35], v[152:155], v[112:115], v[32:35]
    ds_read_b128 v[68:71], v1 offset:18432
    v_mfma_f32_16x16x32_bf16 v[36:39], v[156:159], v[112:115], v[36:39]
    ds_read_b128 v[72:75], v1 offset:20480
    v_mfma_f32_16x16x32_bf16 v[40:43], v[152:155], v[116:119], v[40:43]
    ds_read_b128 v[76:79], v1 offset:22528
    v_mfma_f32_16x16x32_bf16 v[44:47], v[156:159], v[116:119], v[44:47]
    v_mfma_f32_16x16x32_bf16 v[48:51], v[152:155], v[120:123], v[48:51]
    ds_read_b64_tr_b16 v[136:137], v3 offset:40960
    v_mfma_f32_16x16x32_bf16 v[52:55], v[156:159], v[120:123], v[52:55]
    ds_read_b64_tr_b16 v[138:139], v3 offset:41984
    v_mfma_f32_16x16x32_bf16 v[56:59], v[152:155], v[124:127], v[56:59]
    ds_read_b64_tr_b16 v[140:141], v4 offset:40960
    v_mfma_f32_16x16x32_bf16 v[60:63], v[156:159], v[124:127], v[60:63]
    ds_read_b64_tr_b16 v[142:143], v4 offset:41984
    s_waitcnt lgkmcnt(7)
    v_mfma_f32_16x16x32_bf16 v[32:35], v[128:131], v[64:67], v[32:35]
    ds_read_b128 v[80:83], v2 offset:16384
    v_mfma_f32_16x16x32_bf16 v[36:39], v[132:135], v[64:67], v[36:39]
    ds_read_b128 v[84:87], v2 offset:18432
    s_waitcnt lgkmcnt(8)
    v_mfma_f32_16x16x32_bf16 v[40:43], v[128:131], v[68:71], v[40:43]
    ds_read_b128 v[88:91], v2 offset:20480
    v_mfma_f32_16x16x32_bf16 v[44:47], v[132:135], v[68:71], v[44:47]
    ds_read_b128 v[92:95], v2 offset:22528
    s_waitcnt lgkmcnt(9)
    v_mfma_f32_16x16x32_bf16 v[48:51], v[128:131], v[72:75], v[48:51]
    v_mfma_f32_16x16x32_bf16 v[52:55], v[132:135], v[72:75], v[52:55]
    s_waitcnt lgkmcnt(8)
    v_mfma_f32_16x16x32_bf16 v[56:59], v[128:131], v[76:79], v[56:59]
    v_mfma_f32_16x16x32_bf16 v[60:63], v[132:135], v[76:79], v[60:63]
    s_waitcnt lgkmcnt(0)
    s_barrier
    ds_read_b64_tr_b16 v[144:145], v3 offset:49152
    ds_read_b64_tr_b16 v[146:147], v3 offset:50176
    ds_read_b64_tr_b16 v[148:149], v4 offset:49152
    ds_read_b64_tr_b16 v[150:151], v4 offset:50176
    ds_read_b128 v[96:99], v1 offset:24576
    v_mfma_f32_16x16x32_bf16 v[32:35], v[136:139], v[80:83], v[32:35]
    ds_read_b128 v[100:103], v1 offset:26624
    v_mfma_f32_16x16x32_bf16 v[36:39], v[140:143], v[80:83], v[36:39]
    ds_read_b128 v[104:107], v1 offset:28672
    v_mfma_f32_16x16x32_bf16 v[40:43], v[136:139], v[84:87], v[40:43]
    ds_read_b128 v[108:111], v1 offset:30720
    v_mfma_f32_16x16x32_bf16 v[44:47], v[140:143], v[84:87], v[44:47]
    v_mfma_f32_16x16x32_bf16 v[48:51], v[136:139], v[88:91], v[48:51]
    ds_read_b64_tr_b16 v[152:153], v3 offset:57344
    v_mfma_f32_16x16x32_bf16 v[52:55], v[140:143], v[88:91], v[52:55]
    ds_read_b64_tr_b16 v[154:155], v3 offset:58368
    v_mfma_f32_16x16x32_bf16 v[56:59], v[136:139], v[92:95], v[56:59]
    ds_read_b64_tr_b16 v[156:157], v4 offset:57344
    v_mfma_f32_16x16x32_bf16 v[60:63], v[140:143], v[92:95], v[60:63]
    ds_read_b64_tr_b16 v[158:159], v4 offset:58368
    s_waitcnt lgkmcnt(7)
    v_mfma_f32_16x16x32_bf16 v[32:35], v[144:147], v[96:99], v[32:35]
    ds_read_b128 v[112:115], v2 offset:24576
    v_mfma_f32_16x16x32_bf16 v[36:39], v[148:151], v[96:99], v[36:39]
    ds_read_b128 v[116:119], v2 offset:26624
    s_waitcnt lgkmcnt(8)
    v_mfma_f32_16x16x32_bf16 v[40:43], v[144:147], v[100:103], v[40:43]
    ds_read_b128 v[120:123], v2 offset:28672
    v_mfma_f32_16x16x32_bf16 v[44:47], v[148:151], v[100:103], v[44:47]
    ds_read_b128 v[124:127], v2 offset:30720
    s_waitcnt lgkmcnt(9)
    v_mfma_f32_16x16x32_bf16 v[48:51], v[144:147], v[104:107], v[48:51]
    v_mfma_f32_16x16x32_bf16 v[52:55], v[148:151], v[104:107], v[52:55]
    s_waitcnt lgkmcnt(8)
    v_mfma_f32_16x16x32_bf16 v[56:59], v[144:147], v[108:111], v[56:59]
    v_mfma_f32_16x16x32_bf16 v[60:63], v[148:151], v[108:111], v[60:63]
    s_waitcnt lgkmcnt(0)
    s_barrier
    ds_read_b64_tr_b16 v[128:129], v5 offset:0
    ds_read_b64_tr_b16 v[130:131], v5 offset:1024
    ds_read_b64_tr_b16 v[132:133], v6 offset:0
    ds_read_b64_tr_b16 v[134:135], v6 offset:1024
    ds_read_b128 v[64:67], v1 offset:0
    v_mfma_f32_16x16x32_bf16 v[32:35], v[152:155], v[112:115], v[32:35]
    ds_read_b128 v[68:71], v1 offset:2048
    v_mfma_f32_16x16x32_bf16 v[36:39], v[156:159], v[112:115], v[36:39]
    ds_read_b128 v[72:75], v1 offset:4096
    v_mfma_f32_16x16x32_bf16 v[40:43], v[152:155], v[116:119], v[40:43]
    ds_read_b128 v[76:79], v1 offset:6144
    v_mfma_f32_16x16x32_bf16 v[44:47], v[156:159], v[116:119], v[44:47]
    v_mfma_f32_16x16x32_bf16 v[48:51], v[152:155], v[120:123], v[48:51]
    ds_read_b64_tr_b16 v[136:137], v5 offset:8192
    v_mfma_f32_16x16x32_bf16 v[52:55], v[156:159], v[120:123], v[52:55]
    ds_read_b64_tr_b16 v[138:139], v5 offset:9216
    v_mfma_f32_16x16x32_bf16 v[56:59], v[152:155], v[124:127], v[56:59]
    ds_read_b64_tr_b16 v[140:141], v6 offset:8192
    v_mfma_f32_16x16x32_bf16 v[60:63], v[156:159], v[124:127], v[60:63]
    ds_read_b64_tr_b16 v[142:143], v6 offset:9216
    s_waitcnt lgkmcnt(7)
    v_mfma_f32_16x16x32_bf16 v[32:35], v[128:131], v[64:67], v[32:35]
    ds_read_b128 v[80:83], v2 offset:0
    v_mfma_f32_16x16x32_bf16 v[36:39], v[132:135], v[64:67], v[36:39]
    ds_read_b128 v[84:87], v2 offset:2048
    s_waitcnt lgkmcnt(8)
    v_mfma_f32_16x16x32_bf16 v[40:43], v[128:131], v[68:71], v[40:43]
    ds_read_b128 v[88:91], v2 offset:4096
    v_mfma_f32_16x16x32_bf16 v[44:47], v[132:135], v[68:71], v[44:47]
    ds_read_b128 v[92:95], v2 offset:6144
    s_waitcnt lgkmcnt(9)
    v_mfma_f32_16x16x32_bf16 v[48:51], v[128:131], v[72:75], v[48:51]
    v_mfma_f32_16x16x32_bf16 v[52:55], v[132:135], v[72:75], v[52:55]
    s_waitcnt lgkmcnt(8)
    v_mfma_f32_16x16x32_bf16 v[56:59], v[128:131], v[76:79], v[56:59]
    v_mfma_f32_16x16x32_bf16 v[60:63], v[132:135], v[76:79], v[60:63]
    s_waitcnt lgkmcnt(0)
    s_barrier
    ds_read_b64_tr_b16 v[144:145], v5 offset:16384
    ds_read_b64_tr_b16 v[146:147], v5 offset:17408
    ds_read_b64_tr_b16 v[148:149], v6 offset:16384
    ds_read_b64_tr_b16 v[150:151], v6 offset:17408
    ds_read_b128 v[96:99], v1 offset:8192
    v_mfma_f32_16x16x32_bf16 v[32:35], v[136:139], v[80:83], v[32:35]
    ds_read_b128 v[100:103], v1 offset:10240
    v_mfma_f32_16x16x32_bf16 v[36:39], v[140:143], v[80:83], v[36:39]
    ds_read_b128 v[104:107], v1 offset:12288
    v_mfma_f32_16x16x32_bf16 v[40:43], v[136:139], v[84:87], v[40:43]
    ds_read_b128 v[108:111], v1 offset:14336
    v_mfma_f32_16x16x32_bf16 v[44:47], v[140:143], v[84:87], v[44:47]
    v_mfma_f32_16x16x32_bf16 v[48:51], v[136:139], v[88:91], v[48:51]
    ds_read_b64_tr_b16 v[152:153], v5 offset:24576
    v_mfma_f32_16x16x32_bf16 v[52:55], v[140:143], v[88:91], v[52:55]
    ds_read_b64_tr_b16 v[154:155], v5 offset:25600
    v_mfma_f32_16x16x32_bf16 v[56:59], v[136:139], v[92:95], v[56:59]
    ds_read_b64_tr_b16 v[156:157], v6 offset:24576
    v_mfma_f32_16x16x32_bf16 v[60:63], v[140:143], v[92:95], v[60:63]
    ds_read_b64_tr_b16 v[158:159], v6 offset:25600
    s_waitcnt lgkmcnt(7)
    v_mfma_f32_16x16x32_bf16 v[32:35], v[144:147], v[96:99], v[32:35]
    ds_read_b128 v[112:115], v2 offset:8192
    v_mfma_f32_16x16x32_bf16 v[36:39], v[148:151], v[96:99], v[36:39]
    ds_read_b128 v[116:119], v2 offset:10240
    s_waitcnt lgkmcnt(8)
    v_mfma_f32_16x16x32_bf16 v[40:43], v[144:147], v[100:103], v[40:43]
    ds_read_b128 v[120:123], v2 offset:12288
    v_mfma_f32_16x16x32_bf16 v[44:47], v[148:151], v[100:103], v[44:47]
    ds_read_b128 v[124:127], v2 offset:14336
    s_waitcnt lgkmcnt(9)
    v_mfma_f32_16x16x32_bf16 v[48:51], v[144:147], v[104:107], v[48:51]
    v_mfma_f32_16x16x32_bf16 v[52:55], v[148:151], v[104:107], v[52:55]
    s_waitcnt lgkmcnt(8)
    v_mfma_f32_16x16x32_bf16 v[56:59], v[144:147], v[108:111], v[56:59]
    v_mfma_f32_16x16x32_bf16 v[60:63], v[148:151], v[108:111], v[60:63]
    s_waitcnt lgkmcnt(0)
    s_barrier
    ds_read_b64_tr_b16 v[128:129], v5 offset:32768
    ds_read_b64_tr_b16 v[130:131], v5 offset:33792
    ds_read_b64_tr_b16 v[132:133], v6 offset:32768
    ds_read_b64_tr_b16 v[134:135], v6 offset:33792
    ds_read_b128 v[64:67], v1 offset:16384
    v_mfma_f32_16x16x32_bf16 v[32:35], v[152:155], v[112:115], v[32:35]
    ds_read_b128 v[68:71], v1 offset:18432
    v_mfma_f32_16x16x32_bf16 v[36:39], v[156:159], v[112:115], v[36:39]
    ds_read_b128 v[72:75], v1 offset:20480
    v_mfma_f32_16x16x32_bf16 v[40:43], v[152:155], v[116:119], v[40:43]
    ds_read_b128 v[76:79], v1 offset:22528
    v_mfma_f32_16x16x32_bf16 v[44:47], v[156:159], v[116:119], v[44:47]
    v_mfma_f32_16x16x32_bf16 v[48:51], v[152:155], v[120:123], v[48:51]
    ds_read_b64_tr_b16 v[136:137], v5 offset:40960
    v_mfma_f32_16x16x32_bf16 v[52:55], v[156:159], v[120:123], v[52:55]
    ds_read_b64_tr_b16 v[138:139], v5 offset:41984
    v_mfma_f32_16x16x32_bf16 v[56:59], v[152:155], v[124:127], v[56:59]
    ds_read_b64_tr_b16 v[140:141], v6 offset:40960
    v_mfma_f32_16x16x32_bf16 v[60:63], v[156:159], v[124:127], v[60:63]
    ds_read_b64_tr_b16 v[142:143], v6 offset:41984
    s_waitcnt lgkmcnt(7)
    v_mfma_f32_16x16x32_bf16 v[32:35], v[128:131], v[64:67], v[32:35]
    ds_read_b128 v[80:83], v2 offset:16384
    v_mfma_f32_16x16x32_bf16 v[36:39], v[132:135], v[64:67], v[36:39]
    ds_read_b128 v[84:87], v2 offset:18432
    s_waitcnt lgkmcnt(8)
    v_mfma_f32_16x16x32_bf16 v[40:43], v[128:131], v[68:71], v[40:43]
    ds_read_b128 v[88:91], v2 offset:20480
    v_mfma_f32_16x16x32_bf16 v[44:47], v[132:135], v[68:71], v[44:47]
    ds_read_b128 v[92:95], v2 offset:22528
    s_waitcnt lgkmcnt(9)
    v_mfma_f32_16x16x32_bf16 v[48:51], v[128:131], v[72:75], v[48:51]
    v_mfma_f32_16x16x32_bf16 v[52:55], v[132:135], v[72:75], v[52:55]
    s_waitcnt lgkmcnt(8)
    v_mfma_f32_16x16x32_bf16 v[56:59], v[128:131], v[76:79], v[56:59]
    v_mfma_f32_16x16x32_bf16 v[60:63], v[132:135], v[76:79], v[60:63]
    s_waitcnt lgkmcnt(0)
    s_barrier
    ds_read_b64_tr_b16 v[144:145], v5 offset:49152
    ds_read_b64_tr_b16 v[146:147], v5 offset:50176
    ds_read_b64_tr_b16 v[148:149], v6 offset:49152
    ds_read_b64_tr_b16 v[150:151], v6 offset:50176
    ds_read_b128 v[96:99], v1 offset:24576
    v_mfma_f32_16x16x32_bf16 v[32:35], v[136:139], v[80:83], v[32:35]
    ds_read_b128 v[100:103], v1 offset:26624
    v_mfma_f32_16x16x32_bf16 v[36:39], v[140:143], v[80:83], v[36:39]
    ds_read_b128 v[104:107], v1 offset:28672
    v_mfma_f32_16x16x32_bf16 v[40:43], v[136:139], v[84:87], v[40:43]
    ds_read_b128 v[108:111], v1 offset:30720
    v_mfma_f32_16x16x32_bf16 v[44:47], v[140:143], v[84:87], v[44:47]
    v_mfma_f32_16x16x32_bf16 v[48:51], v[136:139], v[88:91], v[48:51]
    ds_read_b64_tr_b16 v[152:153], v5 offset:57344
    v_mfma_f32_16x16x32_bf16 v[52:55], v[140:143], v[88:91], v[52:55]
    ds_read_b64_tr_b16 v[154:155], v5 offset:58368
    v_mfma_f32_16x16x32_bf16 v[56:59], v[136:139], v[92:95], v[56:59]
    ds_read_b64_tr_b16 v[156:157], v6 offset:57344
    v_mfma_f32_16x16x32_bf16 v[60:63], v[140:143], v[92:95], v[60:63]
    ds_read_b64_tr_b16 v[158:159], v6 offset:58368
    s_waitcnt lgkmcnt(7)
    v_mfma_f32_16x16x32_bf16 v[32:35], v[144:147], v[96:99], v[32:35]
    ds_read_b128 v[112:115], v2 offset:24576
    v_mfma_f32_16x16x32_bf16 v[36:39], v[148:151], v[96:99], v[36:39]
    ds_read_b128 v[116:119], v2 offset:26624
    s_waitcnt lgkmcnt(8)
    v_mfma_f32_16x16x32_bf16 v[40:43], v[144:147], v[100:103], v[40:43]
    ds_read_b128 v[120:123], v2 offset:28672
    v_mfma_f32_16x16x32_bf16 v[44:47], v[148:151], v[100:103], v[44:47]
    ds_read_b128 v[124:127], v2 offset:30720
    s_waitcnt lgkmcnt(9)
    v_mfma_f32_16x16x32_bf16 v[48:51], v[144:147], v[104:107], v[48:51]
    v_mfma_f32_16x16x32_bf16 v[52:55], v[148:151], v[104:107], v[52:55]
    s_waitcnt lgkmcnt(8)
    v_mfma_f32_16x16x32_bf16 v[56:59], v[144:147], v[108:111], v[56:59]
    v_mfma_f32_16x16x32_bf16 v[60:63], v[148:151], v[108:111], v[60:63]
    buffer_load_dwordx2 v[160:161], v9, s[36:39], s58 offen offset:0
    buffer_load_dwordx2 v[162:163], v9, s[36:39], s58 offen offset:32
    buffer_load_dword v175, v172, s[48:51], s59 offen offset:4 sc1
    s_add_u32 s60, s59, 0x10000
    buffer_load_dword v193, v172, s[48:51], s60 offen offset:4 sc1
    s_lshl_b32 s56, s52, 6
    s_add_u32 s56, s56, s53
    s_lshl_b32 s56, s56, 2
    s_mov_b64 exec, 1
    buffer_load_dword v173, off, s[44:47], s56 sc1
    s_mov_b64 exec, -1
    s_waitcnt lgkmcnt(0)
    s_barrier
    ds_read_b64_tr_b16 v[128:129], v3 offset:0
    ds_read_b64_tr_b16 v[130:131], v3 offset:1024
    ds_read_b64_tr_b16 v[132:133], v4 offset:0
    ds_read_b64_tr_b16 v[134:135], v4 offset:1024
    ds_read_b128 v[64:67], v1 offset:0
    v_mfma_f32_16x16x32_bf16 v[32:35], v[152:155], v[112:115], v[32:35]
    ds_read_b128 v[68:71], v1 offset:2048
    v_mfma_f32_16x16x32_bf16 v[36:39], v[156:159], v[112:115], v[36:39]
    ds_read_b128 v[72:75], v1 offset:4096
    v_mfma_f32_16x16x32_bf16 v[40:43], v[152:155], v[116:119], v[40:43]
    ds_read_b128 v[76:79], v1 offset:6144
    v_mfma_f32_16x16x32_bf16 v[44:47], v[156:159], v[116:119], v[44:47]
    v_mfma_f32_16x16x32_bf16 v[48:51], v[152:155], v[120:123], v[48:51]
    ds_read_b64_tr_b16 v[136:137], v3 offset:8192
    v_mfma_f32_16x16x32_bf16 v[52:55], v[156:159], v[120:123], v[52:55]
    ds_read_b64_tr_b16 v[138:139], v3 offset:9216
    v_mfma_f32_16x16x32_bf16 v[56:59], v[152:155], v[124:127], v[56:59]
    ds_read_b64_tr_b16 v[140:141], v4 offset:8192
    v_mfma_f32_16x16x32_bf16 v[60:63], v[156:159], v[124:127], v[60:63]
    ds_read_b64_tr_b16 v[142:143], v4 offset:9216
    s_waitcnt lgkmcnt(7)
    v_mfma_f32_16x16x32_bf16 v[32:35], v[128:131], v[64:67], v[32:35]
    ds_read_b128 v[80:83], v2 offset:0
    v_mfma_f32_16x16x32_bf16 v[36:39], v[132:135], v[64:67], v[36:39]
    ds_read_b128 v[84:87], v2 offset:2048
    s_waitcnt lgkmcnt(8)
    v_mfma_f32_16x16x32_bf16 v[40:43], v[128:131], v[68:71], v[40:43]
    ds_read_b128 v[88:91], v2 offset:4096
    v_mfma_f32_16x16x32_bf16 v[44:47], v[132:135], v[68:71], v[44:47]
    ds_read_b128 v[92:95], v2 offset:6144
    s_waitcnt lgkmcnt(9)
    v_mfma_f32_16x16x32_bf16 v[48:51], v[128:131], v[72:75], v[48:51]
    v_mfma_f32_16x16x32_bf16 v[52:55], v[132:135], v[72:75], v[52:55]
    s_waitcnt lgkmcnt(8)
    v_mfma_f32_16x16x32_bf16 v[56:59], v[128:131], v[76:79], v[56:59]
    v_mfma_f32_16x16x32_bf16 v[60:63], v[132:135], v[76:79], v[60:63]
    s_waitcnt lgkmcnt(0)
    s_barrier
    ds_read_b64_tr_b16 v[144:145], v3 offset:16384
    ds_read_b64_tr_b16 v[146:147], v3 offset:17408
    ds_read_b64_tr_b16 v[148:149], v4 offset:16384
    ds_read_b64_tr_b16 v[150:151], v4 offset:17408
    ds_read_b128 v[96:99], v1 offset:8192
    v_mfma_f32_16x16x32_bf16 v[32:35], v[136:139], v[80:83], v[32:35]
    ds_read_b128 v[100:103], v1 offset:10240
    v_mfma_f32_16x16x32_bf16 v[36:39], v[140:143], v[80:83], v[36:39]
    ds_read_b128 v[104:107], v1 offset:12288
    v_mfma_f32_16x16x32_bf16 v[40:43], v[136:139], v[84:87], v[40:43]
    ds_read_b128 v[108:111], v1 offset:14336
    v_mfma_f32_16x16x32_bf16 v[44:47], v[140:143], v[84:87], v[44:47]
    v_mfma_f32_16x16x32_bf16 v[48:51], v[136:139], v[88:91], v[48:51]
    ds_read_b64_tr_b16 v[152:153], v3 offset:24576
    v_mfma_f32_16x16x32_bf16 v[52:55], v[140:143], v[88:91], v[52:55]
    ds_read_b64_tr_b16 v[154:155], v3 offset:25600
    v_mfma_f32_16x16x32_bf16 v[56:59], v[136:139], v[92:95], v[56:59]
    ds_read_b64_tr_b16 v[156:157], v4 offset:24576
    v_mfma_f32_16x16x32_bf16 v[60:63], v[140:143], v[92:95], v[60:63]
    ds_read_b64_tr_b16 v[158:159], v4 offset:25600
    s_waitcnt lgkmcnt(7)
    v_mfma_f32_16x16x32_bf16 v[32:35], v[144:147], v[96:99], v[32:35]
    ds_read_b128 v[112:115], v2 offset:8192
    v_mfma_f32_16x16x32_bf16 v[36:39], v[148:151], v[96:99], v[36:39]
    ds_read_b128 v[116:119], v2 offset:10240
    s_waitcnt lgkmcnt(8)
    v_mfma_f32_16x16x32_bf16 v[40:43], v[144:147], v[100:103], v[40:43]
    ds_read_b128 v[120:123], v2 offset:12288
    v_mfma_f32_16x16x32_bf16 v[44:47], v[148:151], v[100:103], v[44:47]
    ds_read_b128 v[124:127], v2 offset:14336
    s_waitcnt lgkmcnt(9)
    v_mfma_f32_16x16x32_bf16 v[48:51], v[144:147], v[104:107], v[48:51]
    v_mfma_f32_16x16x32_bf16 v[52:55], v[148:151], v[104:107], v[52:55]
    s_waitcnt lgkmcnt(8)
    v_mfma_f32_16x16x32_bf16 v[56:59], v[144:147], v[108:111], v[56:59]
    v_mfma_f32_16x16x32_bf16 v[60:63], v[148:151], v[108:111], v[60:63]
    s_waitcnt lgkmcnt(0)
    v_mfma_f32_16x16x32_bf16 v[32:35], v[152:155], v[112:115], v[32:35]
    v_mfma_f32_16x16x32_bf16 v[36:39], v[156:159], v[112:115], v[36:39]
    v_mfma_f32_16x16x32_bf16 v[40:43], v[152:155], v[116:119], v[40:43]
    v_mfma_f32_16x16x32_bf16 v[44:47], v[156:159], v[116:119], v[44:47]
    v_mfma_f32_16x16x32_bf16 v[48:51], v[152:155], v[120:123], v[48:51]
    v_mfma_f32_16x16x32_bf16 v[52:55], v[156:159], v[120:123], v[52:55]
    v_mfma_f32_16x16x32_bf16 v[56:59], v[152:155], v[124:127], v[56:59]
    v_mfma_f32_16x16x32_bf16 v[60:63], v[156:159], v[124:127], v[60:63]
    s_waitcnt vmcnt(3)
    v_lshlrev_b32 v176, 16, v160
    v_and_b32 v177, s68, v160
    v_lshlrev_b32 v178, 16, v161
    v_and_b32 v179, s68, v161
    v_lshlrev_b32 v180, 16, v162
    v_and_b32 v181, s68, v162
    v_lshlrev_b32 v182, 16, v163
    v_and_b32 v183, s68, v163
    v_pk_mul_f32 v[64:65], v[32:33], v[32:33]
    v_pk_mul_f32 v[66:67], v[34:35], v[34:35]
    v_pk_mul_f32 v[68:69], v[36:37], v[36:37]
    v_pk_mul_f32 v[70:71], v[38:39], v[38:39]
    v_pk_mul_f32 v[72:73], v[40:41], v[40:41]
    v_pk_mul_f32 v[74:75], v[42:43], v[42:43]
    v_pk_mul_f32 v[76:77], v[44:45], v[44:45]
    v_pk_mul_f32 v[78:79], v[46:47], v[46:47]
    v_pk_fma_f32 v[64:65], v[64:65], v[14:15], v[12:13]
    v_pk_fma_f32 v[66:67], v[66:67], v[14:15], v[12:13]
    v_pk_fma_f32 v[68:69], v[68:69], v[14:15], v[12:13]
    v_pk_fma_f32 v[70:71], v[70:71], v[14:15], v[12:13]
    v_pk_fma_f32 v[72:73], v[72:73], v[14:15], v[12:13]
    v_pk_fma_f32 v[74:75], v[74:75], v[14:15], v[12:13]
    v_pk_fma_f32 v[76:77], v[76:77], v[14:15], v[12:13]
    v_pk_fma_f32 v[78:79], v[78:79], v[14:15], v[12:13]
    v_pk_mul_f32 v[64:65], v[64:65], v[32:33]
    v_pk_mul_f32 v[66:67], v[66:67], v[34:35]
    v_pk_mul_f32 v[68:69], v[68:69], v[36:37]
    v_pk_mul_f32 v[70:71], v[70:71], v[38:39]
    v_pk_mul_f32 v[72:73], v[72:73], v[40:41]
    v_pk_mul_f32 v[74:75], v[74:75], v[42:43]
    v_pk_mul_f32 v[76:77], v[76:77], v[44:45]
    v_pk_mul_f32 v[78:79], v[78:79], v[46:47]
    v_exp_f32 v64, v64
    v_exp_f32 v66, v66
    v_exp_f32 v68, v68
    v_exp_f32 v70, v70
    v_exp_f32 v72, v72
    v_exp_f32 v74, v74
    v_exp_f32 v76, v76
    v_exp_f32 v78, v78
    v_exp_f32 v65, v65
    v_exp_f32 v67, v67
    v_exp_f32 v69, v69
    v_exp_f32 v71, v71
    v_exp_f32 v73, v73
    v_exp_f32 v75, v75
    v_exp_f32 v77, v77
    v_exp_f32 v79, v79
    v_pk_mul_f32 v[32:33], v[32:33], v[176:177]
    v_pk_mul_f32 v[34:35], v[34:35], v[178:179]
    v_pk_mul_f32 v[36:37], v[36:37], v[180:181]
    v_pk_mul_f32 v[38:39], v[38:39], v[182:183]
    v_pk_mul_f32 v[40:41], v[40:41], v[176:177]
    v_pk_mul_f32 v[42:43], v[42:43], v[178:179]
    v_pk_mul_f32 v[44:45], v[44:45], v[180:181]
    v_pk_mul_f32 v[46:47], v[46:47], v[182:183]
    v_pk_add_f32 v[64:65], v[64:65], 1.0 op_sel_hi:[1,0]
    v_pk_add_f32 v[66:67], v[66:67], 1.0 op_sel_hi:[1,0]
    v_pk_add_f32 v[68:69], v[68:69], 1.0 op_sel_hi:[1,0]
    v_pk_add_f32 v[70:71], v[70:71], 1.0 op_sel_hi:[1,0]
    v_pk_add_f32 v[72:73], v[72:73], 1.0 op_sel_hi:[1,0]
    v_pk_add_f32 v[74:75], v[74:75], 1.0 op_sel_hi:[1,0]
    v_pk_add_f32 v[76:77], v[76:77], 1.0 op_sel_hi:[1,0]
    v_pk_add_f32 v[78:79], v[78:79], 1.0 op_sel_hi:[1,0]
    v_rcp_f32 v64, v64
    v_rcp_f32 v66, v66
    v_rcp_f32 v68, v68
    v_rcp_f32 v70, v70
    v_rcp_f32 v72, v72
    v_rcp_f32 v74, v74
    v_rcp_f32 v76, v76
    v_rcp_f32 v78, v78
    v_rcp_f32 v65, v65
    v_rcp_f32 v67, v67
    v_rcp_f32 v69, v69
    v_rcp_f32 v71, v71
    v_rcp_f32 v73, v73
    v_rcp_f32 v75, v75
    v_rcp_f32 v77, v77
    v_rcp_f32 v79, v79
    v_pk_mul_f32 v[164:165], v[32:33], v[64:65]
    v_pk_fma_f32 v[164:165], v[34:35], v[66:67], v[164:165]
    v_pk_fma_f32 v[164:165], v[36:37], v[68:69], v[164:165]
    v_pk_fma_f32 v[164:165], v[38:39], v[70:71], v[164:165]
    v_pk_mul_f32 v[166:167], v[40:41], v[72:73]
    v_pk_fma_f32 v[166:167], v[42:43], v[74:75], v[166:167]
    v_pk_fma_f32 v[166:167], v[44:45], v[76:77], v[166:167]
    v_pk_fma_f32 v[166:167], v[46:47], v[78:79], v[166:167]
    v_pk_mul_f32 v[64:65], v[48:49], v[48:49]
    v_pk_mul_f32 v[66:67], v[50:51], v[50:51]
    v_pk_mul_f32 v[68:69], v[52:53], v[52:53]
    v_pk_mul_f32 v[70:71], v[54:55], v[54:55]
    v_pk_mul_f32 v[72:73], v[56:57], v[56:57]
    v_pk_mul_f32 v[74:75], v[58:59], v[58:59]
    v_pk_mul_f32 v[76:77], v[60:61], v[60:61]
    v_pk_mul_f32 v[78:79], v[62:63], v[62:63]
    v_pk_fma_f32 v[64:65], v[64:65], v[14:15], v[12:13]
    v_pk_fma_f32 v[66:67], v[66:67], v[14:15], v[12:13]
    v_pk_fma_f32 v[68:69], v[68:69], v[14:15], v[12:13]
    v_pk_fma_f32 v[70:71], v[70:71], v[14:15], v[12:13]
    v_pk_fma_f32 v[72:73], v[72:73], v[14:15], v[12:13]
    v_pk_fma_f32 v[74:75], v[74:75], v[14:15], v[12:13]
    v_pk_fma_f32 v[76:77], v[76:77], v[14:15], v[12:13]
    v_pk_fma_f32 v[78:79], v[78:79], v[14:15], v[12:13]
    v_pk_mul_f32 v[64:65], v[64:65], v[48:49]
    v_pk_mul_f32 v[66:67], v[66:67], v[50:51]
    v_pk_mul_f32 v[68:69], v[68:69], v[52:53]
    v_pk_mul_f32 v[70:71], v[70:71], v[54:55]
    v_pk_mul_f32 v[72:73], v[72:73], v[56:57]
    v_pk_mul_f32 v[74:75], v[74:75], v[58:59]
    v_pk_mul_f32 v[76:77], v[76:77], v[60:61]
    v_pk_mul_f32 v[78:79], v[78:79], v[62:63]
    v_exp_f32 v64, v64
    v_exp_f32 v66, v66
    v_exp_f32 v68, v68
    v_exp_f32 v70, v70
    v_exp_f32 v72, v72
    v_exp_f32 v74, v74
    v_exp_f32 v76, v76
    v_exp_f32 v78, v78
    v_exp_f32 v65, v65
    v_exp_f32 v67, v67
    v_exp_f32 v69, v69
    v_exp_f32 v71, v71
    v_exp_f32 v73, v73
    v_exp_f32 v75, v75
    v_exp_f32 v77, v77
    v_exp_f32 v79, v79
    v_pk_mul_f32 v[48:49], v[48:49], v[176:177]
    v_pk_mul_f32 v[50:51], v[50:51], v[178:179]
    v_pk_mul_f32 v[52:53], v[52:53], v[180:181]
    v_pk_mul_f32 v[54:55], v[54:55], v[182:183]
    v_pk_mul_f32 v[56:57], v[56:57], v[176:177]
    v_pk_mul_f32 v[58:59], v[58:59], v[178:179]
    v_pk_mul_f32 v[60:61], v[60:61], v[180:181]
    v_pk_mul_f32 v[62:63], v[62:63], v[182:183]
    v_pk_add_f32 v[64:65], v[64:65], 1.0 op_sel_hi:[1,0]
    v_pk_add_f32 v[66:67], v[66:67], 1.0 op_sel_hi:[1,0]
    v_pk_add_f32 v[68:69], v[68:69], 1.0 op_sel_hi:[1,0]
    v_pk_add_f32 v[70:71], v[70:71], 1.0 op_sel_hi:[1,0]
    v_pk_add_f32 v[72:73], v[72:73], 1.0 op_sel_hi:[1,0]
    v_pk_add_f32 v[74:75], v[74:75], 1.0 op_sel_hi:[1,0]
    v_pk_add_f32 v[76:77], v[76:77], 1.0 op_sel_hi:[1,0]
    v_pk_add_f32 v[78:79], v[78:79], 1.0 op_sel_hi:[1,0]
    v_rcp_f32 v64, v64
    v_rcp_f32 v66, v66
    v_rcp_f32 v68, v68
    v_rcp_f32 v70, v70
    v_rcp_f32 v72, v72
    v_rcp_f32 v74, v74
    v_rcp_f32 v76, v76
    v_rcp_f32 v78, v78
    v_rcp_f32 v65, v65
    v_rcp_f32 v67, v67
    v_rcp_f32 v69, v69
    v_rcp_f32 v71, v71
    v_rcp_f32 v73, v73
    v_rcp_f32 v75, v75
    v_rcp_f32 v77, v77
    v_rcp_f32 v79, v79
    v_pk_mul_f32 v[168:169], v[48:49], v[64:65]
    v_pk_fma_f32 v[168:169], v[50:51], v[66:67], v[168:169]
    v_pk_fma_f32 v[168:169], v[52:53], v[68:69], v[168:169]
    v_pk_fma_f32 v[168:169], v[54:55], v[70:71], v[168:169]
    v_pk_mul_f32 v[170:171], v[56:57], v[72:73]
    v_pk_fma_f32 v[170:171], v[58:59], v[74:75], v[170:171]
    v_pk_fma_f32 v[170:171], v[60:61], v[76:77], v[170:171]
    v_pk_fma_f32 v[170:171], v[62:63], v[78:79], v[170:171]
    v_add_f32 v164, v164, v165
    v_add_f32 v166, v166, v167
    v_add_f32 v168, v168, v169
    v_add_f32 v170, v170, v171
    v_lshlrev_b32 v1, 2, v0
    v_add_u32 v1, 65536, v1
    v_permlane32_swap_b32 v164, v168
    v_permlane32_swap_b32 v166, v170
    v_add_f32 v164, v164, v168
    v_add_f32 v166, v166, v170
    s_nop 1
    v_permlane16_swap_b32 v164, v166
    v_add_f32 v164, v164, v166
    ds_write_b32 v1, v164
    s_waitcnt lgkmcnt(0)
    s_barrier
    s_cmp_lg_u32 s52, 0
    s_cbranch_scc1 L_end
    ds_read_b32 v17, v1 offset:256
    ds_read_b32 v18, v1 offset:512
    ds_read_b32 v19, v1 offset:768
    s_lshl_b32 s57, s53, 2
    s_lshl_b32 s58, s54, 4
    s_lshl_b32 s58, 2, s58
    v_mov_b32 v6, s58
    s_waitcnt vmcnt(0) lgkmcnt(0)
    v_add_u32 v175, 1, v175
    v_add_u32 v193, 1, v193
    v_add_f32 v164, v164, v17
    v_add_f32 v18, v18, v19
    v_add_f32 v174, v164, v18
    buffer_store_dwordx2 v[174:175], v172, s[48:51], s59 offen
    v_mov_b32 v192, v174
    buffer_store_dwordx2 v[192:193], v172, s[48:51], s60 offen sc1
    v_readfirstlane_b32 s56, v173
    s_nop 0
    s_and_b32 s56, s56, 0x01000100
    s_cmp_eq_u32 s56, 0x01000100
    s_cbranch_scc1 L_end
    s_waitcnt vmcnt(0)
    s_mov_b64 exec, 1
    buffer_atomic_or v6, off, s[44:47], s57 sc1
L_end:
L_exit:
    s_endpgm
L_codeend:
.section .rodata,"a"
.p2align 6
.amdhsa_kernel standalone__deep_cross_fibinet__recsys_kernel
  .amdhsa_next_free_vgpr 256
  .amdhsa_next_free_sgpr 102
  .amdhsa_accum_offset 256
  .amdhsa_group_segment_fixed_size 0
  .amdhsa_kernarg_size 88
  .amdhsa_user_sgpr_count 2
  .amdhsa_user_sgpr_kernarg_segment_ptr 1
  .amdhsa_system_sgpr_workgroup_id_x 1
.end_amdhsa_kernel
```

```asm
; @launch grid=(256,1,1) block=(512,1,1) lds=163840
.amdgcn_target "amdgcn-amd-amdhsa--gfx950"
.text
.globl standalone__deep_cross_fibinet__recsys_kernel
.p2align 12
.type standalone__deep_cross_fibinet__recsys_kernel,@function
standalone__deep_cross_fibinet__recsys_kernel:
    s_cmp_ge_u32 s2, 256
    s_cbranch_scc1 L_exit
    s_load_dwordx2 s[8:9], s[0:1], 0
    s_load_dwordx2 s[16:17], s[0:1], 48
    s_load_dwordx2 s[12:13], s[0:1], 8
    s_load_dwordx8 s[84:91], s[0:1], 16
    s_load_dwordx8 s[92:99], s[0:1], 56
    v_lshrrev_b32 v1, 6, v0
    s_lshr_b32 s56, s2, 5
    v_readfirstlane_b32 s52, v1
    s_and_b32 s57, s2, 7
    s_lshl3_add_u32 s53, s56, s57
    s_bfe_u32 s54, s2, 0x10003
    s_getpc_b64 s[20:21]
L_pc:
    s_mov_b32 s22, L_codeend-L_pc
    s_mov_b32 s23, 0x00020000
    s_andn2_b32 s56, s2, 7
    s_add_u32 s56, s56, s52
    s_lshl_b32 s56, s56, 7
    s_mov_b64 exec, 1
    buffer_load_dword v8, off, s[20:23], s56
    s_mov_b64 exec, -1
    s_mov_b32 s10, 425984
    s_mov_b32 s11, 0x00020000
    s_mov_b32 s18, 851968
    s_mov_b32 s19, 0x00020000
    s_mov_b32 s14, 12800000
    s_mov_b32 s15, 0x00020000
    s_bitcmp1_b32 s2, 4
    s_cbranch_scc1 L_B
    v_bfe_u32 v228, v0, 3, 5
    v_mul_u32_u24 v228, 104, v228
    v_and_b32 v229, 7, v0
    v_lshl_add_u32 v228, v229, 4, v228
    v_lshrrev_b32 v230, 8, v0
    v_lshl_add_u32 v228, v230, 4, v228
    v_mul_u32_u24 v230, 12, v230
    s_mov_b32 exec_lo, 0x40404040
    s_mov_b32 exec_hi, 0x40404040
    v_sub_u32 v228, v228, v230
    s_mov_b64 exec, -1
    s_lshl1_add_u32 s58, s53, s54
    s_mul_i32 s58, s58, 3328
    s_lshl_b32 s60, s52, 10
    s_and_b32 s79, s53, 3
    s_bfe_u32 s63, s53, 0x20002
    s_bfe_u32 s55, s53, 0x10004
    v_bfe_u32 v229, v0, 3, 1
    v_bfe_u32 v230, v0, 2, 1
    v_lshl_add_u32 v229, v229, 3, v230
    s_lshl3_add_u32 s56, s55, s79
    s_lshl_b32 s56, s56, 1
    v_add_u32 v229, s56, v229
    s_add_u32 s56, s79, 24
    v_min_u32 v229, s56, v229
    v_and_b32 v230, 3, v0
    v_lshl_add_u32 v229, v229, 3, v230
    v_lshlrev_b32 v229, 4, v229
    s_lshr_b32 s56, s52, 1
    s_lshl2_add_u32 s56, s56, s63
    s_min_u32 s56, s56, 12
    s_and_b32 s57, s52, 1
    s_lshl1_add_u32 s56, s56, s57
    s_lshr_b32 s57, s53, 5
    s_mul_i32 s57, s57, 26
    s_add_u32 s56, s56, s57
    s_mul_i32 s56, s56, 3328
    s_lshl_b32 s57, s54, 6
    s_add_u32 s3, s56, s57
    s_mov_b32 s34, 173056
    s_mov_b32 s35, 0x00020000
    s_lshr_b32 s57, s60, 2
    s_add_u32 m0, s57, 106496
    s_lshr_b32 s6, s2, 5
    s_lshl1_add_u32 s6, s6, s54
    s_waitcnt lgkmcnt(0)
    buffer_load_dwordx4 v[2:5], v228, s[8:11], s58 offen
    s_mov_b64 s[32:33], s[90:91]
    s_mov_b64 exec, 0xffff
    buffer_load_dwordx4 v229, s[32:35], s3 offen lds
    s_mov_b64 exec, -1
    s_mov_b32 s26, 8192
    s_mov_b32 s27, 0x00020000
    s_mov_b64 s[24:25], s[88:89]
    v_lshlrev_b32 v231, 4, v0
    s_add_u32 m0, s60, 139264
    s_lshl_b32 s56, s6, 13
    buffer_load_dwordx4 v231, s[24:27], 0 offen lds
    s_addk_i32 m0, 0x2000
    v_and_b32 v230, 63, v0
    buffer_load_dwordx4 v231, s[24:27], 4 offen lds
    v_lshl_add_u32 v7, v230, 7, s56
    s_sub_u32 s57, s52, 6
    s_lshl_b32 s57, s57, 17
    s_add_u32 s57, s57, s56
    s_add_u32 s57, s57, 262144
    s_cmp_lt_u32 s52, 6
    s_cselect_b32 s57, 0x7f000000, s57
    s_cmp_eq_u32 s52, 0
    s_cselect_b64 s[28:29], s[84:85], s[86:87]
    s_min_u32 s56, s60, 2048
    s_add_u32 m0, s56, 155648
    s_cmp_lt_u32 s52, 2
    s_cselect_b64 s[28:29], s[28:29], s[16:17]
    s_cselect_b32 s30, 676, s18
    s_cselect_b32 s57, 0, s57
    s_cselect_b32 s59, 4, 7
    s_mov_b32 s31, 0x00020000
    v_lshlrev_b32 v232, s59, v230
    buffer_load_dwordx4 v232, s[28:31], s57 offen lds
    s_branch L_A2
L_B:
    s_cmp_lt_u32 s52, 4
    s_cbranch_scc1 L_Bc
    s_setprio 3
    v_bfe_u32 v14, v0, 4, 4
    v_lshlrev_b32 v14, 9, v14
    v_bfe_u32 v15, v0, 4, 2
    v_lshlrev_b32 v15, 2, v15
    s_and_b32 s56, s52, 2
    v_xor_b32 v15, v15, v0
    v_xor_b32 v15, s56, v15
    v_and_b32 v15, 15, v15
    v_lshl_add_u32 v14, v15, 4, v14
    s_lshl_b32 s56, s54, 8
    v_add_u32 v1, s56, v14
    s_and_b32 s60, s52, 3
    s_lshl_b32 s60, s60, 10
    v_bfe_u32 v14, v0, 3, 5
    v_mul_u32_u24 v14, 104, v14
    v_and_b32 v15, 7, v0
    v_lshl_add_u32 v14, v15, 4, v14
    s_mul_i32 s57, s53, 6656
    s_lshr_b32 s58, s2, 5
    s_lshl_b32 s56, s58, 15
    s_mov_b32 s59, 0
    s_waitcnt lgkmcnt(0)
    buffer_load_dwordx4 v[4:7], v14, s[8:11], s57 offen
    buffer_load_dwordx4 v[8:11], v14, s[8:11], s57 offen offset:3328
L_lead:
    s_lshr_b32 s58, s56, 1
    s_add_u32 m0, s58, s60
    s_add_u32 s59, s59, 1
    buffer_load_dwordx4 v1, s[16:19], s56 offen lds
    s_addk_i32 m0, 0x1000
    s_addk_i32 s56, 0x2000
    buffer_load_dwordx4 v1, s[16:19], s56 offen lds
    s_addk_i32 m0, 0x1000
    s_addk_i32 s56, 0x2000
    buffer_load_dwordx4 v1, s[16:19], s56 offen lds
    s_addk_i32 m0, 0x1000
    s_addk_i32 s56, 0x2000
    buffer_load_dwordx4 v1, s[16:19], s56 offen lds
    s_addk_i32 s56, 0x2000
    s_and_b32 s56, s56, 262143
    s_cmp_lt_u32 s59, 8
    s_cbranch_scc1 L_lead
    s_branch L_Bl2
L_A2:
    s_and_b32 s56, s60, 0x1000
    s_mul_i32 s56, s56, 3
    s_add_u32 s78, s60, s56
    v_lshrrev_b32 v229, 4, v0
    v_xor_b32 v229, v229, v0
    v_and_b32 v229, 7, v229
    v_lshlrev_b32 v1, 4, v229
    v_and_b32 v147, 15, v0
    v_bfe_u32 v148, v0, 4, 2
    v_bfe_u32 v228, v0, 1, 3
    s_and_b32 s56, s60, 0x400
    s_lshl_b32 s56, s56, 1
    v_lshl_add_u32 v15, v147, 7, s56
    v_xor_b32 v230, v148, v228
    v_lshl_add_u32 v10, v230, 4, v15
    v_xor_b32 v12, 64, v10
    v_xor_b32 v11, 0x800, v10
    v_xor_b32 v13, 0x800, v12
    v_bfe_u32 v150, v0, 2, 2
    v_lshl_add_u32 v231, v148, 3, v150
    v_and_b32 v229, 1, v0
    v_lshl_add_u32 v231, v229, 6, v231
    v_bfe_u32 v232, v0, 1, 1
    v_lshlrev_b32 v233, 3, v232
    v_lshl_add_u32 v231, v231, 7, v233
    s_lshl_b32 s56, s52, 4
    s_add_u32 s56, s56, 139264
    v_add_u32 v149, s56, v231
    v_lshl_add_u32 v229, v150, 1, v229
    v_add_u32 v151, v233, v229
    v_and_b32 v232, 3, v0
    v_lshl_add_u32 v231, v232, 5, v150
    s_lshl_b32 s56, s52, 3
    s_add_u32 s56, s56, 106496
    v_lshl_add_u32 v96, v231, 1, s56
    v_mul_u32_u24 v231, 3328, v150
    v_lshl_add_u32 v97, v232, 4, v231
    v_mov_b32 v103, 0
    s_lshl2_add_u32 s57, s63, s79
    s_lshl_b32 s57, s57, 2
    s_mul_i32 s56, s79, 3
    s_min_u32 s56, s56, 8
    s_mul_i32 s58, s63, 10
    s_add_u32 s56, s56, s58
    s_add_u32 s56, s56, 64
    s_cmp_lt_u32 s79, 2
    s_movk_i32 s79, 0x3333
    s_cselect_b32 s79, 0x7777, s79
    s_cmp_eq_u32 s55, 0
    s_cselect_b32 s56, s57, s56
    s_cselect_b32 s79, 0xffff, s79
    s_lshr_b32 s57, s53, 5
    s_mul_i32 s57, s57, 104
    s_add_u32 s56, s56, s57
    s_lshl_b32 s56, s56, 4
    s_lshl3_add_u32 s57, s54, s52
    s_mul_i32 s57, s57, 13312
    s_add_u32 s56, s56, s57
    s_add_u32 s62, s56, 262144
    s_and_b32 s56, s63, 1
    s_lshl_b32 s56, s56, 3
    s_lshl_b32 s55, 0xff, s56
    s_lshr_b32 s56, s63, 1
    s_xor_b32 s56, s56, s52
    s_bitcmp1_b32 s56, 0
    s_cselect_b32 s55, 0x10000, s55
    s_mov_b32 s50, 268435456
    s_mov_b32 s51, 0x00020000
    s_mov_b64 s[48:49], s[98:99]
    v_and_b32 v231, 31, v0
    v_bfe_u32 v232, v0, 5, 1
    v_lshl_add_u32 v231, v232, 6, v231
    s_lshl2_add_u32 s56, s53, s54
    s_lshl_b32 s56, s56, 8
    v_lshl_add_u32 v20, v231, 3, s56
    s_waitcnt vmcnt(4)
    v_lshlrev_b32 v2, 7, v2
    v_lshlrev_b32 v3, 7, v3
    v_lshlrev_b32 v4, 7, v4
    v_lshlrev_b32 v5, 7, v5
    v_add_u32_dpp v6, v2, v1 row_newbcast:0 row_mask:0xf bank_mask:0x3
    s_add_u32 m0, s78, 0
    v_add_u32_dpp v6, v2, v1 row_newbcast:8 row_mask:0xf bank_mask:0xc
    buffer_load_dwordx4 v6, s[12:15], 0 offen lds
    v_add_u32_dpp v9, v3, v1 row_newbcast:0 row_mask:0xf bank_mask:0x3
    s_add_u32 m0, s78, 4096
    v_add_u32_dpp v9, v3, v1 row_newbcast:8 row_mask:0xf bank_mask:0xc
    buffer_load_dwordx4 v9, s[12:15], 0 offen lds
    v_add_u32_dpp v6, v4, v1 row_newbcast:0 row_mask:0xf bank_mask:0x3
    s_add_u32 m0, s78, 8192
    v_add_u32_dpp v6, v4, v1 row_newbcast:8 row_mask:0xf bank_mask:0xc
    buffer_load_dwordx4 v6, s[12:15], 0 offen lds
    v_add_u32_dpp v9, v5, v1 row_newbcast:0 row_mask:0xf bank_mask:0x3
    s_add_u32 m0, s78, 12288
    v_add_u32_dpp v9, v5, v1 row_newbcast:8 row_mask:0xf bank_mask:0xc
    buffer_load_dwordx4 v9, s[12:15], 0 offen lds
    v_add_u32_dpp v6, v2, v1 row_newbcast:2 row_mask:0xf bank_mask:0x3
    s_add_u32 m0, s78, 32768
    v_add_u32_dpp v6, v2, v1 row_newbcast:10 row_mask:0xf bank_mask:0xc
    buffer_load_dwordx4 v6, s[12:15], 0 offen lds
    s_waitcnt vmcnt(6)
    s_barrier
    ds_read_u16 v108, v96 offset:0
    ds_read_u16 v109, v96 offset:256
    ds_read_u16 v110, v96 offset:512
    ds_read_u16 v111, v96 offset:768
    ds_read_u16 v112, v96 offset:1024
    ds_read_u16 v113, v96 offset:1280
    ds_read_u16 v114, v96 offset:1536
    ds_read_u16 v115, v96 offset:1792
    ds_read_b64_tr_b16 v[152:153], v149 offset:0
    ds_read_b64_tr_b16 v[154:155], v149 offset:512
    ds_read_b64_tr_b16 v[156:157], v149 offset:4096
    ds_read_b64_tr_b16 v[158:159], v149 offset:4608
    s_lshl_b32 s56, s52, 28
    buffer_load_dword v21, v20, s[48:51], s56 offen offset:4 sc1
    s_add_u32 s56, s56, 0x10000
    buffer_load_dword v26, v20, s[48:51], s56 offen offset:4 sc1
    s_waitcnt lgkmcnt(4)
    v_lshl_or_b32 v100, v109, 16, v108
    v_lshl_or_b32 v101, v111, 16, v110
    v_lshl_or_b32 v102, v113, 16, v112
    s_mov_b32 exec_hi, 0
    s_mov_b32 exec_lo, s55
    v_lshl_or_b32 v103, v115, 16, v114
    s_mov_b32 exec_lo, s79
    buffer_store_dwordx4 v[100:103], v97, s[48:51], s62 offen sc1
    s_mov_b64 exec, -1
    s_waitcnt lgkmcnt(0)
    v_mov_b32 v233, 0
    s_cmp_lt_u32 s52, 4
    s_cselect_b32 s56, 0x3c803c80, 0
    s_mov_b32 exec_lo, 0x44444444
    s_mov_b32 exec_hi, 0x44444444
    v_mov_b32 v233, s56
    s_mov_b32 exec_lo, 0xcccccccc
    s_mov_b32 exec_hi, 0xcccccccc
    v_mov_b32 v152, v233
    v_mov_b32 v153, v233
    v_mov_b32 v154, v233
    v_mov_b32 v155, v233
    v_mov_b32 v156, v233
    v_mov_b32 v157, v233
    v_mov_b32 v158, v233
    v_mov_b32 v159, v233
    s_mov_b64 exec, -1
    v_add_u32_dpp v9, v3, v1 row_newbcast:2 row_mask:0xf bank_mask:0x3
    s_add_u32 m0, s78, 36864
    v_add_u32_dpp v9, v3, v1 row_newbcast:10 row_mask:0xf bank_mask:0xc
    buffer_load_dwordx4 v9, s[12:15], 0 offen lds
    v_add_u32_dpp v6, v4, v1 row_newbcast:2 row_mask:0xf bank_mask:0x3
    v_add_u32_dpp v6, v4, v1 row_newbcast:10 row_mask:0xf bank_mask:0xc
    s_cmp_ge_u32 s52, 4
    s_cbranch_scc1 L_nw0
    s_waitcnt vmcnt(5)
L_nw0:
    s_barrier
    ds_read_b128 v[196:199], v10 offset:0
    ds_read_b128 v[200:203], v12 offset:0
    ds_read_b128 v[204:207], v10 offset:4096
    ds_read_b128 v[208:211], v12 offset:4096
    ds_read_b128 v[212:215], v11 offset:0
    ds_read_b128 v[216:219], v13 offset:0
    ds_read_b128 v[220:223], v11 offset:4096
    ds_read_b128 v[224:227], v13 offset:4096
    s_add_u32 m0, s78, 40960
    s_nop 0
    buffer_load_dwordx4 v6, s[12:15], 0 offen lds
    v_bfe_u32 v98, v0, 1, 3
    v_xor_b32 v98, s52, v98
    v_lshl_add_u32 v98, v98, 4, v15
    v_lshl_add_u32 v14, v148, 13, v98
    v_xor_b32 v15, 0x800, v14
    v_min_u32 v99, 1, v148
    v_add_u32 v99, 24, v99
    v_lshl_add_u32 v16, v99, 12, v98
    v_xor_b32 v17, 0x800, v16
    s_and_b32 s57, s52, 2
    s_lshl_b32 s57, s57, 3
    v_add_u32 v98, s57, v151
    v_add_u32 v99, 24, v150
    v_min_u32 v98, v98, v99
    v_mov_b32 v149, 155648
    s_movk_i32 s59, 208
    v_mad_u32_u24 v99, v148, s59, v149
    v_lshl_add_u32 v146, v98, 1, v99
    v_lshl_add_u32 v149, v147, 1, v149
    v_mad_u32_u24 v145, v148, 26, v149
    v_mad_u32_u24 v144, v148, 52, v149
    v_and_b32 v98, 63, v0
    v_lshlrev_b32 v18, 4, v98
    s_lshl3_add_u32 s56, s6, s52
    s_mul_i32 s56, s56, 1664
    s_add_u32 s56, s56, 262144
    v_lshl_add_u32 v23, v98, 7, s56
    v_mul_u32_u24 v98, 3, v150
    v_min_u32 v98, 8, v98
    v_mad_u32_u24 v98, v148, 10, v98
    v_and_b32 v99, 3, v0
    v_bfrev_b32 v19, 2
    s_mov_b32 exec_lo, 0x33773377
    s_mov_b32 exec_hi, 0x33773377
    v_add_lshl_u32 v19, v98, v99, 4
    s_mov_b64 exec, -1
    s_mul_i32 s61, s52, 26624
    s_add_u32 s61, s61, 262144
    s_and_b32 s56, s52, 1
    s_mul_i32 s58, s56, 2304
    s_sub_u32 s59, 160000, s58
    s_add_u32 s58, s58, 157696
    v_mul_u32_u24 v98, 144, v147
    v_lshl_add_u32 v98, v148, 5, v98
    v_add_u32 v29, s58, v98
    v_add_u32 v30, s59, v98
    v_add_u32 v28, s57, v29
    s_lshl_b32 s7, s52, 11
    s_add_u32 s7, s7, 106496
    v_add_u32 v31, s7, v18
    s_mov_b32 s42, 8192
    s_mov_b32 s43, 0x00020000
    s_mov_b32 s46, 256
    s_mov_b32 s47, 0x00020000
    s_mov_b64 s[40:41], s[94:95]
    s_mov_b64 s[44:45], s[96:97]
    s_mov_b32 s66, 0xc0135761
    s_mov_b32 s67, 0xbdd2d3e8
    s_mov_b32 s68, 0xffff0000
    s_mov_b32 s69, 0xbfb8aa3b
    v_mov_b32 v163, 0
    s_waitcnt lgkmcnt(6)
    v_mfma_f32_16x16x32_bf16 v[180:183], v[152:155], v[196:199], 0
    ds_read_b128 v[236:239], v10 offset:8192
    v_add_u32_dpp v9, v5, v1 row_newbcast:2 row_mask:0xf bank_mask:0x3
    v_mfma_f32_16x16x32_bf16 v[180:183], v[156:159], v[200:203], v[180:183]
    ds_read_b128 v[240:243], v12 offset:8192
    v_add_u32_dpp v9, v5, v1 row_newbcast:10 row_mask:0xf bank_mask:0xc
    s_waitcnt lgkmcnt(6)
    v_mfma_f32_16x16x32_bf16 v[188:191], v[152:155], v[204:207], 0
    ds_read_b128 v[244:247], v10 offset:12288
    v_add_u32_dpp v6, v2, v1 row_newbcast:4 row_mask:0xf bank_mask:0x3
    v_mfma_f32_16x16x32_bf16 v[188:191], v[156:159], v[208:211], v[188:191]
    ds_read_b128 v[248:251], v12 offset:12288
    v_add_u32_dpp v6, v2, v1 row_newbcast:12 row_mask:0xf bank_mask:0xc
    s_waitcnt lgkmcnt(6)
    v_mfma_f32_16x16x32_bf16 v[184:187], v[152:155], v[212:215], 0
    ds_read_b128 v[228:231], v11 offset:8192
    v_mfma_f32_16x16x32_bf16 v[184:187], v[156:159], v[216:219], v[184:187]
    ds_read_b128 v[232:235], v13 offset:8192
    s_waitcnt lgkmcnt(6)
    v_mfma_f32_16x16x32_bf16 v[192:195], v[152:155], v[220:223], 0
    ds_read_b128 v[252:255], v11 offset:12288
    v_cvt_pk_bf16_f32 v182, v182, v190
    v_cvt_pk_bf16_f32 v32, v180, v188
    v_cvt_pk_bf16_f32 v40, v181, v189
    v_mfma_f32_16x16x32_bf16 v[192:195], v[156:159], v[224:227], v[192:195]
    ds_read_b128 v[172:175], v13 offset:12288
    v_mov_b32_dpp v160, v182 quad_perm:[0,1,2,3] row_mask:0x1 bank_mask:0xf
    s_add_u32 m0, s78, 45056
    s_nop 0
    buffer_load_dwordx4 v9, s[12:15], 0 offen lds
    s_nop 2
    v_cvt_pk_bf16_f32 v36, v184, v192
    v_cvt_pk_bf16_f32 v44, v185, v193
    s_waitcnt vmcnt(7)
    s_waitcnt vmcnt(3)
    s_barrier
    s_waitcnt lgkmcnt(6)
    v_mfma_f32_16x16x32_bf16 v[128:131], v[152:155], v[236:239], 0
    ds_read_b128 v[196:199], v10 offset:16384
    v_mfma_f32_16x16x32_bf16 v[128:131], v[156:159], v[240:243], v[128:131]
    ds_read_b128 v[200:203], v12 offset:16384
    s_waitcnt lgkmcnt(6)
    v_mfma_f32_16x16x32_bf16 v[136:139], v[152:155], v[244:247], 0
    ds_read_b128 v[204:207], v10 offset:20480
    v_mfma_f32_16x16x32_bf16 v[136:139], v[156:159], v[248:251], v[136:139]
    ds_read_b128 v[208:211], v12 offset:20480
    s_waitcnt lgkmcnt(6)
    v_mfma_f32_16x16x32_bf16 v[132:135], v[152:155], v[228:231], 0
    ds_read_b128 v[212:215], v11 offset:16384
    v_mfma_f32_16x16x32_bf16 v[132:135], v[156:159], v[232:235], v[132:135]
    ds_read_b128 v[216:219], v13 offset:16384
    s_waitcnt lgkmcnt(6)
    v_mfma_f32_16x16x32_bf16 v[140:143], v[152:155], v[252:255], 0
    ds_read_b128 v[220:223], v11 offset:20480
    v_mfma_f32_16x16x32_bf16 v[140:143], v[156:159], v[172:175], v[140:143]
    ds_read_b128 v[224:227], v13 offset:20480
    s_add_u32 m0, s78, 65536
    s_nop 0
    buffer_load_dwordx4 v6, s[12:15], 0 offen lds
    s_lshl_b32 s56, s54, 4
    s_lshl_b32 s56, 0x100, s56
    v_mov_b32 v22, s56
    s_lshl_b32 s56, s52, 6
    s_add_u32 s56, s56, s53
    s_lshl_b32 s56, s56, 2
    s_mov_b64 exec, 1
    buffer_atomic_or v22, off, s[44:47], s56 sc1
    s_mov_b64 exec, -1
    ds_read_u16 v116, v144 offset:0
    ds_read_u16 v117, v144 offset:26
    ds_read_u16 v118, v144 offset:208
    ds_read_u16 v119, v144 offset:234
    ds_read_u16 v120, v144 offset:416
    ds_read_u16 v121, v144 offset:442
    ds_read_u16 v167, v145 offset:624
    s_waitcnt lgkmcnt(13)
    v_mfma_f32_16x16x32_bf16 v[180:183], v[152:155], v[196:199], 0
    ds_read_b128 v[236:239], v10 offset:24576
    v_cvt_pk_bf16_f32 v130, v130, v138
    v_cvt_pk_bf16_f32 v48, v128, v136
    v_mfma_f32_16x16x32_bf16 v[180:183], v[156:159], v[200:203], v[180:183]
    ds_read_b128 v[240:243], v12 offset:24576
    v_cvt_pk_bf16_f32 v56, v129, v137
    v_cvt_pk_bf16_f32 v52, v132, v140
    s_waitcnt lgkmcnt(13)
    v_mfma_f32_16x16x32_bf16 v[188:191], v[152:155], v[204:207], 0
    ds_read_b128 v[244:247], v10 offset:28672
    v_cvt_pk_bf16_f32 v60, v133, v141
    v_mov_b32_dpp v160, v130 quad_perm:[0,1,2,3] row_mask:0x2 bank_mask:0xf
    v_mfma_f32_16x16x32_bf16 v[188:191], v[156:159], v[208:211], v[188:191]
    ds_read_b128 v[248:251], v12 offset:28672
    v_add_u32_dpp v9, v3, v1 row_newbcast:4 row_mask:0xf bank_mask:0x3
    v_add_u32_dpp v9, v3, v1 row_newbcast:12 row_mask:0xf bank_mask:0xc
    s_waitcnt lgkmcnt(13)
    v_mfma_f32_16x16x32_bf16 v[184:187], v[152:155], v[212:215], 0
    ds_read_b128 v[228:231], v11 offset:24576
    v_add_u32_dpp v6, v4, v1 row_newbcast:4 row_mask:0xf bank_mask:0x3
    v_mfma_f32_16x16x32_bf16 v[184:187], v[156:159], v[216:219], v[184:187]
    ds_read_b128 v[232:235], v13 offset:24576
    v_add_u32_dpp v6, v4, v1 row_newbcast:12 row_mask:0xf bank_mask:0xc
    s_waitcnt lgkmcnt(13)
    v_mfma_f32_16x16x32_bf16 v[192:195], v[152:155], v[220:223], 0
    ds_read_b128 v[252:255], v11 offset:28672
    v_cvt_pk_bf16_f32 v182, v182, v190
    v_cvt_pk_bf16_f32 v64, v180, v188
    v_cvt_pk_bf16_f32 v72, v181, v189
    v_mfma_f32_16x16x32_bf16 v[192:195], v[156:159], v[224:227], v[192:195]
    ds_read_b128 v[172:175], v13 offset:28672
    v_mov_b32_dpp v160, v182 quad_perm:[0,1,2,3] row_mask:0x4 bank_mask:0xf
    s_add_u32 m0, s78, 69632
    s_nop 0
    buffer_load_dwordx4 v9, s[12:15], 0 offen lds
    s_waitcnt lgkmcnt(8)
    ds_read_u16 v124, v146 offset:1024
    ds_read_u16 v125, v146 offset:1076
    ds_read_u16 v126, v146 offset:1128
    ds_read_u16 v127, v146 offset:1180
    v_cvt_pk_bf16_f32 v68, v184, v192
    v_cvt_pk_bf16_f32 v76, v185, v193
    s_cmp_ge_u32 s52, 4
    s_cbranch_scc1 L_nw4
    s_waitcnt vmcnt(3)
L_nw4:
    s_barrier
    s_waitcnt lgkmcnt(10)
    v_mfma_f32_16x16x32_bf16 v[128:131], v[152:155], v[236:239], 0
    ds_read_b128 v[196:199], v10 offset:32768
    v_mfma_f32_16x16x32_bf16 v[128:131], v[156:159], v[240:243], v[128:131]
    ds_read_b128 v[200:203], v12 offset:32768
    s_waitcnt lgkmcnt(10)
    v_mfma_f32_16x16x32_bf16 v[136:139], v[152:155], v[244:247], 0
    ds_read_b128 v[204:207], v10 offset:36864
    v_mfma_f32_16x16x32_bf16 v[136:139], v[156:159], v[248:251], v[136:139]
    ds_read_b128 v[208:211], v12 offset:36864
    s_waitcnt lgkmcnt(10)
    v_mfma_f32_16x16x32_bf16 v[132:135], v[152:155], v[228:231], 0
    ds_read_b128 v[212:215], v11 offset:32768
    v_mfma_f32_16x16x32_bf16 v[132:135], v[156:159], v[232:235], v[132:135]
    ds_read_b128 v[216:219], v13 offset:32768
    s_waitcnt lgkmcnt(10)
    v_mfma_f32_16x16x32_bf16 v[140:143], v[152:155], v[252:255], 0
    ds_read_b128 v[220:223], v11 offset:36864
    v_mfma_f32_16x16x32_bf16 v[140:143], v[156:159], v[172:175], v[140:143]
    ds_read_b128 v[224:227], v13 offset:36864
    s_add_u32 m0, s78, 73728
    s_nop 0
    buffer_load_dwordx4 v6, s[12:15], 0 offen lds
    s_waitcnt lgkmcnt(6)
    v_mfma_f32_16x16x32_bf16 v[180:183], v[152:155], v[196:199], 0
    ds_read_b128 v[236:239], v10 offset:40960
    v_cvt_pk_bf16_f32 v130, v130, v138
    v_cvt_pk_bf16_f32 v80, v128, v136
    v_cvt_pk_bf16_f32 v88, v129, v137
    v_mfma_f32_16x16x32_bf16 v[180:183], v[156:159], v[200:203], v[180:183]
    ds_read_b128 v[240:243], v12 offset:40960
    v_cvt_pk_bf16_f32 v84, v132, v140
    v_cvt_pk_bf16_f32 v92, v133, v141
    v_mov_b32_dpp v160, v130 quad_perm:[0,1,2,3] row_mask:0x8 bank_mask:0xf
    s_waitcnt lgkmcnt(6)
    v_mfma_f32_16x16x32_bf16 v[188:191], v[152:155], v[204:207], 0
    ds_read_b128 v[244:247], v10 offset:45056
    v_add_u32_dpp v9, v5, v1 row_newbcast:4 row_mask:0xf bank_mask:0x3
    v_add_u32_dpp v9, v5, v1 row_newbcast:12 row_mask:0xf bank_mask:0xc
    v_add_u32_dpp v6, v2, v1 row_newbcast:6 row_mask:0xf bank_mask:0x3
    v_mfma_f32_16x16x32_bf16 v[188:191], v[156:159], v[208:211], v[188:191]
    ds_read_b128 v[248:251], v12 offset:45056
    v_add_u32_dpp v6, v2, v1 row_newbcast:14 row_mask:0xf bank_mask:0xc
    v_permlane32_swap_b32 v32, v64
    v_permlane32_swap_b32 v48, v80
    s_waitcnt lgkmcnt(6)
    v_mfma_f32_16x16x32_bf16 v[184:187], v[152:155], v[212:215], 0
    ds_read_b128 v[228:231], v11 offset:40960
    v_permlane32_swap_b32 v40, v72
    v_permlane32_swap_b32 v56, v88
    v_permlane16_swap_b32 v32, v48
    v_mfma_f32_16x16x32_bf16 v[184:187], v[156:159], v[216:219], v[184:187]
    ds_read_b128 v[232:235], v13 offset:40960
    v_permlane16_swap_b32 v64, v80
    v_permlane16_swap_b32 v40, v56
    v_permlane16_swap_b32 v72, v88
    s_waitcnt lgkmcnt(6)
    v_mfma_f32_16x16x32_bf16 v[192:195], v[152:155], v[220:223], 0
    ds_read_b128 v[252:255], v11 offset:45056
    v_cvt_pk_bf16_f32 v182, v182, v190
    v_cvt_pk_bf16_f32 v33, v180, v188
    v_cvt_pk_bf16_f32 v41, v181, v189
    v_mfma_f32_16x16x32_bf16 v[192:195], v[156:159], v[224:227], v[192:195]
    ds_read_b128 v[172:175], v13 offset:45056
    v_mov_b32_dpp v161, v182 quad_perm:[0,1,2,3] row_mask:0x1 bank_mask:0xf
    s_add_u32 m0, s78, 77824
    s_nop 0
    buffer_load_dwordx4 v9, s[12:15], 0 offen lds
    v_lshl_or_b32 v164, v117, 16, v116
    v_lshl_or_b32 v165, v119, 16, v118
    v_lshl_or_b32 v166, v121, 16, v120
    v_lshl_or_b32 v168, v125, 16, v124
    v_lshl_or_b32 v169, v127, 16, v126
    v_cvt_pk_bf16_f32 v37, v184, v192
    v_cvt_pk_bf16_f32 v45, v185, v193
    s_waitcnt vmcnt(5)
    s_barrier
    s_waitcnt lgkmcnt(6)
    v_mfma_f32_16x16x32_bf16 v[128:131], v[152:155], v[236:239], 0
    ds_read_b128 v[196:199], v10 offset:49152
    v_mfma_f32_16x16x32_bf16 v[128:131], v[156:159], v[240:243], v[128:131]
    ds_read_b128 v[200:203], v12 offset:49152
    s_waitcnt lgkmcnt(6)
    v_mfma_f32_16x16x32_bf16 v[136:139], v[152:155], v[244:247], 0
    ds_read_b128 v[204:207], v10 offset:53248
    v_mfma_f32_16x16x32_bf16 v[136:139], v[156:159], v[248:251], v[136:139]
    ds_read_b128 v[208:211], v12 offset:53248
    s_waitcnt lgkmcnt(6)
    v_mfma_f32_16x16x32_bf16 v[132:135], v[152:155], v[228:231], 0
    ds_read_b128 v[212:215], v11 offset:49152
    v_mfma_f32_16x16x32_bf16 v[132:135], v[156:159], v[232:235], v[132:135]
    ds_read_b128 v[216:219], v13 offset:49152
    s_waitcnt lgkmcnt(6)
    v_mfma_f32_16x16x32_bf16 v[140:143], v[152:155], v[252:255], 0
    ds_read_b128 v[220:223], v11 offset:53248
    v_mfma_f32_16x16x32_bf16 v[140:143], v[156:159], v[172:175], v[140:143]
    ds_read_b128 v[224:227], v13 offset:53248
    s_add_u32 m0, s60, 98304
    s_nop 0
    buffer_load_dwordx4 v6, s[12:15], 0 offen lds
    s_waitcnt lgkmcnt(6)
    v_mfma_f32_16x16x32_bf16 v[180:183], v[152:155], v[196:199], 0
    ds_read_b128 v[236:239], v10 offset:57344
    v_cvt_pk_bf16_f32 v130, v130, v138
    v_cvt_pk_bf16_f32 v49, v128, v136
    v_cvt_pk_bf16_f32 v57, v129, v137
    v_mfma_f32_16x16x32_bf16 v[180:183], v[156:159], v[200:203], v[180:183]
    ds_read_b128 v[240:243], v12 offset:57344
    v_cvt_pk_bf16_f32 v53, v132, v140
    v_cvt_pk_bf16_f32 v61, v133, v141
    v_mov_b32_dpp v161, v130 quad_perm:[0,1,2,3] row_mask:0x2 bank_mask:0xf
    s_waitcnt lgkmcnt(6)
    v_mfma_f32_16x16x32_bf16 v[188:191], v[152:155], v[204:207], 0
    ds_read_b128 v[244:247], v10 offset:61440
    v_permlane32_swap_b32 v36, v68
    v_permlane32_swap_b32 v52, v84
    v_mfma_f32_16x16x32_bf16 v[188:191], v[156:159], v[208:211], v[188:191]
    ds_read_b128 v[248:251], v12 offset:61440
    v_permlane32_swap_b32 v44, v76
    v_permlane32_swap_b32 v60, v92
    s_waitcnt lgkmcnt(6)
    v_mfma_f32_16x16x32_bf16 v[184:187], v[152:155], v[212:215], 0
    ds_read_b128 v[228:231], v11 offset:57344
    v_permlane16_swap_b32 v36, v52
    v_permlane16_swap_b32 v68, v84
    v_mfma_f32_16x16x32_bf16 v[184:187], v[156:159], v[216:219], v[184:187]
    ds_read_b128 v[232:235], v13 offset:57344
    v_permlane16_swap_b32 v44, v60
    v_permlane16_swap_b32 v76, v92
    s_waitcnt lgkmcnt(6)
    v_mfma_f32_16x16x32_bf16 v[192:195], v[152:155], v[220:223], 0
    ds_read_b128 v[252:255], v11 offset:61440
    v_cvt_pk_bf16_f32 v182, v182, v190
    v_cvt_pk_bf16_f32 v65, v180, v188
    v_cvt_pk_bf16_f32 v73, v181, v189
    v_mfma_f32_16x16x32_bf16 v[192:195], v[156:159], v[224:227], v[192:195]
    ds_read_b128 v[172:175], v13 offset:61440
    v_mov_b32_dpp v161, v182 quad_perm:[0,1,2,3] row_mask:0x4 bank_mask:0xf
    v_lshrrev_b32 v22, 2, v18
    s_lshl_b32 s56, s52, 8
    buffer_load_dword v22, v22, s[44:47], s56 offen sc1
    s_lshl_b32 s57, s52, 17
    s_add_u32 s57, s57, 524288
    buffer_load_dword v8, v7, s[16:19], s57 offen
    v_add_u32 v10, 0x10000, v10
    v_add_u32 v11, 0x10000, v11
    v_add_u32 v12, 0x10000, v12
    v_add_u32 v13, 0x10000, v13
    v_cvt_pk_bf16_f32 v69, v184, v192
    v_cvt_pk_bf16_f32 v77, v185, v193
    s_cmp_ge_u32 s52, 4
    s_cbranch_scc1 L_nw8
    s_waitcnt vmcnt(3)
L_nw8:
    s_barrier
    s_waitcnt lgkmcnt(6)
    v_mfma_f32_16x16x32_bf16 v[128:131], v[152:155], v[236:239], 0
    ds_read_b128 v[196:199], v10 offset:0
    v_mfma_f32_16x16x32_bf16 v[128:131], v[156:159], v[240:243], v[128:131]
    ds_read_b128 v[200:203], v12 offset:0
    s_waitcnt lgkmcnt(6)
    v_mfma_f32_16x16x32_bf16 v[136:139], v[152:155], v[244:247], 0
    ds_read_b128 v[204:207], v10 offset:4096
    v_mfma_f32_16x16x32_bf16 v[136:139], v[156:159], v[248:251], v[136:139]
    ds_read_b128 v[208:211], v12 offset:4096
    s_waitcnt lgkmcnt(6)
    v_mfma_f32_16x16x32_bf16 v[132:135], v[152:155], v[228:231], 0
    ds_read_b128 v[212:215], v11 offset:0
    v_mfma_f32_16x16x32_bf16 v[132:135], v[156:159], v[232:235], v[132:135]
    ds_read_b128 v[216:219], v13 offset:0
    s_waitcnt lgkmcnt(6)
    v_mfma_f32_16x16x32_bf16 v[140:143], v[152:155], v[252:255], 0
    ds_read_b128 v[220:223], v11 offset:4096
    v_mfma_f32_16x16x32_bf16 v[140:143], v[156:159], v[172:175], v[140:143]
    ds_read_b128 v[224:227], v13 offset:4096
    s_waitcnt lgkmcnt(6)
    v_mfma_f32_16x16x32_bf16 v[180:183], v[152:155], v[196:199], 0
    ds_read_b128 v[236:239], v10 offset:8192
    v_cvt_pk_bf16_f32 v130, v130, v138
    v_cvt_pk_bf16_f32 v81, v128, v136
    v_cvt_pk_bf16_f32 v89, v129, v137
    v_mfma_f32_16x16x32_bf16 v[180:183], v[156:159], v[200:203], v[180:183]
    ds_read_b128 v[240:243], v12 offset:8192
    v_cvt_pk_bf16_f32 v85, v132, v140
    v_cvt_pk_bf16_f32 v93, v133, v141
    v_mov_b32_dpp v161, v130 quad_perm:[0,1,2,3] row_mask:0x8 bank_mask:0xf
    s_waitcnt lgkmcnt(6)
    v_mfma_f32_16x16x32_bf16 v[188:191], v[152:155], v[204:207], 0
    ds_read_b128 v[244:247], v10 offset:12288
    v_permlane32_swap_b32 v33, v65
    v_permlane32_swap_b32 v49, v81
    v_mfma_f32_16x16x32_bf16 v[188:191], v[156:159], v[208:211], v[188:191]
    ds_read_b128 v[248:251], v12 offset:12288
    v_permlane32_swap_b32 v41, v73
    v_permlane32_swap_b32 v57, v89
    s_waitcnt lgkmcnt(6)
    v_mfma_f32_16x16x32_bf16 v[184:187], v[152:155], v[212:215], 0
    ds_read_b128 v[228:231], v11 offset:8192
    v_permlane16_swap_b32 v33, v49
    v_permlane16_swap_b32 v65, v81
    v_mfma_f32_16x16x32_bf16 v[184:187], v[156:159], v[216:219], v[184:187]
    ds_read_b128 v[232:235], v13 offset:8192
    v_permlane16_swap_b32 v41, v57
    v_permlane16_swap_b32 v73, v89
    s_waitcnt lgkmcnt(6)
    v_mfma_f32_16x16x32_bf16 v[192:195], v[152:155], v[220:223], 0
    ds_read_b128 v[252:255], v11 offset:12288
    v_cvt_pk_bf16_f32 v182, v182, v190
    v_cvt_pk_bf16_f32 v34, v180, v188
    v_cvt_pk_bf16_f32 v42, v181, v189
    v_mfma_f32_16x16x32_bf16 v[192:195], v[156:159], v[224:227], v[192:195]
    ds_read_b128 v[172:175], v13 offset:12288
    v_mov_b32_dpp v162, v182 quad_perm:[0,1,2,3] row_mask:0x1 bank_mask:0xf
    s_nop 5
    v_cvt_pk_bf16_f32 v38, v184, v192
    v_cvt_pk_bf16_f32 v46, v185, v193
    s_waitcnt vmcnt(2)
    s_waitcnt vmcnt(1)
    s_cmp_lg_u32 s52, 0
    s_cbranch_scc1 L_flok
L_flp:
    v_and_b32 v22, 0x01000100, v22
    v_cmp_ne_u32 vcc, 0x01000100, v22
    s_cbranch_vccz L_flok
    s_sleep 8
    v_lshrrev_b32 v22, 2, v18
    buffer_load_dword v22, v22, s[44:47], 0 offen sc1
    s_waitcnt vmcnt(0)
    s_branch L_flp
L_flok:
    s_barrier
    s_mov_b64 exec, 0x1fff
    buffer_load_dword v8, v23, s[48:51], 0 offen sc1
    s_mov_b64 exec, -1
    s_waitcnt lgkmcnt(6)
    v_mfma_f32_16x16x32_bf16 v[128:131], v[152:155], v[236:239], 0
    ds_read_b128 v[196:199], v10 offset:16384
    v_mfma_f32_16x16x32_bf16 v[128:131], v[156:159], v[240:243], v[128:131]
    ds_read_b128 v[200:203], v12 offset:16384
    s_waitcnt lgkmcnt(6)
    v_mfma_f32_16x16x32_bf16 v[136:139], v[152:155], v[244:247], 0
    ds_read_b128 v[204:207], v10 offset:20480
    v_mfma_f32_16x16x32_bf16 v[136:139], v[156:159], v[248:251], v[136:139]
    ds_read_b128 v[208:211], v12 offset:20480
    s_waitcnt lgkmcnt(6)
    v_mfma_f32_16x16x32_bf16 v[132:135], v[152:155], v[228:231], 0
    ds_read_b128 v[212:215], v11 offset:16384
    v_mfma_f32_16x16x32_bf16 v[132:135], v[156:159], v[232:235], v[132:135]
    ds_read_b128 v[216:219], v13 offset:16384
    s_waitcnt lgkmcnt(6)
    v_mfma_f32_16x16x32_bf16 v[140:143], v[152:155], v[252:255], 0
    ds_read_b128 v[220:223], v11 offset:20480
    v_mfma_f32_16x16x32_bf16 v[140:143], v[156:159], v[172:175], v[140:143]
    ds_read_b128 v[224:227], v13 offset:20480
    s_add_u32 s56, s61, 0
    buffer_load_dwordx4 v[96:99], v18, s[48:51], s56 offen offset:0 sc1
    s_add_u32 s56, s61, 3328
    buffer_load_dwordx4 v[100:103], v18, s[48:51], s56 offen offset:0 sc1
    s_add_u32 s56, s61, 0
    buffer_load_dwordx4 v[104:107], v18, s[48:51], s56 offen offset:1664 sc1
    s_waitcnt lgkmcnt(6)
    v_mfma_f32_16x16x32_bf16 v[180:183], v[152:155], v[196:199], 0
    ds_read_b128 v[236:239], v10 offset:24576
    v_cvt_pk_bf16_f32 v130, v130, v138
    v_cvt_pk_bf16_f32 v50, v128, v136
    v_cvt_pk_bf16_f32 v58, v129, v137
    v_mfma_f32_16x16x32_bf16 v[180:183], v[156:159], v[200:203], v[180:183]
    ds_read_b128 v[240:243], v12 offset:24576
    v_cvt_pk_bf16_f32 v54, v132, v140
    v_cvt_pk_bf16_f32 v62, v133, v141
    v_mov_b32_dpp v162, v130 quad_perm:[0,1,2,3] row_mask:0x2 bank_mask:0xf
    s_waitcnt lgkmcnt(6)
    v_mfma_f32_16x16x32_bf16 v[188:191], v[152:155], v[204:207], 0
    ds_read_b128 v[244:247], v10 offset:28672
    v_permlane32_swap_b32 v37, v69
    v_permlane32_swap_b32 v53, v85
    v_mfma_f32_16x16x32_bf16 v[188:191], v[156:159], v[208:211], v[188:191]
    ds_read_b128 v[248:251], v12 offset:28672
    v_permlane32_swap_b32 v45, v77
    v_permlane32_swap_b32 v61, v93
    s_waitcnt lgkmcnt(6)
    v_mfma_f32_16x16x32_bf16 v[184:187], v[152:155], v[212:215], 0
    ds_read_b128 v[228:231], v11 offset:24576
    v_permlane16_swap_b32 v37, v53
    v_permlane16_swap_b32 v69, v85
    v_mfma_f32_16x16x32_bf16 v[184:187], v[156:159], v[216:219], v[184:187]
    ds_read_b128 v[232:235], v13 offset:24576
    v_permlane16_swap_b32 v45, v61
    v_permlane16_swap_b32 v77, v93
    s_waitcnt lgkmcnt(6)
    v_mfma_f32_16x16x32_bf16 v[192:195], v[152:155], v[220:223], 0
    ds_read_b128 v[252:255], v11 offset:28672
    v_cvt_pk_bf16_f32 v182, v182, v190
    v_cvt_pk_bf16_f32 v66, v180, v188
    v_cvt_pk_bf16_f32 v74, v181, v189
    v_mfma_f32_16x16x32_bf16 v[192:195], v[156:159], v[224:227], v[192:195]
    ds_read_b128 v[172:175], v13 offset:28672
    v_mov_b32_dpp v162, v182 quad_perm:[0,1,2,3] row_mask:0x4 bank_mask:0xf
    s_add_u32 s56, s61, 3328
    buffer_load_dwordx4 v[108:111], v18, s[48:51], s56 offen offset:1664 sc1
    s_add_u32 s56, s61, 0
    buffer_load_dwordx4 v[112:115], v19, s[48:51], s56 offen offset:1024 sc1
    s_add_u32 s56, s61, 3328
    buffer_load_dwordx4 v[116:119], v19, s[48:51], s56 offen offset:1024 sc1
    v_cvt_pk_bf16_f32 v70, v184, v192
    v_cvt_pk_bf16_f32 v78, v185, v193
    s_waitcnt lgkmcnt(6)
    v_mfma_f32_16x16x32_bf16 v[128:131], v[152:155], v[236:239], 0
    ds_read_b128 v[196:199], v10 offset:32768
    v_add_u32 v22, 0x10000, v14
    v_mfma_f32_16x16x32_bf16 v[128:131], v[156:159], v[240:243], v[128:131]
    ds_read_b128 v[200:203], v12 offset:32768
    v_add_u32 v23, 0x10000, v15
    s_waitcnt lgkmcnt(6)
    v_mfma_f32_16x16x32_bf16 v[136:139], v[152:155], v[244:247], 0
    ds_read_b128 v[204:207], v10 offset:36864
    v_mfma_f32_16x16x32_bf16 v[136:139], v[156:159], v[248:251], v[136:139]
    ds_read_b128 v[208:211], v12 offset:36864
    s_waitcnt lgkmcnt(6)
    v_mfma_f32_16x16x32_bf16 v[132:135], v[152:155], v[228:231], 0
    ds_read_b128 v[212:215], v11 offset:32768
    v_mfma_f32_16x16x32_bf16 v[132:135], v[156:159], v[232:235], v[132:135]
    ds_read_b128 v[216:219], v13 offset:32768
    s_waitcnt lgkmcnt(6)
    v_mfma_f32_16x16x32_bf16 v[140:143], v[152:155], v[252:255], 0
    ds_read_b128 v[220:223], v11 offset:36864
    v_cvt_pk_bf16_f32 v130, v130, v138
    v_mfma_f32_16x16x32_bf16 v[140:143], v[156:159], v[172:175], v[140:143]
    ds_read_b128 v[224:227], v13 offset:36864
    v_mov_b32_dpp v162, v130 quad_perm:[0,1,2,3] row_mask:0x8 bank_mask:0xf
    s_waitcnt lgkmcnt(6)
    v_mfma_f32_16x16x32_bf16 v[180:183], v[152:155], v[196:199], 0
    v_mfma_f32_16x16x32_bf16 v[180:183], v[156:159], v[200:203], v[180:183]
    s_waitcnt lgkmcnt(4)
    v_mfma_f32_16x16x32_bf16 v[188:191], v[152:155], v[204:207], 0
    v_mfma_f32_16x16x32_bf16 v[188:191], v[156:159], v[208:211], v[188:191]
    s_waitcnt lgkmcnt(2)
    v_mfma_f32_16x16x32_bf16 v[184:187], v[152:155], v[212:215], 0
    v_mfma_f32_16x16x32_bf16 v[184:187], v[156:159], v[216:219], v[184:187]
    s_waitcnt lgkmcnt(0)
    v_mfma_f32_16x16x32_bf16 v[192:195], v[152:155], v[220:223], 0
    v_mfma_f32_16x16x32_bf16 v[192:195], v[156:159], v[224:227], v[192:195]
    s_cmp_ge_u32 s52, 4
    s_cbranch_scc1 L_nosenet
    s_mov_b64 exec, 0xffff
    v_cvt_pk_bf16_f32 v163, v182, 0
    s_mov_b32 exec_lo, 0xffff0000
    v_cvt_pk_bf16_f32 v163, v190, 0
    s_mov_b64 exec, -1
    s_nop 0
    v_mfma_f32_16x16x32_bf16 v[228:231], v[164:167], v[160:163], 0
    v_mov_b32 v248, s66
    s_nop 6
    v_cvt_pk_bf16_f32 v236, v228, v229
    v_cvt_pk_bf16_f32 v237, v230, v231
    v_lshlrev_b32 v228, 16, v236
    v_and_b32 v229, s68, v236
    v_lshlrev_b32 v230, 16, v237
    v_and_b32 v231, s68, v237
    v_mul_f32 v240, v228, v228
    v_mul_f32 v241, v229, v229
    v_mul_f32 v242, v230, v230
    v_mul_f32 v243, v231, v231
    v_fma_f32 v240, v240, s67, v248
    v_fma_f32 v241, v241, s67, v248
    v_fma_f32 v242, v242, s67, v248
    v_fma_f32 v243, v243, s67, v248
    v_mul_f32 v240, v240, v228
    v_mul_f32 v241, v241, v229
    v_mul_f32 v242, v242, v230
    v_mul_f32 v243, v243, v231
    v_exp_f32 v240, v240
    v_exp_f32 v241, v241
    v_exp_f32 v242, v242
    v_exp_f32 v243, v243
    v_add_f32 v240, 1.0, v240
    v_add_f32 v241, 1.0, v241
    v_add_f32 v242, 1.0, v242
    v_add_f32 v243, 1.0, v243
    v_rcp_f32 v240, v240
    v_rcp_f32 v241, v241
    v_rcp_f32 v242, v242
    v_rcp_f32 v243, v243
    v_mul_f32 v232, v228, v240
    v_mul_f32 v233, v229, v241
    v_mul_f32 v234, v230, v242
    v_mul_f32 v235, v231, v243
    v_cvt_pk_bf16_f32 v238, v232, v233
    v_cvt_pk_bf16_f32 v239, v234, v235
    s_nop 1
    v_mfma_f32_16x16x16_bf16 v[244:247], v[168:169], v[238:239], 0
    s_nop 7
    v_cvt_pk_bf16_f32 v236, v244, v245
    v_cvt_pk_bf16_f32 v237, v246, v247
    v_lshlrev_b32 v228, 16, v236
    v_and_b32 v229, s68, v236
    v_lshlrev_b32 v230, 16, v237
    v_and_b32 v231, s68, v237
    v_mul_f32 v228, s69, v228
    v_mul_f32 v229, s69, v229
    v_mul_f32 v230, s69, v230
    v_mul_f32 v231, s69, v231
    v_exp_f32 v228, v228
    v_exp_f32 v229, v229
    v_exp_f32 v230, v230
    v_exp_f32 v231, v231
    v_add_f32 v228, 1.0, v228
    v_add_f32 v229, 1.0, v229
    v_add_f32 v230, 1.0, v230
    v_add_f32 v231, 1.0, v231
    v_rcp_f32 v228, v228
    v_rcp_f32 v229, v229
    v_rcp_f32 v230, v230
    v_rcp_f32 v231, v231
    v_cvt_pk_bf16_f32 v232, 0, v228
    v_cvt_pk_bf16_f32 v233, 0, v229
    v_cvt_pk_bf16_f32 v234, 0, v230
    v_cvt_pk_bf16_f32 v235, 0, v231
    ds_write_b128 v28, v[232:235]
    s_waitcnt lgkmcnt(0)
    s_barrier
    v_cvt_pk_bf16_f32 v82, v128, v136
    v_cvt_pk_bf16_f32 v90, v129, v137
    v_cvt_pk_bf16_f32 v86, v132, v140
    v_cvt_pk_bf16_f32 v94, v133, v141
    s_add_u32 s56, s61, 0
    buffer_load_dwordx4 v[172:175], v19, s[48:51], s56 offen offset:2688 sc1
    s_add_u32 s56, s61, 3328
    buffer_load_dwordx4 v[176:179], v19, s[48:51], s56 offen offset:2688 sc1
    v_cvt_pk_bf16_f32 v35, v180, v188
    v_cvt_pk_bf16_f32 v43, v181, v189
    v_cvt_pk_bf16_f32 v51, v180, v188
    v_cvt_pk_bf16_f32 v59, v181, v189
    v_cvt_pk_bf16_f32 v67, v180, v188
    v_cvt_pk_bf16_f32 v75, v181, v189
    v_cvt_pk_bf16_f32 v83, v180, v188
    v_cvt_pk_bf16_f32 v91, v181, v189
    v_mov_b32 v2, v180
    v_mov_b32 v3, v181
    v_mov_b32 v4, v188
    v_mov_b32 v5, v189
    v_cvt_pk_bf16_f32 v39, v184, v192
    v_cvt_pk_bf16_f32 v47, v185, v193
    v_cvt_pk_bf16_f32 v55, v184, v192
    v_cvt_pk_bf16_f32 v63, v185, v193
    v_cvt_pk_bf16_f32 v71, v184, v192
    v_cvt_pk_bf16_f32 v79, v185, v193
    v_cvt_pk_bf16_f32 v87, v184, v192
    v_cvt_pk_bf16_f32 v95, v185, v193
    v_mov_b32 v10, v184
    v_mov_b32 v11, v185
    v_mov_b32 v12, v192
    v_mov_b32 v13, v193
    v_permlane32_swap_b32 v34, v66
    v_permlane32_swap_b32 v50, v82
    v_permlane32_swap_b32 v42, v74
    v_permlane32_swap_b32 v58, v90
    v_permlane32_swap_b32 v38, v70
    v_permlane32_swap_b32 v54, v86
    v_permlane32_swap_b32 v46, v78
    v_permlane32_swap_b32 v62, v94
    v_permlane16_swap_b32 v34, v50
    v_permlane16_swap_b32 v66, v82
    v_permlane16_swap_b32 v42, v58
    v_permlane16_swap_b32 v74, v90
    v_permlane16_swap_b32 v38, v54
    v_permlane16_swap_b32 v70, v86
    v_permlane16_swap_b32 v46, v62
    v_permlane16_swap_b32 v78, v94
    v_mov_b32 v134, 0
    v_mov_b32 v135, 0
    v_mov_b32 v150, 0
    v_mov_b32 v151, 0
    s_branch L_post
L_nosenet:
    s_nop 7
    v_cvt_pk_bf16_f32 v82, v128, v136
    v_cvt_pk_bf16_f32 v90, v129, v137
    v_cvt_pk_bf16_f32 v86, v132, v140
    v_cvt_pk_bf16_f32 v94, v133, v141
    s_add_u32 s56, s61, 0
    buffer_load_dwordx4 v[172:175], v19, s[48:51], s56 offen offset:2688 sc1
    s_add_u32 s56, s61, 3328
    buffer_load_dwordx4 v[176:179], v19, s[48:51], s56 offen offset:2688 sc1
    v_cvt_pk_bf16_f32 v35, v180, v188
    v_cvt_pk_bf16_f32 v43, v181, v189
    v_cvt_pk_bf16_f32 v51, v180, v188
    v_cvt_pk_bf16_f32 v59, v181, v189
    v_cvt_pk_bf16_f32 v67, v180, v188
    v_cvt_pk_bf16_f32 v75, v181, v189
    v_cvt_pk_bf16_f32 v83, v180, v188
    v_cvt_pk_bf16_f32 v91, v181, v189
    v_mov_b32 v2, v180
    v_mov_b32 v3, v181
    v_mov_b32 v4, v188
    v_mov_b32 v5, v189
    v_cvt_pk_bf16_f32 v39, v184, v192
    v_cvt_pk_bf16_f32 v47, v185, v193
    v_cvt_pk_bf16_f32 v55, v184, v192
    v_cvt_pk_bf16_f32 v63, v185, v193
    v_cvt_pk_bf16_f32 v71, v184, v192
    v_cvt_pk_bf16_f32 v79, v185, v193
    v_cvt_pk_bf16_f32 v87, v184, v192
    v_cvt_pk_bf16_f32 v95, v185, v193
    v_mov_b32 v10, v184
    v_mov_b32 v11, v185
    v_mov_b32 v12, v192
    v_mov_b32 v13, v193
    v_permlane32_swap_b32 v34, v66
    v_permlane32_swap_b32 v50, v82
    v_permlane32_swap_b32 v42, v74
    v_permlane32_swap_b32 v58, v90
    v_permlane32_swap_b32 v38, v70
    v_permlane32_swap_b32 v54, v86
    v_permlane32_swap_b32 v46, v78
    v_permlane32_swap_b32 v62, v94
    v_permlane16_swap_b32 v34, v50
    v_permlane16_swap_b32 v66, v82
    v_permlane16_swap_b32 v42, v58
    v_permlane16_swap_b32 v74, v90
    v_permlane16_swap_b32 v38, v54
    v_permlane16_swap_b32 v70, v86
    v_permlane16_swap_b32 v46, v62
    v_permlane16_swap_b32 v78, v94
    v_mov_b32 v134, 0
    v_mov_b32 v135, 0
    v_mov_b32 v150, 0
    v_mov_b32 v151, 0
    s_barrier
L_post:
    ds_read_b128 v[180:183], v29 offset:0
    ds_read_b128 v[184:187], v29 offset:16
    ds_read_b128 v[188:191], v30 offset:0
    ds_read_b128 v[192:195], v30 offset:16
    v_bfe_u32 v152, v0, 4, 2
    v_lshlrev_b32 v152, 5, v152
    v_sub_u32 v29, v29, v152
    ds_read2_b32 v[156:157], v29 offset0:6 offset1:14
    v_sub_u32 v30, v30, v152
    ds_read2_b32 v[158:159], v30 offset0:6 offset1:14
    s_waitcnt vmcnt(6)
    v_mfma_f32_16x16x32_bf16 v[196:199], v[96:99], v[32:35], 0
    v_mfma_f32_16x16x32_bf16 v[200:203], v[96:99], v[36:39], 0
    v_mfma_f32_16x16x32_bf16 v[204:207], v[100:103], v[40:43], 0
    v_mfma_f32_16x16x32_bf16 v[208:211], v[100:103], v[44:47], 0
    s_waitcnt lgkmcnt(0)
    v_lshrrev_b32 v1, 16, v180
    v_lshrrev_b32 v6, 16, v182
    v_lshrrev_b32 v7, 16, v184
    v_mul_f32 v2, v2, v156
    v_mul_f32 v3, v3, v156
    v_mul_f32 v4, v4, v157
    v_mul_f32 v5, v5, v157
    v_lshrrev_b32 v8, 16, v188
    v_lshrrev_b32 v9, 16, v190
    v_lshrrev_b32 v27, 16, v192
    v_mul_f32 v10, v10, v158
    v_mul_f32 v11, v11, v158
    v_mul_f32 v12, v12, v159
    v_mul_f32 v13, v13, v159
    v_dot2_f32_bf16 v212, v32, v1, 0
    v_dot2_f32_bf16 v213, v32, v181, 0
    v_dot2_f32_bf16 v214, v33, v6, 0
    v_dot2_f32_bf16 v215, v33, v183, 0
    v_dot2_f32_bf16 v216, v34, v7, 0
    v_dot2_f32_bf16 v217, v34, v185, 0
    v_dot2_f32_bf16 v218, v36, v8, 0
    v_dot2_f32_bf16 v219, v36, v189, 0
    v_dot2_f32_bf16 v220, v37, v9, 0
    v_dot2_f32_bf16 v221, v37, v191, 0
    v_dot2_f32_bf16 v222, v38, v27, 0
    v_dot2_f32_bf16 v223, v38, v193, 0
    v_cvt_pk_bf16_f32 v155, v2, v4
    v_cvt_pk_bf16_f32 v152, v212, v213
    v_cvt_pk_bf16_f32 v153, v214, v215
    v_cvt_pk_bf16_f32 v154, v216, v217
    v_cvt_pk_bf16_f32 v159, v10, v12
    v_cvt_pk_bf16_f32 v156, v218, v219
    v_cvt_pk_bf16_f32 v157, v220, v221
    v_cvt_pk_bf16_f32 v158, v222, v223
    v_dot2_f32_bf16 v212, v40, v1, 0
    v_dot2_f32_bf16 v213, v40, v181, 0
    v_dot2_f32_bf16 v214, v41, v6, 0
    v_dot2_f32_bf16 v215, v41, v183, 0
    v_dot2_f32_bf16 v216, v42, v7, 0
    v_dot2_f32_bf16 v217, v42, v185, 0
    v_dot2_f32_bf16 v218, v44, v8, 0
    v_dot2_f32_bf16 v219, v44, v189, 0
    v_dot2_f32_bf16 v220, v45, v9, 0
    v_dot2_f32_bf16 v221, v45, v191, 0
    v_dot2_f32_bf16 v222, v46, v27, 0
    v_dot2_f32_bf16 v223, v46, v193, 0
    v_cvt_pk_bf16_f32 v163, v3, v5
    v_cvt_pk_bf16_f32 v160, v212, v213
    v_cvt_pk_bf16_f32 v161, v214, v215
    v_cvt_pk_bf16_f32 v162, v216, v217
    v_cvt_pk_bf16_f32 v167, v11, v13
    v_cvt_pk_bf16_f32 v164, v218, v219
    v_cvt_pk_bf16_f32 v165, v220, v221
    v_cvt_pk_bf16_f32 v166, v222, v223
    s_waitcnt vmcnt(4)
    v_mfma_f32_16x16x32_bf16 v[212:215], v[104:107], v[152:155], 0
    v_mfma_f32_16x16x32_bf16 v[216:219], v[104:107], v[156:159], 0
    v_mfma_f32_16x16x32_bf16 v[220:223], v[108:111], v[160:163], 0
    v_mfma_f32_16x16x32_bf16 v[224:227], v[108:111], v[164:167], 0
    s_add_u32 s56, s61, 6656
    buffer_load_dwordx4 v[96:99], v18, s[48:51], s56 offen offset:0 sc1
    s_add_u32 s56, s61, 9984
    buffer_load_dwordx4 v[100:103], v18, s[48:51], s56 offen offset:0 sc1
    s_add_u32 s56, s61, 6656
    buffer_load_dwordx4 v[104:107], v18, s[48:51], s56 offen offset:1664 sc1
    s_add_u32 s56, s61, 9984
    buffer_load_dwordx4 v[108:111], v18, s[48:51], s56 offen offset:1664 sc1
    s_waitcnt vmcnt(6)
    v_mfma_f32_16x16x32_bf16 v[228:231], v[112:115], v[32:35], 0
    v_fmac_f32 v196, v212, v180
    v_fmac_f32 v197, v213, v181
    v_fmac_f32 v198, v214, v182
    v_mfma_f32_16x16x32_bf16 v[232:235], v[112:115], v[36:39], 0
    v_fmac_f32 v199, v215, v183
    v_fmac_f32 v204, v220, v180
    v_fmac_f32 v205, v221, v181
    v_mfma_f32_16x16x32_bf16 v[236:239], v[116:119], v[40:43], 0
    v_fmac_f32 v206, v222, v182
    v_fmac_f32 v207, v223, v183
    v_cvt_pk_bf16_f32 v120, v196, v204
    v_mfma_f32_16x16x32_bf16 v[240:243], v[116:119], v[44:47], 0
    v_cvt_pk_bf16_f32 v122, v197, v205
    v_cvt_pk_bf16_f32 v124, v198, v206
    v_cvt_pk_bf16_f32 v126, v199, v207
    s_waitcnt vmcnt(4)
    v_mfma_f32_16x16x32_bf16 v[244:247], v[172:175], v[152:155], 0
    v_fmac_f32 v200, v216, v188
    v_fmac_f32 v201, v217, v189
    v_fmac_f32 v202, v218, v190
    v_mfma_f32_16x16x32_bf16 v[248:251], v[172:175], v[156:159], 0
    v_fmac_f32 v203, v219, v191
    v_fmac_f32 v208, v224, v188
    v_fmac_f32 v209, v225, v189
    v_mfma_f32_16x16x32_bf16 v[252:255], v[176:179], v[160:163], 0
    v_fmac_f32 v210, v226, v190
    v_fmac_f32 v211, v227, v191
    v_cvt_pk_bf16_f32 v136, v200, v208
    v_mfma_f32_16x16x32_bf16 v[168:171], v[176:179], v[164:167], 0
    v_cvt_pk_bf16_f32 v138, v201, v209
    v_cvt_pk_bf16_f32 v140, v202, v210
    v_cvt_pk_bf16_f32 v142, v203, v211
    s_add_u32 s56, s61, 6656
    buffer_load_dwordx4 v[112:115], v19, s[48:51], s56 offen offset:1024 sc1
    s_add_u32 s56, s61, 9984
    buffer_load_dwordx4 v[116:119], v19, s[48:51], s56 offen offset:1024 sc1
    s_add_u32 s56, s61, 6656
    buffer_load_dwordx4 v[172:175], v19, s[48:51], s56 offen offset:2688 sc1
    s_add_u32 s56, s61, 9984
    buffer_load_dwordx4 v[176:179], v19, s[48:51], s56 offen offset:2688 sc1
    v_dot2_f32_bf16 v212, v48, v1, 0
    v_dot2_f32_bf16 v213, v48, v181, 0
    v_dot2_f32_bf16 v214, v49, v6, 0
    v_dot2_f32_bf16 v215, v49, v183, 0
    v_dot2_f32_bf16 v216, v50, v7, 0
    v_dot2_f32_bf16 v217, v50, v185, 0
    v_dot2_f32_bf16 v218, v52, v8, 0
    v_dot2_f32_bf16 v219, v52, v189, 0
    v_dot2_f32_bf16 v220, v53, v9, 0
    v_dot2_f32_bf16 v221, v53, v191, 0
    v_dot2_f32_bf16 v222, v54, v27, 0
    v_dot2_f32_bf16 v223, v54, v193, 0
    v_cvt_pk_bf16_f32 v152, v212, v213
    v_cvt_pk_bf16_f32 v153, v214, v215
    v_cvt_pk_bf16_f32 v154, v216, v217
    v_cvt_pk_bf16_f32 v156, v218, v219
    v_cvt_pk_bf16_f32 v157, v220, v221
    v_cvt_pk_bf16_f32 v158, v222, v223
    v_dot2_f32_bf16 v212, v56, v1, 0
    v_dot2_f32_bf16 v213, v56, v181, 0
    v_dot2_f32_bf16 v214, v57, v6, 0
    v_dot2_f32_bf16 v215, v57, v183, 0
    v_dot2_f32_bf16 v216, v58, v7, 0
    v_dot2_f32_bf16 v217, v58, v185, 0
    v_dot2_f32_bf16 v218, v60, v8, 0
    v_dot2_f32_bf16 v219, v60, v189, 0
    v_dot2_f32_bf16 v220, v61, v9, 0
    v_dot2_f32_bf16 v221, v61, v191, 0
    v_dot2_f32_bf16 v222, v62, v27, 0
    v_dot2_f32_bf16 v223, v62, v193, 0
    v_cvt_pk_bf16_f32 v160, v212, v213
    v_cvt_pk_bf16_f32 v161, v214, v215
    v_cvt_pk_bf16_f32 v162, v216, v217
    v_cvt_pk_bf16_f32 v164, v218, v219
    v_cvt_pk_bf16_f32 v165, v220, v221
    v_cvt_pk_bf16_f32 v166, v222, v223
    s_waitcnt vmcnt(6)
    v_mfma_f32_16x16x32_bf16 v[196:199], v[96:99], v[48:51], 0
    v_fmac_f32 v228, v244, v184
    v_fmac_f32 v229, v245, v185
    v_mfma_f32_16x16x32_bf16 v[200:203], v[96:99], v[52:55], 0
    v_fmac_f32 v230, v246, v186
    v_fmac_f32 v236, v252, v184
    v_mfma_f32_16x16x32_bf16 v[204:207], v[100:103], v[56:59], 0
    v_fmac_f32 v237, v253, v185
    v_fmac_f32 v238, v254, v186
    v_mfma_f32_16x16x32_bf16 v[208:211], v[100:103], v[60:63], 0
    v_cvt_pk_bf16_f32 v128, v228, v236
    v_cvt_pk_bf16_f32 v130, v229, v237
    v_cvt_pk_bf16_f32 v132, v230, v238
    s_waitcnt vmcnt(4)
    v_mfma_f32_16x16x32_bf16 v[212:215], v[104:107], v[152:155], 0
    v_fmac_f32 v232, v248, v192
    v_fmac_f32 v233, v249, v193
    v_mfma_f32_16x16x32_bf16 v[216:219], v[104:107], v[156:159], 0
    v_fmac_f32 v234, v250, v194
    v_fmac_f32 v240, v168, v192
    v_mfma_f32_16x16x32_bf16 v[220:223], v[108:111], v[160:163], 0
    v_fmac_f32 v241, v169, v193
    v_fmac_f32 v242, v170, v194
    v_mfma_f32_16x16x32_bf16 v[224:227], v[108:111], v[164:167], 0
    v_cvt_pk_bf16_f32 v144, v232, v240
    v_cvt_pk_bf16_f32 v146, v233, v241
    v_cvt_pk_bf16_f32 v148, v234, v242
    s_add_u32 s56, s61, 13312
    buffer_load_dwordx4 v[96:99], v18, s[48:51], s56 offen offset:0 sc1
    s_add_u32 s56, s61, 16640
    buffer_load_dwordx4 v[100:103], v18, s[48:51], s56 offen offset:0 sc1
    s_add_u32 s56, s61, 13312
    buffer_load_dwordx4 v[104:107], v18, s[48:51], s56 offen offset:1664 sc1
    s_add_u32 s56, s61, 16640
    buffer_load_dwordx4 v[108:111], v18, s[48:51], s56 offen offset:1664 sc1
    s_waitcnt vmcnt(6)
    v_mfma_f32_16x16x32_bf16 v[228:231], v[112:115], v[48:51], 0
    v_fmac_f32 v196, v212, v180
    v_fmac_f32 v197, v213, v181
    v_fmac_f32 v198, v214, v182
    v_mfma_f32_16x16x32_bf16 v[232:235], v[112:115], v[52:55], 0
    v_fmac_f32 v199, v215, v183
    v_fmac_f32 v204, v220, v180
    v_fmac_f32 v205, v221, v181
    v_mfma_f32_16x16x32_bf16 v[236:239], v[116:119], v[56:59], 0
    v_fmac_f32 v206, v222, v182
    v_fmac_f32 v207, v223, v183
    v_cvt_pk_bf16_f32 v121, v196, v204
    v_mfma_f32_16x16x32_bf16 v[240:243], v[116:119], v[60:63], 0
    v_cvt_pk_bf16_f32 v123, v197, v205
    v_cvt_pk_bf16_f32 v125, v198, v206
    v_cvt_pk_bf16_f32 v127, v199, v207
    s_waitcnt vmcnt(4)
    v_mfma_f32_16x16x32_bf16 v[244:247], v[172:175], v[152:155], 0
    v_fmac_f32 v200, v216, v188
    v_fmac_f32 v201, v217, v189
    v_fmac_f32 v202, v218, v190
    v_mfma_f32_16x16x32_bf16 v[248:251], v[172:175], v[156:159], 0
    v_fmac_f32 v203, v219, v191
    v_fmac_f32 v208, v224, v188
    v_fmac_f32 v209, v225, v189
    v_mfma_f32_16x16x32_bf16 v[252:255], v[176:179], v[160:163], 0
    v_fmac_f32 v210, v226, v190
    v_fmac_f32 v211, v227, v191
    v_cvt_pk_bf16_f32 v137, v200, v208
    v_mfma_f32_16x16x32_bf16 v[168:171], v[176:179], v[164:167], 0
    v_cvt_pk_bf16_f32 v139, v201, v209
    v_cvt_pk_bf16_f32 v141, v202, v210
    v_cvt_pk_bf16_f32 v143, v203, v211
    s_add_u32 s56, s61, 13312
    buffer_load_dwordx4 v[112:115], v19, s[48:51], s56 offen offset:1024 sc1
    s_add_u32 s56, s61, 16640
    buffer_load_dwordx4 v[116:119], v19, s[48:51], s56 offen offset:1024 sc1
    s_add_u32 s56, s61, 13312
    buffer_load_dwordx4 v[172:175], v19, s[48:51], s56 offen offset:2688 sc1
    s_add_u32 s56, s61, 16640
    buffer_load_dwordx4 v[176:179], v19, s[48:51], s56 offen offset:2688 sc1
    ds_read_b64 v[32:33], v14 offset:0
    ds_read_b64 v[34:35], v14 offset:4096
    ds_read_b64 v[36:37], v14 offset:32768
    ds_read_b64 v[38:39], v14 offset:36864
    ds_read_b64 v[40:41], v22 offset:0
    ds_read_b64 v[42:43], v22 offset:4096
    ds_read_b64 v[44:45], v16 offset:0
    ds_read_b64 v[48:49], v15 offset:0
    ds_read_b64 v[50:51], v15 offset:4096
    ds_read_b64 v[52:53], v15 offset:32768
    ds_read_b64 v[54:55], v15 offset:36864
    ds_read_b64 v[56:57], v23 offset:0
    ds_read_b64 v[58:59], v23 offset:4096
    ds_read_b64 v[60:61], v17 offset:0
    v_dot2_f32_bf16 v212, v64, v1, 0
    v_dot2_f32_bf16 v213, v64, v181, 0
    v_dot2_f32_bf16 v214, v65, v6, 0
    v_dot2_f32_bf16 v215, v65, v183, 0
    v_dot2_f32_bf16 v216, v66, v7, 0
    v_dot2_f32_bf16 v217, v66, v185, 0
    v_dot2_f32_bf16 v218, v68, v8, 0
    v_dot2_f32_bf16 v219, v68, v189, 0
    v_dot2_f32_bf16 v220, v69, v9, 0
    v_dot2_f32_bf16 v221, v69, v191, 0
    v_dot2_f32_bf16 v222, v70, v27, 0
    v_dot2_f32_bf16 v223, v70, v193, 0
    v_cvt_pk_bf16_f32 v152, v212, v213
    v_cvt_pk_bf16_f32 v153, v214, v215
    v_cvt_pk_bf16_f32 v154, v216, v217
    v_cvt_pk_bf16_f32 v156, v218, v219
    v_cvt_pk_bf16_f32 v157, v220, v221
    v_cvt_pk_bf16_f32 v158, v222, v223
    v_dot2_f32_bf16 v212, v72, v1, 0
    v_dot2_f32_bf16 v213, v72, v181, 0
    v_dot2_f32_bf16 v214, v73, v6, 0
    v_dot2_f32_bf16 v215, v73, v183, 0
    v_dot2_f32_bf16 v216, v74, v7, 0
    v_dot2_f32_bf16 v217, v74, v185, 0
    v_dot2_f32_bf16 v218, v76, v8, 0
    v_dot2_f32_bf16 v219, v76, v189, 0
    v_dot2_f32_bf16 v220, v77, v9, 0
    v_dot2_f32_bf16 v221, v77, v191, 0
    v_dot2_f32_bf16 v222, v78, v27, 0
    v_dot2_f32_bf16 v223, v78, v193, 0
    v_cvt_pk_bf16_f32 v160, v212, v213
    v_cvt_pk_bf16_f32 v161, v214, v215
    v_cvt_pk_bf16_f32 v162, v216, v217
    v_cvt_pk_bf16_f32 v164, v218, v219
    v_cvt_pk_bf16_f32 v165, v220, v221
    v_cvt_pk_bf16_f32 v166, v222, v223
    s_waitcnt vmcnt(6)
    v_mfma_f32_16x16x32_bf16 v[196:199], v[96:99], v[64:67], 0
    v_fmac_f32 v228, v244, v184
    v_fmac_f32 v229, v245, v185
    v_mfma_f32_16x16x32_bf16 v[200:203], v[96:99], v[68:71], 0
    v_fmac_f32 v230, v246, v186
    v_fmac_f32 v236, v252, v184
    v_mfma_f32_16x16x32_bf16 v[204:207], v[100:103], v[72:75], 0
    v_fmac_f32 v237, v253, v185
    v_fmac_f32 v238, v254, v186
    v_mfma_f32_16x16x32_bf16 v[208:211], v[100:103], v[76:79], 0
    v_cvt_pk_bf16_f32 v129, v228, v236
    v_cvt_pk_bf16_f32 v131, v229, v237
    v_cvt_pk_bf16_f32 v133, v230, v238
    s_waitcnt vmcnt(4)
    v_mfma_f32_16x16x32_bf16 v[212:215], v[104:107], v[152:155], 0
    v_fmac_f32 v232, v248, v192
    v_fmac_f32 v233, v249, v193
    v_mfma_f32_16x16x32_bf16 v[216:219], v[104:107], v[156:159], 0
    v_fmac_f32 v234, v250, v194
    v_fmac_f32 v240, v168, v192
    v_mfma_f32_16x16x32_bf16 v[220:223], v[108:111], v[160:163], 0
    v_fmac_f32 v241, v169, v193
    v_fmac_f32 v242, v170, v194
    v_mfma_f32_16x16x32_bf16 v[224:227], v[108:111], v[164:167], 0
    v_cvt_pk_bf16_f32 v145, v232, v240
    v_cvt_pk_bf16_f32 v147, v233, v241
    v_cvt_pk_bf16_f32 v149, v234, v242
    s_add_u32 s56, s61, 19968
    buffer_load_dwordx4 v[96:99], v18, s[48:51], s56 offen offset:0 sc1
    s_add_u32 s56, s61, 23296
    buffer_load_dwordx4 v[100:103], v18, s[48:51], s56 offen offset:0 sc1
    s_add_u32 s56, s61, 19968
    buffer_load_dwordx4 v[104:107], v18, s[48:51], s56 offen offset:1664 sc1
    s_add_u32 s56, s61, 23296
    buffer_load_dwordx4 v[108:111], v18, s[48:51], s56 offen offset:1664 sc1
    s_waitcnt lgkmcnt(0)
    v_mfma_f32_16x16x32_bf16 v[2:5], v[120:123], v[32:35], 0
    v_mfma_f32_16x16x32_bf16 v[10:13], v[136:139], v[48:51], 0
    v_mfma_f32_16x16x32_bf16 v[2:5], v[124:127], v[36:39], v[2:5]
    v_mfma_f32_16x16x32_bf16 v[10:13], v[140:143], v[52:55], v[10:13]
    v_mfma_f32_16x16x32_bf16 v[2:5], v[128:131], v[40:43], v[2:5]
    v_mfma_f32_16x16x32_bf16 v[10:13], v[144:147], v[56:59], v[10:13]
    v_mfma_f32_16x16x32_bf16 v[2:5], v[132:135], v[44:47], v[2:5]
    v_mfma_f32_16x16x32_bf16 v[10:13], v[148:151], v[60:63], v[10:13]
    s_waitcnt vmcnt(6)
    v_mfma_f32_16x16x32_bf16 v[228:231], v[112:115], v[64:67], 0
    v_fmac_f32 v196, v212, v180
    v_fmac_f32 v197, v213, v181
    v_fmac_f32 v198, v214, v182
    v_mfma_f32_16x16x32_bf16 v[232:235], v[112:115], v[68:71], 0
    v_fmac_f32 v199, v215, v183
    v_fmac_f32 v204, v220, v180
    v_fmac_f32 v205, v221, v181
    v_mfma_f32_16x16x32_bf16 v[236:239], v[116:119], v[72:75], 0
    v_fmac_f32 v206, v222, v182
    v_fmac_f32 v207, v223, v183
    v_cvt_pk_bf16_f32 v120, v196, v204
    v_mfma_f32_16x16x32_bf16 v[240:243], v[116:119], v[76:79], 0
    v_cvt_pk_bf16_f32 v122, v197, v205
    v_cvt_pk_bf16_f32 v124, v198, v206
    v_cvt_pk_bf16_f32 v126, v199, v207
    s_waitcnt vmcnt(4)
    v_mfma_f32_16x16x32_bf16 v[244:247], v[172:175], v[152:155], 0
    v_fmac_f32 v200, v216, v188
    v_fmac_f32 v201, v217, v189
    v_fmac_f32 v202, v218, v190
    v_mfma_f32_16x16x32_bf16 v[248:251], v[172:175], v[156:159], 0
    v_fmac_f32 v203, v219, v191
    v_fmac_f32 v208, v224, v188
    v_fmac_f32 v209, v225, v189
    v_mfma_f32_16x16x32_bf16 v[252:255], v[176:179], v[160:163], 0
    v_fmac_f32 v210, v226, v190
    v_fmac_f32 v211, v227, v191
    v_cvt_pk_bf16_f32 v136, v200, v208
    v_mfma_f32_16x16x32_bf16 v[168:171], v[176:179], v[164:167], 0
    v_cvt_pk_bf16_f32 v138, v201, v209
    v_cvt_pk_bf16_f32 v140, v202, v210
    v_cvt_pk_bf16_f32 v142, v203, v211
    s_add_u32 s56, s61, 19968
    buffer_load_dwordx4 v[112:115], v19, s[48:51], s56 offen offset:1024 sc1
    s_add_u32 s56, s61, 23296
    buffer_load_dwordx4 v[116:119], v19, s[48:51], s56 offen offset:1024 sc1
    s_add_u32 s56, s61, 19968
    buffer_load_dwordx4 v[172:175], v19, s[48:51], s56 offen offset:2688 sc1
    s_add_u32 s56, s61, 23296
    buffer_load_dwordx4 v[176:179], v19, s[48:51], s56 offen offset:2688 sc1
    ds_read_b64 v[32:33], v14 offset:8
    ds_read_b64 v[34:35], v14 offset:4104
    ds_read_b64 v[36:37], v14 offset:32776
    ds_read_b64 v[38:39], v14 offset:36872
    ds_read_b64 v[40:41], v22 offset:8
    ds_read_b64 v[42:43], v22 offset:4104
    ds_read_b64 v[44:45], v16 offset:8
    ds_read_b64 v[48:49], v15 offset:8
    ds_read_b64 v[50:51], v15 offset:4104
    ds_read_b64 v[52:53], v15 offset:32776
    ds_read_b64 v[54:55], v15 offset:36872
    ds_read_b64 v[56:57], v23 offset:8
    ds_read_b64 v[58:59], v23 offset:4104
    ds_read_b64 v[60:61], v17 offset:8
    v_dot2_f32_bf16 v212, v80, v1, 0
    v_dot2_f32_bf16 v213, v80, v181, 0
    v_dot2_f32_bf16 v214, v81, v6, 0
    v_dot2_f32_bf16 v215, v81, v183, 0
    v_dot2_f32_bf16 v216, v82, v7, 0
    v_dot2_f32_bf16 v217, v82, v185, 0
    v_dot2_f32_bf16 v218, v84, v8, 0
    v_dot2_f32_bf16 v219, v84, v189, 0
    v_dot2_f32_bf16 v220, v85, v9, 0
    v_dot2_f32_bf16 v221, v85, v191, 0
    v_dot2_f32_bf16 v222, v86, v27, 0
    v_dot2_f32_bf16 v223, v86, v193, 0
    v_cvt_pk_bf16_f32 v152, v212, v213
    v_cvt_pk_bf16_f32 v153, v214, v215
    v_cvt_pk_bf16_f32 v154, v216, v217
    v_cvt_pk_bf16_f32 v156, v218, v219
    v_cvt_pk_bf16_f32 v157, v220, v221
    v_cvt_pk_bf16_f32 v158, v222, v223
    v_dot2_f32_bf16 v212, v88, v1, 0
    v_dot2_f32_bf16 v213, v88, v181, 0
    v_dot2_f32_bf16 v214, v89, v6, 0
    v_dot2_f32_bf16 v215, v89, v183, 0
    v_dot2_f32_bf16 v216, v90, v7, 0
    v_dot2_f32_bf16 v217, v90, v185, 0
    v_dot2_f32_bf16 v218, v92, v8, 0
    v_dot2_f32_bf16 v219, v92, v189, 0
    v_dot2_f32_bf16 v220, v93, v9, 0
    v_dot2_f32_bf16 v221, v93, v191, 0
    v_dot2_f32_bf16 v222, v94, v27, 0
    v_dot2_f32_bf16 v223, v94, v193, 0
    v_cvt_pk_bf16_f32 v160, v212, v213
    v_cvt_pk_bf16_f32 v161, v214, v215
    v_cvt_pk_bf16_f32 v162, v216, v217
    v_cvt_pk_bf16_f32 v164, v218, v219
    v_cvt_pk_bf16_f32 v165, v220, v221
    v_cvt_pk_bf16_f32 v166, v222, v223
    s_waitcnt vmcnt(6)
    v_mfma_f32_16x16x32_bf16 v[196:199], v[96:99], v[80:83], 0
    v_fmac_f32 v228, v244, v184
    v_fmac_f32 v229, v245, v185
    v_mfma_f32_16x16x32_bf16 v[200:203], v[96:99], v[84:87], 0
    v_fmac_f32 v230, v246, v186
    v_fmac_f32 v236, v252, v184
    v_mfma_f32_16x16x32_bf16 v[204:207], v[100:103], v[88:91], 0
    v_fmac_f32 v237, v253, v185
    v_fmac_f32 v238, v254, v186
    v_mfma_f32_16x16x32_bf16 v[208:211], v[100:103], v[92:95], 0
    v_cvt_pk_bf16_f32 v128, v228, v236
    v_cvt_pk_bf16_f32 v130, v229, v237
    v_cvt_pk_bf16_f32 v132, v230, v238
    s_waitcnt vmcnt(4)
    v_mfma_f32_16x16x32_bf16 v[212:215], v[104:107], v[152:155], 0
    v_fmac_f32 v232, v248, v192
    v_fmac_f32 v233, v249, v193
    v_mfma_f32_16x16x32_bf16 v[216:219], v[104:107], v[156:159], 0
    v_fmac_f32 v234, v250, v194
    v_fmac_f32 v240, v168, v192
    v_mfma_f32_16x16x32_bf16 v[220:223], v[108:111], v[160:163], 0
    v_fmac_f32 v241, v169, v193
    v_fmac_f32 v242, v170, v194
    v_mfma_f32_16x16x32_bf16 v[224:227], v[108:111], v[164:167], 0
    v_cvt_pk_bf16_f32 v144, v232, v240
    v_cvt_pk_bf16_f32 v146, v233, v241
    v_cvt_pk_bf16_f32 v148, v234, v242
    s_waitcnt vmcnt(2)
    v_mfma_f32_16x16x32_bf16 v[228:231], v[112:115], v[80:83], 0
    v_fmac_f32 v196, v212, v180
    v_fmac_f32 v197, v213, v181
    v_fmac_f32 v198, v214, v182
    v_mfma_f32_16x16x32_bf16 v[232:235], v[112:115], v[84:87], 0
    v_fmac_f32 v199, v215, v183
    v_fmac_f32 v204, v220, v180
    v_fmac_f32 v205, v221, v181
    v_mfma_f32_16x16x32_bf16 v[236:239], v[116:119], v[88:91], 0
    v_fmac_f32 v206, v222, v182
    v_fmac_f32 v207, v223, v183
    v_cvt_pk_bf16_f32 v121, v196, v204
    v_mfma_f32_16x16x32_bf16 v[240:243], v[116:119], v[92:95], 0
    v_cvt_pk_bf16_f32 v123, v197, v205
    v_cvt_pk_bf16_f32 v125, v198, v206
    v_cvt_pk_bf16_f32 v127, v199, v207
    s_waitcnt vmcnt(0)
    v_mfma_f32_16x16x32_bf16 v[244:247], v[172:175], v[152:155], 0
    v_fmac_f32 v200, v216, v188
    v_fmac_f32 v201, v217, v189
    v_fmac_f32 v202, v218, v190
    v_mfma_f32_16x16x32_bf16 v[248:251], v[172:175], v[156:159], 0
    v_fmac_f32 v203, v219, v191
    v_fmac_f32 v208, v224, v188
    v_fmac_f32 v209, v225, v189
    v_mfma_f32_16x16x32_bf16 v[252:255], v[176:179], v[160:163], 0
    v_fmac_f32 v210, v226, v190
    v_fmac_f32 v211, v227, v191
    v_cvt_pk_bf16_f32 v137, v200, v208
    v_mfma_f32_16x16x32_bf16 v[168:171], v[176:179], v[164:167], 0
    v_cvt_pk_bf16_f32 v139, v201, v209
    v_cvt_pk_bf16_f32 v141, v202, v210
    v_cvt_pk_bf16_f32 v143, v203, v211
    s_lshl_b32 s56, s52, 28
    buffer_load_dwordx2 v[24:25], v20, s[48:51], s56 offen sc1
    v_fmac_f32 v228, v244, v184
    v_fmac_f32 v229, v245, v185
    v_fmac_f32 v230, v246, v186
    v_fmac_f32 v236, v252, v184
    v_fmac_f32 v237, v253, v185
    v_fmac_f32 v238, v254, v186
    v_cvt_pk_bf16_f32 v129, v228, v236
    v_cvt_pk_bf16_f32 v131, v229, v237
    v_cvt_pk_bf16_f32 v133, v230, v238
    v_fmac_f32 v232, v248, v192
    v_fmac_f32 v233, v249, v193
    v_fmac_f32 v234, v250, v194
    v_fmac_f32 v240, v168, v192
    v_fmac_f32 v241, v169, v193
    v_fmac_f32 v242, v170, v194
    v_cvt_pk_bf16_f32 v145, v232, v240
    v_cvt_pk_bf16_f32 v147, v233, v241
    v_cvt_pk_bf16_f32 v149, v234, v242
    s_waitcnt lgkmcnt(0)
    v_mfma_f32_16x16x32_bf16 v[2:5], v[120:123], v[32:35], v[2:5]
    v_mfma_f32_16x16x32_bf16 v[10:13], v[136:139], v[48:51], v[10:13]
    v_mfma_f32_16x16x32_bf16 v[2:5], v[124:127], v[36:39], v[2:5]
    v_mfma_f32_16x16x32_bf16 v[10:13], v[140:143], v[52:55], v[10:13]
    v_mfma_f32_16x16x32_bf16 v[2:5], v[128:131], v[40:43], v[2:5]
    v_mfma_f32_16x16x32_bf16 v[10:13], v[144:147], v[56:59], v[10:13]
    v_mfma_f32_16x16x32_bf16 v[2:5], v[132:135], v[44:47], v[2:5]
    v_mfma_f32_16x16x32_bf16 v[10:13], v[148:151], v[60:63], v[10:13]
    s_and_b32 s56, s60, 0x400
    v_add_u32 v31, s56, v31
    v_xor_b32 v29, 0x400, v31
    s_cmp_lg_u32 s52, 0
    s_nop 2
    ds_write_b128 v31, v[2:5]
    ds_write_b128 v29, v[10:13]
    s_cbranch_scc0 L_w0
    s_waitcnt lgkmcnt(0)
    s_barrier
    s_branch L_end
L_w0:
    buffer_load_dwordx2 v[40:41], v20, s[48:51], 0 offen sc1
    v_and_b32 v1, 31, v0
    v_and_b32 v6, 15, v0
    v_lshrrev_b32 v7, 2, v6
    v_lshl_add_u32 v7, v7, 4, v6
    v_lshlrev_b32 v7, 4, v7
    v_and_b32 v6, 3, v0
    v_lshl_add_u32 v7, v6, 2, v7
    v_bfe_u32 v6, v0, 4, 1
    v_lshl_add_u32 v7, v6, 10, v7
    v_bfe_u32 v6, v0, 5, 1
    v_lshl_add_u32 v7, v6, 13, v7
    v_add_u32 v7, 106496, v7
    s_lshl1_add_u32 s56, s53, s54
    s_lshl_b32 s56, s56, 6
    v_lshlrev_b32 v9, 1, v1
    s_lshl_b32 s57, s53, 2
    s_mov_b32 s59, 0
L_poll:
    s_waitcnt vmcnt(1)
    v_cmp_eq_u32 vcc, v25, v21
    s_cbranch_vccz L_got
    buffer_load_dwordx2 v[24:25], v20, s[48:51], 0 offen sc1
    s_waitcnt vmcnt(1)
    v_cmp_eq_u32 vcc, v41, v21
    s_cbranch_vccz L_got2
    buffer_load_dwordx2 v[40:41], v20, s[48:51], 0 offen sc1
    s_add_u32 s59, s59, 1
    s_and_b32 s58, s59, 15
    s_cbranch_scc1 L_poll
    s_mov_b64 exec, 1
    buffer_load_dword v27, off, s[44:47], s57 sc1
    s_waitcnt vmcnt(0)
    v_readfirstlane_b32 s58, v27
    s_mov_b64 exec, -1
    s_bitcmp1_b32 s58, 1
    s_cselect_b32 s6, 0, -1
    s_bitcmp1_b32 s58, 17
    s_cselect_b32 s7, 0, -1
    s_mov_b32 s58, 0x10000
    buffer_load_dwordx2 v[24:25], v20, s[48:51], s58 offen sc1
    s_waitcnt vmcnt(0)
    v_cmp_eq_u32 vcc, v25, v26
    s_nop 0
    s_and_b64 vcc, vcc, s[6:7]
    s_cbranch_scc0 L_got
    buffer_load_dwordx2 v[24:25], v20, s[48:51], 0 offen sc1
    buffer_load_dwordx2 v[40:41], v20, s[48:51], 0 offen sc1
    s_branch L_poll
L_got:
    v_mov_b32 v8, v24
    s_branch L_got3
L_got2:
    v_mov_b32 v8, v40
L_got3:
    s_waitcnt lgkmcnt(0)
    s_barrier
    ds_read_b32 v32, v7 offset:0
    ds_read_b32 v33, v7 offset:2048
    ds_read_b32 v34, v7 offset:4096
    ds_read_b32 v35, v7 offset:6144
    s_waitcnt lgkmcnt(2)
    v_add_f32 v32, v32, v33
    v_add_f32 v32, v32, v8
    s_waitcnt lgkmcnt(0)
    v_add_f32 v34, v34, v35
    v_add_f32 v32, v32, v34
    v_mov_b32 v33, v32
    s_nop 1
    v_permlane32_swap_b32 v32, v33
    v_add_f32 v4, v32, v33
    v_cvt_pk_bf16_f32 v4, v4, v4
    s_mov_b32 exec_hi, 0
    buffer_store_short v4, v9, s[40:43], s56 offen
    s_branch L_end
L_Bl2:
    v_lshrrev_b32 v15, 4, v0
    v_xor_b32 v15, v15, v0
    v_and_b32 v15, 7, v15
    v_lshlrev_b32 v2, 4, v15
    s_waitcnt vmcnt(32)
    v_lshlrev_b32 v4, 7, v4
    v_lshlrev_b32 v5, 7, v5
    v_lshlrev_b32 v6, 7, v6
    v_lshlrev_b32 v7, 7, v7
    v_lshlrev_b32 v8, 7, v8
    v_lshlrev_b32 v9, 7, v9
    v_lshlrev_b32 v10, 7, v10
    v_lshlrev_b32 v11, 7, v11
    v_add_u32_dpp v12, v4, v2 row_newbcast:0 row_mask:0xf bank_mask:0x3
    v_add_u32_dpp v13, v8, v2 row_newbcast:0 row_mask:0xf bank_mask:0x3
    s_add_u32 m0, s60, 131072
    v_add_u32_dpp v12, v4, v2 row_newbcast:8 row_mask:0xf bank_mask:0xc
    v_add_u32_dpp v13, v8, v2 row_newbcast:8 row_mask:0xf bank_mask:0xc
    buffer_load_dwordx4 v12, s[12:15], 0 offen lds
    s_addk_i32 m0, 0x1000
    s_nop 0
    buffer_load_dwordx4 v13, s[12:15], 0 offen lds
    v_add_u32_dpp v12, v5, v2 row_newbcast:0 row_mask:0xf bank_mask:0x3
    v_add_u32_dpp v13, v9, v2 row_newbcast:0 row_mask:0xf bank_mask:0x3
    s_add_u32 m0, s60, 139264
    v_add_u32_dpp v12, v5, v2 row_newbcast:8 row_mask:0xf bank_mask:0xc
    v_add_u32_dpp v13, v9, v2 row_newbcast:8 row_mask:0xf bank_mask:0xc
    buffer_load_dwordx4 v12, s[12:15], 0 offen lds
    s_addk_i32 m0, 0x1000
    s_nop 0
    buffer_load_dwordx4 v13, s[12:15], 0 offen lds
    v_add_u32_dpp v12, v6, v2 row_newbcast:0 row_mask:0xf bank_mask:0x3
    v_add_u32_dpp v13, v10, v2 row_newbcast:0 row_mask:0xf bank_mask:0x3
    s_add_u32 m0, s60, 147456
    v_add_u32_dpp v12, v6, v2 row_newbcast:8 row_mask:0xf bank_mask:0xc
    v_add_u32_dpp v13, v10, v2 row_newbcast:8 row_mask:0xf bank_mask:0xc
    buffer_load_dwordx4 v12, s[12:15], 0 offen lds
    s_addk_i32 m0, 0x1000
    s_nop 0
    buffer_load_dwordx4 v13, s[12:15], 0 offen lds
    v_add_u32_dpp v12, v7, v2 row_newbcast:0 row_mask:0xf bank_mask:0x3
    v_add_u32_dpp v13, v11, v2 row_newbcast:0 row_mask:0xf bank_mask:0x3
    s_add_u32 m0, s60, 155648
    v_add_u32_dpp v12, v7, v2 row_newbcast:8 row_mask:0xf bank_mask:0xc
    v_add_u32_dpp v13, v11, v2 row_newbcast:8 row_mask:0xf bank_mask:0xc
    buffer_load_dwordx4 v12, s[12:15], 0 offen lds
    s_addk_i32 m0, 0x1000
    s_nop 0
    buffer_load_dwordx4 v13, s[12:15], 0 offen lds
    s_waitcnt vmcnt(6)
    s_barrier
    s_waitcnt vmcnt(4)
    s_barrier
    s_add_u32 m0, s60, 0
    s_mov_b32 s56, 262144
    buffer_load_dwordx4 v1, s[16:19], s56 offen lds
    s_add_u32 m0, s60, 4096
    s_mov_b32 s56, 270336
    buffer_load_dwordx4 v1, s[16:19], s56 offen lds
    s_add_u32 m0, s60, 8192
    s_mov_b32 s56, 278528
    buffer_load_dwordx4 v1, s[16:19], s56 offen lds
    v_add_u32_dpp v12, v4, v2 row_newbcast:1 row_mask:0xf bank_mask:0x3
    v_add_u32_dpp v13, v8, v2 row_newbcast:1 row_mask:0xf bank_mask:0x3
    s_add_u32 m0, s60, 131072
    v_add_u32_dpp v12, v4, v2 row_newbcast:9 row_mask:0xf bank_mask:0xc
    v_add_u32_dpp v13, v8, v2 row_newbcast:9 row_mask:0xf bank_mask:0xc
    buffer_load_dwordx4 v12, s[12:15], 0 offen lds
    s_addk_i32 m0, 0x1000
    s_nop 0
    buffer_load_dwordx4 v13, s[12:15], 0 offen lds
    s_waitcnt vmcnt(7)
    s_barrier
    s_add_u32 m0, s60, 12288
    s_mov_b32 s56, 286720
    buffer_load_dwordx4 v1, s[16:19], s56 offen lds
    s_add_u32 m0, s60, 16384
    s_mov_b32 s56, 294912
    buffer_load_dwordx4 v1, s[16:19], s56 offen lds
    s_add_u32 m0, s60, 20480
    s_mov_b32 s56, 303104
    buffer_load_dwordx4 v1, s[16:19], s56 offen lds
    v_add_u32_dpp v12, v5, v2 row_newbcast:1 row_mask:0xf bank_mask:0x3
    v_add_u32_dpp v13, v9, v2 row_newbcast:1 row_mask:0xf bank_mask:0x3
    s_add_u32 m0, s60, 139264
    v_add_u32_dpp v12, v5, v2 row_newbcast:9 row_mask:0xf bank_mask:0xc
    v_add_u32_dpp v13, v9, v2 row_newbcast:9 row_mask:0xf bank_mask:0xc
    buffer_load_dwordx4 v12, s[12:15], 0 offen lds
    s_addk_i32 m0, 0x1000
    s_nop 0
    buffer_load_dwordx4 v13, s[12:15], 0 offen lds
    s_waitcnt vmcnt(10)
    s_barrier
    s_add_u32 m0, s60, 24576
    s_mov_b32 s56, 311296
    buffer_load_dwordx4 v1, s[16:19], s56 offen lds
    s_add_u32 m0, s60, 28672
    s_mov_b32 s56, 319488
    buffer_load_dwordx4 v1, s[16:19], s56 offen lds
    s_add_u32 m0, s60, 32768
    s_mov_b32 s56, 327680
    buffer_load_dwordx4 v1, s[16:19], s56 offen lds
    v_add_u32_dpp v12, v6, v2 row_newbcast:1 row_mask:0xf bank_mask:0x3
    v_add_u32_dpp v13, v10, v2 row_newbcast:1 row_mask:0xf bank_mask:0x3
    s_add_u32 m0, s60, 147456
    v_add_u32_dpp v12, v6, v2 row_newbcast:9 row_mask:0xf bank_mask:0xc
    v_add_u32_dpp v13, v10, v2 row_newbcast:9 row_mask:0xf bank_mask:0xc
    buffer_load_dwordx4 v12, s[12:15], 0 offen lds
    s_addk_i32 m0, 0x1000
    s_nop 0
    buffer_load_dwordx4 v13, s[12:15], 0 offen lds
    s_waitcnt vmcnt(10)
    s_barrier
    s_add_u32 m0, s60, 36864
    s_mov_b32 s56, 335872
    buffer_load_dwordx4 v1, s[16:19], s56 offen lds
    s_add_u32 m0, s60, 40960
    s_mov_b32 s56, 344064
    buffer_load_dwordx4 v1, s[16:19], s56 offen lds
    s_add_u32 m0, s60, 45056
    s_mov_b32 s56, 352256
    buffer_load_dwordx4 v1, s[16:19], s56 offen lds
    s_add_u32 m0, s60, 49152
    s_mov_b32 s56, 360448
    buffer_load_dwordx4 v1, s[16:19], s56 offen lds
    v_add_u32_dpp v12, v7, v2 row_newbcast:1 row_mask:0xf bank_mask:0x3
    v_add_u32_dpp v13, v11, v2 row_newbcast:1 row_mask:0xf bank_mask:0x3
    s_add_u32 m0, s60, 155648
    v_add_u32_dpp v12, v7, v2 row_newbcast:9 row_mask:0xf bank_mask:0xc
    v_add_u32_dpp v13, v11, v2 row_newbcast:9 row_mask:0xf bank_mask:0xc
    buffer_load_dwordx4 v12, s[12:15], 0 offen lds
    s_addk_i32 m0, 0x1000
    s_nop 0
    buffer_load_dwordx4 v13, s[12:15], 0 offen lds
    s_waitcnt vmcnt(11)
    s_barrier
    s_add_u32 m0, s60, 53248
    s_mov_b32 s56, 368640
    buffer_load_dwordx4 v1, s[16:19], s56 offen lds
    s_add_u32 m0, s60, 57344
    s_mov_b32 s56, 376832
    buffer_load_dwordx4 v1, s[16:19], s56 offen lds
    s_add_u32 m0, s60, 61440
    s_mov_b32 s56, 385024
    buffer_load_dwordx4 v1, s[16:19], s56 offen lds
    v_add_u32_dpp v12, v4, v2 row_newbcast:2 row_mask:0xf bank_mask:0x3
    v_add_u32_dpp v13, v8, v2 row_newbcast:2 row_mask:0xf bank_mask:0x3
    s_add_u32 m0, s60, 131072
    v_add_u32_dpp v12, v4, v2 row_newbcast:10 row_mask:0xf bank_mask:0xc
    v_add_u32_dpp v13, v8, v2 row_newbcast:10 row_mask:0xf bank_mask:0xc
    buffer_load_dwordx4 v12, s[12:15], 0 offen lds
    s_addk_i32 m0, 0x1000
    s_nop 0
    buffer_load_dwordx4 v13, s[12:15], 0 offen lds
    s_waitcnt vmcnt(11)
    s_barrier
    s_add_u32 m0, s60, 65536
    s_mov_b32 s56, 393216
    buffer_load_dwordx4 v1, s[16:19], s56 offen lds
    s_add_u32 m0, s60, 69632
    s_mov_b32 s56, 401408
    buffer_load_dwordx4 v1, s[16:19], s56 offen lds
    s_add_u32 m0, s60, 73728
    s_mov_b32 s56, 409600
    buffer_load_dwordx4 v1, s[16:19], s56 offen lds
    v_add_u32_dpp v12, v5, v2 row_newbcast:2 row_mask:0xf bank_mask:0x3
    v_add_u32_dpp v13, v9, v2 row_newbcast:2 row_mask:0xf bank_mask:0x3
    s_add_u32 m0, s60, 139264
    v_add_u32_dpp v12, v5, v2 row_newbcast:10 row_mask:0xf bank_mask:0xc
    v_add_u32_dpp v13, v9, v2 row_newbcast:10 row_mask:0xf bank_mask:0xc
    buffer_load_dwordx4 v12, s[12:15], 0 offen lds
    s_addk_i32 m0, 0x1000
    s_nop 0
    buffer_load_dwordx4 v13, s[12:15], 0 offen lds
    s_waitcnt vmcnt(10)
    s_barrier
    s_add_u32 m0, s60, 77824
    s_mov_b32 s56, 417792
    buffer_load_dwordx4 v1, s[16:19], s56 offen lds
    s_add_u32 m0, s60, 81920
    s_mov_b32 s56, 425984
    buffer_load_dwordx4 v1, s[16:19], s56 offen lds
    s_add_u32 m0, s60, 86016
    s_mov_b32 s56, 434176
    buffer_load_dwordx4 v1, s[16:19], s56 offen lds
    v_add_u32_dpp v12, v6, v2 row_newbcast:2 row_mask:0xf bank_mask:0x3
    v_add_u32_dpp v13, v10, v2 row_newbcast:2 row_mask:0xf bank_mask:0x3
    s_add_u32 m0, s60, 147456
    v_add_u32_dpp v12, v6, v2 row_newbcast:10 row_mask:0xf bank_mask:0xc
    v_add_u32_dpp v13, v10, v2 row_newbcast:10 row_mask:0xf bank_mask:0xc
    buffer_load_dwordx4 v12, s[12:15], 0 offen lds
    s_addk_i32 m0, 0x1000
    s_nop 0
    buffer_load_dwordx4 v13, s[12:15], 0 offen lds
    s_waitcnt vmcnt(10)
    s_barrier
    s_add_u32 m0, s60, 90112
    s_mov_b32 s56, 442368
    buffer_load_dwordx4 v1, s[16:19], s56 offen lds
    s_add_u32 m0, s60, 94208
    s_mov_b32 s56, 450560
    buffer_load_dwordx4 v1, s[16:19], s56 offen lds
    s_add_u32 m0, s60, 98304
    s_mov_b32 s56, 458752
    buffer_load_dwordx4 v1, s[16:19], s56 offen lds
    s_add_u32 m0, s60, 102400
    s_mov_b32 s56, 466944
    buffer_load_dwordx4 v1, s[16:19], s56 offen lds
    v_add_u32_dpp v12, v7, v2 row_newbcast:2 row_mask:0xf bank_mask:0x3
    v_add_u32_dpp v13, v11, v2 row_newbcast:2 row_mask:0xf bank_mask:0x3
    s_add_u32 m0, s60, 155648
    v_add_u32_dpp v12, v7, v2 row_newbcast:10 row_mask:0xf bank_mask:0xc
    v_add_u32_dpp v13, v11, v2 row_newbcast:10 row_mask:0xf bank_mask:0xc
    buffer_load_dwordx4 v12, s[12:15], 0 offen lds
    s_addk_i32 m0, 0x1000
    s_nop 0
    buffer_load_dwordx4 v13, s[12:15], 0 offen lds
    s_waitcnt vmcnt(11)
    s_barrier
    s_add_u32 m0, s60, 106496
    s_mov_b32 s56, 475136
    buffer_load_dwordx4 v1, s[16:19], s56 offen lds
    s_add_u32 m0, s60, 110592
    s_mov_b32 s56, 483328
    buffer_load_dwordx4 v1, s[16:19], s56 offen lds
    s_add_u32 m0, s60, 114688
    s_mov_b32 s56, 491520
    buffer_load_dwordx4 v1, s[16:19], s56 offen lds
    v_add_u32_dpp v12, v4, v2 row_newbcast:3 row_mask:0xf bank_mask:0x3
    v_add_u32_dpp v13, v8, v2 row_newbcast:3 row_mask:0xf bank_mask:0x3
    s_add_u32 m0, s60, 131072
    v_add_u32_dpp v12, v4, v2 row_newbcast:11 row_mask:0xf bank_mask:0xc
    v_add_u32_dpp v13, v8, v2 row_newbcast:11 row_mask:0xf bank_mask:0xc
    buffer_load_dwordx4 v12, s[12:15], 0 offen lds
    s_addk_i32 m0, 0x1000
    s_nop 0
    buffer_load_dwordx4 v13, s[12:15], 0 offen lds
    s_waitcnt vmcnt(11)
    s_barrier
    s_add_u32 m0, s60, 118784
    s_mov_b32 s56, 499712
    buffer_load_dwordx4 v1, s[16:19], s56 offen lds
    s_add_u32 m0, s60, 122880
    s_mov_b32 s56, 507904
    buffer_load_dwordx4 v1, s[16:19], s56 offen lds
    s_add_u32 m0, s60, 126976
    s_mov_b32 s56, 516096
    buffer_load_dwordx4 v1, s[16:19], s56 offen lds
    v_add_u32_dpp v12, v5, v2 row_newbcast:3 row_mask:0xf bank_mask:0x3
    v_add_u32_dpp v13, v9, v2 row_newbcast:3 row_mask:0xf bank_mask:0x3
    s_add_u32 m0, s60, 139264
    v_add_u32_dpp v12, v5, v2 row_newbcast:11 row_mask:0xf bank_mask:0xc
    v_add_u32_dpp v13, v9, v2 row_newbcast:11 row_mask:0xf bank_mask:0xc
    buffer_load_dwordx4 v12, s[12:15], 0 offen lds
    s_addk_i32 m0, 0x1000
    s_nop 0
    buffer_load_dwordx4 v13, s[12:15], 0 offen lds
    s_waitcnt vmcnt(10)
    s_barrier
    s_add_u32 m0, s60, 0
    s_mov_b32 s56, 524288
    buffer_load_dwordx4 v1, s[16:19], s56 offen lds
    s_add_u32 m0, s60, 4096
    s_mov_b32 s56, 532480
    buffer_load_dwordx4 v1, s[16:19], s56 offen lds
    s_add_u32 m0, s60, 8192
    s_mov_b32 s56, 540672
    buffer_load_dwordx4 v1, s[16:19], s56 offen lds
    s_add_u32 m0, s60, 12288
    s_mov_b32 s56, 548864
    buffer_load_dwordx4 v1, s[16:19], s56 offen lds
    v_add_u32_dpp v12, v6, v2 row_newbcast:3 row_mask:0xf bank_mask:0x3
    v_add_u32_dpp v13, v10, v2 row_newbcast:3 row_mask:0xf bank_mask:0x3
    s_add_u32 m0, s60, 147456
    v_add_u32_dpp v12, v6, v2 row_newbcast:11 row_mask:0xf bank_mask:0xc
    v_add_u32_dpp v13, v10, v2 row_newbcast:11 row_mask:0xf bank_mask:0xc
    buffer_load_dwordx4 v12, s[12:15], 0 offen lds
    s_addk_i32 m0, 0x1000
    s_nop 0
    buffer_load_dwordx4 v13, s[12:15], 0 offen lds
    s_waitcnt vmcnt(11)
    s_barrier
    s_add_u32 m0, s60, 16384
    s_mov_b32 s56, 557056
    buffer_load_dwordx4 v1, s[16:19], s56 offen lds
    s_add_u32 m0, s60, 20480
    s_mov_b32 s56, 565248
    buffer_load_dwordx4 v1, s[16:19], s56 offen lds
    s_add_u32 m0, s60, 24576
    s_mov_b32 s56, 573440
    buffer_load_dwordx4 v1, s[16:19], s56 offen lds
    v_add_u32_dpp v12, v7, v2 row_newbcast:3 row_mask:0xf bank_mask:0x3
    v_add_u32_dpp v13, v11, v2 row_newbcast:3 row_mask:0xf bank_mask:0x3
    s_add_u32 m0, s60, 155648
    v_add_u32_dpp v12, v7, v2 row_newbcast:11 row_mask:0xf bank_mask:0xc
    v_add_u32_dpp v13, v11, v2 row_newbcast:11 row_mask:0xf bank_mask:0xc
    buffer_load_dwordx4 v12, s[12:15], 0 offen lds
    s_addk_i32 m0, 0x1000
    s_nop 0
    buffer_load_dwordx4 v13, s[12:15], 0 offen lds
    s_waitcnt vmcnt(11)
    s_barrier
    s_add_u32 m0, s60, 28672
    s_mov_b32 s56, 581632
    buffer_load_dwordx4 v1, s[16:19], s56 offen lds
    s_add_u32 m0, s60, 32768
    s_mov_b32 s56, 589824
    buffer_load_dwordx4 v1, s[16:19], s56 offen lds
    s_add_u32 m0, s60, 36864
    s_mov_b32 s56, 598016
    buffer_load_dwordx4 v1, s[16:19], s56 offen lds
    v_add_u32_dpp v12, v4, v2 row_newbcast:4 row_mask:0xf bank_mask:0x3
    v_add_u32_dpp v13, v8, v2 row_newbcast:4 row_mask:0xf bank_mask:0x3
    s_add_u32 m0, s60, 131072
    v_add_u32_dpp v12, v4, v2 row_newbcast:12 row_mask:0xf bank_mask:0xc
    v_add_u32_dpp v13, v8, v2 row_newbcast:12 row_mask:0xf bank_mask:0xc
    buffer_load_dwordx4 v12, s[12:15], 0 offen lds
    s_addk_i32 m0, 0x1000
    s_nop 0
    buffer_load_dwordx4 v13, s[12:15], 0 offen lds
    s_waitcnt vmcnt(10)
    s_barrier
    s_add_u32 m0, s60, 40960
    s_mov_b32 s56, 606208
    buffer_load_dwordx4 v1, s[16:19], s56 offen lds
    s_add_u32 m0, s60, 45056
    s_mov_b32 s56, 614400
    buffer_load_dwordx4 v1, s[16:19], s56 offen lds
    s_add_u32 m0, s60, 49152
    s_mov_b32 s56, 622592
    buffer_load_dwordx4 v1, s[16:19], s56 offen lds
    v_add_u32_dpp v12, v5, v2 row_newbcast:4 row_mask:0xf bank_mask:0x3
    v_add_u32_dpp v13, v9, v2 row_newbcast:4 row_mask:0xf bank_mask:0x3
    s_add_u32 m0, s60, 139264
    v_add_u32_dpp v12, v5, v2 row_newbcast:12 row_mask:0xf bank_mask:0xc
    v_add_u32_dpp v13, v9, v2 row_newbcast:12 row_mask:0xf bank_mask:0xc
    buffer_load_dwordx4 v12, s[12:15], 0 offen lds
    s_addk_i32 m0, 0x1000
    s_nop 0
    buffer_load_dwordx4 v13, s[12:15], 0 offen lds
    s_waitcnt vmcnt(10)
    s_barrier
    s_add_u32 m0, s60, 53248
    s_mov_b32 s56, 630784
    buffer_load_dwordx4 v1, s[16:19], s56 offen lds
    s_add_u32 m0, s60, 57344
    s_mov_b32 s56, 638976
    buffer_load_dwordx4 v1, s[16:19], s56 offen lds
    s_add_u32 m0, s60, 61440
    s_mov_b32 s56, 647168
    buffer_load_dwordx4 v1, s[16:19], s56 offen lds
    s_add_u32 m0, s60, 65536
    s_mov_b32 s56, 655360
    buffer_load_dwordx4 v1, s[16:19], s56 offen lds
    v_add_u32_dpp v12, v6, v2 row_newbcast:4 row_mask:0xf bank_mask:0x3
    v_add_u32_dpp v13, v10, v2 row_newbcast:4 row_mask:0xf bank_mask:0x3
    s_add_u32 m0, s60, 147456
    v_add_u32_dpp v12, v6, v2 row_newbcast:12 row_mask:0xf bank_mask:0xc
    v_add_u32_dpp v13, v10, v2 row_newbcast:12 row_mask:0xf bank_mask:0xc
    buffer_load_dwordx4 v12, s[12:15], 0 offen lds
    s_addk_i32 m0, 0x1000
    s_nop 0
    buffer_load_dwordx4 v13, s[12:15], 0 offen lds
    s_waitcnt vmcnt(11)
    s_barrier
    s_add_u32 m0, s60, 69632
    s_mov_b32 s56, 663552
    buffer_load_dwordx4 v1, s[16:19], s56 offen lds
    s_add_u32 m0, s60, 73728
    s_mov_b32 s56, 671744
    buffer_load_dwordx4 v1, s[16:19], s56 offen lds
    s_add_u32 m0, s60, 77824
    s_mov_b32 s56, 679936
    buffer_load_dwordx4 v1, s[16:19], s56 offen lds
    v_add_u32_dpp v12, v7, v2 row_newbcast:4 row_mask:0xf bank_mask:0x3
    v_add_u32_dpp v13, v11, v2 row_newbcast:4 row_mask:0xf bank_mask:0x3
    s_add_u32 m0, s60, 155648
    v_add_u32_dpp v12, v7, v2 row_newbcast:12 row_mask:0xf bank_mask:0xc
    v_add_u32_dpp v13, v11, v2 row_newbcast:12 row_mask:0xf bank_mask:0xc
    buffer_load_dwordx4 v12, s[12:15], 0 offen lds
    s_addk_i32 m0, 0x1000
    s_nop 0
    buffer_load_dwordx4 v13, s[12:15], 0 offen lds
    s_waitcnt vmcnt(11)
    s_barrier
    s_add_u32 m0, s60, 81920
    s_mov_b32 s56, 688128
    buffer_load_dwordx4 v1, s[16:19], s56 offen lds
    s_add_u32 m0, s60, 86016
    s_mov_b32 s56, 696320
    buffer_load_dwordx4 v1, s[16:19], s56 offen lds
    s_add_u32 m0, s60, 90112
    s_mov_b32 s56, 704512
    buffer_load_dwordx4 v1, s[16:19], s56 offen lds
    v_add_u32_dpp v12, v4, v2 row_newbcast:5 row_mask:0xf bank_mask:0x3
    v_add_u32_dpp v13, v8, v2 row_newbcast:5 row_mask:0xf bank_mask:0x3
    s_add_u32 m0, s60, 131072
    v_add_u32_dpp v12, v4, v2 row_newbcast:13 row_mask:0xf bank_mask:0xc
    v_add_u32_dpp v13, v8, v2 row_newbcast:13 row_mask:0xf bank_mask:0xc
    buffer_load_dwordx4 v12, s[12:15], 0 offen lds
    s_addk_i32 m0, 0x1000
    s_nop 0
    buffer_load_dwordx4 v13, s[12:15], 0 offen lds
    s_waitcnt vmcnt(10)
    s_barrier
    s_add_u32 m0, s60, 94208
    s_mov_b32 s56, 712704
    buffer_load_dwordx4 v1, s[16:19], s56 offen lds
    s_add_u32 m0, s60, 98304
    s_mov_b32 s56, 720896
    buffer_load_dwordx4 v1, s[16:19], s56 offen lds
    s_add_u32 m0, s60, 102400
    s_mov_b32 s56, 729088
    buffer_load_dwordx4 v1, s[16:19], s56 offen lds
    v_add_u32_dpp v12, v5, v2 row_newbcast:5 row_mask:0xf bank_mask:0x3
    v_add_u32_dpp v13, v9, v2 row_newbcast:5 row_mask:0xf bank_mask:0x3
    s_add_u32 m0, s60, 139264
    v_add_u32_dpp v12, v5, v2 row_newbcast:13 row_mask:0xf bank_mask:0xc
    v_add_u32_dpp v13, v9, v2 row_newbcast:13 row_mask:0xf bank_mask:0xc
    buffer_load_dwordx4 v12, s[12:15], 0 offen lds
    s_addk_i32 m0, 0x1000
    s_nop 0
    buffer_load_dwordx4 v13, s[12:15], 0 offen lds
    s_waitcnt vmcnt(10)
    s_barrier
    s_add_u32 m0, s60, 106496
    s_mov_b32 s56, 737280
    buffer_load_dwordx4 v1, s[16:19], s56 offen lds
    s_add_u32 m0, s60, 110592
    s_mov_b32 s56, 745472
    buffer_load_dwordx4 v1, s[16:19], s56 offen lds
    s_add_u32 m0, s60, 114688
    s_mov_b32 s56, 753664
    buffer_load_dwordx4 v1, s[16:19], s56 offen lds
    s_add_u32 m0, s60, 118784
    s_mov_b32 s56, 761856
    buffer_load_dwordx4 v1, s[16:19], s56 offen lds
    v_add_u32_dpp v12, v6, v2 row_newbcast:5 row_mask:0xf bank_mask:0x3
    v_add_u32_dpp v13, v10, v2 row_newbcast:5 row_mask:0xf bank_mask:0x3
    s_add_u32 m0, s60, 147456
    v_add_u32_dpp v12, v6, v2 row_newbcast:13 row_mask:0xf bank_mask:0xc
    v_add_u32_dpp v13, v10, v2 row_newbcast:13 row_mask:0xf bank_mask:0xc
    buffer_load_dwordx4 v12, s[12:15], 0 offen lds
    s_addk_i32 m0, 0x1000
    s_nop 0
    buffer_load_dwordx4 v13, s[12:15], 0 offen lds
    s_waitcnt vmcnt(11)
    s_barrier
    s_add_u32 m0, s60, 122880
    s_mov_b32 s56, 770048
    buffer_load_dwordx4 v1, s[16:19], s56 offen lds
    s_add_u32 m0, s60, 126976
    s_mov_b32 s56, 778240
    buffer_load_dwordx4 v1, s[16:19], s56 offen lds
    s_add_u32 m0, s60, 0
    s_mov_b32 s56, 786432
    buffer_load_dwordx4 v1, s[16:19], s56 offen lds
    v_add_u32_dpp v12, v7, v2 row_newbcast:5 row_mask:0xf bank_mask:0x3
    v_add_u32_dpp v13, v11, v2 row_newbcast:5 row_mask:0xf bank_mask:0x3
    s_add_u32 m0, s60, 155648
    v_add_u32_dpp v12, v7, v2 row_newbcast:13 row_mask:0xf bank_mask:0xc
    v_add_u32_dpp v13, v11, v2 row_newbcast:13 row_mask:0xf bank_mask:0xc
    buffer_load_dwordx4 v12, s[12:15], 0 offen lds
    s_addk_i32 m0, 0x1000
    s_nop 0
    buffer_load_dwordx4 v13, s[12:15], 0 offen lds
    s_waitcnt vmcnt(11)
    s_barrier
    s_add_u32 m0, s60, 4096
    s_mov_b32 s56, 794624
    buffer_load_dwordx4 v1, s[16:19], s56 offen lds
    s_add_u32 m0, s60, 8192
    s_mov_b32 s56, 802816
    buffer_load_dwordx4 v1, s[16:19], s56 offen lds
    s_add_u32 m0, s60, 12288
    s_mov_b32 s56, 811008
    buffer_load_dwordx4 v1, s[16:19], s56 offen lds
    v_add_u32_dpp v12, v4, v2 row_newbcast:6 row_mask:0xf bank_mask:0x3
    v_add_u32_dpp v13, v8, v2 row_newbcast:6 row_mask:0xf bank_mask:0x3
    s_add_u32 m0, s60, 131072
    v_add_u32_dpp v12, v4, v2 row_newbcast:14 row_mask:0xf bank_mask:0xc
    v_add_u32_dpp v13, v8, v2 row_newbcast:14 row_mask:0xf bank_mask:0xc
    buffer_load_dwordx4 v12, s[12:15], 0 offen lds
    s_addk_i32 m0, 0x1000
    s_nop 0
    buffer_load_dwordx4 v13, s[12:15], 0 offen lds
    s_waitcnt vmcnt(10)
    s_barrier
    s_add_u32 m0, s60, 16384
    s_mov_b32 s56, 819200
    buffer_load_dwordx4 v1, s[16:19], s56 offen lds
    s_add_u32 m0, s60, 20480
    s_mov_b32 s56, 827392
    buffer_load_dwordx4 v1, s[16:19], s56 offen lds
    s_add_u32 m0, s60, 24576
    s_mov_b32 s56, 835584
    buffer_load_dwordx4 v1, s[16:19], s56 offen lds
    s_add_u32 m0, s60, 28672
    s_mov_b32 s56, 843776
    buffer_load_dwordx4 v1, s[16:19], s56 offen lds
    v_add_u32_dpp v12, v5, v2 row_newbcast:6 row_mask:0xf bank_mask:0x3
    v_add_u32_dpp v13, v9, v2 row_newbcast:6 row_mask:0xf bank_mask:0x3
    s_add_u32 m0, s60, 139264
    v_add_u32_dpp v12, v5, v2 row_newbcast:14 row_mask:0xf bank_mask:0xc
    v_add_u32_dpp v13, v9, v2 row_newbcast:14 row_mask:0xf bank_mask:0xc
    buffer_load_dwordx4 v12, s[12:15], 0 offen lds
    s_addk_i32 m0, 0x1000
    s_nop 0
    buffer_load_dwordx4 v13, s[12:15], 0 offen lds
    s_waitcnt vmcnt(11)
    s_barrier
    s_waitcnt vmcnt(6)
    s_barrier
    s_waitcnt vmcnt(0)
    s_barrier
    s_branch L_end
L_Bc:
    s_mov_b32 s30, 676
    s_mov_b32 s31, 0x00020000
    s_mov_b32 s34, 676
    s_mov_b32 s35, 0x00020000
    s_mov_b32 s26, 8192
    s_mov_b32 s27, 0x00020000
    s_mov_b32 s22, 173056
    s_mov_b32 s23, 0x00020000
    s_mov_b32 s38, 512
    s_mov_b32 s39, 0x00020000
    s_mov_b32 s42, 8192
    s_mov_b32 s43, 0x00020000
    s_mov_b32 s46, 256
    s_mov_b32 s47, 0x00020000
    s_mov_b32 s50, 268435456
    s_mov_b32 s51, 0x00020000
    s_mov_b32 s64, 0x05040100
    s_mov_b32 s65, 0x07060302
    s_mov_b32 s66, 0xc0135761
    s_mov_b32 s67, 0xbdd2d3e8
    s_mov_b32 s68, 0xffff0000
    s_mov_b32 s69, 0xbfb8aa3b
    v_and_b32 v7, 15, v0
    v_bfe_u32 v9, v0, 4, 2
    v_bfe_u32 v10, v0, 1, 3
    v_xor_b32 v10, v10, v9
    v_lshlrev_b32 v10, 4, v10
    v_lshl_add_u32 v10, v7, 7, v10
    v_add_u32 v1, 131072, v10
    v_xor_b32 v2, 64, v1
    v_bfe_u32 v7, v0, 2, 2
    v_lshl_add_u32 v10, v9, 3, v7
    v_lshlrev_b32 v10, 8, v10
    v_xor_b32 v7, s52, v7
    v_lshl_add_u32 v10, v7, 6, v10
    v_bfe_u32 v7, v0, 4, 1
    v_lshl_add_u32 v10, v7, 5, v10
    v_and_b32 v7, 3, v0
    v_lshl_add_u32 v3, v7, 3, v10
    v_xor_b32 v4, 32, v3
    v_add_u32 v5, 0x10000, v3
    v_add_u32 v6, 0x10000, v4
    s_lshl_b32 s56, s54, 8
    s_lshl_b32 s57, s52, 6
    s_add_u32 s56, s56, s57
    v_lshlrev_b32 v9, 3, v9
    s_waitcnt lgkmcnt(0)
    s_mov_b64 s[28:29], s[84:85]
    s_mov_b64 s[32:33], s[86:87]
    s_mov_b64 s[24:25], s[88:89]
    s_mov_b64 s[20:21], s[90:91]
    s_mov_b64 s[36:37], s[92:93]
    s_mov_b64 s[40:41], s[94:95]
    s_mov_b64 s[44:45], s[96:97]
    s_mov_b64 s[48:49], s[98:99]
    s_mov_b32 s58, s56
    v_mov_b32 v32, 0
    v_mov_b32 v33, 0
    v_mov_b32 v34, 0
    v_mov_b32 v35, 0
    v_mov_b32 v36, 0
    v_mov_b32 v37, 0
    v_mov_b32 v38, 0
    v_mov_b32 v39, 0
    v_mov_b32 v40, 0
    v_mov_b32 v41, 0
    v_mov_b32 v42, 0
    v_mov_b32 v43, 0
    v_mov_b32 v44, 0
    v_mov_b32 v45, 0
    v_mov_b32 v46, 0
    v_mov_b32 v47, 0
    v_mov_b32 v48, 0
    v_mov_b32 v49, 0
    v_mov_b32 v50, 0
    v_mov_b32 v51, 0
    v_mov_b32 v52, 0
    v_mov_b32 v53, 0
    v_mov_b32 v54, 0
    v_mov_b32 v55, 0
    v_mov_b32 v56, 0
    v_mov_b32 v57, 0
    v_mov_b32 v58, 0
    v_mov_b32 v59, 0
    v_mov_b32 v60, 0
    v_mov_b32 v61, 0
    v_mov_b32 v62, 0
    v_mov_b32 v63, 0
    v_mov_b32 v12, s66
    v_mov_b32 v13, s66
    v_mov_b32 v14, s67
    v_mov_b32 v15, s67
    v_lshlrev_b32 v172, 3, v0
    s_lshl1_add_u32 s59, s53, s54
    s_lshl_b32 s59, s59, 9
    s_lshl_b32 s56, s52, 28
    s_add_u32 s59, s59, s56
    s_barrier
    ds_read_b64_tr_b16 v[128:129], v3 offset:0
    ds_read_b64_tr_b16 v[130:131], v3 offset:1024
    ds_read_b64_tr_b16 v[132:133], v4 offset:0
    ds_read_b64_tr_b16 v[134:135], v4 offset:1024
    ds_read_b128 v[64:67], v1 offset:0
    ds_read_b128 v[68:71], v1 offset:2048
    ds_read_b128 v[72:75], v1 offset:4096
    ds_read_b128 v[76:79], v1 offset:6144
    ds_read_b64_tr_b16 v[136:137], v3 offset:8192
    ds_read_b64_tr_b16 v[138:139], v3 offset:9216
    ds_read_b64_tr_b16 v[140:141], v4 offset:8192
    ds_read_b64_tr_b16 v[142:143], v4 offset:9216
    s_waitcnt lgkmcnt(7)
    v_mfma_f32_16x16x32_bf16 v[32:35], v[128:131], v[64:67], v[32:35]
    ds_read_b128 v[80:83], v2 offset:0
    v_mfma_f32_16x16x32_bf16 v[36:39], v[132:135], v[64:67], v[36:39]
    ds_read_b128 v[84:87], v2 offset:2048
    s_waitcnt lgkmcnt(8)
    v_mfma_f32_16x16x32_bf16 v[40:43], v[128:131], v[68:71], v[40:43]
    ds_read_b128 v[88:91], v2 offset:4096
    v_mfma_f32_16x16x32_bf16 v[44:47], v[132:135], v[68:71], v[44:47]
    ds_read_b128 v[92:95], v2 offset:6144
    s_waitcnt lgkmcnt(9)
    v_mfma_f32_16x16x32_bf16 v[48:51], v[128:131], v[72:75], v[48:51]
    v_mfma_f32_16x16x32_bf16 v[52:55], v[132:135], v[72:75], v[52:55]
    s_waitcnt lgkmcnt(8)
    v_mfma_f32_16x16x32_bf16 v[56:59], v[128:131], v[76:79], v[56:59]
    v_mfma_f32_16x16x32_bf16 v[60:63], v[132:135], v[76:79], v[60:63]
    s_waitcnt lgkmcnt(0)
    s_barrier
    ds_read_b64_tr_b16 v[144:145], v3 offset:16384
    ds_read_b64_tr_b16 v[146:147], v3 offset:17408
    ds_read_b64_tr_b16 v[148:149], v4 offset:16384
    ds_read_b64_tr_b16 v[150:151], v4 offset:17408
    ds_read_b128 v[96:99], v1 offset:8192
    v_mfma_f32_16x16x32_bf16 v[32:35], v[136:139], v[80:83], v[32:35]
    ds_read_b128 v[100:103], v1 offset:10240
    v_mfma_f32_16x16x32_bf16 v[36:39], v[140:143], v[80:83], v[36:39]
    ds_read_b128 v[104:107], v1 offset:12288
    v_mfma_f32_16x16x32_bf16 v[40:43], v[136:139], v[84:87], v[40:43]
    ds_read_b128 v[108:111], v1 offset:14336
    v_mfma_f32_16x16x32_bf16 v[44:47], v[140:143], v[84:87], v[44:47]
    v_mfma_f32_16x16x32_bf16 v[48:51], v[136:139], v[88:91], v[48:51]
    ds_read_b64_tr_b16 v[152:153], v3 offset:24576
    v_mfma_f32_16x16x32_bf16 v[52:55], v[140:143], v[88:91], v[52:55]
    ds_read_b64_tr_b16 v[154:155], v3 offset:25600
    v_mfma_f32_16x16x32_bf16 v[56:59], v[136:139], v[92:95], v[56:59]
    ds_read_b64_tr_b16 v[156:157], v4 offset:24576
    v_mfma_f32_16x16x32_bf16 v[60:63], v[140:143], v[92:95], v[60:63]
    ds_read_b64_tr_b16 v[158:159], v4 offset:25600
    s_waitcnt lgkmcnt(7)
    v_mfma_f32_16x16x32_bf16 v[32:35], v[144:147], v[96:99], v[32:35]
    ds_read_b128 v[112:115], v2 offset:8192
    v_mfma_f32_16x16x32_bf16 v[36:39], v[148:151], v[96:99], v[36:39]
    ds_read_b128 v[116:119], v2 offset:10240
    s_waitcnt lgkmcnt(8)
    v_mfma_f32_16x16x32_bf16 v[40:43], v[144:147], v[100:103], v[40:43]
    ds_read_b128 v[120:123], v2 offset:12288
    v_mfma_f32_16x16x32_bf16 v[44:47], v[148:151], v[100:103], v[44:47]
    ds_read_b128 v[124:127], v2 offset:14336
    s_waitcnt lgkmcnt(9)
    v_mfma_f32_16x16x32_bf16 v[48:51], v[144:147], v[104:107], v[48:51]
    v_mfma_f32_16x16x32_bf16 v[52:55], v[148:151], v[104:107], v[52:55]
    s_waitcnt lgkmcnt(8)
    v_mfma_f32_16x16x32_bf16 v[56:59], v[144:147], v[108:111], v[56:59]
    v_mfma_f32_16x16x32_bf16 v[60:63], v[148:151], v[108:111], v[60:63]
    s_waitcnt lgkmcnt(0)
    s_barrier
    ds_read_b64_tr_b16 v[128:129], v3 offset:32768
    ds_read_b64_tr_b16 v[130:131], v3 offset:33792
    ds_read_b64_tr_b16 v[132:133], v4 offset:32768
    ds_read_b64_tr_b16 v[134:135], v4 offset:33792
    ds_read_b128 v[64:67], v1 offset:16384
    v_mfma_f32_16x16x32_bf16 v[32:35], v[152:155], v[112:115], v[32:35]
    ds_read_b128 v[68:71], v1 offset:18432
    v_mfma_f32_16x16x32_bf16 v[36:39], v[156:159], v[112:115], v[36:39]
    ds_read_b128 v[72:75], v1 offset:20480
    v_mfma_f32_16x16x32_bf16 v[40:43], v[152:155], v[116:119], v[40:43]
    ds_read_b128 v[76:79], v1 offset:22528
    v_mfma_f32_16x16x32_bf16 v[44:47], v[156:159], v[116:119], v[44:47]
    v_mfma_f32_16x16x32_bf16 v[48:51], v[152:155], v[120:123], v[48:51]
    ds_read_b64_tr_b16 v[136:137], v3 offset:40960
    v_mfma_f32_16x16x32_bf16 v[52:55], v[156:159], v[120:123], v[52:55]
    ds_read_b64_tr_b16 v[138:139], v3 offset:41984
    v_mfma_f32_16x16x32_bf16 v[56:59], v[152:155], v[124:127], v[56:59]
    ds_read_b64_tr_b16 v[140:141], v4 offset:40960
    v_mfma_f32_16x16x32_bf16 v[60:63], v[156:159], v[124:127], v[60:63]
    ds_read_b64_tr_b16 v[142:143], v4 offset:41984
    s_waitcnt lgkmcnt(7)
    v_mfma_f32_16x16x32_bf16 v[32:35], v[128:131], v[64:67], v[32:35]
    ds_read_b128 v[80:83], v2 offset:16384
    v_mfma_f32_16x16x32_bf16 v[36:39], v[132:135], v[64:67], v[36:39]
    ds_read_b128 v[84:87], v2 offset:18432
    s_waitcnt lgkmcnt(8)
    v_mfma_f32_16x16x32_bf16 v[40:43], v[128:131], v[68:71], v[40:43]
    ds_read_b128 v[88:91], v2 offset:20480
    v_mfma_f32_16x16x32_bf16 v[44:47], v[132:135], v[68:71], v[44:47]
    ds_read_b128 v[92:95], v2 offset:22528
    s_waitcnt lgkmcnt(9)
    v_mfma_f32_16x16x32_bf16 v[48:51], v[128:131], v[72:75], v[48:51]
    v_mfma_f32_16x16x32_bf16 v[52:55], v[132:135], v[72:75], v[52:55]
    s_waitcnt lgkmcnt(8)
    v_mfma_f32_16x16x32_bf16 v[56:59], v[128:131], v[76:79], v[56:59]
    v_mfma_f32_16x16x32_bf16 v[60:63], v[132:135], v[76:79], v[60:63]
    s_waitcnt lgkmcnt(0)
    s_barrier
    ds_read_b64_tr_b16 v[144:145], v3 offset:49152
    ds_read_b64_tr_b16 v[146:147], v3 offset:50176
    ds_read_b64_tr_b16 v[148:149], v4 offset:49152
    ds_read_b64_tr_b16 v[150:151], v4 offset:50176
    ds_read_b128 v[96:99], v1 offset:24576
    v_mfma_f32_16x16x32_bf16 v[32:35], v[136:139], v[80:83], v[32:35]
    ds_read_b128 v[100:103], v1 offset:26624
    v_mfma_f32_16x16x32_bf16 v[36:39], v[140:143], v[80:83], v[36:39]
    ds_read_b128 v[104:107], v1 offset:28672
    v_mfma_f32_16x16x32_bf16 v[40:43], v[136:139], v[84:87], v[40:43]
    ds_read_b128 v[108:111], v1 offset:30720
    v_mfma_f32_16x16x32_bf16 v[44:47], v[140:143], v[84:87], v[44:47]
    v_mfma_f32_16x16x32_bf16 v[48:51], v[136:139], v[88:91], v[48:51]
    ds_read_b64_tr_b16 v[152:153], v3 offset:57344
    v_mfma_f32_16x16x32_bf16 v[52:55], v[140:143], v[88:91], v[52:55]
    ds_read_b64_tr_b16 v[154:155], v3 offset:58368
    v_mfma_f32_16x16x32_bf16 v[56:59], v[136:139], v[92:95], v[56:59]
    ds_read_b64_tr_b16 v[156:157], v4 offset:57344
    v_mfma_f32_16x16x32_bf16 v[60:63], v[140:143], v[92:95], v[60:63]
    ds_read_b64_tr_b16 v[158:159], v4 offset:58368
    s_waitcnt lgkmcnt(7)
    v_mfma_f32_16x16x32_bf16 v[32:35], v[144:147], v[96:99], v[32:35]
    ds_read_b128 v[112:115], v2 offset:24576
    v_mfma_f32_16x16x32_bf16 v[36:39], v[148:151], v[96:99], v[36:39]
    ds_read_b128 v[116:119], v2 offset:26624
    s_waitcnt lgkmcnt(8)
    v_mfma_f32_16x16x32_bf16 v[40:43], v[144:147], v[100:103], v[40:43]
    ds_read_b128 v[120:123], v2 offset:28672
    v_mfma_f32_16x16x32_bf16 v[44:47], v[148:151], v[100:103], v[44:47]
    ds_read_b128 v[124:127], v2 offset:30720
    s_waitcnt lgkmcnt(9)
    v_mfma_f32_16x16x32_bf16 v[48:51], v[144:147], v[104:107], v[48:51]
    v_mfma_f32_16x16x32_bf16 v[52:55], v[148:151], v[104:107], v[52:55]
    s_waitcnt lgkmcnt(8)
    v_mfma_f32_16x16x32_bf16 v[56:59], v[144:147], v[108:111], v[56:59]
    v_mfma_f32_16x16x32_bf16 v[60:63], v[148:151], v[108:111], v[60:63]
    s_waitcnt lgkmcnt(0)
    s_barrier
    ds_read_b64_tr_b16 v[128:129], v5 offset:0
    ds_read_b64_tr_b16 v[130:131], v5 offset:1024
    ds_read_b64_tr_b16 v[132:133], v6 offset:0
    ds_read_b64_tr_b16 v[134:135], v6 offset:1024
    ds_read_b128 v[64:67], v1 offset:0
    v_mfma_f32_16x16x32_bf16 v[32:35], v[152:155], v[112:115], v[32:35]
    ds_read_b128 v[68:71], v1 offset:2048
    v_mfma_f32_16x16x32_bf16 v[36:39], v[156:159], v[112:115], v[36:39]
    ds_read_b128 v[72:75], v1 offset:4096
    v_mfma_f32_16x16x32_bf16 v[40:43], v[152:155], v[116:119], v[40:43]
    ds_read_b128 v[76:79], v1 offset:6144
    v_mfma_f32_16x16x32_bf16 v[44:47], v[156:159], v[116:119], v[44:47]
    v_mfma_f32_16x16x32_bf16 v[48:51], v[152:155], v[120:123], v[48:51]
    ds_read_b64_tr_b16 v[136:137], v5 offset:8192
    v_mfma_f32_16x16x32_bf16 v[52:55], v[156:159], v[120:123], v[52:55]
    ds_read_b64_tr_b16 v[138:139], v5 offset:9216
    v_mfma_f32_16x16x32_bf16 v[56:59], v[152:155], v[124:127], v[56:59]
    ds_read_b64_tr_b16 v[140:141], v6 offset:8192
    v_mfma_f32_16x16x32_bf16 v[60:63], v[156:159], v[124:127], v[60:63]
    ds_read_b64_tr_b16 v[142:143], v6 offset:9216
    s_waitcnt lgkmcnt(7)
    v_mfma_f32_16x16x32_bf16 v[32:35], v[128:131], v[64:67], v[32:35]
    ds_read_b128 v[80:83], v2 offset:0
    v_mfma_f32_16x16x32_bf16 v[36:39], v[132:135], v[64:67], v[36:39]
    ds_read_b128 v[84:87], v2 offset:2048
    s_waitcnt lgkmcnt(8)
    v_mfma_f32_16x16x32_bf16 v[40:43], v[128:131], v[68:71], v[40:43]
    ds_read_b128 v[88:91], v2 offset:4096
    v_mfma_f32_16x16x32_bf16 v[44:47], v[132:135], v[68:71], v[44:47]
    ds_read_b128 v[92:95], v2 offset:6144
    s_waitcnt lgkmcnt(9)
    v_mfma_f32_16x16x32_bf16 v[48:51], v[128:131], v[72:75], v[48:51]
    v_mfma_f32_16x16x32_bf16 v[52:55], v[132:135], v[72:75], v[52:55]
    s_waitcnt lgkmcnt(8)
    v_mfma_f32_16x16x32_bf16 v[56:59], v[128:131], v[76:79], v[56:59]
    v_mfma_f32_16x16x32_bf16 v[60:63], v[132:135], v[76:79], v[60:63]
    s_waitcnt lgkmcnt(0)
    s_barrier
    ds_read_b64_tr_b16 v[144:145], v5 offset:16384
    ds_read_b64_tr_b16 v[146:147], v5 offset:17408
    ds_read_b64_tr_b16 v[148:149], v6 offset:16384
    ds_read_b64_tr_b16 v[150:151], v6 offset:17408
    ds_read_b128 v[96:99], v1 offset:8192
    v_mfma_f32_16x16x32_bf16 v[32:35], v[136:139], v[80:83], v[32:35]
    ds_read_b128 v[100:103], v1 offset:10240
    v_mfma_f32_16x16x32_bf16 v[36:39], v[140:143], v[80:83], v[36:39]
    ds_read_b128 v[104:107], v1 offset:12288
    v_mfma_f32_16x16x32_bf16 v[40:43], v[136:139], v[84:87], v[40:43]
    ds_read_b128 v[108:111], v1 offset:14336
    v_mfma_f32_16x16x32_bf16 v[44:47], v[140:143], v[84:87], v[44:47]
    v_mfma_f32_16x16x32_bf16 v[48:51], v[136:139], v[88:91], v[48:51]
    ds_read_b64_tr_b16 v[152:153], v5 offset:24576
    v_mfma_f32_16x16x32_bf16 v[52:55], v[140:143], v[88:91], v[52:55]
    ds_read_b64_tr_b16 v[154:155], v5 offset:25600
    v_mfma_f32_16x16x32_bf16 v[56:59], v[136:139], v[92:95], v[56:59]
    ds_read_b64_tr_b16 v[156:157], v6 offset:24576
    v_mfma_f32_16x16x32_bf16 v[60:63], v[140:143], v[92:95], v[60:63]
    ds_read_b64_tr_b16 v[158:159], v6 offset:25600
    s_waitcnt lgkmcnt(7)
    v_mfma_f32_16x16x32_bf16 v[32:35], v[144:147], v[96:99], v[32:35]
    ds_read_b128 v[112:115], v2 offset:8192
    v_mfma_f32_16x16x32_bf16 v[36:39], v[148:151], v[96:99], v[36:39]
    ds_read_b128 v[116:119], v2 offset:10240
    s_waitcnt lgkmcnt(8)
    v_mfma_f32_16x16x32_bf16 v[40:43], v[144:147], v[100:103], v[40:43]
    ds_read_b128 v[120:123], v2 offset:12288
    v_mfma_f32_16x16x32_bf16 v[44:47], v[148:151], v[100:103], v[44:47]
    ds_read_b128 v[124:127], v2 offset:14336
    s_waitcnt lgkmcnt(9)
    v_mfma_f32_16x16x32_bf16 v[48:51], v[144:147], v[104:107], v[48:51]
    v_mfma_f32_16x16x32_bf16 v[52:55], v[148:151], v[104:107], v[52:55]
    s_waitcnt lgkmcnt(8)
    v_mfma_f32_16x16x32_bf16 v[56:59], v[144:147], v[108:111], v[56:59]
    v_mfma_f32_16x16x32_bf16 v[60:63], v[148:151], v[108:111], v[60:63]
    s_waitcnt lgkmcnt(0)
    s_barrier
    ds_read_b64_tr_b16 v[128:129], v5 offset:32768
    ds_read_b64_tr_b16 v[130:131], v5 offset:33792
    ds_read_b64_tr_b16 v[132:133], v6 offset:32768
    ds_read_b64_tr_b16 v[134:135], v6 offset:33792
    ds_read_b128 v[64:67], v1 offset:16384
    v_mfma_f32_16x16x32_bf16 v[32:35], v[152:155], v[112:115], v[32:35]
    ds_read_b128 v[68:71], v1 offset:18432
    v_mfma_f32_16x16x32_bf16 v[36:39], v[156:159], v[112:115], v[36:39]
    ds_read_b128 v[72:75], v1 offset:20480
    v_mfma_f32_16x16x32_bf16 v[40:43], v[152:155], v[116:119], v[40:43]
    ds_read_b128 v[76:79], v1 offset:22528
    v_mfma_f32_16x16x32_bf16 v[44:47], v[156:159], v[116:119], v[44:47]
    v_mfma_f32_16x16x32_bf16 v[48:51], v[152:155], v[120:123], v[48:51]
    ds_read_b64_tr_b16 v[136:137], v5 offset:40960
    v_mfma_f32_16x16x32_bf16 v[52:55], v[156:159], v[120:123], v[52:55]
    ds_read_b64_tr_b16 v[138:139], v5 offset:41984
    v_mfma_f32_16x16x32_bf16 v[56:59], v[152:155], v[124:127], v[56:59]
    ds_read_b64_tr_b16 v[140:141], v6 offset:40960
    v_mfma_f32_16x16x32_bf16 v[60:63], v[156:159], v[124:127], v[60:63]
    ds_read_b64_tr_b16 v[142:143], v6 offset:41984
    s_waitcnt lgkmcnt(7)
    v_mfma_f32_16x16x32_bf16 v[32:35], v[128:131], v[64:67], v[32:35]
    ds_read_b128 v[80:83], v2 offset:16384
    v_mfma_f32_16x16x32_bf16 v[36:39], v[132:135], v[64:67], v[36:39]
    ds_read_b128 v[84:87], v2 offset:18432
    s_waitcnt lgkmcnt(8)
    v_mfma_f32_16x16x32_bf16 v[40:43], v[128:131], v[68:71], v[40:43]
    ds_read_b128 v[88:91], v2 offset:20480
    v_mfma_f32_16x16x32_bf16 v[44:47], v[132:135], v[68:71], v[44:47]
    ds_read_b128 v[92:95], v2 offset:22528
    s_waitcnt lgkmcnt(9)
    v_mfma_f32_16x16x32_bf16 v[48:51], v[128:131], v[72:75], v[48:51]
    v_mfma_f32_16x16x32_bf16 v[52:55], v[132:135], v[72:75], v[52:55]
    s_waitcnt lgkmcnt(8)
    v_mfma_f32_16x16x32_bf16 v[56:59], v[128:131], v[76:79], v[56:59]
    v_mfma_f32_16x16x32_bf16 v[60:63], v[132:135], v[76:79], v[60:63]
    s_waitcnt lgkmcnt(0)
    s_barrier
    ds_read_b64_tr_b16 v[144:145], v5 offset:49152
    ds_read_b64_tr_b16 v[146:147], v5 offset:50176
    ds_read_b64_tr_b16 v[148:149], v6 offset:49152
    ds_read_b64_tr_b16 v[150:151], v6 offset:50176
    ds_read_b128 v[96:99], v1 offset:24576
    v_mfma_f32_16x16x32_bf16 v[32:35], v[136:139], v[80:83], v[32:35]
    ds_read_b128 v[100:103], v1 offset:26624
    v_mfma_f32_16x16x32_bf16 v[36:39], v[140:143], v[80:83], v[36:39]
    ds_read_b128 v[104:107], v1 offset:28672
    v_mfma_f32_16x16x32_bf16 v[40:43], v[136:139], v[84:87], v[40:43]
    ds_read_b128 v[108:111], v1 offset:30720
    v_mfma_f32_16x16x32_bf16 v[44:47], v[140:143], v[84:87], v[44:47]
    v_mfma_f32_16x16x32_bf16 v[48:51], v[136:139], v[88:91], v[48:51]
    ds_read_b64_tr_b16 v[152:153], v5 offset:57344
    v_mfma_f32_16x16x32_bf16 v[52:55], v[140:143], v[88:91], v[52:55]
    ds_read_b64_tr_b16 v[154:155], v5 offset:58368
    v_mfma_f32_16x16x32_bf16 v[56:59], v[136:139], v[92:95], v[56:59]
    ds_read_b64_tr_b16 v[156:157], v6 offset:57344
    v_mfma_f32_16x16x32_bf16 v[60:63], v[140:143], v[92:95], v[60:63]
    ds_read_b64_tr_b16 v[158:159], v6 offset:58368
    s_waitcnt lgkmcnt(7)
    v_mfma_f32_16x16x32_bf16 v[32:35], v[144:147], v[96:99], v[32:35]
    ds_read_b128 v[112:115], v2 offset:24576
    v_mfma_f32_16x16x32_bf16 v[36:39], v[148:151], v[96:99], v[36:39]
    ds_read_b128 v[116:119], v2 offset:26624
    s_waitcnt lgkmcnt(8)
    v_mfma_f32_16x16x32_bf16 v[40:43], v[144:147], v[100:103], v[40:43]
    ds_read_b128 v[120:123], v2 offset:28672
    v_mfma_f32_16x16x32_bf16 v[44:47], v[148:151], v[100:103], v[44:47]
    ds_read_b128 v[124:127], v2 offset:30720
    s_waitcnt lgkmcnt(9)
    v_mfma_f32_16x16x32_bf16 v[48:51], v[144:147], v[104:107], v[48:51]
    v_mfma_f32_16x16x32_bf16 v[52:55], v[148:151], v[104:107], v[52:55]
    s_waitcnt lgkmcnt(8)
    v_mfma_f32_16x16x32_bf16 v[56:59], v[144:147], v[108:111], v[56:59]
    v_mfma_f32_16x16x32_bf16 v[60:63], v[148:151], v[108:111], v[60:63]
    s_waitcnt lgkmcnt(0)
    s_barrier
    ds_read_b64_tr_b16 v[128:129], v3 offset:0
    ds_read_b64_tr_b16 v[130:131], v3 offset:1024
    ds_read_b64_tr_b16 v[132:133], v4 offset:0
    ds_read_b64_tr_b16 v[134:135], v4 offset:1024
    ds_read_b128 v[64:67], v1 offset:0
    v_mfma_f32_16x16x32_bf16 v[32:35], v[152:155], v[112:115], v[32:35]
    ds_read_b128 v[68:71], v1 offset:2048
    v_mfma_f32_16x16x32_bf16 v[36:39], v[156:159], v[112:115], v[36:39]
    ds_read_b128 v[72:75], v1 offset:4096
    v_mfma_f32_16x16x32_bf16 v[40:43], v[152:155], v[116:119], v[40:43]
    ds_read_b128 v[76:79], v1 offset:6144
    v_mfma_f32_16x16x32_bf16 v[44:47], v[156:159], v[116:119], v[44:47]
    v_mfma_f32_16x16x32_bf16 v[48:51], v[152:155], v[120:123], v[48:51]
    ds_read_b64_tr_b16 v[136:137], v3 offset:8192
    v_mfma_f32_16x16x32_bf16 v[52:55], v[156:159], v[120:123], v[52:55]
    ds_read_b64_tr_b16 v[138:139], v3 offset:9216
    v_mfma_f32_16x16x32_bf16 v[56:59], v[152:155], v[124:127], v[56:59]
    ds_read_b64_tr_b16 v[140:141], v4 offset:8192
    v_mfma_f32_16x16x32_bf16 v[60:63], v[156:159], v[124:127], v[60:63]
    ds_read_b64_tr_b16 v[142:143], v4 offset:9216
    s_waitcnt lgkmcnt(7)
    v_mfma_f32_16x16x32_bf16 v[32:35], v[128:131], v[64:67], v[32:35]
    ds_read_b128 v[80:83], v2 offset:0
    v_mfma_f32_16x16x32_bf16 v[36:39], v[132:135], v[64:67], v[36:39]
    ds_read_b128 v[84:87], v2 offset:2048
    s_waitcnt lgkmcnt(8)
    v_mfma_f32_16x16x32_bf16 v[40:43], v[128:131], v[68:71], v[40:43]
    ds_read_b128 v[88:91], v2 offset:4096
    v_mfma_f32_16x16x32_bf16 v[44:47], v[132:135], v[68:71], v[44:47]
    ds_read_b128 v[92:95], v2 offset:6144
    s_waitcnt lgkmcnt(9)
    v_mfma_f32_16x16x32_bf16 v[48:51], v[128:131], v[72:75], v[48:51]
    v_mfma_f32_16x16x32_bf16 v[52:55], v[132:135], v[72:75], v[52:55]
    s_waitcnt lgkmcnt(8)
    v_mfma_f32_16x16x32_bf16 v[56:59], v[128:131], v[76:79], v[56:59]
    v_mfma_f32_16x16x32_bf16 v[60:63], v[132:135], v[76:79], v[60:63]
    s_waitcnt lgkmcnt(0)
    s_barrier
    ds_read_b64_tr_b16 v[144:145], v3 offset:16384
    ds_read_b64_tr_b16 v[146:147], v3 offset:17408
    ds_read_b64_tr_b16 v[148:149], v4 offset:16384
    ds_read_b64_tr_b16 v[150:151], v4 offset:17408
    ds_read_b128 v[96:99], v1 offset:8192
    v_mfma_f32_16x16x32_bf16 v[32:35], v[136:139], v[80:83], v[32:35]
    ds_read_b128 v[100:103], v1 offset:10240
    v_mfma_f32_16x16x32_bf16 v[36:39], v[140:143], v[80:83], v[36:39]
    ds_read_b128 v[104:107], v1 offset:12288
    v_mfma_f32_16x16x32_bf16 v[40:43], v[136:139], v[84:87], v[40:43]
    ds_read_b128 v[108:111], v1 offset:14336
    v_mfma_f32_16x16x32_bf16 v[44:47], v[140:143], v[84:87], v[44:47]
    v_mfma_f32_16x16x32_bf16 v[48:51], v[136:139], v[88:91], v[48:51]
    ds_read_b64_tr_b16 v[152:153], v3 offset:24576
    v_mfma_f32_16x16x32_bf16 v[52:55], v[140:143], v[88:91], v[52:55]
    ds_read_b64_tr_b16 v[154:155], v3 offset:25600
    v_mfma_f32_16x16x32_bf16 v[56:59], v[136:139], v[92:95], v[56:59]
    ds_read_b64_tr_b16 v[156:157], v4 offset:24576
    v_mfma_f32_16x16x32_bf16 v[60:63], v[140:143], v[92:95], v[60:63]
    ds_read_b64_tr_b16 v[158:159], v4 offset:25600
    s_waitcnt lgkmcnt(7)
    v_mfma_f32_16x16x32_bf16 v[32:35], v[144:147], v[96:99], v[32:35]
    ds_read_b128 v[112:115], v2 offset:8192
    v_mfma_f32_16x16x32_bf16 v[36:39], v[148:151], v[96:99], v[36:39]
    ds_read_b128 v[116:119], v2 offset:10240
    s_waitcnt lgkmcnt(8)
    v_mfma_f32_16x16x32_bf16 v[40:43], v[144:147], v[100:103], v[40:43]
    ds_read_b128 v[120:123], v2 offset:12288
    v_mfma_f32_16x16x32_bf16 v[44:47], v[148:151], v[100:103], v[44:47]
    ds_read_b128 v[124:127], v2 offset:14336
    s_waitcnt lgkmcnt(9)
    v_mfma_f32_16x16x32_bf16 v[48:51], v[144:147], v[104:107], v[48:51]
    v_mfma_f32_16x16x32_bf16 v[52:55], v[148:151], v[104:107], v[52:55]
    s_waitcnt lgkmcnt(8)
    v_mfma_f32_16x16x32_bf16 v[56:59], v[144:147], v[108:111], v[56:59]
    v_mfma_f32_16x16x32_bf16 v[60:63], v[148:151], v[108:111], v[60:63]
    s_waitcnt lgkmcnt(0)
    s_barrier
    ds_read_b64_tr_b16 v[128:129], v3 offset:32768
    ds_read_b64_tr_b16 v[130:131], v3 offset:33792
    ds_read_b64_tr_b16 v[132:133], v4 offset:32768
    ds_read_b64_tr_b16 v[134:135], v4 offset:33792
    ds_read_b128 v[64:67], v1 offset:16384
    v_mfma_f32_16x16x32_bf16 v[32:35], v[152:155], v[112:115], v[32:35]
    ds_read_b128 v[68:71], v1 offset:18432
    v_mfma_f32_16x16x32_bf16 v[36:39], v[156:159], v[112:115], v[36:39]
    ds_read_b128 v[72:75], v1 offset:20480
    v_mfma_f32_16x16x32_bf16 v[40:43], v[152:155], v[116:119], v[40:43]
    ds_read_b128 v[76:79], v1 offset:22528
    v_mfma_f32_16x16x32_bf16 v[44:47], v[156:159], v[116:119], v[44:47]
    v_mfma_f32_16x16x32_bf16 v[48:51], v[152:155], v[120:123], v[48:51]
    ds_read_b64_tr_b16 v[136:137], v3 offset:40960
    v_mfma_f32_16x16x32_bf16 v[52:55], v[156:159], v[120:123], v[52:55]
    ds_read_b64_tr_b16 v[138:139], v3 offset:41984
    v_mfma_f32_16x16x32_bf16 v[56:59], v[152:155], v[124:127], v[56:59]
    ds_read_b64_tr_b16 v[140:141], v4 offset:40960
    v_mfma_f32_16x16x32_bf16 v[60:63], v[156:159], v[124:127], v[60:63]
    ds_read_b64_tr_b16 v[142:143], v4 offset:41984
    s_waitcnt lgkmcnt(7)
    v_mfma_f32_16x16x32_bf16 v[32:35], v[128:131], v[64:67], v[32:35]
    ds_read_b128 v[80:83], v2 offset:16384
    v_mfma_f32_16x16x32_bf16 v[36:39], v[132:135], v[64:67], v[36:39]
    ds_read_b128 v[84:87], v2 offset:18432
    s_waitcnt lgkmcnt(8)
    v_mfma_f32_16x16x32_bf16 v[40:43], v[128:131], v[68:71], v[40:43]
    ds_read_b128 v[88:91], v2 offset:20480
    v_mfma_f32_16x16x32_bf16 v[44:47], v[132:135], v[68:71], v[44:47]
    ds_read_b128 v[92:95], v2 offset:22528
    s_waitcnt lgkmcnt(9)
    v_mfma_f32_16x16x32_bf16 v[48:51], v[128:131], v[72:75], v[48:51]
    v_mfma_f32_16x16x32_bf16 v[52:55], v[132:135], v[72:75], v[52:55]
    s_waitcnt lgkmcnt(8)
    v_mfma_f32_16x16x32_bf16 v[56:59], v[128:131], v[76:79], v[56:59]
    v_mfma_f32_16x16x32_bf16 v[60:63], v[132:135], v[76:79], v[60:63]
    s_waitcnt lgkmcnt(0)
    s_barrier
    ds_read_b64_tr_b16 v[144:145], v3 offset:49152
    ds_read_b64_tr_b16 v[146:147], v3 offset:50176
    ds_read_b64_tr_b16 v[148:149], v4 offset:49152
    ds_read_b64_tr_b16 v[150:151], v4 offset:50176
    ds_read_b128 v[96:99], v1 offset:24576
    v_mfma_f32_16x16x32_bf16 v[32:35], v[136:139], v[80:83], v[32:35]
    ds_read_b128 v[100:103], v1 offset:26624
    v_mfma_f32_16x16x32_bf16 v[36:39], v[140:143], v[80:83], v[36:39]
    ds_read_b128 v[104:107], v1 offset:28672
    v_mfma_f32_16x16x32_bf16 v[40:43], v[136:139], v[84:87], v[40:43]
    ds_read_b128 v[108:111], v1 offset:30720
    v_mfma_f32_16x16x32_bf16 v[44:47], v[140:143], v[84:87], v[44:47]
    v_mfma_f32_16x16x32_bf16 v[48:51], v[136:139], v[88:91], v[48:51]
    ds_read_b64_tr_b16 v[152:153], v3 offset:57344
    v_mfma_f32_16x16x32_bf16 v[52:55], v[140:143], v[88:91], v[52:55]
    ds_read_b64_tr_b16 v[154:155], v3 offset:58368
    v_mfma_f32_16x16x32_bf16 v[56:59], v[136:139], v[92:95], v[56:59]
    ds_read_b64_tr_b16 v[156:157], v4 offset:57344
    v_mfma_f32_16x16x32_bf16 v[60:63], v[140:143], v[92:95], v[60:63]
    ds_read_b64_tr_b16 v[158:159], v4 offset:58368
    s_waitcnt lgkmcnt(7)
    v_mfma_f32_16x16x32_bf16 v[32:35], v[144:147], v[96:99], v[32:35]
    ds_read_b128 v[112:115], v2 offset:24576
    v_mfma_f32_16x16x32_bf16 v[36:39], v[148:151], v[96:99], v[36:39]
    ds_read_b128 v[116:119], v2 offset:26624
    s_waitcnt lgkmcnt(8)
    v_mfma_f32_16x16x32_bf16 v[40:43], v[144:147], v[100:103], v[40:43]
    ds_read_b128 v[120:123], v2 offset:28672
    v_mfma_f32_16x16x32_bf16 v[44:47], v[148:151], v[100:103], v[44:47]
    ds_read_b128 v[124:127], v2 offset:30720
    s_waitcnt lgkmcnt(9)
    v_mfma_f32_16x16x32_bf16 v[48:51], v[144:147], v[104:107], v[48:51]
    v_mfma_f32_16x16x32_bf16 v[52:55], v[148:151], v[104:107], v[52:55]
    s_waitcnt lgkmcnt(8)
    v_mfma_f32_16x16x32_bf16 v[56:59], v[144:147], v[108:111], v[56:59]
    v_mfma_f32_16x16x32_bf16 v[60:63], v[148:151], v[108:111], v[60:63]
    s_waitcnt lgkmcnt(0)
    s_barrier
    ds_read_b64_tr_b16 v[128:129], v5 offset:0
    ds_read_b64_tr_b16 v[130:131], v5 offset:1024
    ds_read_b64_tr_b16 v[132:133], v6 offset:0
    ds_read_b64_tr_b16 v[134:135], v6 offset:1024
    ds_read_b128 v[64:67], v1 offset:0
    v_mfma_f32_16x16x32_bf16 v[32:35], v[152:155], v[112:115], v[32:35]
    ds_read_b128 v[68:71], v1 offset:2048
    v_mfma_f32_16x16x32_bf16 v[36:39], v[156:159], v[112:115], v[36:39]
    ds_read_b128 v[72:75], v1 offset:4096
    v_mfma_f32_16x16x32_bf16 v[40:43], v[152:155], v[116:119], v[40:43]
    ds_read_b128 v[76:79], v1 offset:6144
    v_mfma_f32_16x16x32_bf16 v[44:47], v[156:159], v[116:119], v[44:47]
    v_mfma_f32_16x16x32_bf16 v[48:51], v[152:155], v[120:123], v[48:51]
    ds_read_b64_tr_b16 v[136:137], v5 offset:8192
    v_mfma_f32_16x16x32_bf16 v[52:55], v[156:159], v[120:123], v[52:55]
    ds_read_b64_tr_b16 v[138:139], v5 offset:9216
    v_mfma_f32_16x16x32_bf16 v[56:59], v[152:155], v[124:127], v[56:59]
    ds_read_b64_tr_b16 v[140:141], v6 offset:8192
    v_mfma_f32_16x16x32_bf16 v[60:63], v[156:159], v[124:127], v[60:63]
    ds_read_b64_tr_b16 v[142:143], v6 offset:9216
    s_waitcnt lgkmcnt(7)
    v_mfma_f32_16x16x32_bf16 v[32:35], v[128:131], v[64:67], v[32:35]
    ds_read_b128 v[80:83], v2 offset:0
    v_mfma_f32_16x16x32_bf16 v[36:39], v[132:135], v[64:67], v[36:39]
    ds_read_b128 v[84:87], v2 offset:2048
    s_waitcnt lgkmcnt(8)
    v_mfma_f32_16x16x32_bf16 v[40:43], v[128:131], v[68:71], v[40:43]
    ds_read_b128 v[88:91], v2 offset:4096
    v_mfma_f32_16x16x32_bf16 v[44:47], v[132:135], v[68:71], v[44:47]
    ds_read_b128 v[92:95], v2 offset:6144
    s_waitcnt lgkmcnt(9)
    v_mfma_f32_16x16x32_bf16 v[48:51], v[128:131], v[72:75], v[48:51]
    v_mfma_f32_16x16x32_bf16 v[52:55], v[132:135], v[72:75], v[52:55]
    s_waitcnt lgkmcnt(8)
    v_mfma_f32_16x16x32_bf16 v[56:59], v[128:131], v[76:79], v[56:59]
    v_mfma_f32_16x16x32_bf16 v[60:63], v[132:135], v[76:79], v[60:63]
    s_waitcnt lgkmcnt(0)
    s_barrier
    ds_read_b64_tr_b16 v[144:145], v5 offset:16384
    ds_read_b64_tr_b16 v[146:147], v5 offset:17408
    ds_read_b64_tr_b16 v[148:149], v6 offset:16384
    ds_read_b64_tr_b16 v[150:151], v6 offset:17408
    ds_read_b128 v[96:99], v1 offset:8192
    v_mfma_f32_16x16x32_bf16 v[32:35], v[136:139], v[80:83], v[32:35]
    ds_read_b128 v[100:103], v1 offset:10240
    v_mfma_f32_16x16x32_bf16 v[36:39], v[140:143], v[80:83], v[36:39]
    ds_read_b128 v[104:107], v1 offset:12288
    v_mfma_f32_16x16x32_bf16 v[40:43], v[136:139], v[84:87], v[40:43]
    ds_read_b128 v[108:111], v1 offset:14336
    v_mfma_f32_16x16x32_bf16 v[44:47], v[140:143], v[84:87], v[44:47]
    v_mfma_f32_16x16x32_bf16 v[48:51], v[136:139], v[88:91], v[48:51]
    ds_read_b64_tr_b16 v[152:153], v5 offset:24576
    v_mfma_f32_16x16x32_bf16 v[52:55], v[140:143], v[88:91], v[52:55]
    ds_read_b64_tr_b16 v[154:155], v5 offset:25600
    v_mfma_f32_16x16x32_bf16 v[56:59], v[136:139], v[92:95], v[56:59]
    ds_read_b64_tr_b16 v[156:157], v6 offset:24576
    v_mfma_f32_16x16x32_bf16 v[60:63], v[140:143], v[92:95], v[60:63]
    ds_read_b64_tr_b16 v[158:159], v6 offset:25600
    s_waitcnt lgkmcnt(7)
    v_mfma_f32_16x16x32_bf16 v[32:35], v[144:147], v[96:99], v[32:35]
    ds_read_b128 v[112:115], v2 offset:8192
    v_mfma_f32_16x16x32_bf16 v[36:39], v[148:151], v[96:99], v[36:39]
    ds_read_b128 v[116:119], v2 offset:10240
    s_waitcnt lgkmcnt(8)
    v_mfma_f32_16x16x32_bf16 v[40:43], v[144:147], v[100:103], v[40:43]
    ds_read_b128 v[120:123], v2 offset:12288
    v_mfma_f32_16x16x32_bf16 v[44:47], v[148:151], v[100:103], v[44:47]
    ds_read_b128 v[124:127], v2 offset:14336
    s_waitcnt lgkmcnt(9)
    v_mfma_f32_16x16x32_bf16 v[48:51], v[144:147], v[104:107], v[48:51]
    v_mfma_f32_16x16x32_bf16 v[52:55], v[148:151], v[104:107], v[52:55]
    s_waitcnt lgkmcnt(8)
    v_mfma_f32_16x16x32_bf16 v[56:59], v[144:147], v[108:111], v[56:59]
    v_mfma_f32_16x16x32_bf16 v[60:63], v[148:151], v[108:111], v[60:63]
    s_waitcnt lgkmcnt(0)
    s_barrier
    ds_read_b64_tr_b16 v[128:129], v5 offset:32768
    ds_read_b64_tr_b16 v[130:131], v5 offset:33792
    ds_read_b64_tr_b16 v[132:133], v6 offset:32768
    ds_read_b64_tr_b16 v[134:135], v6 offset:33792
    ds_read_b128 v[64:67], v1 offset:16384
    v_mfma_f32_16x16x32_bf16 v[32:35], v[152:155], v[112:115], v[32:35]
    ds_read_b128 v[68:71], v1 offset:18432
    v_mfma_f32_16x16x32_bf16 v[36:39], v[156:159], v[112:115], v[36:39]
    ds_read_b128 v[72:75], v1 offset:20480
    v_mfma_f32_16x16x32_bf16 v[40:43], v[152:155], v[116:119], v[40:43]
    ds_read_b128 v[76:79], v1 offset:22528
    v_mfma_f32_16x16x32_bf16 v[44:47], v[156:159], v[116:119], v[44:47]
    v_mfma_f32_16x16x32_bf16 v[48:51], v[152:155], v[120:123], v[48:51]
    ds_read_b64_tr_b16 v[136:137], v5 offset:40960
    v_mfma_f32_16x16x32_bf16 v[52:55], v[156:159], v[120:123], v[52:55]
    ds_read_b64_tr_b16 v[138:139], v5 offset:41984
    v_mfma_f32_16x16x32_bf16 v[56:59], v[152:155], v[124:127], v[56:59]
    ds_read_b64_tr_b16 v[140:141], v6 offset:40960
    v_mfma_f32_16x16x32_bf16 v[60:63], v[156:159], v[124:127], v[60:63]
    ds_read_b64_tr_b16 v[142:143], v6 offset:41984
    s_waitcnt lgkmcnt(7)
    v_mfma_f32_16x16x32_bf16 v[32:35], v[128:131], v[64:67], v[32:35]
    ds_read_b128 v[80:83], v2 offset:16384
    v_mfma_f32_16x16x32_bf16 v[36:39], v[132:135], v[64:67], v[36:39]
    ds_read_b128 v[84:87], v2 offset:18432
    s_waitcnt lgkmcnt(8)
    v_mfma_f32_16x16x32_bf16 v[40:43], v[128:131], v[68:71], v[40:43]
    ds_read_b128 v[88:91], v2 offset:20480
    v_mfma_f32_16x16x32_bf16 v[44:47], v[132:135], v[68:71], v[44:47]
    ds_read_b128 v[92:95], v2 offset:22528
    s_waitcnt lgkmcnt(9)
    v_mfma_f32_16x16x32_bf16 v[48:51], v[128:131], v[72:75], v[48:51]
    v_mfma_f32_16x16x32_bf16 v[52:55], v[132:135], v[72:75], v[52:55]
    s_waitcnt lgkmcnt(8)
    v_mfma_f32_16x16x32_bf16 v[56:59], v[128:131], v[76:79], v[56:59]
    v_mfma_f32_16x16x32_bf16 v[60:63], v[132:135], v[76:79], v[60:63]
    s_waitcnt lgkmcnt(0)
    s_barrier
    ds_read_b64_tr_b16 v[144:145], v5 offset:49152
    ds_read_b64_tr_b16 v[146:147], v5 offset:50176
    ds_read_b64_tr_b16 v[148:149], v6 offset:49152
    ds_read_b64_tr_b16 v[150:151], v6 offset:50176
    ds_read_b128 v[96:99], v1 offset:24576
    v_mfma_f32_16x16x32_bf16 v[32:35], v[136:139], v[80:83], v[32:35]
    ds_read_b128 v[100:103], v1 offset:26624
    v_mfma_f32_16x16x32_bf16 v[36:39], v[140:143], v[80:83], v[36:39]
    ds_read_b128 v[104:107], v1 offset:28672
    v_mfma_f32_16x16x32_bf16 v[40:43], v[136:139], v[84:87], v[40:43]
    ds_read_b128 v[108:111], v1 offset:30720
    v_mfma_f32_16x16x32_bf16 v[44:47], v[140:143], v[84:87], v[44:47]
    v_mfma_f32_16x16x32_bf16 v[48:51], v[136:139], v[88:91], v[48:51]
    ds_read_b64_tr_b16 v[152:153], v5 offset:57344
    v_mfma_f32_16x16x32_bf16 v[52:55], v[140:143], v[88:91], v[52:55]
    ds_read_b64_tr_b16 v[154:155], v5 offset:58368
    v_mfma_f32_16x16x32_bf16 v[56:59], v[136:139], v[92:95], v[56:59]
    ds_read_b64_tr_b16 v[156:157], v6 offset:57344
    v_mfma_f32_16x16x32_bf16 v[60:63], v[140:143], v[92:95], v[60:63]
    ds_read_b64_tr_b16 v[158:159], v6 offset:58368
    s_waitcnt lgkmcnt(7)
    v_mfma_f32_16x16x32_bf16 v[32:35], v[144:147], v[96:99], v[32:35]
    ds_read_b128 v[112:115], v2 offset:24576
    v_mfma_f32_16x16x32_bf16 v[36:39], v[148:151], v[96:99], v[36:39]
    ds_read_b128 v[116:119], v2 offset:26624
    s_waitcnt lgkmcnt(8)
    v_mfma_f32_16x16x32_bf16 v[40:43], v[144:147], v[100:103], v[40:43]
    ds_read_b128 v[120:123], v2 offset:28672
    v_mfma_f32_16x16x32_bf16 v[44:47], v[148:151], v[100:103], v[44:47]
    ds_read_b128 v[124:127], v2 offset:30720
    s_waitcnt lgkmcnt(9)
    v_mfma_f32_16x16x32_bf16 v[48:51], v[144:147], v[104:107], v[48:51]
    v_mfma_f32_16x16x32_bf16 v[52:55], v[148:151], v[104:107], v[52:55]
    s_waitcnt lgkmcnt(8)
    v_mfma_f32_16x16x32_bf16 v[56:59], v[144:147], v[108:111], v[56:59]
    v_mfma_f32_16x16x32_bf16 v[60:63], v[148:151], v[108:111], v[60:63]
    s_waitcnt lgkmcnt(0)
    s_barrier
    ds_read_b64_tr_b16 v[128:129], v3 offset:0
    ds_read_b64_tr_b16 v[130:131], v3 offset:1024
    ds_read_b64_tr_b16 v[132:133], v4 offset:0
    ds_read_b64_tr_b16 v[134:135], v4 offset:1024
    ds_read_b128 v[64:67], v1 offset:0
    v_mfma_f32_16x16x32_bf16 v[32:35], v[152:155], v[112:115], v[32:35]
    ds_read_b128 v[68:71], v1 offset:2048
    v_mfma_f32_16x16x32_bf16 v[36:39], v[156:159], v[112:115], v[36:39]
    ds_read_b128 v[72:75], v1 offset:4096
    v_mfma_f32_16x16x32_bf16 v[40:43], v[152:155], v[116:119], v[40:43]
    ds_read_b128 v[76:79], v1 offset:6144
    v_mfma_f32_16x16x32_bf16 v[44:47], v[156:159], v[116:119], v[44:47]
    v_mfma_f32_16x16x32_bf16 v[48:51], v[152:155], v[120:123], v[48:51]
    ds_read_b64_tr_b16 v[136:137], v3 offset:8192
    v_mfma_f32_16x16x32_bf16 v[52:55], v[156:159], v[120:123], v[52:55]
    ds_read_b64_tr_b16 v[138:139], v3 offset:9216
    v_mfma_f32_16x16x32_bf16 v[56:59], v[152:155], v[124:127], v[56:59]
    ds_read_b64_tr_b16 v[140:141], v4 offset:8192
    v_mfma_f32_16x16x32_bf16 v[60:63], v[156:159], v[124:127], v[60:63]
    ds_read_b64_tr_b16 v[142:143], v4 offset:9216
    s_waitcnt lgkmcnt(7)
    v_mfma_f32_16x16x32_bf16 v[32:35], v[128:131], v[64:67], v[32:35]
    ds_read_b128 v[80:83], v2 offset:0
    v_mfma_f32_16x16x32_bf16 v[36:39], v[132:135], v[64:67], v[36:39]
    ds_read_b128 v[84:87], v2 offset:2048
    s_waitcnt lgkmcnt(8)
    v_mfma_f32_16x16x32_bf16 v[40:43], v[128:131], v[68:71], v[40:43]
    ds_read_b128 v[88:91], v2 offset:4096
    v_mfma_f32_16x16x32_bf16 v[44:47], v[132:135], v[68:71], v[44:47]
    ds_read_b128 v[92:95], v2 offset:6144
    s_waitcnt lgkmcnt(9)
    v_mfma_f32_16x16x32_bf16 v[48:51], v[128:131], v[72:75], v[48:51]
    v_mfma_f32_16x16x32_bf16 v[52:55], v[132:135], v[72:75], v[52:55]
    s_waitcnt lgkmcnt(8)
    v_mfma_f32_16x16x32_bf16 v[56:59], v[128:131], v[76:79], v[56:59]
    v_mfma_f32_16x16x32_bf16 v[60:63], v[132:135], v[76:79], v[60:63]
    s_waitcnt lgkmcnt(0)
    s_barrier
    ds_read_b64_tr_b16 v[144:145], v3 offset:16384
    ds_read_b64_tr_b16 v[146:147], v3 offset:17408
    ds_read_b64_tr_b16 v[148:149], v4 offset:16384
    ds_read_b64_tr_b16 v[150:151], v4 offset:17408
    ds_read_b128 v[96:99], v1 offset:8192
    v_mfma_f32_16x16x32_bf16 v[32:35], v[136:139], v[80:83], v[32:35]
    ds_read_b128 v[100:103], v1 offset:10240
    v_mfma_f32_16x16x32_bf16 v[36:39], v[140:143], v[80:83], v[36:39]
    ds_read_b128 v[104:107], v1 offset:12288
    v_mfma_f32_16x16x32_bf16 v[40:43], v[136:139], v[84:87], v[40:43]
    ds_read_b128 v[108:111], v1 offset:14336
    v_mfma_f32_16x16x32_bf16 v[44:47], v[140:143], v[84:87], v[44:47]
    v_mfma_f32_16x16x32_bf16 v[48:51], v[136:139], v[88:91], v[48:51]
    ds_read_b64_tr_b16 v[152:153], v3 offset:24576
    v_mfma_f32_16x16x32_bf16 v[52:55], v[140:143], v[88:91], v[52:55]
    ds_read_b64_tr_b16 v[154:155], v3 offset:25600
    v_mfma_f32_16x16x32_bf16 v[56:59], v[136:139], v[92:95], v[56:59]
    ds_read_b64_tr_b16 v[156:157], v4 offset:24576
    v_mfma_f32_16x16x32_bf16 v[60:63], v[140:143], v[92:95], v[60:63]
    ds_read_b64_tr_b16 v[158:159], v4 offset:25600
    s_waitcnt lgkmcnt(7)
    v_mfma_f32_16x16x32_bf16 v[32:35], v[144:147], v[96:99], v[32:35]
    ds_read_b128 v[112:115], v2 offset:8192
    v_mfma_f32_16x16x32_bf16 v[36:39], v[148:151], v[96:99], v[36:39]
    ds_read_b128 v[116:119], v2 offset:10240
    s_waitcnt lgkmcnt(8)
    v_mfma_f32_16x16x32_bf16 v[40:43], v[144:147], v[100:103], v[40:43]
    ds_read_b128 v[120:123], v2 offset:12288
    v_mfma_f32_16x16x32_bf16 v[44:47], v[148:151], v[100:103], v[44:47]
    ds_read_b128 v[124:127], v2 offset:14336
    s_waitcnt lgkmcnt(9)
    v_mfma_f32_16x16x32_bf16 v[48:51], v[144:147], v[104:107], v[48:51]
    v_mfma_f32_16x16x32_bf16 v[52:55], v[148:151], v[104:107], v[52:55]
    s_waitcnt lgkmcnt(8)
    v_mfma_f32_16x16x32_bf16 v[56:59], v[144:147], v[108:111], v[56:59]
    v_mfma_f32_16x16x32_bf16 v[60:63], v[148:151], v[108:111], v[60:63]
    s_waitcnt lgkmcnt(0)
    s_barrier
    ds_read_b64_tr_b16 v[128:129], v3 offset:32768
    ds_read_b64_tr_b16 v[130:131], v3 offset:33792
    ds_read_b64_tr_b16 v[132:133], v4 offset:32768
    ds_read_b64_tr_b16 v[134:135], v4 offset:33792
    ds_read_b128 v[64:67], v1 offset:16384
    v_mfma_f32_16x16x32_bf16 v[32:35], v[152:155], v[112:115], v[32:35]
    ds_read_b128 v[68:71], v1 offset:18432
    v_mfma_f32_16x16x32_bf16 v[36:39], v[156:159], v[112:115], v[36:39]
    ds_read_b128 v[72:75], v1 offset:20480
    v_mfma_f32_16x16x32_bf16 v[40:43], v[152:155], v[116:119], v[40:43]
    ds_read_b128 v[76:79], v1 offset:22528
    v_mfma_f32_16x16x32_bf16 v[44:47], v[156:159], v[116:119], v[44:47]
    v_mfma_f32_16x16x32_bf16 v[48:51], v[152:155], v[120:123], v[48:51]
    ds_read_b64_tr_b16 v[136:137], v3 offset:40960
    v_mfma_f32_16x16x32_bf16 v[52:55], v[156:159], v[120:123], v[52:55]
    ds_read_b64_tr_b16 v[138:139], v3 offset:41984
    v_mfma_f32_16x16x32_bf16 v[56:59], v[152:155], v[124:127], v[56:59]
    ds_read_b64_tr_b16 v[140:141], v4 offset:40960
    v_mfma_f32_16x16x32_bf16 v[60:63], v[156:159], v[124:127], v[60:63]
    ds_read_b64_tr_b16 v[142:143], v4 offset:41984
    s_waitcnt lgkmcnt(7)
    v_mfma_f32_16x16x32_bf16 v[32:35], v[128:131], v[64:67], v[32:35]
    ds_read_b128 v[80:83], v2 offset:16384
    v_mfma_f32_16x16x32_bf16 v[36:39], v[132:135], v[64:67], v[36:39]
    ds_read_b128 v[84:87], v2 offset:18432
    s_waitcnt lgkmcnt(8)
    v_mfma_f32_16x16x32_bf16 v[40:43], v[128:131], v[68:71], v[40:43]
    ds_read_b128 v[88:91], v2 offset:20480
    v_mfma_f32_16x16x32_bf16 v[44:47], v[132:135], v[68:71], v[44:47]
    ds_read_b128 v[92:95], v2 offset:22528
    s_waitcnt lgkmcnt(9)
    v_mfma_f32_16x16x32_bf16 v[48:51], v[128:131], v[72:75], v[48:51]
    v_mfma_f32_16x16x32_bf16 v[52:55], v[132:135], v[72:75], v[52:55]
    s_waitcnt lgkmcnt(8)
    v_mfma_f32_16x16x32_bf16 v[56:59], v[128:131], v[76:79], v[56:59]
    v_mfma_f32_16x16x32_bf16 v[60:63], v[132:135], v[76:79], v[60:63]
    s_waitcnt lgkmcnt(0)
    s_barrier
    ds_read_b64_tr_b16 v[144:145], v3 offset:49152
    ds_read_b64_tr_b16 v[146:147], v3 offset:50176
    ds_read_b64_tr_b16 v[148:149], v4 offset:49152
    ds_read_b64_tr_b16 v[150:151], v4 offset:50176
    ds_read_b128 v[96:99], v1 offset:24576
    v_mfma_f32_16x16x32_bf16 v[32:35], v[136:139], v[80:83], v[32:35]
    ds_read_b128 v[100:103], v1 offset:26624
    v_mfma_f32_16x16x32_bf16 v[36:39], v[140:143], v[80:83], v[36:39]
    ds_read_b128 v[104:107], v1 offset:28672
    v_mfma_f32_16x16x32_bf16 v[40:43], v[136:139], v[84:87], v[40:43]
    ds_read_b128 v[108:111], v1 offset:30720
    v_mfma_f32_16x16x32_bf16 v[44:47], v[140:143], v[84:87], v[44:47]
    v_mfma_f32_16x16x32_bf16 v[48:51], v[136:139], v[88:91], v[48:51]
    ds_read_b64_tr_b16 v[152:153], v3 offset:57344
    v_mfma_f32_16x16x32_bf16 v[52:55], v[140:143], v[88:91], v[52:55]
    ds_read_b64_tr_b16 v[154:155], v3 offset:58368
    v_mfma_f32_16x16x32_bf16 v[56:59], v[136:139], v[92:95], v[56:59]
    ds_read_b64_tr_b16 v[156:157], v4 offset:57344
    v_mfma_f32_16x16x32_bf16 v[60:63], v[140:143], v[92:95], v[60:63]
    ds_read_b64_tr_b16 v[158:159], v4 offset:58368
    s_waitcnt lgkmcnt(7)
    v_mfma_f32_16x16x32_bf16 v[32:35], v[144:147], v[96:99], v[32:35]
    ds_read_b128 v[112:115], v2 offset:24576
    v_mfma_f32_16x16x32_bf16 v[36:39], v[148:151], v[96:99], v[36:39]
    ds_read_b128 v[116:119], v2 offset:26624
    s_waitcnt lgkmcnt(8)
    v_mfma_f32_16x16x32_bf16 v[40:43], v[144:147], v[100:103], v[40:43]
    ds_read_b128 v[120:123], v2 offset:28672
    v_mfma_f32_16x16x32_bf16 v[44:47], v[148:151], v[100:103], v[44:47]
    ds_read_b128 v[124:127], v2 offset:30720
    s_waitcnt lgkmcnt(9)
    v_mfma_f32_16x16x32_bf16 v[48:51], v[144:147], v[104:107], v[48:51]
    v_mfma_f32_16x16x32_bf16 v[52:55], v[148:151], v[104:107], v[52:55]
    s_waitcnt lgkmcnt(8)
    v_mfma_f32_16x16x32_bf16 v[56:59], v[144:147], v[108:111], v[56:59]
    v_mfma_f32_16x16x32_bf16 v[60:63], v[148:151], v[108:111], v[60:63]
    s_waitcnt lgkmcnt(0)
    s_barrier
    ds_read_b64_tr_b16 v[128:129], v5 offset:0
    ds_read_b64_tr_b16 v[130:131], v5 offset:1024
    ds_read_b64_tr_b16 v[132:133], v6 offset:0
    ds_read_b64_tr_b16 v[134:135], v6 offset:1024
    ds_read_b128 v[64:67], v1 offset:0
    v_mfma_f32_16x16x32_bf16 v[32:35], v[152:155], v[112:115], v[32:35]
    ds_read_b128 v[68:71], v1 offset:2048
    v_mfma_f32_16x16x32_bf16 v[36:39], v[156:159], v[112:115], v[36:39]
    ds_read_b128 v[72:75], v1 offset:4096
    v_mfma_f32_16x16x32_bf16 v[40:43], v[152:155], v[116:119], v[40:43]
    ds_read_b128 v[76:79], v1 offset:6144
    v_mfma_f32_16x16x32_bf16 v[44:47], v[156:159], v[116:119], v[44:47]
    v_mfma_f32_16x16x32_bf16 v[48:51], v[152:155], v[120:123], v[48:51]
    ds_read_b64_tr_b16 v[136:137], v5 offset:8192
    v_mfma_f32_16x16x32_bf16 v[52:55], v[156:159], v[120:123], v[52:55]
    ds_read_b64_tr_b16 v[138:139], v5 offset:9216
    v_mfma_f32_16x16x32_bf16 v[56:59], v[152:155], v[124:127], v[56:59]
    ds_read_b64_tr_b16 v[140:141], v6 offset:8192
    v_mfma_f32_16x16x32_bf16 v[60:63], v[156:159], v[124:127], v[60:63]
    ds_read_b64_tr_b16 v[142:143], v6 offset:9216
    s_waitcnt lgkmcnt(7)
    v_mfma_f32_16x16x32_bf16 v[32:35], v[128:131], v[64:67], v[32:35]
    ds_read_b128 v[80:83], v2 offset:0
    v_mfma_f32_16x16x32_bf16 v[36:39], v[132:135], v[64:67], v[36:39]
    ds_read_b128 v[84:87], v2 offset:2048
    s_waitcnt lgkmcnt(8)
    v_mfma_f32_16x16x32_bf16 v[40:43], v[128:131], v[68:71], v[40:43]
    ds_read_b128 v[88:91], v2 offset:4096
    v_mfma_f32_16x16x32_bf16 v[44:47], v[132:135], v[68:71], v[44:47]
    ds_read_b128 v[92:95], v2 offset:6144
    s_waitcnt lgkmcnt(9)
    v_mfma_f32_16x16x32_bf16 v[48:51], v[128:131], v[72:75], v[48:51]
    v_mfma_f32_16x16x32_bf16 v[52:55], v[132:135], v[72:75], v[52:55]
    s_waitcnt lgkmcnt(8)
    v_mfma_f32_16x16x32_bf16 v[56:59], v[128:131], v[76:79], v[56:59]
    v_mfma_f32_16x16x32_bf16 v[60:63], v[132:135], v[76:79], v[60:63]
    s_waitcnt lgkmcnt(0)
    s_barrier
    ds_read_b64_tr_b16 v[144:145], v5 offset:16384
    ds_read_b64_tr_b16 v[146:147], v5 offset:17408
    ds_read_b64_tr_b16 v[148:149], v6 offset:16384
    ds_read_b64_tr_b16 v[150:151], v6 offset:17408
    ds_read_b128 v[96:99], v1 offset:8192
    v_mfma_f32_16x16x32_bf16 v[32:35], v[136:139], v[80:83], v[32:35]
    ds_read_b128 v[100:103], v1 offset:10240
    v_mfma_f32_16x16x32_bf16 v[36:39], v[140:143], v[80:83], v[36:39]
    ds_read_b128 v[104:107], v1 offset:12288
    v_mfma_f32_16x16x32_bf16 v[40:43], v[136:139], v[84:87], v[40:43]
    ds_read_b128 v[108:111], v1 offset:14336
    v_mfma_f32_16x16x32_bf16 v[44:47], v[140:143], v[84:87], v[44:47]
    v_mfma_f32_16x16x32_bf16 v[48:51], v[136:139], v[88:91], v[48:51]
    ds_read_b64_tr_b16 v[152:153], v5 offset:24576
    v_mfma_f32_16x16x32_bf16 v[52:55], v[140:143], v[88:91], v[52:55]
    ds_read_b64_tr_b16 v[154:155], v5 offset:25600
    v_mfma_f32_16x16x32_bf16 v[56:59], v[136:139], v[92:95], v[56:59]
    ds_read_b64_tr_b16 v[156:157], v6 offset:24576
    v_mfma_f32_16x16x32_bf16 v[60:63], v[140:143], v[92:95], v[60:63]
    ds_read_b64_tr_b16 v[158:159], v6 offset:25600
    s_waitcnt lgkmcnt(7)
    v_mfma_f32_16x16x32_bf16 v[32:35], v[144:147], v[96:99], v[32:35]
    ds_read_b128 v[112:115], v2 offset:8192
    v_mfma_f32_16x16x32_bf16 v[36:39], v[148:151], v[96:99], v[36:39]
    ds_read_b128 v[116:119], v2 offset:10240
    s_waitcnt lgkmcnt(8)
    v_mfma_f32_16x16x32_bf16 v[40:43], v[144:147], v[100:103], v[40:43]
    ds_read_b128 v[120:123], v2 offset:12288
    v_mfma_f32_16x16x32_bf16 v[44:47], v[148:151], v[100:103], v[44:47]
    ds_read_b128 v[124:127], v2 offset:14336
    s_waitcnt lgkmcnt(9)
    v_mfma_f32_16x16x32_bf16 v[48:51], v[144:147], v[104:107], v[48:51]
    v_mfma_f32_16x16x32_bf16 v[52:55], v[148:151], v[104:107], v[52:55]
    s_waitcnt lgkmcnt(8)
    v_mfma_f32_16x16x32_bf16 v[56:59], v[144:147], v[108:111], v[56:59]
    v_mfma_f32_16x16x32_bf16 v[60:63], v[148:151], v[108:111], v[60:63]
    s_waitcnt lgkmcnt(0)
    s_barrier
    ds_read_b64_tr_b16 v[128:129], v5 offset:32768
    ds_read_b64_tr_b16 v[130:131], v5 offset:33792
    ds_read_b64_tr_b16 v[132:133], v6 offset:32768
    ds_read_b64_tr_b16 v[134:135], v6 offset:33792
    ds_read_b128 v[64:67], v1 offset:16384
    v_mfma_f32_16x16x32_bf16 v[32:35], v[152:155], v[112:115], v[32:35]
    ds_read_b128 v[68:71], v1 offset:18432
    v_mfma_f32_16x16x32_bf16 v[36:39], v[156:159], v[112:115], v[36:39]
    ds_read_b128 v[72:75], v1 offset:20480
    v_mfma_f32_16x16x32_bf16 v[40:43], v[152:155], v[116:119], v[40:43]
    ds_read_b128 v[76:79], v1 offset:22528
    v_mfma_f32_16x16x32_bf16 v[44:47], v[156:159], v[116:119], v[44:47]
    v_mfma_f32_16x16x32_bf16 v[48:51], v[152:155], v[120:123], v[48:51]
    ds_read_b64_tr_b16 v[136:137], v5 offset:40960
    v_mfma_f32_16x16x32_bf16 v[52:55], v[156:159], v[120:123], v[52:55]
    ds_read_b64_tr_b16 v[138:139], v5 offset:41984
    v_mfma_f32_16x16x32_bf16 v[56:59], v[152:155], v[124:127], v[56:59]
    ds_read_b64_tr_b16 v[140:141], v6 offset:40960
    v_mfma_f32_16x16x32_bf16 v[60:63], v[156:159], v[124:127], v[60:63]
    ds_read_b64_tr_b16 v[142:143], v6 offset:41984
    s_waitcnt lgkmcnt(7)
    v_mfma_f32_16x16x32_bf16 v[32:35], v[128:131], v[64:67], v[32:35]
    ds_read_b128 v[80:83], v2 offset:16384
    v_mfma_f32_16x16x32_bf16 v[36:39], v[132:135], v[64:67], v[36:39]
    ds_read_b128 v[84:87], v2 offset:18432
    s_waitcnt lgkmcnt(8)
    v_mfma_f32_16x16x32_bf16 v[40:43], v[128:131], v[68:71], v[40:43]
    ds_read_b128 v[88:91], v2 offset:20480
    v_mfma_f32_16x16x32_bf16 v[44:47], v[132:135], v[68:71], v[44:47]
    ds_read_b128 v[92:95], v2 offset:22528
    s_waitcnt lgkmcnt(9)
    v_mfma_f32_16x16x32_bf16 v[48:51], v[128:131], v[72:75], v[48:51]
    v_mfma_f32_16x16x32_bf16 v[52:55], v[132:135], v[72:75], v[52:55]
    s_waitcnt lgkmcnt(8)
    v_mfma_f32_16x16x32_bf16 v[56:59], v[128:131], v[76:79], v[56:59]
    v_mfma_f32_16x16x32_bf16 v[60:63], v[132:135], v[76:79], v[60:63]
    s_waitcnt lgkmcnt(0)
    s_barrier
    ds_read_b64_tr_b16 v[144:145], v5 offset:49152
    ds_read_b64_tr_b16 v[146:147], v5 offset:50176
    ds_read_b64_tr_b16 v[148:149], v6 offset:49152
    ds_read_b64_tr_b16 v[150:151], v6 offset:50176
    ds_read_b128 v[96:99], v1 offset:24576
    v_mfma_f32_16x16x32_bf16 v[32:35], v[136:139], v[80:83], v[32:35]
    ds_read_b128 v[100:103], v1 offset:26624
    v_mfma_f32_16x16x32_bf16 v[36:39], v[140:143], v[80:83], v[36:39]
    ds_read_b128 v[104:107], v1 offset:28672
    v_mfma_f32_16x16x32_bf16 v[40:43], v[136:139], v[84:87], v[40:43]
    ds_read_b128 v[108:111], v1 offset:30720
    v_mfma_f32_16x16x32_bf16 v[44:47], v[140:143], v[84:87], v[44:47]
    v_mfma_f32_16x16x32_bf16 v[48:51], v[136:139], v[88:91], v[48:51]
    ds_read_b64_tr_b16 v[152:153], v5 offset:57344
    v_mfma_f32_16x16x32_bf16 v[52:55], v[140:143], v[88:91], v[52:55]
    ds_read_b64_tr_b16 v[154:155], v5 offset:58368
    v_mfma_f32_16x16x32_bf16 v[56:59], v[136:139], v[92:95], v[56:59]
    ds_read_b64_tr_b16 v[156:157], v6 offset:57344
    v_mfma_f32_16x16x32_bf16 v[60:63], v[140:143], v[92:95], v[60:63]
    ds_read_b64_tr_b16 v[158:159], v6 offset:58368
    s_waitcnt lgkmcnt(7)
    v_mfma_f32_16x16x32_bf16 v[32:35], v[144:147], v[96:99], v[32:35]
    ds_read_b128 v[112:115], v2 offset:24576
    v_mfma_f32_16x16x32_bf16 v[36:39], v[148:151], v[96:99], v[36:39]
    ds_read_b128 v[116:119], v2 offset:26624
    s_waitcnt lgkmcnt(8)
    v_mfma_f32_16x16x32_bf16 v[40:43], v[144:147], v[100:103], v[40:43]
    ds_read_b128 v[120:123], v2 offset:28672
    v_mfma_f32_16x16x32_bf16 v[44:47], v[148:151], v[100:103], v[44:47]
    ds_read_b128 v[124:127], v2 offset:30720
    s_waitcnt lgkmcnt(9)
    v_mfma_f32_16x16x32_bf16 v[48:51], v[144:147], v[104:107], v[48:51]
    v_mfma_f32_16x16x32_bf16 v[52:55], v[148:151], v[104:107], v[52:55]
    s_waitcnt lgkmcnt(8)
    v_mfma_f32_16x16x32_bf16 v[56:59], v[144:147], v[108:111], v[56:59]
    v_mfma_f32_16x16x32_bf16 v[60:63], v[148:151], v[108:111], v[60:63]
    buffer_load_dwordx2 v[160:161], v9, s[36:39], s58 offen offset:0
    buffer_load_dwordx2 v[162:163], v9, s[36:39], s58 offen offset:32
    buffer_load_dword v175, v172, s[48:51], s59 offen offset:4 sc1
    s_add_u32 s60, s59, 0x10000
    buffer_load_dword v193, v172, s[48:51], s60 offen offset:4 sc1
    s_lshl_b32 s56, s52, 6
    s_add_u32 s56, s56, s53
    s_lshl_b32 s56, s56, 2
    s_mov_b64 exec, 1
    buffer_load_dword v173, off, s[44:47], s56 sc1
    s_mov_b64 exec, -1
    s_waitcnt lgkmcnt(0)
    s_barrier
    ds_read_b64_tr_b16 v[128:129], v3 offset:0
    ds_read_b64_tr_b16 v[130:131], v3 offset:1024
    ds_read_b64_tr_b16 v[132:133], v4 offset:0
    ds_read_b64_tr_b16 v[134:135], v4 offset:1024
    ds_read_b128 v[64:67], v1 offset:0
    v_mfma_f32_16x16x32_bf16 v[32:35], v[152:155], v[112:115], v[32:35]
    ds_read_b128 v[68:71], v1 offset:2048
    v_mfma_f32_16x16x32_bf16 v[36:39], v[156:159], v[112:115], v[36:39]
    ds_read_b128 v[72:75], v1 offset:4096
    v_mfma_f32_16x16x32_bf16 v[40:43], v[152:155], v[116:119], v[40:43]
    ds_read_b128 v[76:79], v1 offset:6144
    v_mfma_f32_16x16x32_bf16 v[44:47], v[156:159], v[116:119], v[44:47]
    v_mfma_f32_16x16x32_bf16 v[48:51], v[152:155], v[120:123], v[48:51]
    ds_read_b64_tr_b16 v[136:137], v3 offset:8192
    v_mfma_f32_16x16x32_bf16 v[52:55], v[156:159], v[120:123], v[52:55]
    ds_read_b64_tr_b16 v[138:139], v3 offset:9216
    v_mfma_f32_16x16x32_bf16 v[56:59], v[152:155], v[124:127], v[56:59]
    ds_read_b64_tr_b16 v[140:141], v4 offset:8192
    v_mfma_f32_16x16x32_bf16 v[60:63], v[156:159], v[124:127], v[60:63]
    ds_read_b64_tr_b16 v[142:143], v4 offset:9216
    s_waitcnt lgkmcnt(7)
    v_mfma_f32_16x16x32_bf16 v[32:35], v[128:131], v[64:67], v[32:35]
    ds_read_b128 v[80:83], v2 offset:0
    v_mfma_f32_16x16x32_bf16 v[36:39], v[132:135], v[64:67], v[36:39]
    ds_read_b128 v[84:87], v2 offset:2048
    s_waitcnt lgkmcnt(8)
    v_mfma_f32_16x16x32_bf16 v[40:43], v[128:131], v[68:71], v[40:43]
    ds_read_b128 v[88:91], v2 offset:4096
    v_mfma_f32_16x16x32_bf16 v[44:47], v[132:135], v[68:71], v[44:47]
    ds_read_b128 v[92:95], v2 offset:6144
    s_waitcnt lgkmcnt(9)
    v_mfma_f32_16x16x32_bf16 v[48:51], v[128:131], v[72:75], v[48:51]
    v_mfma_f32_16x16x32_bf16 v[52:55], v[132:135], v[72:75], v[52:55]
    s_waitcnt lgkmcnt(8)
    v_mfma_f32_16x16x32_bf16 v[56:59], v[128:131], v[76:79], v[56:59]
    v_mfma_f32_16x16x32_bf16 v[60:63], v[132:135], v[76:79], v[60:63]
    s_waitcnt lgkmcnt(0)
    s_barrier
    ds_read_b64_tr_b16 v[144:145], v3 offset:16384
    ds_read_b64_tr_b16 v[146:147], v3 offset:17408
    ds_read_b64_tr_b16 v[148:149], v4 offset:16384
    ds_read_b64_tr_b16 v[150:151], v4 offset:17408
    ds_read_b128 v[96:99], v1 offset:8192
    v_mfma_f32_16x16x32_bf16 v[32:35], v[136:139], v[80:83], v[32:35]
    ds_read_b128 v[100:103], v1 offset:10240
    v_mfma_f32_16x16x32_bf16 v[36:39], v[140:143], v[80:83], v[36:39]
    ds_read_b128 v[104:107], v1 offset:12288
    v_mfma_f32_16x16x32_bf16 v[40:43], v[136:139], v[84:87], v[40:43]
    ds_read_b128 v[108:111], v1 offset:14336
    v_mfma_f32_16x16x32_bf16 v[44:47], v[140:143], v[84:87], v[44:47]
    v_mfma_f32_16x16x32_bf16 v[48:51], v[136:139], v[88:91], v[48:51]
    ds_read_b64_tr_b16 v[152:153], v3 offset:24576
    v_mfma_f32_16x16x32_bf16 v[52:55], v[140:143], v[88:91], v[52:55]
    ds_read_b64_tr_b16 v[154:155], v3 offset:25600
    v_mfma_f32_16x16x32_bf16 v[56:59], v[136:139], v[92:95], v[56:59]
    ds_read_b64_tr_b16 v[156:157], v4 offset:24576
    v_mfma_f32_16x16x32_bf16 v[60:63], v[140:143], v[92:95], v[60:63]
    ds_read_b64_tr_b16 v[158:159], v4 offset:25600
    s_waitcnt lgkmcnt(7)
    v_mfma_f32_16x16x32_bf16 v[32:35], v[144:147], v[96:99], v[32:35]
    ds_read_b128 v[112:115], v2 offset:8192
    v_mfma_f32_16x16x32_bf16 v[36:39], v[148:151], v[96:99], v[36:39]
    ds_read_b128 v[116:119], v2 offset:10240
    s_waitcnt lgkmcnt(8)
    v_mfma_f32_16x16x32_bf16 v[40:43], v[144:147], v[100:103], v[40:43]
    ds_read_b128 v[120:123], v2 offset:12288
    v_mfma_f32_16x16x32_bf16 v[44:47], v[148:151], v[100:103], v[44:47]
    ds_read_b128 v[124:127], v2 offset:14336
    s_waitcnt lgkmcnt(9)
    v_mfma_f32_16x16x32_bf16 v[48:51], v[144:147], v[104:107], v[48:51]
    v_mfma_f32_16x16x32_bf16 v[52:55], v[148:151], v[104:107], v[52:55]
    s_waitcnt lgkmcnt(8)
    v_mfma_f32_16x16x32_bf16 v[56:59], v[144:147], v[108:111], v[56:59]
    v_mfma_f32_16x16x32_bf16 v[60:63], v[148:151], v[108:111], v[60:63]
    s_waitcnt lgkmcnt(0)
    v_mfma_f32_16x16x32_bf16 v[32:35], v[152:155], v[112:115], v[32:35]
    v_mfma_f32_16x16x32_bf16 v[36:39], v[156:159], v[112:115], v[36:39]
    v_mfma_f32_16x16x32_bf16 v[40:43], v[152:155], v[116:119], v[40:43]
    v_mfma_f32_16x16x32_bf16 v[44:47], v[156:159], v[116:119], v[44:47]
    v_mfma_f32_16x16x32_bf16 v[48:51], v[152:155], v[120:123], v[48:51]
    v_mfma_f32_16x16x32_bf16 v[52:55], v[156:159], v[120:123], v[52:55]
    v_mfma_f32_16x16x32_bf16 v[56:59], v[152:155], v[124:127], v[56:59]
    v_mfma_f32_16x16x32_bf16 v[60:63], v[156:159], v[124:127], v[60:63]
    s_waitcnt vmcnt(3)
    v_lshlrev_b32 v176, 16, v160
    v_and_b32 v177, s68, v160
    v_lshlrev_b32 v178, 16, v161
    v_and_b32 v179, s68, v161
    v_lshlrev_b32 v180, 16, v162
    v_and_b32 v181, s68, v162
    v_lshlrev_b32 v182, 16, v163
    v_and_b32 v183, s68, v163
    v_pk_mul_f32 v[64:65], v[32:33], v[32:33]
    v_pk_mul_f32 v[66:67], v[34:35], v[34:35]
    v_pk_mul_f32 v[68:69], v[36:37], v[36:37]
    v_pk_mul_f32 v[70:71], v[38:39], v[38:39]
    v_pk_mul_f32 v[72:73], v[40:41], v[40:41]
    v_pk_mul_f32 v[74:75], v[42:43], v[42:43]
    v_pk_mul_f32 v[76:77], v[44:45], v[44:45]
    v_pk_mul_f32 v[78:79], v[46:47], v[46:47]
    v_pk_fma_f32 v[64:65], v[64:65], v[14:15], v[12:13]
    v_pk_fma_f32 v[66:67], v[66:67], v[14:15], v[12:13]
    v_pk_fma_f32 v[68:69], v[68:69], v[14:15], v[12:13]
    v_pk_fma_f32 v[70:71], v[70:71], v[14:15], v[12:13]
    v_pk_fma_f32 v[72:73], v[72:73], v[14:15], v[12:13]
    v_pk_fma_f32 v[74:75], v[74:75], v[14:15], v[12:13]
    v_pk_fma_f32 v[76:77], v[76:77], v[14:15], v[12:13]
    v_pk_fma_f32 v[78:79], v[78:79], v[14:15], v[12:13]
    v_pk_mul_f32 v[64:65], v[64:65], v[32:33]
    v_pk_mul_f32 v[66:67], v[66:67], v[34:35]
    v_pk_mul_f32 v[68:69], v[68:69], v[36:37]
    v_pk_mul_f32 v[70:71], v[70:71], v[38:39]
    v_pk_mul_f32 v[72:73], v[72:73], v[40:41]
    v_pk_mul_f32 v[74:75], v[74:75], v[42:43]
    v_pk_mul_f32 v[76:77], v[76:77], v[44:45]
    v_pk_mul_f32 v[78:79], v[78:79], v[46:47]
    v_exp_f32 v64, v64
    v_exp_f32 v66, v66
    v_exp_f32 v68, v68
    v_exp_f32 v70, v70
    v_exp_f32 v72, v72
    v_exp_f32 v74, v74
    v_exp_f32 v76, v76
    v_exp_f32 v78, v78
    v_exp_f32 v65, v65
    v_exp_f32 v67, v67
    v_exp_f32 v69, v69
    v_exp_f32 v71, v71
    v_exp_f32 v73, v73
    v_exp_f32 v75, v75
    v_exp_f32 v77, v77
    v_exp_f32 v79, v79
    v_pk_mul_f32 v[32:33], v[32:33], v[176:177]
    v_pk_mul_f32 v[34:35], v[34:35], v[178:179]
    v_pk_mul_f32 v[36:37], v[36:37], v[180:181]
    v_pk_mul_f32 v[38:39], v[38:39], v[182:183]
    v_pk_mul_f32 v[40:41], v[40:41], v[176:177]
    v_pk_mul_f32 v[42:43], v[42:43], v[178:179]
    v_pk_mul_f32 v[44:45], v[44:45], v[180:181]
    v_pk_mul_f32 v[46:47], v[46:47], v[182:183]
    v_pk_add_f32 v[64:65], v[64:65], 1.0 op_sel_hi:[1,0]
    v_pk_add_f32 v[66:67], v[66:67], 1.0 op_sel_hi:[1,0]
    v_pk_add_f32 v[68:69], v[68:69], 1.0 op_sel_hi:[1,0]
    v_pk_add_f32 v[70:71], v[70:71], 1.0 op_sel_hi:[1,0]
    v_pk_add_f32 v[72:73], v[72:73], 1.0 op_sel_hi:[1,0]
    v_pk_add_f32 v[74:75], v[74:75], 1.0 op_sel_hi:[1,0]
    v_pk_add_f32 v[76:77], v[76:77], 1.0 op_sel_hi:[1,0]
    v_pk_add_f32 v[78:79], v[78:79], 1.0 op_sel_hi:[1,0]
    v_rcp_f32 v64, v64
    v_rcp_f32 v66, v66
    v_rcp_f32 v68, v68
    v_rcp_f32 v70, v70
    v_rcp_f32 v72, v72
    v_rcp_f32 v74, v74
    v_rcp_f32 v76, v76
    v_rcp_f32 v78, v78
    v_rcp_f32 v65, v65
    v_rcp_f32 v67, v67
    v_rcp_f32 v69, v69
    v_rcp_f32 v71, v71
    v_rcp_f32 v73, v73
    v_rcp_f32 v75, v75
    v_rcp_f32 v77, v77
    v_rcp_f32 v79, v79
    v_pk_mul_f32 v[164:165], v[32:33], v[64:65]
    v_pk_fma_f32 v[164:165], v[34:35], v[66:67], v[164:165]
    v_pk_fma_f32 v[164:165], v[36:37], v[68:69], v[164:165]
    v_pk_fma_f32 v[164:165], v[38:39], v[70:71], v[164:165]
    v_pk_mul_f32 v[166:167], v[40:41], v[72:73]
    v_pk_fma_f32 v[166:167], v[42:43], v[74:75], v[166:167]
    v_pk_fma_f32 v[166:167], v[44:45], v[76:77], v[166:167]
    v_pk_fma_f32 v[166:167], v[46:47], v[78:79], v[166:167]
    v_pk_mul_f32 v[64:65], v[48:49], v[48:49]
    v_pk_mul_f32 v[66:67], v[50:51], v[50:51]
    v_pk_mul_f32 v[68:69], v[52:53], v[52:53]
    v_pk_mul_f32 v[70:71], v[54:55], v[54:55]
    v_pk_mul_f32 v[72:73], v[56:57], v[56:57]
    v_pk_mul_f32 v[74:75], v[58:59], v[58:59]
    v_pk_mul_f32 v[76:77], v[60:61], v[60:61]
    v_pk_mul_f32 v[78:79], v[62:63], v[62:63]
    v_pk_fma_f32 v[64:65], v[64:65], v[14:15], v[12:13]
    v_pk_fma_f32 v[66:67], v[66:67], v[14:15], v[12:13]
    v_pk_fma_f32 v[68:69], v[68:69], v[14:15], v[12:13]
    v_pk_fma_f32 v[70:71], v[70:71], v[14:15], v[12:13]
    v_pk_fma_f32 v[72:73], v[72:73], v[14:15], v[12:13]
    v_pk_fma_f32 v[74:75], v[74:75], v[14:15], v[12:13]
    v_pk_fma_f32 v[76:77], v[76:77], v[14:15], v[12:13]
    v_pk_fma_f32 v[78:79], v[78:79], v[14:15], v[12:13]
    v_pk_mul_f32 v[64:65], v[64:65], v[48:49]
    v_pk_mul_f32 v[66:67], v[66:67], v[50:51]
    v_pk_mul_f32 v[68:69], v[68:69], v[52:53]
    v_pk_mul_f32 v[70:71], v[70:71], v[54:55]
    v_pk_mul_f32 v[72:73], v[72:73], v[56:57]
    v_pk_mul_f32 v[74:75], v[74:75], v[58:59]
    v_pk_mul_f32 v[76:77], v[76:77], v[60:61]
    v_pk_mul_f32 v[78:79], v[78:79], v[62:63]
    v_exp_f32 v64, v64
    v_exp_f32 v66, v66
    v_exp_f32 v68, v68
    v_exp_f32 v70, v70
    v_exp_f32 v72, v72
    v_exp_f32 v74, v74
    v_exp_f32 v76, v76
    v_exp_f32 v78, v78
    v_exp_f32 v65, v65
    v_exp_f32 v67, v67
    v_exp_f32 v69, v69
    v_exp_f32 v71, v71
    v_exp_f32 v73, v73
    v_exp_f32 v75, v75
    v_exp_f32 v77, v77
    v_exp_f32 v79, v79
    v_pk_mul_f32 v[48:49], v[48:49], v[176:177]
    v_pk_mul_f32 v[50:51], v[50:51], v[178:179]
    v_pk_mul_f32 v[52:53], v[52:53], v[180:181]
    v_pk_mul_f32 v[54:55], v[54:55], v[182:183]
    v_pk_mul_f32 v[56:57], v[56:57], v[176:177]
    v_pk_mul_f32 v[58:59], v[58:59], v[178:179]
    v_pk_mul_f32 v[60:61], v[60:61], v[180:181]
    v_pk_mul_f32 v[62:63], v[62:63], v[182:183]
    v_pk_add_f32 v[64:65], v[64:65], 1.0 op_sel_hi:[1,0]
    v_pk_add_f32 v[66:67], v[66:67], 1.0 op_sel_hi:[1,0]
    v_pk_add_f32 v[68:69], v[68:69], 1.0 op_sel_hi:[1,0]
    v_pk_add_f32 v[70:71], v[70:71], 1.0 op_sel_hi:[1,0]
    v_pk_add_f32 v[72:73], v[72:73], 1.0 op_sel_hi:[1,0]
    v_pk_add_f32 v[74:75], v[74:75], 1.0 op_sel_hi:[1,0]
    v_pk_add_f32 v[76:77], v[76:77], 1.0 op_sel_hi:[1,0]
    v_pk_add_f32 v[78:79], v[78:79], 1.0 op_sel_hi:[1,0]
    v_rcp_f32 v64, v64
    v_rcp_f32 v66, v66
    v_rcp_f32 v68, v68
    v_rcp_f32 v70, v70
    v_rcp_f32 v72, v72
    v_rcp_f32 v74, v74
    v_rcp_f32 v76, v76
    v_rcp_f32 v78, v78
    v_rcp_f32 v65, v65
    v_rcp_f32 v67, v67
    v_rcp_f32 v69, v69
    v_rcp_f32 v71, v71
    v_rcp_f32 v73, v73
    v_rcp_f32 v75, v75
    v_rcp_f32 v77, v77
    v_rcp_f32 v79, v79
    v_pk_mul_f32 v[168:169], v[48:49], v[64:65]
    v_pk_fma_f32 v[168:169], v[50:51], v[66:67], v[168:169]
    v_pk_fma_f32 v[168:169], v[52:53], v[68:69], v[168:169]
    v_pk_fma_f32 v[168:169], v[54:55], v[70:71], v[168:169]
    v_pk_mul_f32 v[170:171], v[56:57], v[72:73]
    v_pk_fma_f32 v[170:171], v[58:59], v[74:75], v[170:171]
    v_pk_fma_f32 v[170:171], v[60:61], v[76:77], v[170:171]
    v_pk_fma_f32 v[170:171], v[62:63], v[78:79], v[170:171]
    v_add_f32 v164, v164, v165
    v_add_f32 v166, v166, v167
    v_add_f32 v168, v168, v169
    v_add_f32 v170, v170, v171
    v_lshlrev_b32 v1, 2, v0
    v_add_u32 v1, 65536, v1
    v_permlane32_swap_b32 v164, v168
    v_permlane32_swap_b32 v166, v170
    v_add_f32 v164, v164, v168
    v_add_f32 v166, v166, v170
    s_nop 1
    v_permlane16_swap_b32 v164, v166
    v_add_f32 v164, v164, v166
    ds_write_b32 v1, v164
    s_waitcnt lgkmcnt(0)
    s_barrier
    s_cmp_lg_u32 s52, 0
    s_cbranch_scc1 L_end
    ds_read_b32 v17, v1 offset:256
    ds_read_b32 v18, v1 offset:512
    ds_read_b32 v19, v1 offset:768
    s_lshl_b32 s57, s53, 2
    s_lshl_b32 s58, s54, 4
    s_lshl_b32 s58, 2, s58
    v_mov_b32 v6, s58
    s_waitcnt vmcnt(0) lgkmcnt(0)
    v_add_u32 v175, 1, v175
    v_add_u32 v193, 1, v193
    v_add_f32 v164, v164, v17
    v_add_f32 v18, v18, v19
    v_add_f32 v174, v164, v18
    buffer_store_dwordx2 v[174:175], v172, s[48:51], s59 offen
    v_mov_b32 v192, v174
    buffer_store_dwordx2 v[192:193], v172, s[48:51], s60 offen sc1
    v_readfirstlane_b32 s56, v173
    s_nop 0
    s_and_b32 s56, s56, 0x01000100
    s_cmp_eq_u32 s56, 0x01000100
    s_cbranch_scc1 L_end
    s_waitcnt vmcnt(0)
    s_mov_b64 exec, 1
    buffer_atomic_or v6, off, s[44:47], s57 sc1
L_end:
L_exit:
    s_endpgm
L_codeend:
.section .rodata,"a"
.p2align 6
.amdhsa_kernel standalone__deep_cross_fibinet__recsys_kernel
  .amdhsa_next_free_vgpr 256
  .amdhsa_next_free_sgpr 102
  .amdhsa_accum_offset 256
  .amdhsa_group_segment_fixed_size 0
  .amdhsa_kernarg_size 88
  .amdhsa_user_sgpr_count 2
  .amdhsa_user_sgpr_kernarg_segment_ptr 1
  .amdhsa_system_sgpr_workgroup_id_x 1
.end_amdhsa_kernel
```

```asm
; @launch grid=(256,1,1) block=(512,1,1) lds=163840
.amdgcn_target "amdgcn-amd-amdhsa--gfx950"
.text
.globl standalone__deep_cross_fibinet__recsys_kernel
.p2align 12
.type standalone__deep_cross_fibinet__recsys_kernel,@function
standalone__deep_cross_fibinet__recsys_kernel:
    s_cmp_ge_u32 s2, 256
    s_cbranch_scc1 L_exit
    s_load_dwordx2 s[8:9], s[0:1], 0
    s_load_dwordx2 s[16:17], s[0:1], 48
    s_load_dwordx2 s[12:13], s[0:1], 8
    s_load_dwordx8 s[84:91], s[0:1], 16
    s_load_dwordx8 s[92:99], s[0:1], 56
    s_lshr_b32 s56, s2, 2
    s_xor_b32 s56, s56, s2
    s_bfe_u32 s56, s56, 0x10004
    s_mul_i32 s56, s56, 80
    s_xor_b32 s2, s2, s56
    v_lshrrev_b32 v1, 6, v0
    s_lshr_b32 s56, s2, 5
    v_readfirstlane_b32 s52, v1
    s_and_b32 s57, s2, 7
    s_lshl3_add_u32 s53, s56, s57
    s_bfe_u32 s54, s2, 0x10003
    s_getpc_b64 s[20:21]
L_pc:
    s_mov_b32 s22, L_codeend-L_pc
    s_mov_b32 s23, 0x00020000
    s_andn2_b32 s56, s2, 7
    s_add_u32 s56, s56, s52
    s_lshl_b32 s56, s56, 7
    s_mov_b64 exec, 1
    buffer_load_dword v8, off, s[20:23], s56
    s_mov_b64 exec, -1
    s_mov_b32 s10, 425984
    s_mov_b32 s11, 0x00020000
    s_mov_b32 s18, 851968
    s_mov_b32 s19, 0x00020000
    s_mov_b32 s14, 12800000
    s_mov_b32 s15, 0x00020000
    s_bitcmp1_b32 s2, 4
    s_cbranch_scc1 L_B
    v_bfe_u32 v228, v0, 3, 5
    v_mul_u32_u24 v228, 104, v228
    v_and_b32 v229, 7, v0
    v_lshl_add_u32 v228, v229, 4, v228
    v_lshrrev_b32 v230, 8, v0
    v_lshl_add_u32 v228, v230, 4, v228
    v_mul_u32_u24 v230, 12, v230
    s_mov_b32 exec_lo, 0x40404040
    s_mov_b32 exec_hi, 0x40404040
    v_sub_u32 v228, v228, v230
    s_mov_b64 exec, -1
    s_lshl1_add_u32 s58, s53, s54
    s_mul_i32 s58, s58, 3328
    s_lshl_b32 s60, s52, 10
    s_and_b32 s79, s53, 3
    s_bfe_u32 s63, s53, 0x10003
    s_lshl1_add_u32 s63, s63, s54
    s_bfe_u32 s55, s53, 0x10004
    s_and_b32 s82, s53, 4
    s_lshl_b32 s82, s82, 26
    v_bfe_u32 v229, v0, 4, 1
    v_bfe_u32 v230, v0, 3, 1
    v_lshl_add_u32 v229, v229, 3, v230
    s_lshl3_add_u32 s56, s55, s79
    s_lshl_b32 s56, s56, 1
    v_add_u32 v229, s56, v229
    s_add_u32 s56, s79, 24
    v_min_u32 v229, s56, v229
    v_and_b32 v230, 7, v0
    v_lshl_add_u32 v229, v229, 3, v230
    v_lshlrev_b32 v229, 4, v229
    s_lshr_b32 s56, s52, 1
    s_lshl2_add_u32 s56, s56, s63
    s_min_u32 s56, s56, 12
    s_and_b32 s57, s52, 1
    s_lshl1_add_u32 s56, s56, s57
    s_lshr_b32 s57, s53, 5
    s_mul_i32 s57, s57, 26
    s_add_u32 s56, s56, s57
    s_mul_i32 s56, s56, 3328
    s_add_u32 s3, s56, s82
    s_mov_b32 s34, 173056
    s_mov_b32 s35, 0x00020000
    s_lshr_b32 s57, s60, 1
    s_add_u32 m0, s57, 106496
    s_lshr_b32 s6, s2, 5
    s_lshl1_add_u32 s6, s6, s54
    s_waitcnt lgkmcnt(0)
    buffer_load_dwordx4 v[2:5], v228, s[8:11], s58 offen
    s_mov_b64 s[32:33], s[90:91]
    s_mov_b32 exec_hi, 0
    buffer_load_dwordx4 v229, s[32:35], s3 offen lds
    s_mov_b64 exec, -1
    s_mov_b32 s26, 8192
    s_mov_b32 s27, 0x00020000
    s_mov_b64 s[24:25], s[88:89]
    v_lshlrev_b32 v231, 4, v0
    s_add_u32 m0, s60, 139264
    s_lshl_b32 s56, s6, 13
    buffer_load_dwordx4 v231, s[24:27], 0 offen lds
    v_and_b32 v230, 63, v0
    v_lshl_add_u32 v7, v230, 7, s56
    s_sub_u32 s57, s52, 6
    s_lshl_b32 s57, s57, 17
    s_add_u32 s57, s57, s56
    s_add_u32 s57, s57, 262144
    s_cmp_lt_u32 s52, 6
    s_cselect_b32 s57, 0x7f000000, s57
    s_cmp_eq_u32 s52, 0
    s_cselect_b64 s[28:29], s[84:85], s[86:87]
    s_min_u32 s56, s60, 2048
    s_add_u32 m0, s56, 155648
    s_cmp_lt_u32 s52, 2
    s_cselect_b64 s[28:29], s[28:29], s[16:17]
    s_cselect_b32 s30, 676, s18
    s_cselect_b32 s57, 0, s57
    s_cselect_b32 s59, 4, 7
    s_mov_b32 s31, 0x00020000
    v_lshlrev_b32 v232, s59, v230
    buffer_load_dwordx4 v232, s[28:31], s57 offen lds
    s_branch L_A2
L_B:
    s_cmp_lt_u32 s52, 4
    s_cbranch_scc1 L_Bc
    s_setprio 3
    v_bfe_u32 v14, v0, 4, 4
    v_lshlrev_b32 v14, 9, v14
    v_bfe_u32 v15, v0, 4, 2
    v_lshlrev_b32 v15, 2, v15
    s_and_b32 s56, s52, 2
    v_xor_b32 v15, v15, v0
    v_xor_b32 v15, s56, v15
    v_and_b32 v15, 15, v15
    v_lshl_add_u32 v14, v15, 4, v14
    s_lshl_b32 s56, s54, 8
    v_add_u32 v1, s56, v14
    s_and_b32 s60, s52, 3
    s_lshl_b32 s60, s60, 10
    v_bfe_u32 v14, v0, 3, 5
    v_mul_u32_u24 v14, 104, v14
    v_and_b32 v15, 7, v0
    v_lshl_add_u32 v14, v15, 4, v14
    s_mul_i32 s57, s53, 6656
    s_lshr_b32 s58, s2, 5
    s_lshl_b32 s56, s58, 15
    s_mov_b32 s59, 0
    s_waitcnt lgkmcnt(0)
    buffer_load_dwordx4 v[4:7], v14, s[8:11], s57 offen
    buffer_load_dwordx4 v[8:11], v14, s[8:11], s57 offen offset:3328
    s_mov_b32 s38, 512
    s_mov_b32 s39, 0x00020000
    s_mov_b64 s[36:37], s[92:93]
    s_lshr_b32 s58, s60, 3
    s_mov_b64 exec, 1
    buffer_load_dword v16, off, s[36:39], s58
    s_mov_b64 exec, -1
L_lead:
    s_lshr_b32 s58, s56, 1
    s_add_u32 m0, s58, s60
    s_add_u32 s59, s59, 1
    buffer_load_dwordx4 v1, s[16:19], s56 offen lds
    s_addk_i32 m0, 0x1000
    s_addk_i32 s56, 0x2000
    buffer_load_dwordx4 v1, s[16:19], s56 offen lds
    s_addk_i32 m0, 0x1000
    s_addk_i32 s56, 0x2000
    buffer_load_dwordx4 v1, s[16:19], s56 offen lds
    s_addk_i32 m0, 0x1000
    s_addk_i32 s56, 0x2000
    buffer_load_dwordx4 v1, s[16:19], s56 offen lds
    s_addk_i32 s56, 0x2000
    s_and_b32 s56, s56, 262143
    s_cmp_lt_u32 s59, 8
    s_cbranch_scc1 L_lead
    s_branch L_Bl2
L_A2:
    s_and_b32 s56, s60, 0x1000
    s_mul_i32 s56, s56, 3
    s_add_u32 s78, s60, s56
    v_lshrrev_b32 v229, 4, v0
    v_xor_b32 v229, v229, v0
    v_and_b32 v229, 7, v229
    v_lshlrev_b32 v1, 4, v229
    v_and_b32 v147, 15, v0
    v_bfe_u32 v148, v0, 4, 2
    v_bfe_u32 v228, v0, 1, 3
    s_and_b32 s56, s60, 0x400
    s_lshl_b32 s56, s56, 1
    v_lshl_add_u32 v15, v147, 7, s56
    v_xor_b32 v230, v148, v228
    v_lshl_add_u32 v10, v230, 4, v15
    v_xor_b32 v12, 64, v10
    v_xor_b32 v11, 0x800, v10
    v_xor_b32 v13, 0x800, v12
    v_bfe_u32 v150, v0, 2, 2
    v_and_b32 v229, 1, v0
    v_lshl_add_u32 v229, v150, 1, v229
    v_bfe_u32 v232, v0, 1, 1
    v_lshl_add_u32 v151, v232, 3, v229
    s_lshl_b32 s56, s52, 3
    v_xor_b32 v231, s56, v151
    v_lshl_add_u32 v231, v148, 9, v231
    s_mov_b32 s56, 139264
    v_lshl_add_u32 v149, v231, 1, s56
    s_lshl_b32 s56, s52, 11
    s_add_u32 s56, s56, 106496
    s_xor_b32 s57, s56, 0x800
    v_lshl_add_u32 v231, v148, 7, v147
    v_lshl_add_u32 v27, v231, 2, s57
    v_and_b32 v231, 63, v0
    v_lshl_add_u32 v25, v231, 2, s56
    v_and_b32 v232, 3, v0
    v_bfe_u32 v233, v0, 2, 3
    v_lshl_add_u32 v231, v232, 6, v233
    s_lshl_b32 s56, s52, 4
    s_add_u32 s56, s56, 106496
    v_lshl_add_u32 v96, v231, 1, s56
    v_mul_u32_u24 v231, 3328, v233
    v_lshl_add_u32 v97, v232, 4, v231
    v_mov_b32 v103, 0
    s_lshl2_add_u32 s57, s63, s79
    s_lshl_b32 s57, s57, 2
    s_mul_i32 s56, s79, 3
    s_min_u32 s56, s56, 8
    s_mul_i32 s58, s63, 10
    s_add_u32 s56, s56, s58
    s_add_u32 s56, s56, 64
    s_cmp_lt_u32 s79, 2
    s_mov_b32 s79, 0x33333333
    s_cselect_b32 s79, 0x77777777, s79
    s_cmp_eq_u32 s55, 0
    s_cselect_b32 s56, s57, s56
    s_cselect_b32 s79, -1, s79
    s_lshr_b32 s57, s53, 5
    s_mul_i32 s57, s57, 104
    s_add_u32 s56, s56, s57
    s_lshl_b32 s56, s56, 4
    s_mul_i32 s61, s52, 26624
    s_add_u32 s61, s61, 262144
    s_add_u32 s56, s56, s61
    s_add_u32 s62, s56, s82
    s_lshl_b32 s56, s63, 3
    s_lshl_b32 s55, 0xff, s56
    s_mov_b32 s50, 268435456
    s_mov_b32 s51, 0x00020000
    s_mov_b64 s[48:49], s[98:99]
    v_and_b32 v231, 31, v0
    v_bfe_u32 v232, v0, 5, 1
    v_lshl_add_u32 v231, v232, 6, v231
    s_lshl2_add_u32 s56, s53, s54
    s_lshl_b32 s56, s56, 8
    v_lshl_add_u32 v20, v231, 3, s56
    s_waitcnt vmcnt(3)
    v_lshlrev_b32 v2, 7, v2
    v_lshlrev_b32 v3, 7, v3
    v_lshlrev_b32 v4, 7, v4
    v_lshlrev_b32 v5, 7, v5
    v_add_u32_dpp v6, v2, v1 row_newbcast:0 row_mask:0xf bank_mask:0x3
    s_add_u32 m0, s78, 0
    v_add_u32_dpp v6, v2, v1 row_newbcast:8 row_mask:0xf bank_mask:0xc
    buffer_load_dwordx4 v6, s[12:15], 0 offen lds
    v_add_u32_dpp v9, v3, v1 row_newbcast:0 row_mask:0xf bank_mask:0x3
    s_add_u32 m0, s78, 4096
    v_add_u32_dpp v9, v3, v1 row_newbcast:8 row_mask:0xf bank_mask:0xc
    buffer_load_dwordx4 v9, s[12:15], 0 offen lds
    v_add_u32_dpp v6, v4, v1 row_newbcast:0 row_mask:0xf bank_mask:0x3
    s_add_u32 m0, s78, 8192
    v_add_u32_dpp v6, v4, v1 row_newbcast:8 row_mask:0xf bank_mask:0xc
    buffer_load_dwordx4 v6, s[12:15], 0 offen lds
    v_add_u32_dpp v9, v5, v1 row_newbcast:0 row_mask:0xf bank_mask:0x3
    s_add_u32 m0, s78, 12288
    v_add_u32_dpp v9, v5, v1 row_newbcast:8 row_mask:0xf bank_mask:0xc
    buffer_load_dwordx4 v9, s[12:15], 0 offen lds
    v_add_u32_dpp v6, v2, v1 row_newbcast:2 row_mask:0xf bank_mask:0x3
    s_add_u32 m0, s78, 32768
    v_add_u32_dpp v6, v2, v1 row_newbcast:10 row_mask:0xf bank_mask:0xc
    buffer_load_dwordx4 v6, s[12:15], 0 offen lds
    s_waitcnt vmcnt(6)
    s_barrier
    ds_read_u16 v108, v96 offset:0
    ds_read_u16 v109, v96 offset:512
    ds_read_u16 v110, v96 offset:1024
    ds_read_u16 v111, v96 offset:1536
    ds_read_u16 v112, v96 offset:2048
    ds_read_u16 v113, v96 offset:2560
    ds_read_u16 v114, v96 offset:3072
    ds_read_u16 v115, v96 offset:3584
    ds_read_u16 v196, v149 offset:0
    ds_read_u16 v197, v149 offset:128
    ds_read_u16 v198, v149 offset:256
    ds_read_u16 v199, v149 offset:384
    ds_read_u16 v200, v149 offset:512
    ds_read_u16 v201, v149 offset:640
    ds_read_u16 v202, v149 offset:768
    s_waitcnt lgkmcnt(11)
    ds_read_u16 v203, v149 offset:896
    ds_read_u16 v204, v149 offset:4096
    ds_read_u16 v205, v149 offset:4224
    ds_read_u16 v206, v149 offset:4352
    s_waitcnt lgkmcnt(11)
    ds_read_u16 v207, v149 offset:4480
    ds_read_u16 v208, v149 offset:4608
    ds_read_u16 v209, v149 offset:4736
    ds_read_u16 v210, v149 offset:4864
    s_waitcnt lgkmcnt(11)
    ds_read_u16 v211, v149 offset:4992
    s_cmp_ge_u32 s52, 4
    s_cbranch_scc1 L_o1
    s_lshl_b32 s56, s52, 28
    buffer_load_dword v21, v20, s[48:51], s56 offen offset:4 sc1
    s_add_u32 s56, s56, 0x10000
    buffer_load_dword v26, v20, s[48:51], s56 offen offset:4 sc1
L_o1:
    v_lshl_or_b32 v100, v109, 16, v108
    v_lshl_or_b32 v101, v111, 16, v110
    v_lshl_or_b32 v102, v113, 16, v112
    s_mov_b32 exec_hi, 0
    s_mov_b32 exec_lo, s55
    v_lshl_or_b32 v103, v115, 16, v114
    s_mov_b32 exec_lo, s79
    buffer_store_dwordx4 v[100:103], v97, s[48:51], s62 offen sc1
    s_mov_b64 exec, -1
    s_waitcnt lgkmcnt(0)
    v_lshl_or_b32 v152, v197, 16, v196
    v_lshl_or_b32 v153, v199, 16, v198
    v_lshl_or_b32 v154, v201, 16, v200
    v_lshl_or_b32 v155, v203, 16, v202
    v_lshl_or_b32 v156, v205, 16, v204
    v_lshl_or_b32 v157, v207, 16, v206
    v_lshl_or_b32 v158, v209, 16, v208
    v_lshl_or_b32 v159, v211, 16, v210
    s_cmp_ge_u32 s52, 4
    s_cbranch_scc1 L_o2
    v_and_b32 v232, 3, v0
    v_mov_b32 v233, 0x3c803c80
    v_cmp_eq_u32 vcc, 0, v232
    s_nop 1
    v_cndmask_b32 v128, 0, v233, vcc
    v_mov_b32 v129, v128
    v_mov_b32 v130, v128
    v_mov_b32 v131, v128
    v_cmp_eq_u32 vcc, 1, v232
    s_nop 1
    v_cndmask_b32 v132, 0, v233, vcc
    v_mov_b32 v133, v132
    v_mov_b32 v134, v132
    v_mov_b32 v135, v132
    v_cmp_eq_u32 vcc, 2, v232
    s_nop 1
    v_cndmask_b32 v136, 0, v233, vcc
    v_mov_b32 v137, v136
    v_mov_b32 v138, v136
    v_mov_b32 v139, v136
    v_cmp_eq_u32 vcc, 3, v232
    s_nop 1
    v_cndmask_b32 v140, 0, v233, vcc
    v_mov_b32 v141, v140
    v_mov_b32 v142, v140
    v_mov_b32 v143, v140
L_o2:
    v_add_u32_dpp v9, v3, v1 row_newbcast:2 row_mask:0xf bank_mask:0x3
    s_add_u32 m0, s78, 36864
    v_add_u32_dpp v9, v3, v1 row_newbcast:10 row_mask:0xf bank_mask:0xc
    buffer_load_dwordx4 v9, s[12:15], 0 offen lds
    s_cmp_ge_u32 s52, 4
    s_cbranch_scc1 L_o3
    s_waitcnt vmcnt(5)
L_o3:
    s_barrier
    ds_read_b128 v[196:199], v10 offset:0
    ds_read_b128 v[200:203], v12 offset:0
    ds_read_b128 v[204:207], v10 offset:4096
    ds_read_b128 v[208:211], v12 offset:4096
    ds_read_b128 v[212:215], v10 offset:8192
    ds_read_b128 v[216:219], v12 offset:8192
    ds_read_b128 v[220:223], v10 offset:12288
    ds_read_b128 v[224:227], v12 offset:12288
    v_add_u32_dpp v6, v4, v1 row_newbcast:2 row_mask:0xf bank_mask:0x3
    s_add_u32 m0, s78, 40960
    v_add_u32_dpp v6, v4, v1 row_newbcast:10 row_mask:0xf bank_mask:0xc
    buffer_load_dwordx4 v6, s[12:15], 0 offen lds
    v_bfe_u32 v98, v0, 1, 3
    v_xor_b32 v98, s52, v98
    v_lshl_add_u32 v98, v98, 4, v15
    v_lshl_add_u32 v14, v148, 13, v98
    v_xor_b32 v15, 0x800, v14
    v_min_u32 v99, 1, v148
    v_add_u32 v99, 24, v99
    v_lshl_add_u32 v16, v99, 12, v98
    v_xor_b32 v17, 0x800, v16
    v_and_b32 v98, 63, v0
    v_lshlrev_b32 v18, 4, v98
    s_lshl3_add_u32 s56, s6, s52
    s_mul_i32 s56, s56, 1664
    s_add_u32 s56, s56, 262144
    v_lshl_add_u32 v23, v98, 7, s56
    v_mul_u32_u24 v98, 3, v150
    v_min_u32 v98, 8, v98
    v_mad_u32_u24 v98, v148, 10, v98
    v_and_b32 v99, 3, v0
    v_bfrev_b32 v19, 2
    s_mov_b32 exec_lo, 0x33773377
    s_mov_b32 exec_hi, 0x33773377
    v_add_lshl_u32 v19, v98, v99, 4
    s_mov_b64 exec, -1
    s_and_b32 s56, s52, 1
    s_mul_i32 s58, s56, 2304
    s_sub_u32 s59, 160000, s58
    s_add_u32 s58, s58, 157696
    v_mul_u32_u24 v98, 144, v147
    v_lshl_add_u32 v98, v148, 5, v98
    v_add_u32 v29, s58, v98
    v_add_u32 v30, s59, v98
    s_lshl_b32 s7, s52, 11
    s_add_u32 s7, s7, 106496
    v_add_u32 v31, s7, v18
    s_cmp_ge_u32 s52, 4
    s_cbranch_scc1 L_o4
    s_and_b32 s57, s52, 2
    s_lshl_b32 s57, s57, 3
    v_add_u32 v98, s57, v151
    v_add_u32 v99, 24, v150
    v_min_u32 v98, v98, v99
    v_mov_b32 v149, 155648
    s_movk_i32 s59, 208
    v_mad_u32_u24 v99, v148, s59, v149
    v_lshl_add_u32 v146, v98, 1, v99
    v_lshl_add_u32 v149, v147, 1, v149
    v_mad_u32_u24 v145, v148, 26, v149
    v_mad_u32_u24 v144, v148, 52, v149
    v_add_u32 v28, s57, v29
    s_mov_b32 s42, 8192
    s_mov_b32 s43, 0x00020000
    s_mov_b32 s46, 256
    s_mov_b32 s47, 0x00020000
    s_mov_b64 s[40:41], s[94:95]
    s_mov_b64 s[44:45], s[96:97]
    s_mov_b32 s66, 0xc0135761
    s_mov_b32 s67, 0xbdd2d3e8
    s_mov_b32 s68, 0xffff0000
    s_mov_b32 s69, 0xbfb8aa3b
    v_mov_b32 v163, 0
L_o4:
    v_add_u32_dpp v9, v5, v1 row_newbcast:2 row_mask:0xf bank_mask:0x3
    s_add_u32 m0, s78, 45056
    v_add_u32_dpp v9, v5, v1 row_newbcast:10 row_mask:0xf bank_mask:0xc
    buffer_load_dwordx4 v9, s[12:15], 0 offen lds
    s_cmp_ge_u32 s52, 4
    s_cbranch_scc1 L_o5
    s_waitcnt lgkmcnt(4)
    ds_read_u16 v116, v144 offset:0
    ds_read_u16 v117, v144 offset:26
    ds_read_u16 v118, v144 offset:208
    ds_read_u16 v119, v144 offset:234
    ds_read_u16 v120, v144 offset:416
    ds_read_u16 v121, v144 offset:442
    ds_read_u16 v167, v145 offset:624
    ds_read_u16 v124, v146 offset:1024
    ds_read_u16 v125, v146 offset:1076
    ds_read_u16 v126, v146 offset:1128
    ds_read_u16 v127, v146 offset:1180
    s_waitcnt lgkmcnt(0)
    v_lshl_or_b32 v164, v117, 16, v116
    v_lshl_or_b32 v165, v119, 16, v118
    v_lshl_or_b32 v166, v121, 16, v120
    v_lshl_or_b32 v168, v125, 16, v124
    v_lshl_or_b32 v169, v127, 16, v126
L_o5:
    s_waitcnt vmcnt(3)
    s_barrier
    s_cmp_ge_u32 s52, 4
    s_cbranch_scc1 L_o6
    s_lshl_b32 s56, s54, 4
    s_lshl_b32 s56, 0x100, s56
    v_mov_b32 v151, s56
    s_lshl_b32 s56, s52, 6
    s_add_u32 s56, s56, s53
    s_lshl2_add_u32 s56, s56, s82
    s_mov_b64 exec, 1
    buffer_atomic_or v151, off, s[44:47], s56 sc1
    s_mov_b64 exec, -1
L_o6:
    s_waitcnt lgkmcnt(6)
    v_mfma_f32_16x16x32_bf16 v[180:183], v[152:155], v[196:199], 0
    ds_read_b128 v[236:239], v10 offset:16384
    v_mfma_f32_16x16x32_bf16 v[180:183], v[156:159], v[200:203], v[180:183]
    ds_read_b128 v[240:243], v12 offset:16384
    s_waitcnt lgkmcnt(6)
    v_mfma_f32_16x16x32_bf16 v[184:187], v[152:155], v[204:207], 0
    ds_read_b128 v[244:247], v10 offset:20480
    v_mfma_f32_16x16x32_bf16 v[184:187], v[156:159], v[208:211], v[184:187]
    ds_read_b128 v[248:251], v12 offset:20480
    s_waitcnt lgkmcnt(6)
    v_mfma_f32_16x16x32_bf16 v[188:191], v[152:155], v[212:215], 0
    ds_read_b128 v[228:231], v10 offset:24576
    v_mfma_f32_16x16x32_bf16 v[188:191], v[156:159], v[216:219], v[188:191]
    ds_read_b128 v[232:235], v12 offset:24576
    s_waitcnt lgkmcnt(6)
    v_mfma_f32_16x16x32_bf16 v[192:195], v[152:155], v[220:223], 0
    ds_read_b128 v[252:255], v10 offset:28672
    v_mfma_f32_16x16x32_bf16 v[192:195], v[156:159], v[224:227], v[192:195]
    ds_read_b128 v[172:175], v12 offset:28672
    v_add_u32_dpp v6, v2, v1 row_newbcast:4 row_mask:0xf bank_mask:0x3
    s_add_u32 m0, s78, 65536
    v_add_u32_dpp v6, v2, v1 row_newbcast:12 row_mask:0xf bank_mask:0xc
    buffer_load_dwordx4 v6, s[12:15], 0 offen lds
    v_cvt_pk_bf16_f32 v182, v182, v186
    v_cvt_pk_bf16_f32 v183, v183, v187
    ds_write2_b32 v27, v182, v183 offset0:0 offset1:64
    v_cvt_pk_bf16_f32 v32, v180, v184
    v_cvt_pk_bf16_f32 v40, v181, v185
    v_cvt_pk_bf16_f32 v190, v190, v194
    v_cvt_pk_bf16_f32 v191, v191, v195
    ds_write2_b32 v27, v190, v191 offset0:16 offset1:80
    v_cvt_pk_bf16_f32 v48, v188, v192
    v_cvt_pk_bf16_f32 v56, v189, v193
    v_add_u32_dpp v9, v3, v1 row_newbcast:4 row_mask:0xf bank_mask:0x3
    s_add_u32 m0, s78, 69632
    v_add_u32_dpp v9, v3, v1 row_newbcast:12 row_mask:0xf bank_mask:0xc
    buffer_load_dwordx4 v9, s[12:15], 0 offen lds
    s_cmp_ge_u32 s52, 4
    s_cbranch_scc1 L_o7
    v_mfma_f32_16x16x32_bf16 v[176:179], v[128:131], v[196:199], 0
    v_mfma_f32_16x16x32_bf16 v[176:179], v[128:131], v[200:203], v[176:179]
    v_mfma_f32_16x16x32_bf16 v[176:179], v[132:135], v[204:207], v[176:179]
    v_mfma_f32_16x16x32_bf16 v[176:179], v[132:135], v[208:211], v[176:179]
    v_mfma_f32_16x16x32_bf16 v[176:179], v[136:139], v[212:215], v[176:179]
    v_mfma_f32_16x16x32_bf16 v[176:179], v[136:139], v[216:219], v[176:179]
    v_mfma_f32_16x16x32_bf16 v[176:179], v[140:143], v[220:223], v[176:179]
    v_mfma_f32_16x16x32_bf16 v[176:179], v[140:143], v[224:227], v[176:179]
L_o7:
    s_cmp_ge_u32 s52, 4
    s_cbranch_scc1 L_o8
    s_waitcnt vmcnt(3)
L_o8:
    s_barrier
    s_waitcnt lgkmcnt(8)
    v_mfma_f32_16x16x32_bf16 v[180:183], v[152:155], v[236:239], 0
    ds_read_b128 v[196:199], v10 offset:32768
    v_mfma_f32_16x16x32_bf16 v[180:183], v[156:159], v[240:243], v[180:183]
    ds_read_b128 v[200:203], v12 offset:32768
    s_waitcnt lgkmcnt(8)
    v_mfma_f32_16x16x32_bf16 v[184:187], v[152:155], v[244:247], 0
    ds_read_b128 v[204:207], v10 offset:36864
    v_mfma_f32_16x16x32_bf16 v[184:187], v[156:159], v[248:251], v[184:187]
    ds_read_b128 v[208:211], v12 offset:36864
    s_waitcnt lgkmcnt(8)
    v_mfma_f32_16x16x32_bf16 v[188:191], v[152:155], v[228:231], 0
    ds_read_b128 v[212:215], v10 offset:40960
    v_mfma_f32_16x16x32_bf16 v[188:191], v[156:159], v[232:235], v[188:191]
    ds_read_b128 v[216:219], v12 offset:40960
    s_waitcnt lgkmcnt(8)
    v_mfma_f32_16x16x32_bf16 v[192:195], v[152:155], v[252:255], 0
    ds_read_b128 v[220:223], v10 offset:45056
    v_mfma_f32_16x16x32_bf16 v[192:195], v[156:159], v[172:175], v[192:195]
    ds_read_b128 v[224:227], v12 offset:45056
    v_add_u32_dpp v6, v4, v1 row_newbcast:4 row_mask:0xf bank_mask:0x3
    s_add_u32 m0, s78, 73728
    v_add_u32_dpp v6, v4, v1 row_newbcast:12 row_mask:0xf bank_mask:0xc
    buffer_load_dwordx4 v6, s[12:15], 0 offen lds
    v_cvt_pk_bf16_f32 v182, v182, v186
    v_cvt_pk_bf16_f32 v183, v183, v187
    ds_write2_b32 v27, v182, v183 offset0:32 offset1:96
    v_cvt_pk_bf16_f32 v64, v180, v184
    v_cvt_pk_bf16_f32 v72, v181, v185
    v_cvt_pk_bf16_f32 v190, v190, v194
    v_cvt_pk_bf16_f32 v191, v191, v195
    ds_write2_b32 v27, v190, v191 offset0:48 offset1:112
    v_cvt_pk_bf16_f32 v80, v188, v192
    v_cvt_pk_bf16_f32 v88, v189, v193
    v_permlane32_swap_b32 v32, v64
    v_permlane32_swap_b32 v48, v80
    v_permlane32_swap_b32 v40, v72
    v_permlane32_swap_b32 v56, v88
    v_permlane16_swap_b32 v32, v48
    v_permlane16_swap_b32 v64, v80
    v_permlane16_swap_b32 v40, v56
    v_permlane16_swap_b32 v72, v88
    v_add_u32_dpp v9, v5, v1 row_newbcast:4 row_mask:0xf bank_mask:0x3
    s_add_u32 m0, s78, 77824
    v_add_u32_dpp v9, v5, v1 row_newbcast:12 row_mask:0xf bank_mask:0xc
    buffer_load_dwordx4 v9, s[12:15], 0 offen lds
    s_cmp_ge_u32 s52, 4
    s_cbranch_scc1 L_o9
    v_cvt_pk_bf16_f32 v176, v176, v177
    v_cvt_pk_bf16_f32 v178, v178, v179
    s_nop 0
    v_mov_b32_dpp v160, v176 quad_perm:[0,1,2,3] row_mask:0x1 bank_mask:0xf
    v_mov_b32_dpp v160, v178 quad_perm:[0,1,2,3] row_mask:0x2 bank_mask:0xf
    v_mfma_f32_16x16x32_bf16 v[176:179], v[128:131], v[236:239], 0
    v_mfma_f32_16x16x32_bf16 v[176:179], v[128:131], v[240:243], v[176:179]
    v_mfma_f32_16x16x32_bf16 v[176:179], v[132:135], v[244:247], v[176:179]
    v_mfma_f32_16x16x32_bf16 v[176:179], v[132:135], v[248:251], v[176:179]
    v_mfma_f32_16x16x32_bf16 v[176:179], v[136:139], v[228:231], v[176:179]
    v_mfma_f32_16x16x32_bf16 v[176:179], v[136:139], v[232:235], v[176:179]
    v_mfma_f32_16x16x32_bf16 v[176:179], v[140:143], v[252:255], v[176:179]
    v_mfma_f32_16x16x32_bf16 v[176:179], v[140:143], v[172:175], v[176:179]
L_o9:
    s_cmp_lt_u32 s52, 4
    s_cbranch_scc1 L_o10
    s_waitcnt vmcnt(4)
L_o10:
    s_barrier
    s_waitcnt lgkmcnt(8)
    v_mfma_f32_16x16x32_bf16 v[180:183], v[152:155], v[196:199], 0
    ds_read_b128 v[236:239], v10 offset:49152
    v_mfma_f32_16x16x32_bf16 v[180:183], v[156:159], v[200:203], v[180:183]
    ds_read_b128 v[240:243], v12 offset:49152
    s_waitcnt lgkmcnt(8)
    v_mfma_f32_16x16x32_bf16 v[184:187], v[152:155], v[204:207], 0
    ds_read_b128 v[244:247], v10 offset:53248
    v_mfma_f32_16x16x32_bf16 v[184:187], v[156:159], v[208:211], v[184:187]
    ds_read_b128 v[248:251], v12 offset:53248
    s_waitcnt lgkmcnt(8)
    v_mfma_f32_16x16x32_bf16 v[188:191], v[152:155], v[212:215], 0
    ds_read_b128 v[228:231], v10 offset:57344
    v_mfma_f32_16x16x32_bf16 v[188:191], v[156:159], v[216:219], v[188:191]
    ds_read_b128 v[232:235], v12 offset:57344
    s_waitcnt lgkmcnt(8)
    v_mfma_f32_16x16x32_bf16 v[192:195], v[152:155], v[220:223], 0
    ds_read_b128 v[252:255], v10 offset:61440
    v_mfma_f32_16x16x32_bf16 v[192:195], v[156:159], v[224:227], v[192:195]
    ds_read_b128 v[172:175], v12 offset:61440
    v_add_u32_dpp v6, v2, v1 row_newbcast:6 row_mask:0xf bank_mask:0x3
    s_add_u32 m0, s60, 98304
    v_add_u32_dpp v6, v2, v1 row_newbcast:14 row_mask:0xf bank_mask:0xc
    buffer_load_dwordx4 v6, s[12:15], 0 offen lds
    v_add_u32 v27, 0x4000, v27
    v_cvt_pk_bf16_f32 v182, v182, v186
    v_cvt_pk_bf16_f32 v183, v183, v187
    ds_write2_b32 v27, v182, v183 offset0:0 offset1:64
    v_cvt_pk_bf16_f32 v33, v180, v184
    v_cvt_pk_bf16_f32 v41, v181, v185
    v_cvt_pk_bf16_f32 v190, v190, v194
    v_cvt_pk_bf16_f32 v191, v191, v195
    ds_write2_b32 v27, v190, v191 offset0:16 offset1:80
    v_cvt_pk_bf16_f32 v49, v188, v192
    v_cvt_pk_bf16_f32 v57, v189, v193
    s_cmp_ge_u32 s52, 4
    s_cbranch_scc1 L_o11
    v_lshrrev_b32 v22, 2, v18
    s_lshl_b32 s56, s52, 8
    buffer_load_dword v22, v22, s[44:47], s56 offen sc1
L_o11:
    v_add_u32 v10, 0x10000, v10
    v_add_u32 v11, 0x10000, v11
    v_add_u32 v12, 0x10000, v12
    v_add_u32 v13, 0x10000, v13
    s_cmp_ge_u32 s52, 4
    s_cbranch_scc1 L_o12
    v_cvt_pk_bf16_f32 v176, v176, v177
    v_cvt_pk_bf16_f32 v178, v178, v179
    s_nop 0
    v_mov_b32_dpp v160, v176 quad_perm:[0,1,2,3] row_mask:0x4 bank_mask:0xf
    v_mov_b32_dpp v160, v178 quad_perm:[0,1,2,3] row_mask:0x8 bank_mask:0xf
    v_mfma_f32_16x16x32_bf16 v[176:179], v[128:131], v[196:199], 0
    v_mfma_f32_16x16x32_bf16 v[176:179], v[128:131], v[200:203], v[176:179]
    v_mfma_f32_16x16x32_bf16 v[176:179], v[132:135], v[204:207], v[176:179]
    v_mfma_f32_16x16x32_bf16 v[176:179], v[132:135], v[208:211], v[176:179]
    v_mfma_f32_16x16x32_bf16 v[176:179], v[136:139], v[212:215], v[176:179]
    v_mfma_f32_16x16x32_bf16 v[176:179], v[136:139], v[216:219], v[176:179]
    v_mfma_f32_16x16x32_bf16 v[176:179], v[140:143], v[220:223], v[176:179]
    v_mfma_f32_16x16x32_bf16 v[176:179], v[140:143], v[224:227], v[176:179]
L_o12:
    s_cmp_ge_u32 s52, 4
    s_cbranch_scc1 L_o13
    s_waitcnt vmcnt(2)
L_o13:
    s_barrier
    s_waitcnt lgkmcnt(8)
    v_mfma_f32_16x16x32_bf16 v[180:183], v[152:155], v[236:239], 0
    ds_read_b128 v[196:199], v10 offset:0
    v_mfma_f32_16x16x32_bf16 v[180:183], v[156:159], v[240:243], v[180:183]
    ds_read_b128 v[200:203], v12 offset:0
    s_waitcnt lgkmcnt(8)
    v_mfma_f32_16x16x32_bf16 v[184:187], v[152:155], v[244:247], 0
    ds_read_b128 v[204:207], v10 offset:4096
    v_mfma_f32_16x16x32_bf16 v[184:187], v[156:159], v[248:251], v[184:187]
    ds_read_b128 v[208:211], v12 offset:4096
    s_waitcnt lgkmcnt(8)
    v_mfma_f32_16x16x32_bf16 v[188:191], v[152:155], v[228:231], 0
    ds_read_b128 v[212:215], v10 offset:8192
    v_mfma_f32_16x16x32_bf16 v[188:191], v[156:159], v[232:235], v[188:191]
    ds_read_b128 v[216:219], v12 offset:8192
    s_waitcnt lgkmcnt(8)
    v_mfma_f32_16x16x32_bf16 v[192:195], v[152:155], v[252:255], 0
    ds_read_b128 v[220:223], v10 offset:12288
    v_mfma_f32_16x16x32_bf16 v[192:195], v[156:159], v[172:175], v[192:195]
    ds_read_b128 v[224:227], v12 offset:12288
    v_cvt_pk_bf16_f32 v182, v182, v186
    v_cvt_pk_bf16_f32 v183, v183, v187
    ds_write2_b32 v27, v182, v183 offset0:32 offset1:96
    v_cvt_pk_bf16_f32 v65, v180, v184
    v_cvt_pk_bf16_f32 v73, v181, v185
    s_nop 1
    v_cvt_pk_bf16_f32 v190, v190, v194
    v_cvt_pk_bf16_f32 v191, v191, v195
    ds_write2_b32 v27, v190, v191 offset0:48 offset1:112
    v_cvt_pk_bf16_f32 v81, v188, v192
    v_cvt_pk_bf16_f32 v89, v189, v193
    v_permlane32_swap_b32 v33, v65
    v_permlane32_swap_b32 v49, v81
    v_permlane32_swap_b32 v41, v73
    v_permlane32_swap_b32 v57, v89
    v_permlane16_swap_b32 v33, v49
    v_permlane16_swap_b32 v65, v81
    v_permlane16_swap_b32 v41, v57
    v_permlane16_swap_b32 v73, v89
    s_cmp_ge_u32 s52, 4
    s_cbranch_scc1 L_o14
    s_lshl_b32 s57, s52, 17
    s_add_u32 s57, s57, 524288
    buffer_load_dword v8, v7, s[16:19], s57 offen
L_o14:
    s_cmp_ge_u32 s52, 4
    s_cbranch_scc1 L_o15
    v_cvt_pk_bf16_f32 v176, v176, v177
    v_cvt_pk_bf16_f32 v178, v178, v179
    s_nop 0
    v_mov_b32_dpp v161, v176 quad_perm:[0,1,2,3] row_mask:0x1 bank_mask:0xf
    v_mov_b32_dpp v161, v178 quad_perm:[0,1,2,3] row_mask:0x2 bank_mask:0xf
    v_mfma_f32_16x16x32_bf16 v[176:179], v[128:131], v[236:239], 0
    v_mfma_f32_16x16x32_bf16 v[176:179], v[128:131], v[240:243], v[176:179]
    v_mfma_f32_16x16x32_bf16 v[176:179], v[132:135], v[244:247], v[176:179]
    v_mfma_f32_16x16x32_bf16 v[176:179], v[132:135], v[248:251], v[176:179]
    v_mfma_f32_16x16x32_bf16 v[176:179], v[136:139], v[228:231], v[176:179]
    v_mfma_f32_16x16x32_bf16 v[176:179], v[136:139], v[232:235], v[176:179]
    v_mfma_f32_16x16x32_bf16 v[176:179], v[140:143], v[252:255], v[176:179]
    v_mfma_f32_16x16x32_bf16 v[176:179], v[140:143], v[172:175], v[176:179]
L_o15:
    s_cmp_ge_u32 s52, 4
    s_cbranch_scc1 L_o16
    s_waitcnt vmcnt(1)
L_o16:
    s_cmp_lt_u32 s52, 4
    s_cbranch_scc1 L_o17
    s_waitcnt vmcnt(0)
L_o17:
    s_waitcnt lgkmcnt(0)
    s_cmp_lg_u32 s52, 0
    s_cbranch_scc1 L_flok
L_flp:
    v_and_b32 v22, 0x01000100, v22
    v_cmp_ne_u32 vcc, 0x01000100, v22
    s_nop 0
    s_or_b32 vcc_lo, vcc_lo, vcc_hi
    s_and_b32 vcc_lo, vcc_lo, 0x0f0f0f0f
    s_cbranch_scc0 L_flok
    s_sleep 8
    v_lshrrev_b32 v22, 2, v18
    buffer_load_dword v22, v22, s[44:47], 0 offen sc1
    s_waitcnt vmcnt(0)
    s_branch L_flp
L_flok:
    s_barrier
    s_mov_b64 exec, 0x1fff
    buffer_load_dword v8, v23, s[48:51], 0 offen sc1
    s_mov_b64 exec, -1
    v_mfma_f32_16x16x32_bf16 v[180:183], v[152:155], v[196:199], 0
    ds_read_b128 v[236:239], v10 offset:16384
    v_mfma_f32_16x16x32_bf16 v[180:183], v[156:159], v[200:203], v[180:183]
    ds_read_b128 v[240:243], v12 offset:16384
    v_mfma_f32_16x16x32_bf16 v[184:187], v[152:155], v[204:207], 0
    ds_read_b128 v[244:247], v10 offset:20480
    v_mfma_f32_16x16x32_bf16 v[184:187], v[156:159], v[208:211], v[184:187]
    ds_read_b128 v[248:251], v12 offset:20480
    v_mfma_f32_16x16x32_bf16 v[188:191], v[152:155], v[212:215], 0
    ds_read_b128 v[228:231], v10 offset:24576
    v_mfma_f32_16x16x32_bf16 v[188:191], v[156:159], v[216:219], v[188:191]
    ds_read_b128 v[232:235], v12 offset:24576
    v_mfma_f32_16x16x32_bf16 v[192:195], v[152:155], v[220:223], 0
    ds_read_b128 v[252:255], v10 offset:28672
    v_mfma_f32_16x16x32_bf16 v[192:195], v[156:159], v[224:227], v[192:195]
    ds_read_b128 v[172:175], v12 offset:28672
    s_add_u32 s80, s61, 0
    buffer_load_dwordx4 v[96:99], v18, s[48:51], s80 offen offset:0 sc1
    s_add_u32 s81, s61, 3328
    buffer_load_dwordx4 v[100:103], v18, s[48:51], s81 offen offset:0 sc1
    v_add_u32 v27, 0x4000, v27
    v_cvt_pk_bf16_f32 v182, v182, v186
    v_cvt_pk_bf16_f32 v183, v183, v187
    ds_write2_b32 v27, v182, v183 offset0:0 offset1:64
    v_cvt_pk_bf16_f32 v34, v180, v184
    v_cvt_pk_bf16_f32 v42, v181, v185
    v_cvt_pk_bf16_f32 v190, v190, v194
    v_cvt_pk_bf16_f32 v191, v191, v195
    ds_write2_b32 v27, v190, v191 offset0:16 offset1:80
    v_cvt_pk_bf16_f32 v50, v188, v192
    v_cvt_pk_bf16_f32 v58, v189, v193
    ds_read2st64_b32 v[36:37], v25 offset0:0 offset1:64
    ds_read2st64_b32 v[44:45], v25 offset0:1 offset1:65
    ds_read2st64_b32 v[52:53], v25 offset0:2 offset1:66
    ds_read2st64_b32 v[60:61], v25 offset0:3 offset1:67
    ds_read2st64_b32 v[68:69], v25 offset0:4 offset1:68
    s_waitcnt lgkmcnt(11)
    ds_read2st64_b32 v[76:77], v25 offset0:5 offset1:69
    ds_read2st64_b32 v[84:85], v25 offset0:6 offset1:70
    ds_read2st64_b32 v[92:93], v25 offset0:7 offset1:71
    buffer_load_dwordx4 v[104:107], v18, s[48:51], s80 offen offset:1664 sc1
    buffer_load_dwordx4 v[108:111], v18, s[48:51], s81 offen offset:1664 sc1
    s_cmp_ge_u32 s52, 4
    s_cbranch_scc1 L_o18
    s_lshl_b32 s56, s54, 4
    s_lshl_b32 s56, 0x100, s56
    v_mov_b32 v151, s56
    s_lshl_b32 s56, s52, 6
    s_add_u32 s56, s56, s53
    s_lshl2_add_u32 s56, s56, s82
    s_xor_b32 s56, s56, 0x10000000
    s_mov_b64 exec, 1
    buffer_atomic_or v151, off, s[44:47], s56 sc1
    s_mov_b64 exec, -1
L_o18:
    s_cmp_ge_u32 s52, 4
    s_cbranch_scc1 L_o19
    v_cvt_pk_bf16_f32 v176, v176, v177
    v_cvt_pk_bf16_f32 v178, v178, v179
    s_nop 0
    v_mov_b32_dpp v161, v176 quad_perm:[0,1,2,3] row_mask:0x4 bank_mask:0xf
    v_mov_b32_dpp v161, v178 quad_perm:[0,1,2,3] row_mask:0x8 bank_mask:0xf
    v_mfma_f32_16x16x32_bf16 v[176:179], v[128:131], v[196:199], 0
    v_mfma_f32_16x16x32_bf16 v[176:179], v[128:131], v[200:203], v[176:179]
    v_mfma_f32_16x16x32_bf16 v[176:179], v[132:135], v[204:207], v[176:179]
    v_mfma_f32_16x16x32_bf16 v[176:179], v[132:135], v[208:211], v[176:179]
    v_mfma_f32_16x16x32_bf16 v[176:179], v[136:139], v[212:215], v[176:179]
    v_mfma_f32_16x16x32_bf16 v[176:179], v[136:139], v[216:219], v[176:179]
    v_mfma_f32_16x16x32_bf16 v[176:179], v[140:143], v[220:223], v[176:179]
    v_mfma_f32_16x16x32_bf16 v[176:179], v[140:143], v[224:227], v[176:179]
L_o19:
    ds_read_b128 v[196:199], v10 offset:32768
    s_waitcnt lgkmcnt(11)
    ds_read_b128 v[200:203], v12 offset:32768
    ds_read_b128 v[204:207], v10 offset:36864
    ds_read_b128 v[208:211], v12 offset:36864
    ds_read_b128 v[212:215], v11 offset:32768
    s_waitcnt lgkmcnt(11)
    ds_read_b128 v[216:219], v13 offset:32768
    ds_read_b128 v[220:223], v11 offset:36864
    ds_read_b128 v[224:227], v13 offset:36864
    v_add_u32 v22, 0x10000, v14
    v_add_u32 v23, 0x10000, v15
    s_cmp_ge_u32 s52, 4
    s_cbranch_scc1 L_nosenet
    v_cvt_pk_bf16_f32 v176, v176, v177
    v_cvt_pk_bf16_f32 v178, v178, v179
    s_nop 0
    v_mov_b32_dpp v162, v176 quad_perm:[0,1,2,3] row_mask:0x1 bank_mask:0xf
    v_mov_b32_dpp v162, v178 quad_perm:[0,1,2,3] row_mask:0x2 bank_mask:0xf
    v_mfma_f32_16x16x32_bf16 v[176:179], v[128:131], v[236:239], 0
    v_mfma_f32_16x16x32_bf16 v[176:179], v[128:131], v[240:243], v[176:179]
    v_mfma_f32_16x16x32_bf16 v[176:179], v[132:135], v[244:247], v[176:179]
    v_mfma_f32_16x16x32_bf16 v[176:179], v[132:135], v[248:251], v[176:179]
    v_mfma_f32_16x16x32_bf16 v[176:179], v[136:139], v[228:231], v[176:179]
    v_mfma_f32_16x16x32_bf16 v[176:179], v[136:139], v[232:235], v[176:179]
    v_mfma_f32_16x16x32_bf16 v[176:179], v[140:143], v[252:255], v[176:179]
    v_mfma_f32_16x16x32_bf16 v[176:179], v[140:143], v[172:175], v[176:179]
    s_waitcnt lgkmcnt(4)
    v_mfma_f32_16x16x32_bf16 v[112:115], v[128:131], v[196:199], 0
    v_mfma_f32_16x16x32_bf16 v[112:115], v[128:131], v[200:203], v[112:115]
    v_mfma_f32_16x16x32_bf16 v[112:115], v[132:135], v[204:207], v[112:115]
    v_mfma_f32_16x16x32_bf16 v[112:115], v[132:135], v[208:211], v[112:115]
    v_mfma_f32_16x16x32_bf16 v[180:183], v[152:155], v[236:239], 0
    v_mfma_f32_16x16x32_bf16 v[180:183], v[156:159], v[240:243], v[180:183]
    v_mfma_f32_16x16x32_bf16 v[184:187], v[152:155], v[244:247], 0
    v_mfma_f32_16x16x32_bf16 v[184:187], v[156:159], v[248:251], v[184:187]
    v_cvt_pk_bf16_f32 v176, v176, v177
    v_cvt_pk_bf16_f32 v178, v178, v179
    s_nop 0
    v_mov_b32_dpp v162, v176 quad_perm:[0,1,2,3] row_mask:0x4 bank_mask:0xf
    v_mov_b32_dpp v162, v178 quad_perm:[0,1,2,3] row_mask:0x8 bank_mask:0xf
    v_cvt_pk_bf16_f32 v112, v112, 0
    v_cvt_pk_bf16_f32 v113, v113, 0
    s_nop 0
    v_mov_b32_dpp v163, v112 quad_perm:[0,1,2,3] row_mask:0x1 bank_mask:0xf
    v_mov_b32_dpp v163, v113 quad_perm:[0,1,2,3] row_mask:0x2 bank_mask:0xf
    s_nop 1
    v_mfma_f32_16x16x32_bf16 v[128:131], v[164:167], v[160:163], 0
    v_mfma_f32_16x16x32_bf16 v[188:191], v[152:155], v[228:231], 0
    v_mfma_f32_16x16x32_bf16 v[188:191], v[156:159], v[232:235], v[188:191]
    v_mfma_f32_16x16x32_bf16 v[192:195], v[152:155], v[252:255], 0
    v_mfma_f32_16x16x32_bf16 v[192:195], v[156:159], v[172:175], v[192:195]
    v_cvt_pk_bf16_f32 v182, v182, v186
    v_cvt_pk_bf16_f32 v183, v183, v187
    ds_write2_b32 v27, v182, v183 offset0:32 offset1:96
    v_cvt_pk_bf16_f32 v66, v180, v184
    v_cvt_pk_bf16_f32 v74, v181, v185
    v_mov_b32 v148, s66
    v_cvt_pk_bf16_f32 v136, v128, v129
    v_cvt_pk_bf16_f32 v137, v130, v131
    v_lshlrev_b32 v128, 16, v136
    v_and_b32 v129, s68, v136
    v_lshlrev_b32 v130, 16, v137
    v_and_b32 v131, s68, v137
    v_mul_f32 v140, v128, v128
    v_mul_f32 v141, v129, v129
    v_mul_f32 v142, v130, v130
    v_mul_f32 v143, v131, v131
    v_fma_f32 v140, v140, s67, v148
    v_fma_f32 v141, v141, s67, v148
    v_fma_f32 v142, v142, s67, v148
    v_fma_f32 v143, v143, s67, v148
    v_mul_f32 v140, v140, v128
    v_mul_f32 v141, v141, v129
    v_mul_f32 v142, v142, v130
    v_mul_f32 v143, v143, v131
    v_exp_f32 v140, v140
    v_exp_f32 v141, v141
    v_exp_f32 v142, v142
    v_exp_f32 v143, v143
    v_add_f32 v140, 1.0, v140
    v_add_f32 v141, 1.0, v141
    v_add_f32 v142, 1.0, v142
    v_add_f32 v143, 1.0, v143
    v_rcp_f32 v140, v140
    v_rcp_f32 v141, v141
    v_rcp_f32 v142, v142
    v_rcp_f32 v143, v143
    v_mul_f32 v132, v128, v140
    v_mul_f32 v133, v129, v141
    v_mul_f32 v134, v130, v142
    v_mul_f32 v135, v131, v143
    v_cvt_pk_bf16_f32 v138, v132, v133
    v_cvt_pk_bf16_f32 v139, v134, v135
    s_nop 1
    v_mfma_f32_16x16x16_bf16 v[144:147], v[168:169], v[138:139], 0
    v_cvt_pk_bf16_f32 v190, v190, v194
    v_cvt_pk_bf16_f32 v191, v191, v195
    ds_write2_b32 v27, v190, v191 offset0:48 offset1:112
    v_cvt_pk_bf16_f32 v82, v188, v192
    v_cvt_pk_bf16_f32 v90, v189, v193
    s_nop 2
    v_cvt_pk_bf16_f32 v136, v144, v145
    v_cvt_pk_bf16_f32 v137, v146, v147
    v_lshlrev_b32 v128, 16, v136
    v_and_b32 v129, s68, v136
    v_lshlrev_b32 v130, 16, v137
    v_and_b32 v131, s68, v137
    v_mul_f32 v128, s69, v128
    v_mul_f32 v129, s69, v129
    v_mul_f32 v130, s69, v130
    v_mul_f32 v131, s69, v131
    v_exp_f32 v128, v128
    v_exp_f32 v129, v129
    v_exp_f32 v130, v130
    v_exp_f32 v131, v131
    v_add_f32 v128, 1.0, v128
    v_add_f32 v129, 1.0, v129
    v_add_f32 v130, 1.0, v130
    v_add_f32 v131, 1.0, v131
    v_rcp_f32 v128, v128
    v_rcp_f32 v129, v129
    v_rcp_f32 v130, v130
    v_rcp_f32 v131, v131
    v_cvt_pk_bf16_f32 v132, 0, v128
    v_cvt_pk_bf16_f32 v133, 0, v129
    v_cvt_pk_bf16_f32 v134, 0, v130
    v_cvt_pk_bf16_f32 v135, 0, v131
    ds_write_b128 v28, v[132:135]
    s_waitcnt lgkmcnt(0)
    s_barrier
    v_mfma_f32_16x16x32_bf16 v[228:231], v[152:155], v[196:199], 0
    v_mfma_f32_16x16x32_bf16 v[228:231], v[156:159], v[200:203], v[228:231]
    v_mfma_f32_16x16x32_bf16 v[232:235], v[152:155], v[204:207], 0
    v_mfma_f32_16x16x32_bf16 v[232:235], v[156:159], v[208:211], v[232:235]
    v_mfma_f32_16x16x32_bf16 v[236:239], v[152:155], v[212:215], 0
    v_mfma_f32_16x16x32_bf16 v[236:239], v[156:159], v[216:219], v[236:239]
    v_mfma_f32_16x16x32_bf16 v[240:243], v[152:155], v[220:223], 0
    v_mfma_f32_16x16x32_bf16 v[240:243], v[156:159], v[224:227], v[240:243]
    v_permlane32_swap_b32 v34, v66
    v_permlane32_swap_b32 v50, v82
    v_permlane32_swap_b32 v42, v74
    v_permlane32_swap_b32 v58, v90
    v_permlane16_swap_b32 v34, v50
    v_permlane16_swap_b32 v66, v82
    v_permlane16_swap_b32 v42, v58
    v_permlane16_swap_b32 v74, v90
    v_cvt_pk_bf16_f32 v35, v228, v232
    v_cvt_pk_bf16_f32 v43, v229, v233
    v_mov_b32 v51, v35
    v_mov_b32 v59, v43
    v_mov_b32 v67, v35
    v_mov_b32 v75, v43
    v_mov_b32 v83, v35
    v_mov_b32 v91, v43
    v_cvt_pk_bf16_f32 v39, v236, v240
    v_cvt_pk_bf16_f32 v47, v237, v241
    v_mov_b32 v55, v39
    v_mov_b32 v63, v47
    v_mov_b32 v71, v39
    v_mov_b32 v79, v47
    v_mov_b32 v87, v39
    v_mov_b32 v95, v47
    buffer_load_dwordx4 v[112:115], v19, s[48:51], s80 offen offset:1024 sc1
    buffer_load_dwordx4 v[116:119], v19, s[48:51], s81 offen offset:1024 sc1
    buffer_load_dwordx4 v[172:175], v19, s[48:51], s80 offen offset:2688 sc1
    buffer_load_dwordx4 v[176:179], v19, s[48:51], s81 offen offset:2688 sc1
    v_mov_b32 v134, 0
    v_mov_b32 v135, 0
    v_mov_b32 v150, 0
    v_mov_b32 v151, 0
    s_branch L_post
L_nosenet:
    s_nop 7
    v_mfma_f32_16x16x32_bf16 v[180:183], v[152:155], v[236:239], 0
    v_mfma_f32_16x16x32_bf16 v[180:183], v[156:159], v[240:243], v[180:183]
    v_mfma_f32_16x16x32_bf16 v[184:187], v[152:155], v[244:247], 0
    v_mfma_f32_16x16x32_bf16 v[184:187], v[156:159], v[248:251], v[184:187]
    v_mfma_f32_16x16x32_bf16 v[188:191], v[152:155], v[228:231], 0
    v_mfma_f32_16x16x32_bf16 v[188:191], v[156:159], v[232:235], v[188:191]
    v_mfma_f32_16x16x32_bf16 v[192:195], v[152:155], v[252:255], 0
    v_mfma_f32_16x16x32_bf16 v[192:195], v[156:159], v[172:175], v[192:195]
    s_waitcnt lgkmcnt(6)
    v_mfma_f32_16x16x32_bf16 v[228:231], v[152:155], v[196:199], 0
    v_mfma_f32_16x16x32_bf16 v[228:231], v[156:159], v[200:203], v[228:231]
    s_waitcnt lgkmcnt(4)
    v_mfma_f32_16x16x32_bf16 v[232:235], v[152:155], v[204:207], 0
    v_mfma_f32_16x16x32_bf16 v[232:235], v[156:159], v[208:211], v[232:235]
    s_waitcnt lgkmcnt(2)
    v_mfma_f32_16x16x32_bf16 v[236:239], v[152:155], v[212:215], 0
    v_mfma_f32_16x16x32_bf16 v[236:239], v[156:159], v[216:219], v[236:239]
    s_waitcnt lgkmcnt(0)
    v_mfma_f32_16x16x32_bf16 v[240:243], v[152:155], v[220:223], 0
    v_mfma_f32_16x16x32_bf16 v[240:243], v[156:159], v[224:227], v[240:243]
    v_cvt_pk_bf16_f32 v182, v182, v186
    v_cvt_pk_bf16_f32 v183, v183, v187
    ds_write2_b32 v27, v182, v183 offset0:32 offset1:96
    v_cvt_pk_bf16_f32 v66, v180, v184
    v_cvt_pk_bf16_f32 v74, v181, v185
    v_cvt_pk_bf16_f32 v190, v190, v194
    v_cvt_pk_bf16_f32 v191, v191, v195
    ds_write2_b32 v27, v190, v191 offset0:48 offset1:112
    v_cvt_pk_bf16_f32 v82, v188, v192
    v_cvt_pk_bf16_f32 v90, v189, v193
    v_permlane32_swap_b32 v34, v66
    v_permlane32_swap_b32 v50, v82
    v_permlane32_swap_b32 v42, v74
    v_permlane32_swap_b32 v58, v90
    v_permlane16_swap_b32 v34, v50
    v_permlane16_swap_b32 v66, v82
    v_permlane16_swap_b32 v42, v58
    v_permlane16_swap_b32 v74, v90
    v_cvt_pk_bf16_f32 v35, v228, v232
    v_cvt_pk_bf16_f32 v43, v229, v233
    v_mov_b32 v51, v35
    v_mov_b32 v59, v43
    v_mov_b32 v67, v35
    v_mov_b32 v75, v43
    v_mov_b32 v83, v35
    v_mov_b32 v91, v43
    v_cvt_pk_bf16_f32 v39, v236, v240
    v_cvt_pk_bf16_f32 v47, v237, v241
    v_mov_b32 v55, v39
    v_mov_b32 v63, v47
    v_mov_b32 v71, v39
    v_mov_b32 v79, v47
    v_mov_b32 v87, v39
    v_mov_b32 v95, v47
    buffer_load_dwordx4 v[112:115], v19, s[48:51], s80 offen offset:1024 sc1
    buffer_load_dwordx4 v[116:119], v19, s[48:51], s81 offen offset:1024 sc1
    buffer_load_dwordx4 v[172:175], v19, s[48:51], s80 offen offset:2688 sc1
    buffer_load_dwordx4 v[176:179], v19, s[48:51], s81 offen offset:2688 sc1
    v_mov_b32 v134, 0
    v_mov_b32 v135, 0
    v_mov_b32 v150, 0
    v_mov_b32 v151, 0
    s_waitcnt lgkmcnt(0)
    s_barrier
L_post:
    ds_read_b32 v38, v25 offset:32768
    ds_read_b32 v46, v25 offset:33024
    ds_read_b128 v[180:183], v29 offset:0
    ds_read_b128 v[184:187], v29 offset:16
    ds_read_b128 v[188:191], v30 offset:0
    ds_read_b128 v[192:195], v30 offset:16
    v_bfe_u32 v152, v0, 4, 2
    v_lshlrev_b32 v152, 5, v152
    v_sub_u32 v29, v29, v152
    ds_read2_b32 v[156:157], v29 offset0:6 offset1:14
    v_sub_u32 v30, v30, v152
    ds_read2_b32 v[158:159], v30 offset0:6 offset1:14
    ds_read_b32 v54, v25 offset:33280
    ds_read_b32 v62, v25 offset:33536
    ds_read_b32 v70, v25 offset:33792
    ds_read_b32 v78, v25 offset:34048
    ds_read_b32 v86, v25 offset:34304
    ds_read_b32 v94, v25 offset:34560
    s_waitcnt lgkmcnt(12)
    s_waitcnt vmcnt(6)
    v_mfma_f32_16x16x32_bf16 v[196:199], v[96:99], v[32:35], 0
    v_mfma_f32_16x16x32_bf16 v[200:203], v[96:99], v[36:39], 0
    v_mfma_f32_16x16x32_bf16 v[204:207], v[100:103], v[40:43], 0
    v_mfma_f32_16x16x32_bf16 v[208:211], v[100:103], v[44:47], 0
    s_waitcnt lgkmcnt(6)
    v_lshrrev_b32 v1, 16, v180
    v_lshrrev_b32 v6, 16, v182
    v_lshrrev_b32 v7, 16, v184
    v_mul_f32 v228, v228, v156
    v_mul_f32 v229, v229, v156
    v_mul_f32 v232, v232, v157
    v_mul_f32 v233, v233, v157
    v_lshrrev_b32 v8, 16, v188
    v_lshrrev_b32 v9, 16, v190
    v_lshrrev_b32 v27, 16, v192
    v_mul_f32 v236, v236, v158
    v_mul_f32 v237, v237, v158
    v_mul_f32 v240, v240, v159
    v_mul_f32 v241, v241, v159
    v_dot2_f32_bf16 v212, v32, v1, 0
    v_dot2_f32_bf16 v213, v32, v181, 0
    v_dot2_f32_bf16 v214, v33, v6, 0
    v_dot2_f32_bf16 v215, v33, v183, 0
    v_dot2_f32_bf16 v216, v34, v7, 0
    v_dot2_f32_bf16 v217, v34, v185, 0
    v_dot2_f32_bf16 v218, v36, v8, 0
    v_dot2_f32_bf16 v219, v36, v189, 0
    v_dot2_f32_bf16 v220, v37, v9, 0
    v_dot2_f32_bf16 v221, v37, v191, 0
    v_dot2_f32_bf16 v222, v38, v27, 0
    v_dot2_f32_bf16 v223, v38, v193, 0
    v_cvt_pk_bf16_f32 v155, v228, v232
    v_cvt_pk_bf16_f32 v152, v212, v213
    v_cvt_pk_bf16_f32 v153, v214, v215
    v_cvt_pk_bf16_f32 v154, v216, v217
    v_cvt_pk_bf16_f32 v159, v236, v240
    v_cvt_pk_bf16_f32 v156, v218, v219
    v_cvt_pk_bf16_f32 v157, v220, v221
    v_cvt_pk_bf16_f32 v158, v222, v223
    v_dot2_f32_bf16 v212, v40, v1, 0
    v_dot2_f32_bf16 v213, v40, v181, 0
    v_dot2_f32_bf16 v214, v41, v6, 0
    v_dot2_f32_bf16 v215, v41, v183, 0
    v_dot2_f32_bf16 v216, v42, v7, 0
    v_dot2_f32_bf16 v217, v42, v185, 0
    v_dot2_f32_bf16 v218, v44, v8, 0
    v_dot2_f32_bf16 v219, v44, v189, 0
    v_dot2_f32_bf16 v220, v45, v9, 0
    v_dot2_f32_bf16 v221, v45, v191, 0
    v_dot2_f32_bf16 v222, v46, v27, 0
    v_dot2_f32_bf16 v223, v46, v193, 0
    v_cvt_pk_bf16_f32 v163, v229, v233
    v_cvt_pk_bf16_f32 v160, v212, v213
    v_cvt_pk_bf16_f32 v161, v214, v215
    v_cvt_pk_bf16_f32 v162, v216, v217
    v_cvt_pk_bf16_f32 v167, v237, v241
    v_cvt_pk_bf16_f32 v164, v218, v219
    v_cvt_pk_bf16_f32 v165, v220, v221
    v_cvt_pk_bf16_f32 v166, v222, v223
    s_waitcnt vmcnt(4)
    v_mfma_f32_16x16x32_bf16 v[212:215], v[104:107], v[152:155], 0
    v_mfma_f32_16x16x32_bf16 v[216:219], v[104:107], v[156:159], 0
    v_mfma_f32_16x16x32_bf16 v[220:223], v[108:111], v[160:163], 0
    v_mfma_f32_16x16x32_bf16 v[224:227], v[108:111], v[164:167], 0
    s_add_u32 s80, s61, 6656
    buffer_load_dwordx4 v[96:99], v18, s[48:51], s80 offen offset:0 sc1
    s_add_u32 s81, s61, 9984
    buffer_load_dwordx4 v[100:103], v18, s[48:51], s81 offen offset:0 sc1
    buffer_load_dwordx4 v[104:107], v18, s[48:51], s80 offen offset:1664 sc1
    buffer_load_dwordx4 v[108:111], v18, s[48:51], s81 offen offset:1664 sc1
    s_waitcnt vmcnt(4)
    v_mfma_f32_16x16x32_bf16 v[228:231], v[112:115], v[32:35], 0
    v_fmac_f32 v196, v212, v180
    v_fmac_f32 v197, v213, v181
    v_fmac_f32 v198, v214, v182
    v_mfma_f32_16x16x32_bf16 v[232:235], v[112:115], v[36:39], 0
    v_fmac_f32 v199, v215, v183
    v_fmac_f32 v204, v220, v180
    v_fmac_f32 v205, v221, v181
    v_mfma_f32_16x16x32_bf16 v[236:239], v[116:119], v[40:43], 0
    v_fmac_f32 v206, v222, v182
    v_fmac_f32 v207, v223, v183
    v_cvt_pk_bf16_f32 v120, v196, v204
    v_mfma_f32_16x16x32_bf16 v[240:243], v[116:119], v[44:47], 0
    v_cvt_pk_bf16_f32 v122, v197, v205
    v_cvt_pk_bf16_f32 v124, v198, v206
    v_cvt_pk_bf16_f32 v126, v199, v207
    v_mfma_f32_16x16x32_bf16 v[244:247], v[172:175], v[152:155], 0
    v_fmac_f32 v200, v216, v188
    v_fmac_f32 v201, v217, v189
    v_fmac_f32 v202, v218, v190
    v_mfma_f32_16x16x32_bf16 v[248:251], v[172:175], v[156:159], 0
    v_fmac_f32 v203, v219, v191
    v_fmac_f32 v208, v224, v188
    v_fmac_f32 v209, v225, v189
    v_mfma_f32_16x16x32_bf16 v[252:255], v[176:179], v[160:163], 0
    v_fmac_f32 v210, v226, v190
    v_fmac_f32 v211, v227, v191
    v_cvt_pk_bf16_f32 v136, v200, v208
    v_mfma_f32_16x16x32_bf16 v[168:171], v[176:179], v[164:167], 0
    v_cvt_pk_bf16_f32 v138, v201, v209
    v_cvt_pk_bf16_f32 v140, v202, v210
    v_cvt_pk_bf16_f32 v142, v203, v211
    buffer_load_dwordx4 v[112:115], v19, s[48:51], s80 offen offset:1024 sc1
    buffer_load_dwordx4 v[116:119], v19, s[48:51], s81 offen offset:1024 sc1
    buffer_load_dwordx4 v[172:175], v19, s[48:51], s80 offen offset:2688 sc1
    buffer_load_dwordx4 v[176:179], v19, s[48:51], s81 offen offset:2688 sc1
    s_waitcnt lgkmcnt(0)
    v_pk_fma_f32 v[228:229], v[244:245], v[184:185], v[228:229]
    v_pk_fma_f32 v[236:237], v[252:253], v[184:185], v[236:237]
    v_pk_fma_f32 v[232:233], v[248:249], v[192:193], v[232:233]
    v_pk_fma_f32 v[240:241], v[168:169], v[192:193], v[240:241]
    v_dot2_f32_bf16 v212, v48, v1, 0
    v_dot2_f32_bf16 v213, v48, v181, 0
    v_dot2_f32_bf16 v214, v49, v6, 0
    v_dot2_f32_bf16 v215, v49, v183, 0
    v_dot2_f32_bf16 v216, v50, v7, 0
    v_dot2_f32_bf16 v217, v50, v185, 0
    v_dot2_f32_bf16 v218, v52, v8, 0
    v_dot2_f32_bf16 v219, v52, v189, 0
    v_dot2_f32_bf16 v220, v53, v9, 0
    v_dot2_f32_bf16 v221, v53, v191, 0
    v_dot2_f32_bf16 v222, v54, v27, 0
    v_dot2_f32_bf16 v223, v54, v193, 0
    v_cvt_pk_bf16_f32 v152, v212, v213
    v_cvt_pk_bf16_f32 v153, v214, v215
    v_cvt_pk_bf16_f32 v154, v216, v217
    v_cvt_pk_bf16_f32 v156, v218, v219
    v_cvt_pk_bf16_f32 v157, v220, v221
    v_cvt_pk_bf16_f32 v158, v222, v223
    v_dot2_f32_bf16 v212, v56, v1, 0
    v_dot2_f32_bf16 v213, v56, v181, 0
    v_dot2_f32_bf16 v214, v57, v6, 0
    v_dot2_f32_bf16 v215, v57, v183, 0
    v_dot2_f32_bf16 v216, v58, v7, 0
    v_dot2_f32_bf16 v217, v58, v185, 0
    v_dot2_f32_bf16 v218, v60, v8, 0
    v_dot2_f32_bf16 v219, v60, v189, 0
    v_dot2_f32_bf16 v220, v61, v9, 0
    v_dot2_f32_bf16 v221, v61, v191, 0
    v_dot2_f32_bf16 v222, v62, v27, 0
    v_dot2_f32_bf16 v223, v62, v193, 0
    s_waitcnt vmcnt(4)
    v_mfma_f32_16x16x32_bf16 v[196:199], v[96:99], v[48:51], 0
    v_cvt_pk_bf16_f32 v160, v212, v213
    v_cvt_pk_bf16_f32 v161, v214, v215
    v_mfma_f32_16x16x32_bf16 v[200:203], v[96:99], v[52:55], 0
    v_cvt_pk_bf16_f32 v162, v216, v217
    v_cvt_pk_bf16_f32 v164, v218, v219
    v_mfma_f32_16x16x32_bf16 v[204:207], v[100:103], v[56:59], 0
    v_cvt_pk_bf16_f32 v165, v220, v221
    v_cvt_pk_bf16_f32 v166, v222, v223
    v_mfma_f32_16x16x32_bf16 v[208:211], v[100:103], v[60:63], 0
    v_fmac_f32 v230, v246, v186
    v_fmac_f32 v238, v254, v186
    v_mfma_f32_16x16x32_bf16 v[212:215], v[104:107], v[152:155], 0
    v_cvt_pk_bf16_f32 v128, v228, v236
    v_cvt_pk_bf16_f32 v130, v229, v237
    v_mfma_f32_16x16x32_bf16 v[216:219], v[104:107], v[156:159], 0
    v_cvt_pk_bf16_f32 v132, v230, v238
    v_fmac_f32 v234, v250, v194
    v_mfma_f32_16x16x32_bf16 v[220:223], v[108:111], v[160:163], 0
    v_fmac_f32 v242, v170, v194
    v_cvt_pk_bf16_f32 v144, v232, v240
    v_mfma_f32_16x16x32_bf16 v[224:227], v[108:111], v[164:167], 0
    v_cvt_pk_bf16_f32 v146, v233, v241
    v_cvt_pk_bf16_f32 v148, v234, v242
    s_add_u32 s80, s61, 13312
    buffer_load_dwordx4 v[96:99], v18, s[48:51], s80 offen offset:0 sc1
    s_add_u32 s81, s61, 16640
    buffer_load_dwordx4 v[100:103], v18, s[48:51], s81 offen offset:0 sc1
    buffer_load_dwordx4 v[104:107], v18, s[48:51], s80 offen offset:1664 sc1
    buffer_load_dwordx4 v[108:111], v18, s[48:51], s81 offen offset:1664 sc1
    s_waitcnt vmcnt(4)
    v_mfma_f32_16x16x32_bf16 v[228:231], v[112:115], v[48:51], 0
    v_fmac_f32 v196, v212, v180
    v_fmac_f32 v197, v213, v181
    v_fmac_f32 v198, v214, v182
    v_mfma_f32_16x16x32_bf16 v[232:235], v[112:115], v[52:55], 0
    v_fmac_f32 v199, v215, v183
    v_fmac_f32 v204, v220, v180
    v_fmac_f32 v205, v221, v181
    v_mfma_f32_16x16x32_bf16 v[236:239], v[116:119], v[56:59], 0
    v_fmac_f32 v206, v222, v182
    v_fmac_f32 v207, v223, v183
    v_cvt_pk_bf16_f32 v121, v196, v204
    v_mfma_f32_16x16x32_bf16 v[240:243], v[116:119], v[60:63], 0
    v_cvt_pk_bf16_f32 v123, v197, v205
    v_cvt_pk_bf16_f32 v125, v198, v206
    v_cvt_pk_bf16_f32 v127, v199, v207
    v_mfma_f32_16x16x32_bf16 v[244:247], v[172:175], v[152:155], 0
    v_fmac_f32 v200, v216, v188
    v_fmac_f32 v201, v217, v189
    v_fmac_f32 v202, v218, v190
    v_mfma_f32_16x16x32_bf16 v[248:251], v[172:175], v[156:159], 0
    v_fmac_f32 v203, v219, v191
    v_fmac_f32 v208, v224, v188
    v_fmac_f32 v209, v225, v189
    v_mfma_f32_16x16x32_bf16 v[252:255], v[176:179], v[160:163], 0
    v_fmac_f32 v210, v226, v190
    v_fmac_f32 v211, v227, v191
    v_cvt_pk_bf16_f32 v137, v200, v208
    v_mfma_f32_16x16x32_bf16 v[168:171], v[176:179], v[164:167], 0
    v_cvt_pk_bf16_f32 v139, v201, v209
    v_cvt_pk_bf16_f32 v141, v202, v210
    v_cvt_pk_bf16_f32 v143, v203, v211
    buffer_load_dwordx4 v[112:115], v19, s[48:51], s80 offen offset:1024 sc1
    buffer_load_dwordx4 v[116:119], v19, s[48:51], s81 offen offset:1024 sc1
    buffer_load_dwordx4 v[172:175], v19, s[48:51], s80 offen offset:2688 sc1
    buffer_load_dwordx4 v[176:179], v19, s[48:51], s81 offen offset:2688 sc1
    ds_read_b64 v[32:33], v14 offset:0
    ds_read_b64 v[34:35], v14 offset:4096
    ds_read_b64 v[36:37], v14 offset:32768
    ds_read_b64 v[38:39], v14 offset:36864
    ds_read_b64 v[40:41], v22 offset:0
    ds_read_b64 v[42:43], v22 offset:4096
    ds_read_b64 v[44:45], v16 offset:0
    ds_read_b64 v[48:49], v15 offset:0
    ds_read_b64 v[50:51], v15 offset:4096
    ds_read_b64 v[52:53], v15 offset:32768
    ds_read_b64 v[54:55], v15 offset:36864
    ds_read_b64 v[56:57], v23 offset:0
    ds_read_b64 v[58:59], v23 offset:4096
    ds_read_b64 v[60:61], v17 offset:0
    v_pk_fma_f32 v[228:229], v[244:245], v[184:185], v[228:229]
    v_pk_fma_f32 v[236:237], v[252:253], v[184:185], v[236:237]
    v_pk_fma_f32 v[232:233], v[248:249], v[192:193], v[232:233]
    v_pk_fma_f32 v[240:241], v[168:169], v[192:193], v[240:241]
    v_dot2_f32_bf16 v212, v64, v1, 0
    v_dot2_f32_bf16 v213, v64, v181, 0
    v_dot2_f32_bf16 v214, v65, v6, 0
    v_dot2_f32_bf16 v215, v65, v183, 0
    v_dot2_f32_bf16 v216, v66, v7, 0
    v_dot2_f32_bf16 v217, v66, v185, 0
    v_dot2_f32_bf16 v218, v68, v8, 0
    v_dot2_f32_bf16 v219, v68, v189, 0
    v_dot2_f32_bf16 v220, v69, v9, 0
    v_dot2_f32_bf16 v221, v69, v191, 0
    v_dot2_f32_bf16 v222, v70, v27, 0
    v_dot2_f32_bf16 v223, v70, v193, 0
    v_cvt_pk_bf16_f32 v152, v212, v213
    v_cvt_pk_bf16_f32 v153, v214, v215
    v_cvt_pk_bf16_f32 v154, v216, v217
    v_cvt_pk_bf16_f32 v156, v218, v219
    v_cvt_pk_bf16_f32 v157, v220, v221
    v_cvt_pk_bf16_f32 v158, v222, v223
    v_dot2_f32_bf16 v212, v72, v1, 0
    v_dot2_f32_bf16 v213, v72, v181, 0
    v_dot2_f32_bf16 v214, v73, v6, 0
    v_dot2_f32_bf16 v215, v73, v183, 0
    v_dot2_f32_bf16 v216, v74, v7, 0
    v_dot2_f32_bf16 v217, v74, v185, 0
    v_dot2_f32_bf16 v218, v76, v8, 0
    v_dot2_f32_bf16 v219, v76, v189, 0
    v_dot2_f32_bf16 v220, v77, v9, 0
    v_dot2_f32_bf16 v221, v77, v191, 0
    v_dot2_f32_bf16 v222, v78, v27, 0
    v_dot2_f32_bf16 v223, v78, v193, 0
    s_waitcnt vmcnt(4)
    v_mfma_f32_16x16x32_bf16 v[196:199], v[96:99], v[64:67], 0
    v_cvt_pk_bf16_f32 v160, v212, v213
    v_cvt_pk_bf16_f32 v161, v214, v215
    v_mfma_f32_16x16x32_bf16 v[200:203], v[96:99], v[68:71], 0
    v_cvt_pk_bf16_f32 v162, v216, v217
    v_cvt_pk_bf16_f32 v164, v218, v219
    v_mfma_f32_16x16x32_bf16 v[204:207], v[100:103], v[72:75], 0
    v_cvt_pk_bf16_f32 v165, v220, v221
    v_cvt_pk_bf16_f32 v166, v222, v223
    v_mfma_f32_16x16x32_bf16 v[208:211], v[100:103], v[76:79], 0
    v_fmac_f32 v230, v246, v186
    v_fmac_f32 v238, v254, v186
    v_mfma_f32_16x16x32_bf16 v[212:215], v[104:107], v[152:155], 0
    v_cvt_pk_bf16_f32 v129, v228, v236
    v_cvt_pk_bf16_f32 v131, v229, v237
    v_mfma_f32_16x16x32_bf16 v[216:219], v[104:107], v[156:159], 0
    v_cvt_pk_bf16_f32 v133, v230, v238
    v_fmac_f32 v234, v250, v194
    v_mfma_f32_16x16x32_bf16 v[220:223], v[108:111], v[160:163], 0
    v_fmac_f32 v242, v170, v194
    v_cvt_pk_bf16_f32 v145, v232, v240
    v_mfma_f32_16x16x32_bf16 v[224:227], v[108:111], v[164:167], 0
    v_cvt_pk_bf16_f32 v147, v233, v241
    v_cvt_pk_bf16_f32 v149, v234, v242
    s_add_u32 s80, s61, 19968
    buffer_load_dwordx4 v[96:99], v18, s[48:51], s80 offen offset:0 sc1
    s_add_u32 s81, s61, 23296
    buffer_load_dwordx4 v[100:103], v18, s[48:51], s81 offen offset:0 sc1
    buffer_load_dwordx4 v[104:107], v18, s[48:51], s80 offen offset:1664 sc1
    buffer_load_dwordx4 v[108:111], v18, s[48:51], s81 offen offset:1664 sc1
    s_waitcnt lgkmcnt(0)
    v_mfma_f32_16x16x32_bf16 v[2:5], v[120:123], v[32:35], 0
    v_fmac_f32 v196, v212, v180
    v_fmac_f32 v197, v213, v181
    v_mfma_f32_16x16x32_bf16 v[10:13], v[136:139], v[48:51], 0
    v_fmac_f32 v198, v214, v182
    v_fmac_f32 v199, v215, v183
    v_mfma_f32_16x16x32_bf16 v[2:5], v[124:127], v[36:39], v[2:5]
    v_fmac_f32 v204, v220, v180
    v_fmac_f32 v205, v221, v181
    v_mfma_f32_16x16x32_bf16 v[10:13], v[140:143], v[52:55], v[10:13]
    v_fmac_f32 v206, v222, v182
    v_fmac_f32 v207, v223, v183
    v_mfma_f32_16x16x32_bf16 v[2:5], v[128:131], v[40:43], v[2:5]
    v_fmac_f32 v200, v216, v188
    v_fmac_f32 v201, v217, v189
    v_mfma_f32_16x16x32_bf16 v[10:13], v[144:147], v[56:59], v[10:13]
    v_fmac_f32 v202, v218, v190
    v_fmac_f32 v203, v219, v191
    v_mfma_f32_16x16x32_bf16 v[2:5], v[132:135], v[44:47], v[2:5]
    v_fmac_f32 v208, v224, v188
    v_fmac_f32 v209, v225, v189
    v_mfma_f32_16x16x32_bf16 v[10:13], v[148:151], v[60:63], v[10:13]
    v_fmac_f32 v210, v226, v190
    v_fmac_f32 v211, v227, v191
    s_waitcnt vmcnt(4)
    v_mfma_f32_16x16x32_bf16 v[228:231], v[112:115], v[64:67], 0
    v_cvt_pk_bf16_f32 v120, v196, v204
    v_mfma_f32_16x16x32_bf16 v[232:235], v[112:115], v[68:71], 0
    v_cvt_pk_bf16_f32 v122, v197, v205
    v_mfma_f32_16x16x32_bf16 v[236:239], v[116:119], v[72:75], 0
    v_cvt_pk_bf16_f32 v124, v198, v206
    v_mfma_f32_16x16x32_bf16 v[240:243], v[116:119], v[76:79], 0
    v_cvt_pk_bf16_f32 v126, v199, v207
    v_mfma_f32_16x16x32_bf16 v[244:247], v[172:175], v[152:155], 0
    v_cvt_pk_bf16_f32 v136, v200, v208
    v_mfma_f32_16x16x32_bf16 v[248:251], v[172:175], v[156:159], 0
    v_cvt_pk_bf16_f32 v138, v201, v209
    v_mfma_f32_16x16x32_bf16 v[252:255], v[176:179], v[160:163], 0
    v_cvt_pk_bf16_f32 v140, v202, v210
    v_mfma_f32_16x16x32_bf16 v[168:171], v[176:179], v[164:167], 0
    v_cvt_pk_bf16_f32 v142, v203, v211
    buffer_load_dwordx4 v[112:115], v19, s[48:51], s80 offen offset:1024 sc1
    buffer_load_dwordx4 v[116:119], v19, s[48:51], s81 offen offset:1024 sc1
    buffer_load_dwordx4 v[172:175], v19, s[48:51], s80 offen offset:2688 sc1
    buffer_load_dwordx4 v[176:179], v19, s[48:51], s81 offen offset:2688 sc1
    ds_read_b64 v[32:33], v14 offset:8
    ds_read_b64 v[34:35], v14 offset:4104
    ds_read_b64 v[36:37], v14 offset:32776
    ds_read_b64 v[38:39], v14 offset:36872
    ds_read_b64 v[40:41], v22 offset:8
    ds_read_b64 v[42:43], v22 offset:4104
    ds_read_b64 v[44:45], v16 offset:8
    ds_read_b64 v[48:49], v15 offset:8
    ds_read_b64 v[50:51], v15 offset:4104
    ds_read_b64 v[52:53], v15 offset:32776
    ds_read_b64 v[54:55], v15 offset:36872
    ds_read_b64 v[56:57], v23 offset:8
    ds_read_b64 v[58:59], v23 offset:4104
    ds_read_b64 v[60:61], v17 offset:8
    v_pk_fma_f32 v[228:229], v[244:245], v[184:185], v[228:229]
    v_pk_fma_f32 v[236:237], v[252:253], v[184:185], v[236:237]
    v_pk_fma_f32 v[232:233], v[248:249], v[192:193], v[232:233]
    v_pk_fma_f32 v[240:241], v[168:169], v[192:193], v[240:241]
    v_dot2_f32_bf16 v212, v80, v1, 0
    v_dot2_f32_bf16 v213, v80, v181, 0
    v_dot2_f32_bf16 v214, v81, v6, 0
    v_dot2_f32_bf16 v215, v81, v183, 0
    v_dot2_f32_bf16 v216, v82, v7, 0
    v_dot2_f32_bf16 v217, v82, v185, 0
    v_dot2_f32_bf16 v218, v84, v8, 0
    v_dot2_f32_bf16 v219, v84, v189, 0
    v_dot2_f32_bf16 v220, v85, v9, 0
    v_dot2_f32_bf16 v221, v85, v191, 0
    v_dot2_f32_bf16 v222, v86, v27, 0
    v_dot2_f32_bf16 v223, v86, v193, 0
    v_cvt_pk_bf16_f32 v152, v212, v213
    v_cvt_pk_bf16_f32 v153, v214, v215
    v_cvt_pk_bf16_f32 v154, v216, v217
    v_cvt_pk_bf16_f32 v156, v218, v219
    v_cvt_pk_bf16_f32 v157, v220, v221
    v_cvt_pk_bf16_f32 v158, v222, v223
    v_dot2_f32_bf16 v212, v88, v1, 0
    v_dot2_f32_bf16 v213, v88, v181, 0
    v_dot2_f32_bf16 v214, v89, v6, 0
    v_dot2_f32_bf16 v215, v89, v183, 0
    v_dot2_f32_bf16 v216, v90, v7, 0
    v_dot2_f32_bf16 v217, v90, v185, 0
    v_dot2_f32_bf16 v218, v92, v8, 0
    v_dot2_f32_bf16 v219, v92, v189, 0
    v_dot2_f32_bf16 v220, v93, v9, 0
    v_dot2_f32_bf16 v221, v93, v191, 0
    v_dot2_f32_bf16 v222, v94, v27, 0
    v_dot2_f32_bf16 v223, v94, v193, 0
    s_waitcnt vmcnt(4)
    v_mfma_f32_16x16x32_bf16 v[196:199], v[96:99], v[80:83], 0
    v_cvt_pk_bf16_f32 v160, v212, v213
    v_cvt_pk_bf16_f32 v161, v214, v215
    v_mfma_f32_16x16x32_bf16 v[200:203], v[96:99], v[84:87], 0
    v_cvt_pk_bf16_f32 v162, v216, v217
    v_cvt_pk_bf16_f32 v164, v218, v219
    v_mfma_f32_16x16x32_bf16 v[204:207], v[100:103], v[88:91], 0
    v_cvt_pk_bf16_f32 v165, v220, v221
    v_cvt_pk_bf16_f32 v166, v222, v223
    v_mfma_f32_16x16x32_bf16 v[208:211], v[100:103], v[92:95], 0
    v_fmac_f32 v230, v246, v186
    v_fmac_f32 v238, v254, v186
    v_mfma_f32_16x16x32_bf16 v[212:215], v[104:107], v[152:155], 0
    v_cvt_pk_bf16_f32 v128, v228, v236
    v_cvt_pk_bf16_f32 v130, v229, v237
    v_mfma_f32_16x16x32_bf16 v[216:219], v[104:107], v[156:159], 0
    v_cvt_pk_bf16_f32 v132, v230, v238
    v_fmac_f32 v234, v250, v194
    v_mfma_f32_16x16x32_bf16 v[220:223], v[108:111], v[160:163], 0
    v_fmac_f32 v242, v170, v194
    v_cvt_pk_bf16_f32 v144, v232, v240
    v_mfma_f32_16x16x32_bf16 v[224:227], v[108:111], v[164:167], 0
    v_cvt_pk_bf16_f32 v146, v233, v241
    v_cvt_pk_bf16_f32 v148, v234, v242
    s_waitcnt vmcnt(0)
    v_mfma_f32_16x16x32_bf16 v[228:231], v[112:115], v[80:83], 0
    v_fmac_f32 v196, v212, v180
    v_fmac_f32 v197, v213, v181
    v_fmac_f32 v198, v214, v182
    v_mfma_f32_16x16x32_bf16 v[232:235], v[112:115], v[84:87], 0
    v_fmac_f32 v199, v215, v183
    v_fmac_f32 v204, v220, v180
    v_fmac_f32 v205, v221, v181
    v_mfma_f32_16x16x32_bf16 v[236:239], v[116:119], v[88:91], 0
    v_fmac_f32 v206, v222, v182
    v_fmac_f32 v207, v223, v183
    v_cvt_pk_bf16_f32 v121, v196, v204
    v_mfma_f32_16x16x32_bf16 v[240:243], v[116:119], v[92:95], 0
    v_cvt_pk_bf16_f32 v123, v197, v205
    v_cvt_pk_bf16_f32 v125, v198, v206
    v_cvt_pk_bf16_f32 v127, v199, v207
    v_mfma_f32_16x16x32_bf16 v[244:247], v[172:175], v[152:155], 0
    v_fmac_f32 v200, v216, v188
    v_fmac_f32 v201, v217, v189
    v_fmac_f32 v202, v218, v190
    v_mfma_f32_16x16x32_bf16 v[248:251], v[172:175], v[156:159], 0
    v_fmac_f32 v203, v219, v191
    v_fmac_f32 v208, v224, v188
    v_fmac_f32 v209, v225, v189
    v_mfma_f32_16x16x32_bf16 v[252:255], v[176:179], v[160:163], 0
    v_fmac_f32 v210, v226, v190
    v_fmac_f32 v211, v227, v191
    v_cvt_pk_bf16_f32 v137, v200, v208
    v_mfma_f32_16x16x32_bf16 v[168:171], v[176:179], v[164:167], 0
    v_cvt_pk_bf16_f32 v139, v201, v209
    v_cvt_pk_bf16_f32 v141, v202, v210
    v_cvt_pk_bf16_f32 v143, v203, v211
    s_and_b32 s56, s60, 0x400
    v_add_u32 v31, s56, v31
    v_xor_b32 v29, 0x400, v31
    s_lshl_b32 s56, s52, 28
    buffer_load_dwordx2 v[24:25], v20, s[48:51], s56 offen sc1
    v_pk_fma_f32 v[228:229], v[244:245], v[184:185], v[228:229]
    v_pk_fma_f32 v[236:237], v[252:253], v[184:185], v[236:237]
    v_pk_fma_f32 v[232:233], v[248:249], v[192:193], v[232:233]
    v_pk_fma_f32 v[240:241], v[168:169], v[192:193], v[240:241]
    s_waitcnt lgkmcnt(0)
    v_mfma_f32_16x16x32_bf16 v[2:5], v[120:123], v[32:35], v[2:5]
    v_fmac_f32 v230, v246, v186
    v_fmac_f32 v238, v254, v186
    v_mfma_f32_16x16x32_bf16 v[10:13], v[136:139], v[48:51], v[10:13]
    v_cvt_pk_bf16_f32 v129, v228, v236
    v_cvt_pk_bf16_f32 v131, v229, v237
    v_cvt_pk_bf16_f32 v133, v230, v238
    v_mfma_f32_16x16x32_bf16 v[2:5], v[124:127], v[36:39], v[2:5]
    v_fmac_f32 v234, v250, v194
    v_fmac_f32 v242, v170, v194
    v_mfma_f32_16x16x32_bf16 v[10:13], v[140:143], v[52:55], v[10:13]
    v_cvt_pk_bf16_f32 v145, v232, v240
    v_cvt_pk_bf16_f32 v147, v233, v241
    v_cvt_pk_bf16_f32 v149, v234, v242
    v_mfma_f32_16x16x32_bf16 v[2:5], v[128:131], v[40:43], v[2:5]
    v_mfma_f32_16x16x32_bf16 v[10:13], v[144:147], v[56:59], v[10:13]
    v_mfma_f32_16x16x32_bf16 v[2:5], v[132:135], v[44:47], v[2:5]
    v_mfma_f32_16x16x32_bf16 v[10:13], v[148:151], v[60:63], v[10:13]
    s_cmp_lg_u32 s52, 0
    s_nop 5
    ds_write_b128 v31, v[2:5]
    ds_write_b128 v29, v[10:13]
    s_cbranch_scc0 L_w0
    s_waitcnt lgkmcnt(0)
    s_barrier
    s_branch L_end
L_w0:
    buffer_load_dwordx2 v[40:41], v20, s[48:51], 0 offen sc1
    v_and_b32 v1, 31, v0
    v_and_b32 v6, 15, v0
    v_lshrrev_b32 v7, 2, v6
    v_lshl_add_u32 v7, v7, 4, v6
    v_lshlrev_b32 v7, 4, v7
    v_and_b32 v6, 3, v0
    v_lshl_add_u32 v7, v6, 2, v7
    v_bfe_u32 v6, v0, 4, 1
    v_lshl_add_u32 v7, v6, 10, v7
    v_bfe_u32 v6, v0, 5, 1
    v_lshl_add_u32 v7, v6, 13, v7
    v_add_u32 v7, 106496, v7
    s_lshl1_add_u32 s56, s53, s54
    s_lshl_b32 s56, s56, 6
    v_lshlrev_b32 v9, 1, v1
    s_lshl_b32 s57, s53, 2
    s_mov_b32 s59, 0
L_poll:
    s_waitcnt vmcnt(1)
    v_cmp_eq_u32 vcc, v25, v21
    s_cbranch_vccz L_got
    buffer_load_dwordx2 v[24:25], v20, s[48:51], 0 offen sc1
    s_waitcnt vmcnt(1)
    v_cmp_eq_u32 vcc, v41, v21
    s_cbranch_vccz L_got2
    buffer_load_dwordx2 v[40:41], v20, s[48:51], 0 offen sc1
    s_add_u32 s59, s59, 1
    s_and_b32 s58, s59, 15
    s_cbranch_scc1 L_poll
    s_mov_b64 exec, 1
    buffer_load_dword v27, off, s[44:47], s57 sc1
    s_waitcnt vmcnt(0)
    v_readfirstlane_b32 s58, v27
    s_mov_b64 exec, -1
    s_bitcmp1_b32 s58, 1
    s_cselect_b32 s6, 0, -1
    s_bitcmp1_b32 s58, 17
    s_cselect_b32 s7, 0, -1
    s_mov_b32 s58, 0x10000
    buffer_load_dwordx2 v[24:25], v20, s[48:51], s58 offen sc1
    s_waitcnt vmcnt(0)
    v_cmp_eq_u32 vcc, v25, v26
    s_nop 0
    s_and_b64 vcc, vcc, s[6:7]
    s_cbranch_scc0 L_got
    buffer_load_dwordx2 v[24:25], v20, s[48:51], 0 offen sc1
    buffer_load_dwordx2 v[40:41], v20, s[48:51], 0 offen sc1
    s_branch L_poll
L_got:
    v_mov_b32 v8, v24
    s_branch L_got3
L_got2:
    v_mov_b32 v8, v40
L_got3:
    s_waitcnt lgkmcnt(0)
    s_barrier
    ds_read_b32 v32, v7 offset:0
    ds_read_b32 v33, v7 offset:2048
    ds_read_b32 v34, v7 offset:4096
    ds_read_b32 v35, v7 offset:6144
    s_waitcnt lgkmcnt(2)
    v_add_f32 v32, v32, v33
    v_add_f32 v32, v32, v8
    s_waitcnt lgkmcnt(0)
    v_add_f32 v34, v34, v35
    v_add_f32 v32, v32, v34
    v_mov_b32 v33, v32
    s_nop 1
    v_permlane32_swap_b32 v32, v33
    v_add_f32 v4, v32, v33
    v_cvt_pk_bf16_f32 v4, v4, v4
    s_mov_b32 exec_hi, 0
    buffer_store_short v4, v9, s[40:43], s56 offen
    s_branch L_end
L_Bl2:
    v_lshrrev_b32 v15, 4, v0
    v_xor_b32 v15, v15, v0
    v_and_b32 v15, 7, v15
    v_lshlrev_b32 v2, 4, v15
    s_waitcnt vmcnt(33)
    v_lshlrev_b32 v4, 7, v4
    v_lshlrev_b32 v5, 7, v5
    v_lshlrev_b32 v6, 7, v6
    v_lshlrev_b32 v7, 7, v7
    v_lshlrev_b32 v8, 7, v8
    v_lshlrev_b32 v9, 7, v9
    v_lshlrev_b32 v10, 7, v10
    v_lshlrev_b32 v11, 7, v11
    v_add_u32_dpp v12, v4, v2 row_newbcast:0 row_mask:0xf bank_mask:0x3
    v_add_u32_dpp v13, v8, v2 row_newbcast:0 row_mask:0xf bank_mask:0x3
    s_add_u32 m0, s60, 131072
    v_add_u32_dpp v12, v4, v2 row_newbcast:8 row_mask:0xf bank_mask:0xc
    v_add_u32_dpp v13, v8, v2 row_newbcast:8 row_mask:0xf bank_mask:0xc
    buffer_load_dwordx4 v12, s[12:15], 0 offen lds
    s_addk_i32 m0, 0x1000
    s_nop 0
    buffer_load_dwordx4 v13, s[12:15], 0 offen lds
    v_add_u32_dpp v12, v5, v2 row_newbcast:0 row_mask:0xf bank_mask:0x3
    v_add_u32_dpp v13, v9, v2 row_newbcast:0 row_mask:0xf bank_mask:0x3
    s_add_u32 m0, s60, 139264
    v_add_u32_dpp v12, v5, v2 row_newbcast:8 row_mask:0xf bank_mask:0xc
    v_add_u32_dpp v13, v9, v2 row_newbcast:8 row_mask:0xf bank_mask:0xc
    buffer_load_dwordx4 v12, s[12:15], 0 offen lds
    s_addk_i32 m0, 0x1000
    s_nop 0
    buffer_load_dwordx4 v13, s[12:15], 0 offen lds
    v_add_u32_dpp v12, v6, v2 row_newbcast:0 row_mask:0xf bank_mask:0x3
    v_add_u32_dpp v13, v10, v2 row_newbcast:0 row_mask:0xf bank_mask:0x3
    s_add_u32 m0, s60, 147456
    v_add_u32_dpp v12, v6, v2 row_newbcast:8 row_mask:0xf bank_mask:0xc
    v_add_u32_dpp v13, v10, v2 row_newbcast:8 row_mask:0xf bank_mask:0xc
    buffer_load_dwordx4 v12, s[12:15], 0 offen lds
    s_addk_i32 m0, 0x1000
    s_nop 0
    buffer_load_dwordx4 v13, s[12:15], 0 offen lds
    v_add_u32_dpp v12, v7, v2 row_newbcast:0 row_mask:0xf bank_mask:0x3
    v_add_u32_dpp v13, v11, v2 row_newbcast:0 row_mask:0xf bank_mask:0x3
    s_add_u32 m0, s60, 155648
    v_add_u32_dpp v12, v7, v2 row_newbcast:8 row_mask:0xf bank_mask:0xc
    v_add_u32_dpp v13, v11, v2 row_newbcast:8 row_mask:0xf bank_mask:0xc
    buffer_load_dwordx4 v12, s[12:15], 0 offen lds
    s_addk_i32 m0, 0x1000
    s_nop 0
    buffer_load_dwordx4 v13, s[12:15], 0 offen lds
    s_waitcnt vmcnt(6)
    s_barrier
    s_waitcnt vmcnt(4)
    s_barrier
    s_add_u32 m0, s60, 0
    s_mov_b32 s56, 262144
    buffer_load_dwordx4 v1, s[16:19], s56 offen lds
    s_add_u32 m0, s60, 4096
    s_mov_b32 s56, 270336
    buffer_load_dwordx4 v1, s[16:19], s56 offen lds
    s_add_u32 m0, s60, 8192
    s_mov_b32 s56, 278528
    buffer_load_dwordx4 v1, s[16:19], s56 offen lds
    v_add_u32_dpp v12, v4, v2 row_newbcast:1 row_mask:0xf bank_mask:0x3
    v_add_u32_dpp v13, v8, v2 row_newbcast:1 row_mask:0xf bank_mask:0x3
    s_add_u32 m0, s60, 131072
    v_add_u32_dpp v12, v4, v2 row_newbcast:9 row_mask:0xf bank_mask:0xc
    v_add_u32_dpp v13, v8, v2 row_newbcast:9 row_mask:0xf bank_mask:0xc
    buffer_load_dwordx4 v12, s[12:15], 0 offen lds
    s_addk_i32 m0, 0x1000
    s_nop 0
    buffer_load_dwordx4 v13, s[12:15], 0 offen lds
    s_waitcnt vmcnt(7)
    s_barrier
    s_add_u32 m0, s60, 12288
    s_mov_b32 s56, 286720
    buffer_load_dwordx4 v1, s[16:19], s56 offen lds
    s_add_u32 m0, s60, 16384
    s_mov_b32 s56, 294912
    buffer_load_dwordx4 v1, s[16:19], s56 offen lds
    s_add_u32 m0, s60, 20480
    s_mov_b32 s56, 303104
    buffer_load_dwordx4 v1, s[16:19], s56 offen lds
    v_add_u32_dpp v12, v5, v2 row_newbcast:1 row_mask:0xf bank_mask:0x3
    v_add_u32_dpp v13, v9, v2 row_newbcast:1 row_mask:0xf bank_mask:0x3
    s_add_u32 m0, s60, 139264
    v_add_u32_dpp v12, v5, v2 row_newbcast:9 row_mask:0xf bank_mask:0xc
    v_add_u32_dpp v13, v9, v2 row_newbcast:9 row_mask:0xf bank_mask:0xc
    buffer_load_dwordx4 v12, s[12:15], 0 offen lds
    s_addk_i32 m0, 0x1000
    s_nop 0
    buffer_load_dwordx4 v13, s[12:15], 0 offen lds
    s_waitcnt vmcnt(10)
    s_barrier
    s_add_u32 m0, s60, 24576
    s_mov_b32 s56, 311296
    buffer_load_dwordx4 v1, s[16:19], s56 offen lds
    s_add_u32 m0, s60, 28672
    s_mov_b32 s56, 319488
    buffer_load_dwordx4 v1, s[16:19], s56 offen lds
    s_add_u32 m0, s60, 32768
    s_mov_b32 s56, 327680
    buffer_load_dwordx4 v1, s[16:19], s56 offen lds
    v_add_u32_dpp v12, v6, v2 row_newbcast:1 row_mask:0xf bank_mask:0x3
    v_add_u32_dpp v13, v10, v2 row_newbcast:1 row_mask:0xf bank_mask:0x3
    s_add_u32 m0, s60, 147456
    v_add_u32_dpp v12, v6, v2 row_newbcast:9 row_mask:0xf bank_mask:0xc
    v_add_u32_dpp v13, v10, v2 row_newbcast:9 row_mask:0xf bank_mask:0xc
    buffer_load_dwordx4 v12, s[12:15], 0 offen lds
    s_addk_i32 m0, 0x1000
    s_nop 0
    buffer_load_dwordx4 v13, s[12:15], 0 offen lds
    s_waitcnt vmcnt(10)
    s_barrier
    s_add_u32 m0, s60, 36864
    s_mov_b32 s56, 335872
    buffer_load_dwordx4 v1, s[16:19], s56 offen lds
    s_add_u32 m0, s60, 40960
    s_mov_b32 s56, 344064
    buffer_load_dwordx4 v1, s[16:19], s56 offen lds
    s_add_u32 m0, s60, 45056
    s_mov_b32 s56, 352256
    buffer_load_dwordx4 v1, s[16:19], s56 offen lds
    s_add_u32 m0, s60, 49152
    s_mov_b32 s56, 360448
    buffer_load_dwordx4 v1, s[16:19], s56 offen lds
    v_add_u32_dpp v12, v7, v2 row_newbcast:1 row_mask:0xf bank_mask:0x3
    v_add_u32_dpp v13, v11, v2 row_newbcast:1 row_mask:0xf bank_mask:0x3
    s_add_u32 m0, s60, 155648
    v_add_u32_dpp v12, v7, v2 row_newbcast:9 row_mask:0xf bank_mask:0xc
    v_add_u32_dpp v13, v11, v2 row_newbcast:9 row_mask:0xf bank_mask:0xc
    buffer_load_dwordx4 v12, s[12:15], 0 offen lds
    s_addk_i32 m0, 0x1000
    s_nop 0
    buffer_load_dwordx4 v13, s[12:15], 0 offen lds
    s_waitcnt vmcnt(11)
    s_barrier
    s_add_u32 m0, s60, 53248
    s_mov_b32 s56, 368640
    buffer_load_dwordx4 v1, s[16:19], s56 offen lds
    s_add_u32 m0, s60, 57344
    s_mov_b32 s56, 376832
    buffer_load_dwordx4 v1, s[16:19], s56 offen lds
    s_add_u32 m0, s60, 61440
    s_mov_b32 s56, 385024
    buffer_load_dwordx4 v1, s[16:19], s56 offen lds
    v_add_u32_dpp v12, v4, v2 row_newbcast:2 row_mask:0xf bank_mask:0x3
    v_add_u32_dpp v13, v8, v2 row_newbcast:2 row_mask:0xf bank_mask:0x3
    s_add_u32 m0, s60, 131072
    v_add_u32_dpp v12, v4, v2 row_newbcast:10 row_mask:0xf bank_mask:0xc
    v_add_u32_dpp v13, v8, v2 row_newbcast:10 row_mask:0xf bank_mask:0xc
    buffer_load_dwordx4 v12, s[12:15], 0 offen lds
    s_addk_i32 m0, 0x1000
    s_nop 0
    buffer_load_dwordx4 v13, s[12:15], 0 offen lds
    s_waitcnt vmcnt(11)
    s_barrier
    s_add_u32 m0, s60, 65536
    s_mov_b32 s56, 393216
    buffer_load_dwordx4 v1, s[16:19], s56 offen lds
    s_add_u32 m0, s60, 69632
    s_mov_b32 s56, 401408
    buffer_load_dwordx4 v1, s[16:19], s56 offen lds
    s_add_u32 m0, s60, 73728
    s_mov_b32 s56, 409600
    buffer_load_dwordx4 v1, s[16:19], s56 offen lds
    v_add_u32_dpp v12, v5, v2 row_newbcast:2 row_mask:0xf bank_mask:0x3
    v_add_u32_dpp v13, v9, v2 row_newbcast:2 row_mask:0xf bank_mask:0x3
    s_add_u32 m0, s60, 139264
    v_add_u32_dpp v12, v5, v2 row_newbcast:10 row_mask:0xf bank_mask:0xc
    v_add_u32_dpp v13, v9, v2 row_newbcast:10 row_mask:0xf bank_mask:0xc
    buffer_load_dwordx4 v12, s[12:15], 0 offen lds
    s_addk_i32 m0, 0x1000
    s_nop 0
    buffer_load_dwordx4 v13, s[12:15], 0 offen lds
    s_waitcnt vmcnt(10)
    s_barrier
    s_add_u32 m0, s60, 77824
    s_mov_b32 s56, 417792
    buffer_load_dwordx4 v1, s[16:19], s56 offen lds
    s_add_u32 m0, s60, 81920
    s_mov_b32 s56, 425984
    buffer_load_dwordx4 v1, s[16:19], s56 offen lds
    s_add_u32 m0, s60, 86016
    s_mov_b32 s56, 434176
    buffer_load_dwordx4 v1, s[16:19], s56 offen lds
    v_add_u32_dpp v12, v6, v2 row_newbcast:2 row_mask:0xf bank_mask:0x3
    v_add_u32_dpp v13, v10, v2 row_newbcast:2 row_mask:0xf bank_mask:0x3
    s_add_u32 m0, s60, 147456
    v_add_u32_dpp v12, v6, v2 row_newbcast:10 row_mask:0xf bank_mask:0xc
    v_add_u32_dpp v13, v10, v2 row_newbcast:10 row_mask:0xf bank_mask:0xc
    buffer_load_dwordx4 v12, s[12:15], 0 offen lds
    s_addk_i32 m0, 0x1000
    s_nop 0
    buffer_load_dwordx4 v13, s[12:15], 0 offen lds
    s_waitcnt vmcnt(10)
    s_barrier
    s_add_u32 m0, s60, 90112
    s_mov_b32 s56, 442368
    buffer_load_dwordx4 v1, s[16:19], s56 offen lds
    s_add_u32 m0, s60, 94208
    s_mov_b32 s56, 450560
    buffer_load_dwordx4 v1, s[16:19], s56 offen lds
    s_add_u32 m0, s60, 98304
    s_mov_b32 s56, 458752
    buffer_load_dwordx4 v1, s[16:19], s56 offen lds
    s_add_u32 m0, s60, 102400
    s_mov_b32 s56, 466944
    buffer_load_dwordx4 v1, s[16:19], s56 offen lds
    v_add_u32_dpp v12, v7, v2 row_newbcast:2 row_mask:0xf bank_mask:0x3
    v_add_u32_dpp v13, v11, v2 row_newbcast:2 row_mask:0xf bank_mask:0x3
    s_add_u32 m0, s60, 155648
    v_add_u32_dpp v12, v7, v2 row_newbcast:10 row_mask:0xf bank_mask:0xc
    v_add_u32_dpp v13, v11, v2 row_newbcast:10 row_mask:0xf bank_mask:0xc
    buffer_load_dwordx4 v12, s[12:15], 0 offen lds
    s_addk_i32 m0, 0x1000
    s_nop 0
    buffer_load_dwordx4 v13, s[12:15], 0 offen lds
    s_waitcnt vmcnt(11)
    s_barrier
    s_add_u32 m0, s60, 106496
    s_mov_b32 s56, 475136
    buffer_load_dwordx4 v1, s[16:19], s56 offen lds
    s_add_u32 m0, s60, 110592
    s_mov_b32 s56, 483328
    buffer_load_dwordx4 v1, s[16:19], s56 offen lds
    s_add_u32 m0, s60, 114688
    s_mov_b32 s56, 491520
    buffer_load_dwordx4 v1, s[16:19], s56 offen lds
    v_add_u32_dpp v12, v4, v2 row_newbcast:3 row_mask:0xf bank_mask:0x3
    v_add_u32_dpp v13, v8, v2 row_newbcast:3 row_mask:0xf bank_mask:0x3
    s_add_u32 m0, s60, 131072
    v_add_u32_dpp v12, v4, v2 row_newbcast:11 row_mask:0xf bank_mask:0xc
    v_add_u32_dpp v13, v8, v2 row_newbcast:11 row_mask:0xf bank_mask:0xc
    buffer_load_dwordx4 v12, s[12:15], 0 offen lds
    s_addk_i32 m0, 0x1000
    s_nop 0
    buffer_load_dwordx4 v13, s[12:15], 0 offen lds
    s_waitcnt vmcnt(11)
    s_barrier
    s_add_u32 m0, s60, 118784
    s_mov_b32 s56, 499712
    buffer_load_dwordx4 v1, s[16:19], s56 offen lds
    s_add_u32 m0, s60, 122880
    s_mov_b32 s56, 507904
    buffer_load_dwordx4 v1, s[16:19], s56 offen lds
    s_add_u32 m0, s60, 126976
    s_mov_b32 s56, 516096
    buffer_load_dwordx4 v1, s[16:19], s56 offen lds
    v_add_u32_dpp v12, v5, v2 row_newbcast:3 row_mask:0xf bank_mask:0x3
    v_add_u32_dpp v13, v9, v2 row_newbcast:3 row_mask:0xf bank_mask:0x3
    s_add_u32 m0, s60, 139264
    v_add_u32_dpp v12, v5, v2 row_newbcast:11 row_mask:0xf bank_mask:0xc
    v_add_u32_dpp v13, v9, v2 row_newbcast:11 row_mask:0xf bank_mask:0xc
    buffer_load_dwordx4 v12, s[12:15], 0 offen lds
    s_addk_i32 m0, 0x1000
    s_nop 0
    buffer_load_dwordx4 v13, s[12:15], 0 offen lds
    s_waitcnt vmcnt(10)
    s_barrier
    s_add_u32 m0, s60, 0
    s_mov_b32 s56, 524288
    buffer_load_dwordx4 v1, s[16:19], s56 offen lds
    s_add_u32 m0, s60, 4096
    s_mov_b32 s56, 532480
    buffer_load_dwordx4 v1, s[16:19], s56 offen lds
    s_add_u32 m0, s60, 8192
    s_mov_b32 s56, 540672
    buffer_load_dwordx4 v1, s[16:19], s56 offen lds
    s_add_u32 m0, s60, 12288
    s_mov_b32 s56, 548864
    buffer_load_dwordx4 v1, s[16:19], s56 offen lds
    v_add_u32_dpp v12, v6, v2 row_newbcast:3 row_mask:0xf bank_mask:0x3
    v_add_u32_dpp v13, v10, v2 row_newbcast:3 row_mask:0xf bank_mask:0x3
    s_add_u32 m0, s60, 147456
    v_add_u32_dpp v12, v6, v2 row_newbcast:11 row_mask:0xf bank_mask:0xc
    v_add_u32_dpp v13, v10, v2 row_newbcast:11 row_mask:0xf bank_mask:0xc
    buffer_load_dwordx4 v12, s[12:15], 0 offen lds
    s_addk_i32 m0, 0x1000
    s_nop 0
    buffer_load_dwordx4 v13, s[12:15], 0 offen lds
    s_waitcnt vmcnt(11)
    s_barrier
    s_add_u32 m0, s60, 16384
    s_mov_b32 s56, 557056
    buffer_load_dwordx4 v1, s[16:19], s56 offen lds
    s_add_u32 m0, s60, 20480
    s_mov_b32 s56, 565248
    buffer_load_dwordx4 v1, s[16:19], s56 offen lds
    s_add_u32 m0, s60, 24576
    s_mov_b32 s56, 573440
    buffer_load_dwordx4 v1, s[16:19], s56 offen lds
    v_add_u32_dpp v12, v7, v2 row_newbcast:3 row_mask:0xf bank_mask:0x3
    v_add_u32_dpp v13, v11, v2 row_newbcast:3 row_mask:0xf bank_mask:0x3
    s_add_u32 m0, s60, 155648
    v_add_u32_dpp v12, v7, v2 row_newbcast:11 row_mask:0xf bank_mask:0xc
    v_add_u32_dpp v13, v11, v2 row_newbcast:11 row_mask:0xf bank_mask:0xc
    buffer_load_dwordx4 v12, s[12:15], 0 offen lds
    s_addk_i32 m0, 0x1000
    s_nop 0
    buffer_load_dwordx4 v13, s[12:15], 0 offen lds
    s_waitcnt vmcnt(11)
    s_barrier
    s_add_u32 m0, s60, 28672
    s_mov_b32 s56, 581632
    buffer_load_dwordx4 v1, s[16:19], s56 offen lds
    s_add_u32 m0, s60, 32768
    s_mov_b32 s56, 589824
    buffer_load_dwordx4 v1, s[16:19], s56 offen lds
    s_add_u32 m0, s60, 36864
    s_mov_b32 s56, 598016
    buffer_load_dwordx4 v1, s[16:19], s56 offen lds
    v_add_u32_dpp v12, v4, v2 row_newbcast:4 row_mask:0xf bank_mask:0x3
    v_add_u32_dpp v13, v8, v2 row_newbcast:4 row_mask:0xf bank_mask:0x3
    s_add_u32 m0, s60, 131072
    v_add_u32_dpp v12, v4, v2 row_newbcast:12 row_mask:0xf bank_mask:0xc
    v_add_u32_dpp v13, v8, v2 row_newbcast:12 row_mask:0xf bank_mask:0xc
    buffer_load_dwordx4 v12, s[12:15], 0 offen lds
    s_addk_i32 m0, 0x1000
    s_nop 0
    buffer_load_dwordx4 v13, s[12:15], 0 offen lds
    s_waitcnt vmcnt(10)
    s_barrier
    s_add_u32 m0, s60, 40960
    s_mov_b32 s56, 606208
    buffer_load_dwordx4 v1, s[16:19], s56 offen lds
    s_add_u32 m0, s60, 45056
    s_mov_b32 s56, 614400
    buffer_load_dwordx4 v1, s[16:19], s56 offen lds
    s_add_u32 m0, s60, 49152
    s_mov_b32 s56, 622592
    buffer_load_dwordx4 v1, s[16:19], s56 offen lds
    v_add_u32_dpp v12, v5, v2 row_newbcast:4 row_mask:0xf bank_mask:0x3
    v_add_u32_dpp v13, v9, v2 row_newbcast:4 row_mask:0xf bank_mask:0x3
    s_add_u32 m0, s60, 139264
    v_add_u32_dpp v12, v5, v2 row_newbcast:12 row_mask:0xf bank_mask:0xc
    v_add_u32_dpp v13, v9, v2 row_newbcast:12 row_mask:0xf bank_mask:0xc
    buffer_load_dwordx4 v12, s[12:15], 0 offen lds
    s_addk_i32 m0, 0x1000
    s_nop 0
    buffer_load_dwordx4 v13, s[12:15], 0 offen lds
    s_waitcnt vmcnt(10)
    s_barrier
    s_add_u32 m0, s60, 53248
    s_mov_b32 s56, 630784
    buffer_load_dwordx4 v1, s[16:19], s56 offen lds
    s_add_u32 m0, s60, 57344
    s_mov_b32 s56, 638976
    buffer_load_dwordx4 v1, s[16:19], s56 offen lds
    s_add_u32 m0, s60, 61440
    s_mov_b32 s56, 647168
    buffer_load_dwordx4 v1, s[16:19], s56 offen lds
    s_add_u32 m0, s60, 65536
    s_mov_b32 s56, 655360
    buffer_load_dwordx4 v1, s[16:19], s56 offen lds
    v_add_u32_dpp v12, v6, v2 row_newbcast:4 row_mask:0xf bank_mask:0x3
    v_add_u32_dpp v13, v10, v2 row_newbcast:4 row_mask:0xf bank_mask:0x3
    s_add_u32 m0, s60, 147456
    v_add_u32_dpp v12, v6, v2 row_newbcast:12 row_mask:0xf bank_mask:0xc
    v_add_u32_dpp v13, v10, v2 row_newbcast:12 row_mask:0xf bank_mask:0xc
    buffer_load_dwordx4 v12, s[12:15], 0 offen lds
    s_addk_i32 m0, 0x1000
    s_nop 0
    buffer_load_dwordx4 v13, s[12:15], 0 offen lds
    s_waitcnt vmcnt(11)
    s_barrier
    s_add_u32 m0, s60, 69632
    s_mov_b32 s56, 663552
    buffer_load_dwordx4 v1, s[16:19], s56 offen lds
    s_add_u32 m0, s60, 73728
    s_mov_b32 s56, 671744
    buffer_load_dwordx4 v1, s[16:19], s56 offen lds
    s_add_u32 m0, s60, 77824
    s_mov_b32 s56, 679936
    buffer_load_dwordx4 v1, s[16:19], s56 offen lds
    v_add_u32_dpp v12, v7, v2 row_newbcast:4 row_mask:0xf bank_mask:0x3
    v_add_u32_dpp v13, v11, v2 row_newbcast:4 row_mask:0xf bank_mask:0x3
    s_add_u32 m0, s60, 155648
    v_add_u32_dpp v12, v7, v2 row_newbcast:12 row_mask:0xf bank_mask:0xc
    v_add_u32_dpp v13, v11, v2 row_newbcast:12 row_mask:0xf bank_mask:0xc
    buffer_load_dwordx4 v12, s[12:15], 0 offen lds
    s_addk_i32 m0, 0x1000
    s_nop 0
    buffer_load_dwordx4 v13, s[12:15], 0 offen lds
    s_waitcnt vmcnt(11)
    s_barrier
    s_add_u32 m0, s60, 81920
    s_mov_b32 s56, 688128
    buffer_load_dwordx4 v1, s[16:19], s56 offen lds
    s_add_u32 m0, s60, 86016
    s_mov_b32 s56, 696320
    buffer_load_dwordx4 v1, s[16:19], s56 offen lds
    s_add_u32 m0, s60, 90112
    s_mov_b32 s56, 704512
    buffer_load_dwordx4 v1, s[16:19], s56 offen lds
    v_add_u32_dpp v12, v4, v2 row_newbcast:5 row_mask:0xf bank_mask:0x3
    v_add_u32_dpp v13, v8, v2 row_newbcast:5 row_mask:0xf bank_mask:0x3
    s_add_u32 m0, s60, 131072
    v_add_u32_dpp v12, v4, v2 row_newbcast:13 row_mask:0xf bank_mask:0xc
    v_add_u32_dpp v13, v8, v2 row_newbcast:13 row_mask:0xf bank_mask:0xc
    buffer_load_dwordx4 v12, s[12:15], 0 offen lds
    s_addk_i32 m0, 0x1000
    s_nop 0
    buffer_load_dwordx4 v13, s[12:15], 0 offen lds
    s_waitcnt vmcnt(10)
    s_barrier
    s_add_u32 m0, s60, 94208
    s_mov_b32 s56, 712704
    buffer_load_dwordx4 v1, s[16:19], s56 offen lds
    s_add_u32 m0, s60, 98304
    s_mov_b32 s56, 720896
    buffer_load_dwordx4 v1, s[16:19], s56 offen lds
    s_add_u32 m0, s60, 102400
    s_mov_b32 s56, 729088
    buffer_load_dwordx4 v1, s[16:19], s56 offen lds
    v_add_u32_dpp v12, v5, v2 row_newbcast:5 row_mask:0xf bank_mask:0x3
    v_add_u32_dpp v13, v9, v2 row_newbcast:5 row_mask:0xf bank_mask:0x3
    s_add_u32 m0, s60, 139264
    v_add_u32_dpp v12, v5, v2 row_newbcast:13 row_mask:0xf bank_mask:0xc
    v_add_u32_dpp v13, v9, v2 row_newbcast:13 row_mask:0xf bank_mask:0xc
    buffer_load_dwordx4 v12, s[12:15], 0 offen lds
    s_addk_i32 m0, 0x1000
    s_nop 0
    buffer_load_dwordx4 v13, s[12:15], 0 offen lds
    s_waitcnt vmcnt(10)
    s_barrier
    s_add_u32 m0, s60, 106496
    s_mov_b32 s56, 737280
    buffer_load_dwordx4 v1, s[16:19], s56 offen lds
    s_add_u32 m0, s60, 110592
    s_mov_b32 s56, 745472
    buffer_load_dwordx4 v1, s[16:19], s56 offen lds
    s_add_u32 m0, s60, 114688
    s_mov_b32 s56, 753664
    buffer_load_dwordx4 v1, s[16:19], s56 offen lds
    s_add_u32 m0, s60, 118784
    s_mov_b32 s56, 761856
    buffer_load_dwordx4 v1, s[16:19], s56 offen lds
    v_add_u32_dpp v12, v6, v2 row_newbcast:5 row_mask:0xf bank_mask:0x3
    v_add_u32_dpp v13, v10, v2 row_newbcast:5 row_mask:0xf bank_mask:0x3
    s_add_u32 m0, s60, 147456
    v_add_u32_dpp v12, v6, v2 row_newbcast:13 row_mask:0xf bank_mask:0xc
    v_add_u32_dpp v13, v10, v2 row_newbcast:13 row_mask:0xf bank_mask:0xc
    buffer_load_dwordx4 v12, s[12:15], 0 offen lds
    s_addk_i32 m0, 0x1000
    s_nop 0
    buffer_load_dwordx4 v13, s[12:15], 0 offen lds
    s_waitcnt vmcnt(11)
    s_barrier
    s_add_u32 m0, s60, 122880
    s_mov_b32 s56, 770048
    buffer_load_dwordx4 v1, s[16:19], s56 offen lds
    s_add_u32 m0, s60, 126976
    s_mov_b32 s56, 778240
    buffer_load_dwordx4 v1, s[16:19], s56 offen lds
    s_add_u32 m0, s60, 0
    s_mov_b32 s56, 786432
    buffer_load_dwordx4 v1, s[16:19], s56 offen lds
    v_add_u32_dpp v12, v7, v2 row_newbcast:5 row_mask:0xf bank_mask:0x3
    v_add_u32_dpp v13, v11, v2 row_newbcast:5 row_mask:0xf bank_mask:0x3
    s_add_u32 m0, s60, 155648
    v_add_u32_dpp v12, v7, v2 row_newbcast:13 row_mask:0xf bank_mask:0xc
    v_add_u32_dpp v13, v11, v2 row_newbcast:13 row_mask:0xf bank_mask:0xc
    buffer_load_dwordx4 v12, s[12:15], 0 offen lds
    s_addk_i32 m0, 0x1000
    s_nop 0
    buffer_load_dwordx4 v13, s[12:15], 0 offen lds
    s_waitcnt vmcnt(11)
    s_barrier
    s_add_u32 m0, s60, 4096
    s_mov_b32 s56, 794624
    buffer_load_dwordx4 v1, s[16:19], s56 offen lds
    s_add_u32 m0, s60, 8192
    s_mov_b32 s56, 802816
    buffer_load_dwordx4 v1, s[16:19], s56 offen lds
    s_add_u32 m0, s60, 12288
    s_mov_b32 s56, 811008
    buffer_load_dwordx4 v1, s[16:19], s56 offen lds
    v_add_u32_dpp v12, v4, v2 row_newbcast:6 row_mask:0xf bank_mask:0x3
    v_add_u32_dpp v13, v8, v2 row_newbcast:6 row_mask:0xf bank_mask:0x3
    s_add_u32 m0, s60, 131072
    v_add_u32_dpp v12, v4, v2 row_newbcast:14 row_mask:0xf bank_mask:0xc
    v_add_u32_dpp v13, v8, v2 row_newbcast:14 row_mask:0xf bank_mask:0xc
    buffer_load_dwordx4 v12, s[12:15], 0 offen lds
    s_addk_i32 m0, 0x1000
    s_nop 0
    buffer_load_dwordx4 v13, s[12:15], 0 offen lds
    s_waitcnt vmcnt(10)
    s_barrier
    s_add_u32 m0, s60, 16384
    s_mov_b32 s56, 819200
    buffer_load_dwordx4 v1, s[16:19], s56 offen lds
    s_add_u32 m0, s60, 20480
    s_mov_b32 s56, 827392
    buffer_load_dwordx4 v1, s[16:19], s56 offen lds
    s_add_u32 m0, s60, 24576
    s_mov_b32 s56, 835584
    buffer_load_dwordx4 v1, s[16:19], s56 offen lds
    s_add_u32 m0, s60, 28672
    s_mov_b32 s56, 843776
    buffer_load_dwordx4 v1, s[16:19], s56 offen lds
    v_add_u32_dpp v12, v5, v2 row_newbcast:6 row_mask:0xf bank_mask:0x3
    v_add_u32_dpp v13, v9, v2 row_newbcast:6 row_mask:0xf bank_mask:0x3
    s_add_u32 m0, s60, 139264
    v_add_u32_dpp v12, v5, v2 row_newbcast:14 row_mask:0xf bank_mask:0xc
    v_add_u32_dpp v13, v9, v2 row_newbcast:14 row_mask:0xf bank_mask:0xc
    buffer_load_dwordx4 v12, s[12:15], 0 offen lds
    s_addk_i32 m0, 0x1000
    s_nop 0
    buffer_load_dwordx4 v13, s[12:15], 0 offen lds
    s_waitcnt vmcnt(11)
    s_barrier
    s_waitcnt vmcnt(6)
    s_barrier
    s_waitcnt vmcnt(0)
    s_barrier
    s_branch L_end
L_Bc:
    s_mov_b32 s30, 676
    s_mov_b32 s31, 0x00020000
    s_mov_b32 s34, 676
    s_mov_b32 s35, 0x00020000
    s_mov_b32 s26, 8192
    s_mov_b32 s27, 0x00020000
    s_mov_b32 s22, 173056
    s_mov_b32 s23, 0x00020000
    s_mov_b32 s38, 512
    s_mov_b32 s39, 0x00020000
    s_mov_b32 s42, 8192
    s_mov_b32 s43, 0x00020000
    s_mov_b32 s46, 256
    s_mov_b32 s47, 0x00020000
    s_mov_b32 s50, 268435456
    s_mov_b32 s51, 0x00020000
    s_mov_b32 s64, 0x05040100
    s_mov_b32 s65, 0x07060302
    s_mov_b32 s66, 0xc0135761
    s_mov_b32 s67, 0xbdd2d3e8
    s_mov_b32 s68, 0xffff0000
    s_mov_b32 s69, 0xbfb8aa3b
    v_and_b32 v7, 15, v0
    v_bfe_u32 v9, v0, 4, 2
    v_bfe_u32 v10, v0, 1, 3
    v_xor_b32 v10, v10, v9
    v_lshlrev_b32 v10, 4, v10
    v_lshl_add_u32 v10, v7, 7, v10
    v_add_u32 v1, 131072, v10
    v_xor_b32 v2, 64, v1
    v_bfe_u32 v7, v0, 2, 2
    v_lshl_add_u32 v10, v9, 3, v7
    v_lshlrev_b32 v10, 8, v10
    v_xor_b32 v7, s52, v7
    v_lshl_add_u32 v10, v7, 6, v10
    v_bfe_u32 v7, v0, 4, 1
    v_lshl_add_u32 v10, v7, 5, v10
    v_and_b32 v7, 3, v0
    v_lshl_add_u32 v3, v7, 3, v10
    v_xor_b32 v4, 32, v3
    v_add_u32 v5, 0x10000, v3
    v_add_u32 v6, 0x10000, v4
    s_lshl_b32 s56, s54, 8
    s_lshl_b32 s57, s52, 6
    s_add_u32 s56, s56, s57
    v_lshlrev_b32 v9, 3, v9
    s_waitcnt lgkmcnt(0)
    s_mov_b64 s[28:29], s[84:85]
    s_mov_b64 s[32:33], s[86:87]
    s_mov_b64 s[24:25], s[88:89]
    s_mov_b64 s[20:21], s[90:91]
    s_mov_b64 s[36:37], s[92:93]
    s_mov_b64 s[40:41], s[94:95]
    s_mov_b64 s[44:45], s[96:97]
    s_mov_b64 s[48:49], s[98:99]
    s_mov_b32 s58, s56
    v_mov_b32 v32, 0
    v_mov_b32 v33, 0
    v_mov_b32 v34, 0
    v_mov_b32 v35, 0
    v_mov_b32 v36, 0
    v_mov_b32 v37, 0
    v_mov_b32 v38, 0
    v_mov_b32 v39, 0
    v_mov_b32 v40, 0
    v_mov_b32 v41, 0
    v_mov_b32 v42, 0
    v_mov_b32 v43, 0
    v_mov_b32 v44, 0
    v_mov_b32 v45, 0
    v_mov_b32 v46, 0
    v_mov_b32 v47, 0
    v_mov_b32 v48, 0
    v_mov_b32 v49, 0
    v_mov_b32 v50, 0
    v_mov_b32 v51, 0
    v_mov_b32 v52, 0
    v_mov_b32 v53, 0
    v_mov_b32 v54, 0
    v_mov_b32 v55, 0
    v_mov_b32 v56, 0
    v_mov_b32 v57, 0
    v_mov_b32 v58, 0
    v_mov_b32 v59, 0
    v_mov_b32 v60, 0
    v_mov_b32 v61, 0
    v_mov_b32 v62, 0
    v_mov_b32 v63, 0
    v_mov_b32 v12, s66
    v_mov_b32 v13, s66
    v_mov_b32 v14, s67
    v_mov_b32 v15, s67
    v_lshlrev_b32 v172, 3, v0
    s_lshl1_add_u32 s59, s53, s54
    s_lshl_b32 s59, s59, 9
    s_lshl_b32 s56, s52, 28
    s_add_u32 s59, s59, s56
    s_barrier
    ds_read_b64_tr_b16 v[128:129], v3 offset:0
    ds_read_b64_tr_b16 v[130:131], v3 offset:1024
    ds_read_b64_tr_b16 v[132:133], v4 offset:0
    ds_read_b64_tr_b16 v[134:135], v4 offset:1024
    ds_read_b128 v[64:67], v1 offset:0
    ds_read_b128 v[68:71], v1 offset:2048
    ds_read_b128 v[72:75], v1 offset:4096
    ds_read_b128 v[76:79], v1 offset:6144
    ds_read_b64_tr_b16 v[136:137], v3 offset:8192
    ds_read_b64_tr_b16 v[138:139], v3 offset:9216
    ds_read_b64_tr_b16 v[140:141], v4 offset:8192
    ds_read_b64_tr_b16 v[142:143], v4 offset:9216
    ds_read_b128 v[80:83], v2 offset:0
    ds_read_b128 v[84:87], v2 offset:2048
    ds_read_b128 v[88:91], v2 offset:4096
    s_waitcnt lgkmcnt(11)
    ds_read_b128 v[92:95], v2 offset:6144
    s_waitcnt lgkmcnt(0)
    s_barrier
    v_mfma_f32_16x16x32_bf16 v[32:35], v[128:131], v[64:67], v[32:35]
    ds_read_b64_tr_b16 v[144:145], v3 offset:16384
    ds_read_b64_tr_b16 v[146:147], v3 offset:17408
    v_mfma_f32_16x16x32_bf16 v[36:39], v[132:135], v[64:67], v[36:39]
    ds_read_b64_tr_b16 v[148:149], v4 offset:16384
    ds_read_b64_tr_b16 v[150:151], v4 offset:17408
    v_mfma_f32_16x16x32_bf16 v[40:43], v[128:131], v[68:71], v[40:43]
    ds_read_b128 v[96:99], v1 offset:8192
    ds_read_b128 v[100:103], v1 offset:10240
    v_mfma_f32_16x16x32_bf16 v[44:47], v[132:135], v[68:71], v[44:47]
    ds_read_b128 v[104:107], v1 offset:12288
    ds_read_b128 v[108:111], v1 offset:14336
    v_mfma_f32_16x16x32_bf16 v[48:51], v[128:131], v[72:75], v[48:51]
    ds_read_b64_tr_b16 v[152:153], v3 offset:24576
    ds_read_b64_tr_b16 v[154:155], v3 offset:25600
    v_mfma_f32_16x16x32_bf16 v[52:55], v[132:135], v[72:75], v[52:55]
    ds_read_b64_tr_b16 v[156:157], v4 offset:24576
    ds_read_b64_tr_b16 v[158:159], v4 offset:25600
    v_mfma_f32_16x16x32_bf16 v[56:59], v[128:131], v[76:79], v[56:59]
    ds_read_b128 v[112:115], v2 offset:8192
    ds_read_b128 v[116:119], v2 offset:10240
    v_mfma_f32_16x16x32_bf16 v[60:63], v[132:135], v[76:79], v[60:63]
    ds_read_b128 v[120:123], v2 offset:12288
    s_waitcnt lgkmcnt(11)
    ds_read_b128 v[124:127], v2 offset:14336
    v_mfma_f32_16x16x32_bf16 v[32:35], v[136:139], v[80:83], v[32:35]
    v_mfma_f32_16x16x32_bf16 v[36:39], v[140:143], v[80:83], v[36:39]
    v_mfma_f32_16x16x32_bf16 v[40:43], v[136:139], v[84:87], v[40:43]
    v_mfma_f32_16x16x32_bf16 v[44:47], v[140:143], v[84:87], v[44:47]
    v_mfma_f32_16x16x32_bf16 v[48:51], v[136:139], v[88:91], v[48:51]
    v_mfma_f32_16x16x32_bf16 v[52:55], v[140:143], v[88:91], v[52:55]
    v_mfma_f32_16x16x32_bf16 v[56:59], v[136:139], v[92:95], v[56:59]
    v_mfma_f32_16x16x32_bf16 v[60:63], v[140:143], v[92:95], v[60:63]
    s_waitcnt lgkmcnt(0)
    s_barrier
    v_mfma_f32_16x16x32_bf16 v[32:35], v[144:147], v[96:99], v[32:35]
    ds_read_b64_tr_b16 v[128:129], v3 offset:32768
    ds_read_b64_tr_b16 v[130:131], v3 offset:33792
    v_mfma_f32_16x16x32_bf16 v[36:39], v[148:151], v[96:99], v[36:39]
    ds_read_b64_tr_b16 v[132:133], v4 offset:32768
    ds_read_b64_tr_b16 v[134:135], v4 offset:33792
    v_mfma_f32_16x16x32_bf16 v[40:43], v[144:147], v[100:103], v[40:43]
    ds_read_b128 v[64:67], v1 offset:16384
    ds_read_b128 v[68:71], v1 offset:18432
    v_mfma_f32_16x16x32_bf16 v[44:47], v[148:151], v[100:103], v[44:47]
    ds_read_b128 v[72:75], v1 offset:20480
    ds_read_b128 v[76:79], v1 offset:22528
    v_mfma_f32_16x16x32_bf16 v[48:51], v[144:147], v[104:107], v[48:51]
    ds_read_b64_tr_b16 v[136:137], v3 offset:40960
    ds_read_b64_tr_b16 v[138:139], v3 offset:41984
    v_mfma_f32_16x16x32_bf16 v[52:55], v[148:151], v[104:107], v[52:55]
    ds_read_b64_tr_b16 v[140:141], v4 offset:40960
    ds_read_b64_tr_b16 v[142:143], v4 offset:41984
    v_mfma_f32_16x16x32_bf16 v[56:59], v[144:147], v[108:111], v[56:59]
    ds_read_b128 v[80:83], v2 offset:16384
    ds_read_b128 v[84:87], v2 offset:18432
    v_mfma_f32_16x16x32_bf16 v[60:63], v[148:151], v[108:111], v[60:63]
    ds_read_b128 v[88:91], v2 offset:20480
    s_waitcnt lgkmcnt(11)
    ds_read_b128 v[92:95], v2 offset:22528
    v_mfma_f32_16x16x32_bf16 v[32:35], v[152:155], v[112:115], v[32:35]
    v_mfma_f32_16x16x32_bf16 v[36:39], v[156:159], v[112:115], v[36:39]
    v_mfma_f32_16x16x32_bf16 v[40:43], v[152:155], v[116:119], v[40:43]
    v_mfma_f32_16x16x32_bf16 v[44:47], v[156:159], v[116:119], v[44:47]
    v_mfma_f32_16x16x32_bf16 v[48:51], v[152:155], v[120:123], v[48:51]
    v_mfma_f32_16x16x32_bf16 v[52:55], v[156:159], v[120:123], v[52:55]
    v_mfma_f32_16x16x32_bf16 v[56:59], v[152:155], v[124:127], v[56:59]
    v_mfma_f32_16x16x32_bf16 v[60:63], v[156:159], v[124:127], v[60:63]
    s_waitcnt lgkmcnt(0)
    s_barrier
    v_mfma_f32_16x16x32_bf16 v[32:35], v[128:131], v[64:67], v[32:35]
    ds_read_b64_tr_b16 v[144:145], v3 offset:49152
    ds_read_b64_tr_b16 v[146:147], v3 offset:50176
    v_mfma_f32_16x16x32_bf16 v[36:39], v[132:135], v[64:67], v[36:39]
    ds_read_b64_tr_b16 v[148:149], v4 offset:49152
    ds_read_b64_tr_b16 v[150:151], v4 offset:50176
    v_mfma_f32_16x16x32_bf16 v[40:43], v[128:131], v[68:71], v[40:43]
    ds_read_b128 v[96:99], v1 offset:24576
    ds_read_b128 v[100:103], v1 offset:26624
    v_mfma_f32_16x16x32_bf16 v[44:47], v[132:135], v[68:71], v[44:47]
    ds_read_b128 v[104:107], v1 offset:28672
    ds_read_b128 v[108:111], v1 offset:30720
    v_mfma_f32_16x16x32_bf16 v[48:51], v[128:131], v[72:75], v[48:51]
    ds_read_b64_tr_b16 v[152:153], v3 offset:57344
    ds_read_b64_tr_b16 v[154:155], v3 offset:58368
    v_mfma_f32_16x16x32_bf16 v[52:55], v[132:135], v[72:75], v[52:55]
    ds_read_b64_tr_b16 v[156:157], v4 offset:57344
    ds_read_b64_tr_b16 v[158:159], v4 offset:58368
    v_mfma_f32_16x16x32_bf16 v[56:59], v[128:131], v[76:79], v[56:59]
    ds_read_b128 v[112:115], v2 offset:24576
    ds_read_b128 v[116:119], v2 offset:26624
    v_mfma_f32_16x16x32_bf16 v[60:63], v[132:135], v[76:79], v[60:63]
    ds_read_b128 v[120:123], v2 offset:28672
    s_waitcnt lgkmcnt(11)
    ds_read_b128 v[124:127], v2 offset:30720
    v_mfma_f32_16x16x32_bf16 v[32:35], v[136:139], v[80:83], v[32:35]
    v_mfma_f32_16x16x32_bf16 v[36:39], v[140:143], v[80:83], v[36:39]
    v_mfma_f32_16x16x32_bf16 v[40:43], v[136:139], v[84:87], v[40:43]
    v_mfma_f32_16x16x32_bf16 v[44:47], v[140:143], v[84:87], v[44:47]
    v_mfma_f32_16x16x32_bf16 v[48:51], v[136:139], v[88:91], v[48:51]
    v_mfma_f32_16x16x32_bf16 v[52:55], v[140:143], v[88:91], v[52:55]
    v_mfma_f32_16x16x32_bf16 v[56:59], v[136:139], v[92:95], v[56:59]
    v_mfma_f32_16x16x32_bf16 v[60:63], v[140:143], v[92:95], v[60:63]
    s_waitcnt lgkmcnt(0)
    s_barrier
    v_mfma_f32_16x16x32_bf16 v[32:35], v[144:147], v[96:99], v[32:35]
    ds_read_b64_tr_b16 v[128:129], v5 offset:0
    ds_read_b64_tr_b16 v[130:131], v5 offset:1024
    v_mfma_f32_16x16x32_bf16 v[36:39], v[148:151], v[96:99], v[36:39]
    ds_read_b64_tr_b16 v[132:133], v6 offset:0
    ds_read_b64_tr_b16 v[134:135], v6 offset:1024
    v_mfma_f32_16x16x32_bf16 v[40:43], v[144:147], v[100:103], v[40:43]
    ds_read_b128 v[64:67], v1 offset:0
    ds_read_b128 v[68:71], v1 offset:2048
    v_mfma_f32_16x16x32_bf16 v[44:47], v[148:151], v[100:103], v[44:47]
    ds_read_b128 v[72:75], v1 offset:4096
    ds_read_b128 v[76:79], v1 offset:6144
    v_mfma_f32_16x16x32_bf16 v[48:51], v[144:147], v[104:107], v[48:51]
    ds_read_b64_tr_b16 v[136:137], v5 offset:8192
    ds_read_b64_tr_b16 v[138:139], v5 offset:9216
    v_mfma_f32_16x16x32_bf16 v[52:55], v[148:151], v[104:107], v[52:55]
    ds_read_b64_tr_b16 v[140:141], v6 offset:8192
    ds_read_b64_tr_b16 v[142:143], v6 offset:9216
    v_mfma_f32_16x16x32_bf16 v[56:59], v[144:147], v[108:111], v[56:59]
    ds_read_b128 v[80:83], v2 offset:0
    ds_read_b128 v[84:87], v2 offset:2048
    v_mfma_f32_16x16x32_bf16 v[60:63], v[148:151], v[108:111], v[60:63]
    ds_read_b128 v[88:91], v2 offset:4096
    s_waitcnt lgkmcnt(11)
    ds_read_b128 v[92:95], v2 offset:6144
    v_mfma_f32_16x16x32_bf16 v[32:35], v[152:155], v[112:115], v[32:35]
    v_mfma_f32_16x16x32_bf16 v[36:39], v[156:159], v[112:115], v[36:39]
    v_mfma_f32_16x16x32_bf16 v[40:43], v[152:155], v[116:119], v[40:43]
    v_mfma_f32_16x16x32_bf16 v[44:47], v[156:159], v[116:119], v[44:47]
    v_mfma_f32_16x16x32_bf16 v[48:51], v[152:155], v[120:123], v[48:51]
    v_mfma_f32_16x16x32_bf16 v[52:55], v[156:159], v[120:123], v[52:55]
    v_mfma_f32_16x16x32_bf16 v[56:59], v[152:155], v[124:127], v[56:59]
    v_mfma_f32_16x16x32_bf16 v[60:63], v[156:159], v[124:127], v[60:63]
    s_waitcnt lgkmcnt(0)
    s_barrier
    v_mfma_f32_16x16x32_bf16 v[32:35], v[128:131], v[64:67], v[32:35]
    ds_read_b64_tr_b16 v[144:145], v5 offset:16384
    ds_read_b64_tr_b16 v[146:147], v5 offset:17408
    v_mfma_f32_16x16x32_bf16 v[36:39], v[132:135], v[64:67], v[36:39]
    ds_read_b64_tr_b16 v[148:149], v6 offset:16384
    ds_read_b64_tr_b16 v[150:151], v6 offset:17408
    v_mfma_f32_16x16x32_bf16 v[40:43], v[128:131], v[68:71], v[40:43]
    ds_read_b128 v[96:99], v1 offset:8192
    ds_read_b128 v[100:103], v1 offset:10240
    v_mfma_f32_16x16x32_bf16 v[44:47], v[132:135], v[68:71], v[44:47]
    ds_read_b128 v[104:107], v1 offset:12288
    ds_read_b128 v[108:111], v1 offset:14336
    v_mfma_f32_16x16x32_bf16 v[48:51], v[128:131], v[72:75], v[48:51]
    ds_read_b64_tr_b16 v[152:153], v5 offset:24576
    ds_read_b64_tr_b16 v[154:155], v5 offset:25600
    v_mfma_f32_16x16x32_bf16 v[52:55], v[132:135], v[72:75], v[52:55]
    ds_read_b64_tr_b16 v[156:157], v6 offset:24576
    ds_read_b64_tr_b16 v[158:159], v6 offset:25600
    v_mfma_f32_16x16x32_bf16 v[56:59], v[128:131], v[76:79], v[56:59]
    ds_read_b128 v[112:115], v2 offset:8192
    ds_read_b128 v[116:119], v2 offset:10240
    v_mfma_f32_16x16x32_bf16 v[60:63], v[132:135], v[76:79], v[60:63]
    ds_read_b128 v[120:123], v2 offset:12288
    s_waitcnt lgkmcnt(11)
    ds_read_b128 v[124:127], v2 offset:14336
    v_mfma_f32_16x16x32_bf16 v[32:35], v[136:139], v[80:83], v[32:35]
    v_mfma_f32_16x16x32_bf16 v[36:39], v[140:143], v[80:83], v[36:39]
    v_mfma_f32_16x16x32_bf16 v[40:43], v[136:139], v[84:87], v[40:43]
    v_mfma_f32_16x16x32_bf16 v[44:47], v[140:143], v[84:87], v[44:47]
    v_mfma_f32_16x16x32_bf16 v[48:51], v[136:139], v[88:91], v[48:51]
    v_mfma_f32_16x16x32_bf16 v[52:55], v[140:143], v[88:91], v[52:55]
    v_mfma_f32_16x16x32_bf16 v[56:59], v[136:139], v[92:95], v[56:59]
    v_mfma_f32_16x16x32_bf16 v[60:63], v[140:143], v[92:95], v[60:63]
    s_waitcnt lgkmcnt(0)
    s_barrier
    v_mfma_f32_16x16x32_bf16 v[32:35], v[144:147], v[96:99], v[32:35]
    ds_read_b64_tr_b16 v[128:129], v5 offset:32768
    ds_read_b64_tr_b16 v[130:131], v5 offset:33792
    v_mfma_f32_16x16x32_bf16 v[36:39], v[148:151], v[96:99], v[36:39]
    ds_read_b64_tr_b16 v[132:133], v6 offset:32768
    ds_read_b64_tr_b16 v[134:135], v6 offset:33792
    v_mfma_f32_16x16x32_bf16 v[40:43], v[144:147], v[100:103], v[40:43]
    ds_read_b128 v[64:67], v1 offset:16384
    ds_read_b128 v[68:71], v1 offset:18432
    v_mfma_f32_16x16x32_bf16 v[44:47], v[148:151], v[100:103], v[44:47]
    ds_read_b128 v[72:75], v1 offset:20480
    ds_read_b128 v[76:79], v1 offset:22528
    v_mfma_f32_16x16x32_bf16 v[48:51], v[144:147], v[104:107], v[48:51]
    ds_read_b64_tr_b16 v[136:137], v5 offset:40960
    ds_read_b64_tr_b16 v[138:139], v5 offset:41984
    v_mfma_f32_16x16x32_bf16 v[52:55], v[148:151], v[104:107], v[52:55]
    ds_read_b64_tr_b16 v[140:141], v6 offset:40960
    ds_read_b64_tr_b16 v[142:143], v6 offset:41984
    v_mfma_f32_16x16x32_bf16 v[56:59], v[144:147], v[108:111], v[56:59]
    ds_read_b128 v[80:83], v2 offset:16384
    ds_read_b128 v[84:87], v2 offset:18432
    v_mfma_f32_16x16x32_bf16 v[60:63], v[148:151], v[108:111], v[60:63]
    ds_read_b128 v[88:91], v2 offset:20480
    s_waitcnt lgkmcnt(11)
    ds_read_b128 v[92:95], v2 offset:22528
    v_mfma_f32_16x16x32_bf16 v[32:35], v[152:155], v[112:115], v[32:35]
    v_mfma_f32_16x16x32_bf16 v[36:39], v[156:159], v[112:115], v[36:39]
    v_mfma_f32_16x16x32_bf16 v[40:43], v[152:155], v[116:119], v[40:43]
    v_mfma_f32_16x16x32_bf16 v[44:47], v[156:159], v[116:119], v[44:47]
    v_mfma_f32_16x16x32_bf16 v[48:51], v[152:155], v[120:123], v[48:51]
    v_mfma_f32_16x16x32_bf16 v[52:55], v[156:159], v[120:123], v[52:55]
    v_mfma_f32_16x16x32_bf16 v[56:59], v[152:155], v[124:127], v[56:59]
    v_mfma_f32_16x16x32_bf16 v[60:63], v[156:159], v[124:127], v[60:63]
    s_waitcnt lgkmcnt(0)
    s_barrier
    v_mfma_f32_16x16x32_bf16 v[32:35], v[128:131], v[64:67], v[32:35]
    ds_read_b64_tr_b16 v[144:145], v5 offset:49152
    ds_read_b64_tr_b16 v[146:147], v5 offset:50176
    v_mfma_f32_16x16x32_bf16 v[36:39], v[132:135], v[64:67], v[36:39]
    ds_read_b64_tr_b16 v[148:149], v6 offset:49152
    ds_read_b64_tr_b16 v[150:151], v6 offset:50176
    v_mfma_f32_16x16x32_bf16 v[40:43], v[128:131], v[68:71], v[40:43]
    ds_read_b128 v[96:99], v1 offset:24576
    ds_read_b128 v[100:103], v1 offset:26624
    v_mfma_f32_16x16x32_bf16 v[44:47], v[132:135], v[68:71], v[44:47]
    ds_read_b128 v[104:107], v1 offset:28672
    ds_read_b128 v[108:111], v1 offset:30720
    v_mfma_f32_16x16x32_bf16 v[48:51], v[128:131], v[72:75], v[48:51]
    ds_read_b64_tr_b16 v[152:153], v5 offset:57344
    ds_read_b64_tr_b16 v[154:155], v5 offset:58368
    v_mfma_f32_16x16x32_bf16 v[52:55], v[132:135], v[72:75], v[52:55]
    ds_read_b64_tr_b16 v[156:157], v6 offset:57344
    ds_read_b64_tr_b16 v[158:159], v6 offset:58368
    v_mfma_f32_16x16x32_bf16 v[56:59], v[128:131], v[76:79], v[56:59]
    ds_read_b128 v[112:115], v2 offset:24576
    ds_read_b128 v[116:119], v2 offset:26624
    v_mfma_f32_16x16x32_bf16 v[60:63], v[132:135], v[76:79], v[60:63]
    ds_read_b128 v[120:123], v2 offset:28672
    s_waitcnt lgkmcnt(11)
    ds_read_b128 v[124:127], v2 offset:30720
    v_mfma_f32_16x16x32_bf16 v[32:35], v[136:139], v[80:83], v[32:35]
    v_mfma_f32_16x16x32_bf16 v[36:39], v[140:143], v[80:83], v[36:39]
    v_mfma_f32_16x16x32_bf16 v[40:43], v[136:139], v[84:87], v[40:43]
    v_mfma_f32_16x16x32_bf16 v[44:47], v[140:143], v[84:87], v[44:47]
    v_mfma_f32_16x16x32_bf16 v[48:51], v[136:139], v[88:91], v[48:51]
    v_mfma_f32_16x16x32_bf16 v[52:55], v[140:143], v[88:91], v[52:55]
    v_mfma_f32_16x16x32_bf16 v[56:59], v[136:139], v[92:95], v[56:59]
    v_mfma_f32_16x16x32_bf16 v[60:63], v[140:143], v[92:95], v[60:63]
    s_waitcnt lgkmcnt(0)
    s_barrier
    v_mfma_f32_16x16x32_bf16 v[32:35], v[144:147], v[96:99], v[32:35]
    ds_read_b64_tr_b16 v[128:129], v3 offset:0
    ds_read_b64_tr_b16 v[130:131], v3 offset:1024
    v_mfma_f32_16x16x32_bf16 v[36:39], v[148:151], v[96:99], v[36:39]
    ds_read_b64_tr_b16 v[132:133], v4 offset:0
    ds_read_b64_tr_b16 v[134:135], v4 offset:1024
    v_mfma_f32_16x16x32_bf16 v[40:43], v[144:147], v[100:103], v[40:43]
    ds_read_b128 v[64:67], v1 offset:0
    ds_read_b128 v[68:71], v1 offset:2048
    v_mfma_f32_16x16x32_bf16 v[44:47], v[148:151], v[100:103], v[44:47]
    ds_read_b128 v[72:75], v1 offset:4096
    ds_read_b128 v[76:79], v1 offset:6144
    v_mfma_f32_16x16x32_bf16 v[48:51], v[144:147], v[104:107], v[48:51]
    ds_read_b64_tr_b16 v[136:137], v3 offset:8192
    ds_read_b64_tr_b16 v[138:139], v3 offset:9216
    v_mfma_f32_16x16x32_bf16 v[52:55], v[148:151], v[104:107], v[52:55]
    ds_read_b64_tr_b16 v[140:141], v4 offset:8192
    ds_read_b64_tr_b16 v[142:143], v4 offset:9216
    v_mfma_f32_16x16x32_bf16 v[56:59], v[144:147], v[108:111], v[56:59]
    ds_read_b128 v[80:83], v2 offset:0
    ds_read_b128 v[84:87], v2 offset:2048
    v_mfma_f32_16x16x32_bf16 v[60:63], v[148:151], v[108:111], v[60:63]
    ds_read_b128 v[88:91], v2 offset:4096
    s_waitcnt lgkmcnt(11)
    ds_read_b128 v[92:95], v2 offset:6144
    v_mfma_f32_16x16x32_bf16 v[32:35], v[152:155], v[112:115], v[32:35]
    v_mfma_f32_16x16x32_bf16 v[36:39], v[156:159], v[112:115], v[36:39]
    v_mfma_f32_16x16x32_bf16 v[40:43], v[152:155], v[116:119], v[40:43]
    v_mfma_f32_16x16x32_bf16 v[44:47], v[156:159], v[116:119], v[44:47]
    v_mfma_f32_16x16x32_bf16 v[48:51], v[152:155], v[120:123], v[48:51]
    v_mfma_f32_16x16x32_bf16 v[52:55], v[156:159], v[120:123], v[52:55]
    v_mfma_f32_16x16x32_bf16 v[56:59], v[152:155], v[124:127], v[56:59]
    v_mfma_f32_16x16x32_bf16 v[60:63], v[156:159], v[124:127], v[60:63]
    s_waitcnt lgkmcnt(0)
    s_barrier
    v_mfma_f32_16x16x32_bf16 v[32:35], v[128:131], v[64:67], v[32:35]
    ds_read_b64_tr_b16 v[144:145], v3 offset:16384
    ds_read_b64_tr_b16 v[146:147], v3 offset:17408
    v_mfma_f32_16x16x32_bf16 v[36:39], v[132:135], v[64:67], v[36:39]
    ds_read_b64_tr_b16 v[148:149], v4 offset:16384
    ds_read_b64_tr_b16 v[150:151], v4 offset:17408
    v_mfma_f32_16x16x32_bf16 v[40:43], v[128:131], v[68:71], v[40:43]
    ds_read_b128 v[96:99], v1 offset:8192
    ds_read_b128 v[100:103], v1 offset:10240
    v_mfma_f32_16x16x32_bf16 v[44:47], v[132:135], v[68:71], v[44:47]
    ds_read_b128 v[104:107], v1 offset:12288
    ds_read_b128 v[108:111], v1 offset:14336
    v_mfma_f32_16x16x32_bf16 v[48:51], v[128:131], v[72:75], v[48:51]
    ds_read_b64_tr_b16 v[152:153], v3 offset:24576
    ds_read_b64_tr_b16 v[154:155], v3 offset:25600
    v_mfma_f32_16x16x32_bf16 v[52:55], v[132:135], v[72:75], v[52:55]
    ds_read_b64_tr_b16 v[156:157], v4 offset:24576
    ds_read_b64_tr_b16 v[158:159], v4 offset:25600
    v_mfma_f32_16x16x32_bf16 v[56:59], v[128:131], v[76:79], v[56:59]
    ds_read_b128 v[112:115], v2 offset:8192
    ds_read_b128 v[116:119], v2 offset:10240
    v_mfma_f32_16x16x32_bf16 v[60:63], v[132:135], v[76:79], v[60:63]
    ds_read_b128 v[120:123], v2 offset:12288
    s_waitcnt lgkmcnt(11)
    ds_read_b128 v[124:127], v2 offset:14336
    v_mfma_f32_16x16x32_bf16 v[32:35], v[136:139], v[80:83], v[32:35]
    v_mfma_f32_16x16x32_bf16 v[36:39], v[140:143], v[80:83], v[36:39]
    v_mfma_f32_16x16x32_bf16 v[40:43], v[136:139], v[84:87], v[40:43]
    v_mfma_f32_16x16x32_bf16 v[44:47], v[140:143], v[84:87], v[44:47]
    v_mfma_f32_16x16x32_bf16 v[48:51], v[136:139], v[88:91], v[48:51]
    v_mfma_f32_16x16x32_bf16 v[52:55], v[140:143], v[88:91], v[52:55]
    v_mfma_f32_16x16x32_bf16 v[56:59], v[136:139], v[92:95], v[56:59]
    v_mfma_f32_16x16x32_bf16 v[60:63], v[140:143], v[92:95], v[60:63]
    s_waitcnt lgkmcnt(0)
    s_barrier
    v_mfma_f32_16x16x32_bf16 v[32:35], v[144:147], v[96:99], v[32:35]
    ds_read_b64_tr_b16 v[128:129], v3 offset:32768
    ds_read_b64_tr_b16 v[130:131], v3 offset:33792
    v_mfma_f32_16x16x32_bf16 v[36:39], v[148:151], v[96:99], v[36:39]
    ds_read_b64_tr_b16 v[132:133], v4 offset:32768
    ds_read_b64_tr_b16 v[134:135], v4 offset:33792
    v_mfma_f32_16x16x32_bf16 v[40:43], v[144:147], v[100:103], v[40:43]
    ds_read_b128 v[64:67], v1 offset:16384
    ds_read_b128 v[68:71], v1 offset:18432
    v_mfma_f32_16x16x32_bf16 v[44:47], v[148:151], v[100:103], v[44:47]
    ds_read_b128 v[72:75], v1 offset:20480
    ds_read_b128 v[76:79], v1 offset:22528
    v_mfma_f32_16x16x32_bf16 v[48:51], v[144:147], v[104:107], v[48:51]
    ds_read_b64_tr_b16 v[136:137], v3 offset:40960
    ds_read_b64_tr_b16 v[138:139], v3 offset:41984
    v_mfma_f32_16x16x32_bf16 v[52:55], v[148:151], v[104:107], v[52:55]
    ds_read_b64_tr_b16 v[140:141], v4 offset:40960
    ds_read_b64_tr_b16 v[142:143], v4 offset:41984
    v_mfma_f32_16x16x32_bf16 v[56:59], v[144:147], v[108:111], v[56:59]
    ds_read_b128 v[80:83], v2 offset:16384
    ds_read_b128 v[84:87], v2 offset:18432
    v_mfma_f32_16x16x32_bf16 v[60:63], v[148:151], v[108:111], v[60:63]
    ds_read_b128 v[88:91], v2 offset:20480
    s_waitcnt lgkmcnt(11)
    ds_read_b128 v[92:95], v2 offset:22528
    v_mfma_f32_16x16x32_bf16 v[32:35], v[152:155], v[112:115], v[32:35]
    v_mfma_f32_16x16x32_bf16 v[36:39], v[156:159], v[112:115], v[36:39]
    v_mfma_f32_16x16x32_bf16 v[40:43], v[152:155], v[116:119], v[40:43]
    v_mfma_f32_16x16x32_bf16 v[44:47], v[156:159], v[116:119], v[44:47]
    v_mfma_f32_16x16x32_bf16 v[48:51], v[152:155], v[120:123], v[48:51]
    v_mfma_f32_16x16x32_bf16 v[52:55], v[156:159], v[120:123], v[52:55]
    v_mfma_f32_16x16x32_bf16 v[56:59], v[152:155], v[124:127], v[56:59]
    v_mfma_f32_16x16x32_bf16 v[60:63], v[156:159], v[124:127], v[60:63]
    s_waitcnt lgkmcnt(0)
    s_barrier
    v_mfma_f32_16x16x32_bf16 v[32:35], v[128:131], v[64:67], v[32:35]
    ds_read_b64_tr_b16 v[144:145], v3 offset:49152
    ds_read_b64_tr_b16 v[146:147], v3 offset:50176
    v_mfma_f32_16x16x32_bf16 v[36:39], v[132:135], v[64:67], v[36:39]
    ds_read_b64_tr_b16 v[148:149], v4 offset:49152
    ds_read_b64_tr_b16 v[150:151], v4 offset:50176
    v_mfma_f32_16x16x32_bf16 v[40:43], v[128:131], v[68:71], v[40:43]
    ds_read_b128 v[96:99], v1 offset:24576
    ds_read_b128 v[100:103], v1 offset:26624
    v_mfma_f32_16x16x32_bf16 v[44:47], v[132:135], v[68:71], v[44:47]
    ds_read_b128 v[104:107], v1 offset:28672
    ds_read_b128 v[108:111], v1 offset:30720
    v_mfma_f32_16x16x32_bf16 v[48:51], v[128:131], v[72:75], v[48:51]
    ds_read_b64_tr_b16 v[152:153], v3 offset:57344
    ds_read_b64_tr_b16 v[154:155], v3 offset:58368
    v_mfma_f32_16x16x32_bf16 v[52:55], v[132:135], v[72:75], v[52:55]
    ds_read_b64_tr_b16 v[156:157], v4 offset:57344
    ds_read_b64_tr_b16 v[158:159], v4 offset:58368
    v_mfma_f32_16x16x32_bf16 v[56:59], v[128:131], v[76:79], v[56:59]
    ds_read_b128 v[112:115], v2 offset:24576
    ds_read_b128 v[116:119], v2 offset:26624
    v_mfma_f32_16x16x32_bf16 v[60:63], v[132:135], v[76:79], v[60:63]
    ds_read_b128 v[120:123], v2 offset:28672
    s_waitcnt lgkmcnt(11)
    ds_read_b128 v[124:127], v2 offset:30720
    v_mfma_f32_16x16x32_bf16 v[32:35], v[136:139], v[80:83], v[32:35]
    v_mfma_f32_16x16x32_bf16 v[36:39], v[140:143], v[80:83], v[36:39]
    v_mfma_f32_16x16x32_bf16 v[40:43], v[136:139], v[84:87], v[40:43]
    v_mfma_f32_16x16x32_bf16 v[44:47], v[140:143], v[84:87], v[44:47]
    v_mfma_f32_16x16x32_bf16 v[48:51], v[136:139], v[88:91], v[48:51]
    v_mfma_f32_16x16x32_bf16 v[52:55], v[140:143], v[88:91], v[52:55]
    v_mfma_f32_16x16x32_bf16 v[56:59], v[136:139], v[92:95], v[56:59]
    v_mfma_f32_16x16x32_bf16 v[60:63], v[140:143], v[92:95], v[60:63]
    s_waitcnt lgkmcnt(0)
    s_barrier
    v_mfma_f32_16x16x32_bf16 v[32:35], v[144:147], v[96:99], v[32:35]
    ds_read_b64_tr_b16 v[128:129], v5 offset:0
    ds_read_b64_tr_b16 v[130:131], v5 offset:1024
    v_mfma_f32_16x16x32_bf16 v[36:39], v[148:151], v[96:99], v[36:39]
    ds_read_b64_tr_b16 v[132:133], v6 offset:0
    ds_read_b64_tr_b16 v[134:135], v6 offset:1024
    v_mfma_f32_16x16x32_bf16 v[40:43], v[144:147], v[100:103], v[40:43]
    ds_read_b128 v[64:67], v1 offset:0
    ds_read_b128 v[68:71], v1 offset:2048
    v_mfma_f32_16x16x32_bf16 v[44:47], v[148:151], v[100:103], v[44:47]
    ds_read_b128 v[72:75], v1 offset:4096
    ds_read_b128 v[76:79], v1 offset:6144
    v_mfma_f32_16x16x32_bf16 v[48:51], v[144:147], v[104:107], v[48:51]
    ds_read_b64_tr_b16 v[136:137], v5 offset:8192
    ds_read_b64_tr_b16 v[138:139], v5 offset:9216
    v_mfma_f32_16x16x32_bf16 v[52:55], v[148:151], v[104:107], v[52:55]
    ds_read_b64_tr_b16 v[140:141], v6 offset:8192
    ds_read_b64_tr_b16 v[142:143], v6 offset:9216
    v_mfma_f32_16x16x32_bf16 v[56:59], v[144:147], v[108:111], v[56:59]
    ds_read_b128 v[80:83], v2 offset:0
    ds_read_b128 v[84:87], v2 offset:2048
    v_mfma_f32_16x16x32_bf16 v[60:63], v[148:151], v[108:111], v[60:63]
    ds_read_b128 v[88:91], v2 offset:4096
    s_waitcnt lgkmcnt(11)
    ds_read_b128 v[92:95], v2 offset:6144
    v_mfma_f32_16x16x32_bf16 v[32:35], v[152:155], v[112:115], v[32:35]
    v_mfma_f32_16x16x32_bf16 v[36:39], v[156:159], v[112:115], v[36:39]
    v_mfma_f32_16x16x32_bf16 v[40:43], v[152:155], v[116:119], v[40:43]
    v_mfma_f32_16x16x32_bf16 v[44:47], v[156:159], v[116:119], v[44:47]
    v_mfma_f32_16x16x32_bf16 v[48:51], v[152:155], v[120:123], v[48:51]
    v_mfma_f32_16x16x32_bf16 v[52:55], v[156:159], v[120:123], v[52:55]
    v_mfma_f32_16x16x32_bf16 v[56:59], v[152:155], v[124:127], v[56:59]
    v_mfma_f32_16x16x32_bf16 v[60:63], v[156:159], v[124:127], v[60:63]
    s_waitcnt lgkmcnt(0)
    s_barrier
    v_mfma_f32_16x16x32_bf16 v[32:35], v[128:131], v[64:67], v[32:35]
    ds_read_b64_tr_b16 v[144:145], v5 offset:16384
    ds_read_b64_tr_b16 v[146:147], v5 offset:17408
    v_mfma_f32_16x16x32_bf16 v[36:39], v[132:135], v[64:67], v[36:39]
    ds_read_b64_tr_b16 v[148:149], v6 offset:16384
    ds_read_b64_tr_b16 v[150:151], v6 offset:17408
    v_mfma_f32_16x16x32_bf16 v[40:43], v[128:131], v[68:71], v[40:43]
    ds_read_b128 v[96:99], v1 offset:8192
    ds_read_b128 v[100:103], v1 offset:10240
    v_mfma_f32_16x16x32_bf16 v[44:47], v[132:135], v[68:71], v[44:47]
    ds_read_b128 v[104:107], v1 offset:12288
    ds_read_b128 v[108:111], v1 offset:14336
    v_mfma_f32_16x16x32_bf16 v[48:51], v[128:131], v[72:75], v[48:51]
    ds_read_b64_tr_b16 v[152:153], v5 offset:24576
    ds_read_b64_tr_b16 v[154:155], v5 offset:25600
    v_mfma_f32_16x16x32_bf16 v[52:55], v[132:135], v[72:75], v[52:55]
    ds_read_b64_tr_b16 v[156:157], v6 offset:24576
    ds_read_b64_tr_b16 v[158:159], v6 offset:25600
    v_mfma_f32_16x16x32_bf16 v[56:59], v[128:131], v[76:79], v[56:59]
    ds_read_b128 v[112:115], v2 offset:8192
    ds_read_b128 v[116:119], v2 offset:10240
    v_mfma_f32_16x16x32_bf16 v[60:63], v[132:135], v[76:79], v[60:63]
    ds_read_b128 v[120:123], v2 offset:12288
    s_waitcnt lgkmcnt(11)
    ds_read_b128 v[124:127], v2 offset:14336
    v_mfma_f32_16x16x32_bf16 v[32:35], v[136:139], v[80:83], v[32:35]
    v_mfma_f32_16x16x32_bf16 v[36:39], v[140:143], v[80:83], v[36:39]
    v_mfma_f32_16x16x32_bf16 v[40:43], v[136:139], v[84:87], v[40:43]
    v_mfma_f32_16x16x32_bf16 v[44:47], v[140:143], v[84:87], v[44:47]
    v_mfma_f32_16x16x32_bf16 v[48:51], v[136:139], v[88:91], v[48:51]
    v_mfma_f32_16x16x32_bf16 v[52:55], v[140:143], v[88:91], v[52:55]
    v_mfma_f32_16x16x32_bf16 v[56:59], v[136:139], v[92:95], v[56:59]
    v_mfma_f32_16x16x32_bf16 v[60:63], v[140:143], v[92:95], v[60:63]
    s_waitcnt lgkmcnt(0)
    s_barrier
    v_mfma_f32_16x16x32_bf16 v[32:35], v[144:147], v[96:99], v[32:35]
    ds_read_b64_tr_b16 v[128:129], v5 offset:32768
    ds_read_b64_tr_b16 v[130:131], v5 offset:33792
    v_mfma_f32_16x16x32_bf16 v[36:39], v[148:151], v[96:99], v[36:39]
    ds_read_b64_tr_b16 v[132:133], v6 offset:32768
    ds_read_b64_tr_b16 v[134:135], v6 offset:33792
    v_mfma_f32_16x16x32_bf16 v[40:43], v[144:147], v[100:103], v[40:43]
    ds_read_b128 v[64:67], v1 offset:16384
    ds_read_b128 v[68:71], v1 offset:18432
    v_mfma_f32_16x16x32_bf16 v[44:47], v[148:151], v[100:103], v[44:47]
    ds_read_b128 v[72:75], v1 offset:20480
    ds_read_b128 v[76:79], v1 offset:22528
    v_mfma_f32_16x16x32_bf16 v[48:51], v[144:147], v[104:107], v[48:51]
    ds_read_b64_tr_b16 v[136:137], v5 offset:40960
    ds_read_b64_tr_b16 v[138:139], v5 offset:41984
    v_mfma_f32_16x16x32_bf16 v[52:55], v[148:151], v[104:107], v[52:55]
    ds_read_b64_tr_b16 v[140:141], v6 offset:40960
    ds_read_b64_tr_b16 v[142:143], v6 offset:41984
    v_mfma_f32_16x16x32_bf16 v[56:59], v[144:147], v[108:111], v[56:59]
    ds_read_b128 v[80:83], v2 offset:16384
    ds_read_b128 v[84:87], v2 offset:18432
    v_mfma_f32_16x16x32_bf16 v[60:63], v[148:151], v[108:111], v[60:63]
    ds_read_b128 v[88:91], v2 offset:20480
    s_waitcnt lgkmcnt(11)
    ds_read_b128 v[92:95], v2 offset:22528
    v_mfma_f32_16x16x32_bf16 v[32:35], v[152:155], v[112:115], v[32:35]
    v_mfma_f32_16x16x32_bf16 v[36:39], v[156:159], v[112:115], v[36:39]
    v_mfma_f32_16x16x32_bf16 v[40:43], v[152:155], v[116:119], v[40:43]
    v_mfma_f32_16x16x32_bf16 v[44:47], v[156:159], v[116:119], v[44:47]
    v_mfma_f32_16x16x32_bf16 v[48:51], v[152:155], v[120:123], v[48:51]
    v_mfma_f32_16x16x32_bf16 v[52:55], v[156:159], v[120:123], v[52:55]
    v_mfma_f32_16x16x32_bf16 v[56:59], v[152:155], v[124:127], v[56:59]
    v_mfma_f32_16x16x32_bf16 v[60:63], v[156:159], v[124:127], v[60:63]
    s_waitcnt lgkmcnt(0)
    s_barrier
    v_mfma_f32_16x16x32_bf16 v[32:35], v[128:131], v[64:67], v[32:35]
    ds_read_b64_tr_b16 v[144:145], v5 offset:49152
    ds_read_b64_tr_b16 v[146:147], v5 offset:50176
    v_mfma_f32_16x16x32_bf16 v[36:39], v[132:135], v[64:67], v[36:39]
    ds_read_b64_tr_b16 v[148:149], v6 offset:49152
    ds_read_b64_tr_b16 v[150:151], v6 offset:50176
    v_mfma_f32_16x16x32_bf16 v[40:43], v[128:131], v[68:71], v[40:43]
    ds_read_b128 v[96:99], v1 offset:24576
    ds_read_b128 v[100:103], v1 offset:26624
    v_mfma_f32_16x16x32_bf16 v[44:47], v[132:135], v[68:71], v[44:47]
    ds_read_b128 v[104:107], v1 offset:28672
    ds_read_b128 v[108:111], v1 offset:30720
    v_mfma_f32_16x16x32_bf16 v[48:51], v[128:131], v[72:75], v[48:51]
    ds_read_b64_tr_b16 v[152:153], v5 offset:57344
    ds_read_b64_tr_b16 v[154:155], v5 offset:58368
    v_mfma_f32_16x16x32_bf16 v[52:55], v[132:135], v[72:75], v[52:55]
    ds_read_b64_tr_b16 v[156:157], v6 offset:57344
    ds_read_b64_tr_b16 v[158:159], v6 offset:58368
    v_mfma_f32_16x16x32_bf16 v[56:59], v[128:131], v[76:79], v[56:59]
    ds_read_b128 v[112:115], v2 offset:24576
    ds_read_b128 v[116:119], v2 offset:26624
    v_mfma_f32_16x16x32_bf16 v[60:63], v[132:135], v[76:79], v[60:63]
    ds_read_b128 v[120:123], v2 offset:28672
    s_waitcnt lgkmcnt(11)
    ds_read_b128 v[124:127], v2 offset:30720
    v_mfma_f32_16x16x32_bf16 v[32:35], v[136:139], v[80:83], v[32:35]
    v_mfma_f32_16x16x32_bf16 v[36:39], v[140:143], v[80:83], v[36:39]
    v_mfma_f32_16x16x32_bf16 v[40:43], v[136:139], v[84:87], v[40:43]
    v_mfma_f32_16x16x32_bf16 v[44:47], v[140:143], v[84:87], v[44:47]
    v_mfma_f32_16x16x32_bf16 v[48:51], v[136:139], v[88:91], v[48:51]
    v_mfma_f32_16x16x32_bf16 v[52:55], v[140:143], v[88:91], v[52:55]
    v_mfma_f32_16x16x32_bf16 v[56:59], v[136:139], v[92:95], v[56:59]
    v_mfma_f32_16x16x32_bf16 v[60:63], v[140:143], v[92:95], v[60:63]
    s_waitcnt lgkmcnt(0)
    s_barrier
    v_mfma_f32_16x16x32_bf16 v[32:35], v[144:147], v[96:99], v[32:35]
    ds_read_b64_tr_b16 v[128:129], v3 offset:0
    ds_read_b64_tr_b16 v[130:131], v3 offset:1024
    v_mfma_f32_16x16x32_bf16 v[36:39], v[148:151], v[96:99], v[36:39]
    ds_read_b64_tr_b16 v[132:133], v4 offset:0
    ds_read_b64_tr_b16 v[134:135], v4 offset:1024
    v_mfma_f32_16x16x32_bf16 v[40:43], v[144:147], v[100:103], v[40:43]
    ds_read_b128 v[64:67], v1 offset:0
    ds_read_b128 v[68:71], v1 offset:2048
    v_mfma_f32_16x16x32_bf16 v[44:47], v[148:151], v[100:103], v[44:47]
    ds_read_b128 v[72:75], v1 offset:4096
    ds_read_b128 v[76:79], v1 offset:6144
    v_mfma_f32_16x16x32_bf16 v[48:51], v[144:147], v[104:107], v[48:51]
    ds_read_b64_tr_b16 v[136:137], v3 offset:8192
    ds_read_b64_tr_b16 v[138:139], v3 offset:9216
    v_mfma_f32_16x16x32_bf16 v[52:55], v[148:151], v[104:107], v[52:55]
    ds_read_b64_tr_b16 v[140:141], v4 offset:8192
    ds_read_b64_tr_b16 v[142:143], v4 offset:9216
    v_mfma_f32_16x16x32_bf16 v[56:59], v[144:147], v[108:111], v[56:59]
    ds_read_b128 v[80:83], v2 offset:0
    ds_read_b128 v[84:87], v2 offset:2048
    v_mfma_f32_16x16x32_bf16 v[60:63], v[148:151], v[108:111], v[60:63]
    ds_read_b128 v[88:91], v2 offset:4096
    s_waitcnt lgkmcnt(11)
    ds_read_b128 v[92:95], v2 offset:6144
    v_mfma_f32_16x16x32_bf16 v[32:35], v[152:155], v[112:115], v[32:35]
    v_mfma_f32_16x16x32_bf16 v[36:39], v[156:159], v[112:115], v[36:39]
    v_mfma_f32_16x16x32_bf16 v[40:43], v[152:155], v[116:119], v[40:43]
    v_mfma_f32_16x16x32_bf16 v[44:47], v[156:159], v[116:119], v[44:47]
    v_mfma_f32_16x16x32_bf16 v[48:51], v[152:155], v[120:123], v[48:51]
    v_mfma_f32_16x16x32_bf16 v[52:55], v[156:159], v[120:123], v[52:55]
    v_mfma_f32_16x16x32_bf16 v[56:59], v[152:155], v[124:127], v[56:59]
    v_mfma_f32_16x16x32_bf16 v[60:63], v[156:159], v[124:127], v[60:63]
    s_waitcnt lgkmcnt(0)
    s_barrier
    v_mfma_f32_16x16x32_bf16 v[32:35], v[128:131], v[64:67], v[32:35]
    ds_read_b64_tr_b16 v[144:145], v3 offset:16384
    ds_read_b64_tr_b16 v[146:147], v3 offset:17408
    v_mfma_f32_16x16x32_bf16 v[36:39], v[132:135], v[64:67], v[36:39]
    ds_read_b64_tr_b16 v[148:149], v4 offset:16384
    ds_read_b64_tr_b16 v[150:151], v4 offset:17408
    v_mfma_f32_16x16x32_bf16 v[40:43], v[128:131], v[68:71], v[40:43]
    ds_read_b128 v[96:99], v1 offset:8192
    ds_read_b128 v[100:103], v1 offset:10240
    v_mfma_f32_16x16x32_bf16 v[44:47], v[132:135], v[68:71], v[44:47]
    ds_read_b128 v[104:107], v1 offset:12288
    ds_read_b128 v[108:111], v1 offset:14336
    v_mfma_f32_16x16x32_bf16 v[48:51], v[128:131], v[72:75], v[48:51]
    ds_read_b64_tr_b16 v[152:153], v3 offset:24576
    ds_read_b64_tr_b16 v[154:155], v3 offset:25600
    v_mfma_f32_16x16x32_bf16 v[52:55], v[132:135], v[72:75], v[52:55]
    ds_read_b64_tr_b16 v[156:157], v4 offset:24576
    ds_read_b64_tr_b16 v[158:159], v4 offset:25600
    v_mfma_f32_16x16x32_bf16 v[56:59], v[128:131], v[76:79], v[56:59]
    ds_read_b128 v[112:115], v2 offset:8192
    ds_read_b128 v[116:119], v2 offset:10240
    v_mfma_f32_16x16x32_bf16 v[60:63], v[132:135], v[76:79], v[60:63]
    ds_read_b128 v[120:123], v2 offset:12288
    s_waitcnt lgkmcnt(11)
    ds_read_b128 v[124:127], v2 offset:14336
    v_mfma_f32_16x16x32_bf16 v[32:35], v[136:139], v[80:83], v[32:35]
    v_mfma_f32_16x16x32_bf16 v[36:39], v[140:143], v[80:83], v[36:39]
    v_mfma_f32_16x16x32_bf16 v[40:43], v[136:139], v[84:87], v[40:43]
    v_mfma_f32_16x16x32_bf16 v[44:47], v[140:143], v[84:87], v[44:47]
    v_mfma_f32_16x16x32_bf16 v[48:51], v[136:139], v[88:91], v[48:51]
    v_mfma_f32_16x16x32_bf16 v[52:55], v[140:143], v[88:91], v[52:55]
    v_mfma_f32_16x16x32_bf16 v[56:59], v[136:139], v[92:95], v[56:59]
    v_mfma_f32_16x16x32_bf16 v[60:63], v[140:143], v[92:95], v[60:63]
    s_waitcnt lgkmcnt(0)
    s_barrier
    v_mfma_f32_16x16x32_bf16 v[32:35], v[144:147], v[96:99], v[32:35]
    ds_read_b64_tr_b16 v[128:129], v3 offset:32768
    ds_read_b64_tr_b16 v[130:131], v3 offset:33792
    v_mfma_f32_16x16x32_bf16 v[36:39], v[148:151], v[96:99], v[36:39]
    ds_read_b64_tr_b16 v[132:133], v4 offset:32768
    ds_read_b64_tr_b16 v[134:135], v4 offset:33792
    v_mfma_f32_16x16x32_bf16 v[40:43], v[144:147], v[100:103], v[40:43]
    ds_read_b128 v[64:67], v1 offset:16384
    ds_read_b128 v[68:71], v1 offset:18432
    v_mfma_f32_16x16x32_bf16 v[44:47], v[148:151], v[100:103], v[44:47]
    ds_read_b128 v[72:75], v1 offset:20480
    ds_read_b128 v[76:79], v1 offset:22528
    v_mfma_f32_16x16x32_bf16 v[48:51], v[144:147], v[104:107], v[48:51]
    ds_read_b64_tr_b16 v[136:137], v3 offset:40960
    ds_read_b64_tr_b16 v[138:139], v3 offset:41984
    v_mfma_f32_16x16x32_bf16 v[52:55], v[148:151], v[104:107], v[52:55]
    ds_read_b64_tr_b16 v[140:141], v4 offset:40960
    ds_read_b64_tr_b16 v[142:143], v4 offset:41984
    v_mfma_f32_16x16x32_bf16 v[56:59], v[144:147], v[108:111], v[56:59]
    ds_read_b128 v[80:83], v2 offset:16384
    ds_read_b128 v[84:87], v2 offset:18432
    v_mfma_f32_16x16x32_bf16 v[60:63], v[148:151], v[108:111], v[60:63]
    ds_read_b128 v[88:91], v2 offset:20480
    s_waitcnt lgkmcnt(11)
    ds_read_b128 v[92:95], v2 offset:22528
    v_mfma_f32_16x16x32_bf16 v[32:35], v[152:155], v[112:115], v[32:35]
    v_mfma_f32_16x16x32_bf16 v[36:39], v[156:159], v[112:115], v[36:39]
    v_mfma_f32_16x16x32_bf16 v[40:43], v[152:155], v[116:119], v[40:43]
    v_mfma_f32_16x16x32_bf16 v[44:47], v[156:159], v[116:119], v[44:47]
    v_mfma_f32_16x16x32_bf16 v[48:51], v[152:155], v[120:123], v[48:51]
    v_mfma_f32_16x16x32_bf16 v[52:55], v[156:159], v[120:123], v[52:55]
    v_mfma_f32_16x16x32_bf16 v[56:59], v[152:155], v[124:127], v[56:59]
    v_mfma_f32_16x16x32_bf16 v[60:63], v[156:159], v[124:127], v[60:63]
    s_waitcnt lgkmcnt(0)
    s_barrier
    v_mfma_f32_16x16x32_bf16 v[32:35], v[128:131], v[64:67], v[32:35]
    ds_read_b64_tr_b16 v[144:145], v3 offset:49152
    ds_read_b64_tr_b16 v[146:147], v3 offset:50176
    v_mfma_f32_16x16x32_bf16 v[36:39], v[132:135], v[64:67], v[36:39]
    ds_read_b64_tr_b16 v[148:149], v4 offset:49152
    ds_read_b64_tr_b16 v[150:151], v4 offset:50176
    v_mfma_f32_16x16x32_bf16 v[40:43], v[128:131], v[68:71], v[40:43]
    ds_read_b128 v[96:99], v1 offset:24576
    ds_read_b128 v[100:103], v1 offset:26624
    v_mfma_f32_16x16x32_bf16 v[44:47], v[132:135], v[68:71], v[44:47]
    ds_read_b128 v[104:107], v1 offset:28672
    ds_read_b128 v[108:111], v1 offset:30720
    v_mfma_f32_16x16x32_bf16 v[48:51], v[128:131], v[72:75], v[48:51]
    ds_read_b64_tr_b16 v[152:153], v3 offset:57344
    ds_read_b64_tr_b16 v[154:155], v3 offset:58368
    v_mfma_f32_16x16x32_bf16 v[52:55], v[132:135], v[72:75], v[52:55]
    ds_read_b64_tr_b16 v[156:157], v4 offset:57344
    ds_read_b64_tr_b16 v[158:159], v4 offset:58368
    v_mfma_f32_16x16x32_bf16 v[56:59], v[128:131], v[76:79], v[56:59]
    ds_read_b128 v[112:115], v2 offset:24576
    ds_read_b128 v[116:119], v2 offset:26624
    v_mfma_f32_16x16x32_bf16 v[60:63], v[132:135], v[76:79], v[60:63]
    ds_read_b128 v[120:123], v2 offset:28672
    s_waitcnt lgkmcnt(11)
    ds_read_b128 v[124:127], v2 offset:30720
    v_mfma_f32_16x16x32_bf16 v[32:35], v[136:139], v[80:83], v[32:35]
    v_mfma_f32_16x16x32_bf16 v[36:39], v[140:143], v[80:83], v[36:39]
    v_mfma_f32_16x16x32_bf16 v[40:43], v[136:139], v[84:87], v[40:43]
    v_mfma_f32_16x16x32_bf16 v[44:47], v[140:143], v[84:87], v[44:47]
    v_mfma_f32_16x16x32_bf16 v[48:51], v[136:139], v[88:91], v[48:51]
    v_mfma_f32_16x16x32_bf16 v[52:55], v[140:143], v[88:91], v[52:55]
    v_mfma_f32_16x16x32_bf16 v[56:59], v[136:139], v[92:95], v[56:59]
    v_mfma_f32_16x16x32_bf16 v[60:63], v[140:143], v[92:95], v[60:63]
    s_waitcnt lgkmcnt(0)
    s_barrier
    v_mfma_f32_16x16x32_bf16 v[32:35], v[144:147], v[96:99], v[32:35]
    ds_read_b64_tr_b16 v[128:129], v5 offset:0
    ds_read_b64_tr_b16 v[130:131], v5 offset:1024
    v_mfma_f32_16x16x32_bf16 v[36:39], v[148:151], v[96:99], v[36:39]
    ds_read_b64_tr_b16 v[132:133], v6 offset:0
    ds_read_b64_tr_b16 v[134:135], v6 offset:1024
    v_mfma_f32_16x16x32_bf16 v[40:43], v[144:147], v[100:103], v[40:43]
    ds_read_b128 v[64:67], v1 offset:0
    ds_read_b128 v[68:71], v1 offset:2048
    v_mfma_f32_16x16x32_bf16 v[44:47], v[148:151], v[100:103], v[44:47]
    ds_read_b128 v[72:75], v1 offset:4096
    ds_read_b128 v[76:79], v1 offset:6144
    v_mfma_f32_16x16x32_bf16 v[48:51], v[144:147], v[104:107], v[48:51]
    ds_read_b64_tr_b16 v[136:137], v5 offset:8192
    ds_read_b64_tr_b16 v[138:139], v5 offset:9216
    v_mfma_f32_16x16x32_bf16 v[52:55], v[148:151], v[104:107], v[52:55]
    ds_read_b64_tr_b16 v[140:141], v6 offset:8192
    ds_read_b64_tr_b16 v[142:143], v6 offset:9216
    v_mfma_f32_16x16x32_bf16 v[56:59], v[144:147], v[108:111], v[56:59]
    ds_read_b128 v[80:83], v2 offset:0
    ds_read_b128 v[84:87], v2 offset:2048
    v_mfma_f32_16x16x32_bf16 v[60:63], v[148:151], v[108:111], v[60:63]
    ds_read_b128 v[88:91], v2 offset:4096
    s_waitcnt lgkmcnt(11)
    ds_read_b128 v[92:95], v2 offset:6144
    v_mfma_f32_16x16x32_bf16 v[32:35], v[152:155], v[112:115], v[32:35]
    v_mfma_f32_16x16x32_bf16 v[36:39], v[156:159], v[112:115], v[36:39]
    v_mfma_f32_16x16x32_bf16 v[40:43], v[152:155], v[116:119], v[40:43]
    v_mfma_f32_16x16x32_bf16 v[44:47], v[156:159], v[116:119], v[44:47]
    v_mfma_f32_16x16x32_bf16 v[48:51], v[152:155], v[120:123], v[48:51]
    v_mfma_f32_16x16x32_bf16 v[52:55], v[156:159], v[120:123], v[52:55]
    v_mfma_f32_16x16x32_bf16 v[56:59], v[152:155], v[124:127], v[56:59]
    v_mfma_f32_16x16x32_bf16 v[60:63], v[156:159], v[124:127], v[60:63]
    s_waitcnt lgkmcnt(0)
    s_barrier
    v_mfma_f32_16x16x32_bf16 v[32:35], v[128:131], v[64:67], v[32:35]
    ds_read_b64_tr_b16 v[144:145], v5 offset:16384
    ds_read_b64_tr_b16 v[146:147], v5 offset:17408
    v_mfma_f32_16x16x32_bf16 v[36:39], v[132:135], v[64:67], v[36:39]
    ds_read_b64_tr_b16 v[148:149], v6 offset:16384
    ds_read_b64_tr_b16 v[150:151], v6 offset:17408
    v_mfma_f32_16x16x32_bf16 v[40:43], v[128:131], v[68:71], v[40:43]
    ds_read_b128 v[96:99], v1 offset:8192
    ds_read_b128 v[100:103], v1 offset:10240
    v_mfma_f32_16x16x32_bf16 v[44:47], v[132:135], v[68:71], v[44:47]
    ds_read_b128 v[104:107], v1 offset:12288
    ds_read_b128 v[108:111], v1 offset:14336
    v_mfma_f32_16x16x32_bf16 v[48:51], v[128:131], v[72:75], v[48:51]
    ds_read_b64_tr_b16 v[152:153], v5 offset:24576
    ds_read_b64_tr_b16 v[154:155], v5 offset:25600
    v_mfma_f32_16x16x32_bf16 v[52:55], v[132:135], v[72:75], v[52:55]
    ds_read_b64_tr_b16 v[156:157], v6 offset:24576
    ds_read_b64_tr_b16 v[158:159], v6 offset:25600
    v_mfma_f32_16x16x32_bf16 v[56:59], v[128:131], v[76:79], v[56:59]
    ds_read_b128 v[112:115], v2 offset:8192
    ds_read_b128 v[116:119], v2 offset:10240
    v_mfma_f32_16x16x32_bf16 v[60:63], v[132:135], v[76:79], v[60:63]
    ds_read_b128 v[120:123], v2 offset:12288
    s_waitcnt lgkmcnt(11)
    ds_read_b128 v[124:127], v2 offset:14336
    v_mfma_f32_16x16x32_bf16 v[32:35], v[136:139], v[80:83], v[32:35]
    v_mfma_f32_16x16x32_bf16 v[36:39], v[140:143], v[80:83], v[36:39]
    v_mfma_f32_16x16x32_bf16 v[40:43], v[136:139], v[84:87], v[40:43]
    v_mfma_f32_16x16x32_bf16 v[44:47], v[140:143], v[84:87], v[44:47]
    v_mfma_f32_16x16x32_bf16 v[48:51], v[136:139], v[88:91], v[48:51]
    v_mfma_f32_16x16x32_bf16 v[52:55], v[140:143], v[88:91], v[52:55]
    v_mfma_f32_16x16x32_bf16 v[56:59], v[136:139], v[92:95], v[56:59]
    v_mfma_f32_16x16x32_bf16 v[60:63], v[140:143], v[92:95], v[60:63]
    s_waitcnt lgkmcnt(0)
    s_barrier
    v_mfma_f32_16x16x32_bf16 v[32:35], v[144:147], v[96:99], v[32:35]
    ds_read_b64_tr_b16 v[128:129], v5 offset:32768
    ds_read_b64_tr_b16 v[130:131], v5 offset:33792
    v_mfma_f32_16x16x32_bf16 v[36:39], v[148:151], v[96:99], v[36:39]
    ds_read_b64_tr_b16 v[132:133], v6 offset:32768
    ds_read_b64_tr_b16 v[134:135], v6 offset:33792
    v_mfma_f32_16x16x32_bf16 v[40:43], v[144:147], v[100:103], v[40:43]
    ds_read_b128 v[64:67], v1 offset:16384
    ds_read_b128 v[68:71], v1 offset:18432
    v_mfma_f32_16x16x32_bf16 v[44:47], v[148:151], v[100:103], v[44:47]
    ds_read_b128 v[72:75], v1 offset:20480
    ds_read_b128 v[76:79], v1 offset:22528
    v_mfma_f32_16x16x32_bf16 v[48:51], v[144:147], v[104:107], v[48:51]
    ds_read_b64_tr_b16 v[136:137], v5 offset:40960
    ds_read_b64_tr_b16 v[138:139], v5 offset:41984
    v_mfma_f32_16x16x32_bf16 v[52:55], v[148:151], v[104:107], v[52:55]
    ds_read_b64_tr_b16 v[140:141], v6 offset:40960
    ds_read_b64_tr_b16 v[142:143], v6 offset:41984
    v_mfma_f32_16x16x32_bf16 v[56:59], v[144:147], v[108:111], v[56:59]
    ds_read_b128 v[80:83], v2 offset:16384
    ds_read_b128 v[84:87], v2 offset:18432
    v_mfma_f32_16x16x32_bf16 v[60:63], v[148:151], v[108:111], v[60:63]
    ds_read_b128 v[88:91], v2 offset:20480
    s_waitcnt lgkmcnt(11)
    ds_read_b128 v[92:95], v2 offset:22528
    v_mfma_f32_16x16x32_bf16 v[32:35], v[152:155], v[112:115], v[32:35]
    v_mfma_f32_16x16x32_bf16 v[36:39], v[156:159], v[112:115], v[36:39]
    v_mfma_f32_16x16x32_bf16 v[40:43], v[152:155], v[116:119], v[40:43]
    v_mfma_f32_16x16x32_bf16 v[44:47], v[156:159], v[116:119], v[44:47]
    v_mfma_f32_16x16x32_bf16 v[48:51], v[152:155], v[120:123], v[48:51]
    v_mfma_f32_16x16x32_bf16 v[52:55], v[156:159], v[120:123], v[52:55]
    v_mfma_f32_16x16x32_bf16 v[56:59], v[152:155], v[124:127], v[56:59]
    v_mfma_f32_16x16x32_bf16 v[60:63], v[156:159], v[124:127], v[60:63]
    s_waitcnt lgkmcnt(0)
    s_barrier
    v_mfma_f32_16x16x32_bf16 v[32:35], v[128:131], v[64:67], v[32:35]
    ds_read_b64_tr_b16 v[144:145], v5 offset:49152
    ds_read_b64_tr_b16 v[146:147], v5 offset:50176
    v_mfma_f32_16x16x32_bf16 v[36:39], v[132:135], v[64:67], v[36:39]
    ds_read_b64_tr_b16 v[148:149], v6 offset:49152
    ds_read_b64_tr_b16 v[150:151], v6 offset:50176
    v_mfma_f32_16x16x32_bf16 v[40:43], v[128:131], v[68:71], v[40:43]
    ds_read_b128 v[96:99], v1 offset:24576
    ds_read_b128 v[100:103], v1 offset:26624
    v_mfma_f32_16x16x32_bf16 v[44:47], v[132:135], v[68:71], v[44:47]
    ds_read_b128 v[104:107], v1 offset:28672
    ds_read_b128 v[108:111], v1 offset:30720
    v_mfma_f32_16x16x32_bf16 v[48:51], v[128:131], v[72:75], v[48:51]
    ds_read_b64_tr_b16 v[152:153], v5 offset:57344
    ds_read_b64_tr_b16 v[154:155], v5 offset:58368
    v_mfma_f32_16x16x32_bf16 v[52:55], v[132:135], v[72:75], v[52:55]
    ds_read_b64_tr_b16 v[156:157], v6 offset:57344
    ds_read_b64_tr_b16 v[158:159], v6 offset:58368
    v_mfma_f32_16x16x32_bf16 v[56:59], v[128:131], v[76:79], v[56:59]
    ds_read_b128 v[112:115], v2 offset:24576
    ds_read_b128 v[116:119], v2 offset:26624
    v_mfma_f32_16x16x32_bf16 v[60:63], v[132:135], v[76:79], v[60:63]
    ds_read_b128 v[120:123], v2 offset:28672
    s_waitcnt lgkmcnt(11)
    ds_read_b128 v[124:127], v2 offset:30720
    v_mfma_f32_16x16x32_bf16 v[32:35], v[136:139], v[80:83], v[32:35]
    v_mfma_f32_16x16x32_bf16 v[36:39], v[140:143], v[80:83], v[36:39]
    v_mfma_f32_16x16x32_bf16 v[40:43], v[136:139], v[84:87], v[40:43]
    v_mfma_f32_16x16x32_bf16 v[44:47], v[140:143], v[84:87], v[44:47]
    v_mfma_f32_16x16x32_bf16 v[48:51], v[136:139], v[88:91], v[48:51]
    v_mfma_f32_16x16x32_bf16 v[52:55], v[140:143], v[88:91], v[52:55]
    v_mfma_f32_16x16x32_bf16 v[56:59], v[136:139], v[92:95], v[56:59]
    v_mfma_f32_16x16x32_bf16 v[60:63], v[140:143], v[92:95], v[60:63]
    buffer_load_dwordx2 v[160:161], v9, s[36:39], s58 offen offset:0
    buffer_load_dwordx2 v[162:163], v9, s[36:39], s58 offen offset:32
    buffer_load_dword v175, v172, s[48:51], s59 offen offset:4 sc1
    s_add_u32 s60, s59, 0x10000
    buffer_load_dword v193, v172, s[48:51], s60 offen offset:4 sc1
    s_lshl_b32 s56, s52, 6
    s_add_u32 s56, s56, s53
    s_lshl_b32 s56, s56, 2
    s_mov_b64 exec, 1
    buffer_load_dword v173, off, s[44:47], s56 sc1
    s_mov_b64 exec, -1
    s_waitcnt lgkmcnt(0)
    s_barrier
    v_mfma_f32_16x16x32_bf16 v[32:35], v[144:147], v[96:99], v[32:35]
    ds_read_b64_tr_b16 v[128:129], v3 offset:0
    ds_read_b64_tr_b16 v[130:131], v3 offset:1024
    v_mfma_f32_16x16x32_bf16 v[36:39], v[148:151], v[96:99], v[36:39]
    ds_read_b64_tr_b16 v[132:133], v4 offset:0
    ds_read_b64_tr_b16 v[134:135], v4 offset:1024
    v_mfma_f32_16x16x32_bf16 v[40:43], v[144:147], v[100:103], v[40:43]
    ds_read_b128 v[64:67], v1 offset:0
    ds_read_b128 v[68:71], v1 offset:2048
    v_mfma_f32_16x16x32_bf16 v[44:47], v[148:151], v[100:103], v[44:47]
    ds_read_b128 v[72:75], v1 offset:4096
    ds_read_b128 v[76:79], v1 offset:6144
    v_mfma_f32_16x16x32_bf16 v[48:51], v[144:147], v[104:107], v[48:51]
    ds_read_b64_tr_b16 v[136:137], v3 offset:8192
    ds_read_b64_tr_b16 v[138:139], v3 offset:9216
    v_mfma_f32_16x16x32_bf16 v[52:55], v[148:151], v[104:107], v[52:55]
    ds_read_b64_tr_b16 v[140:141], v4 offset:8192
    ds_read_b64_tr_b16 v[142:143], v4 offset:9216
    v_mfma_f32_16x16x32_bf16 v[56:59], v[144:147], v[108:111], v[56:59]
    ds_read_b128 v[80:83], v2 offset:0
    ds_read_b128 v[84:87], v2 offset:2048
    v_mfma_f32_16x16x32_bf16 v[60:63], v[148:151], v[108:111], v[60:63]
    ds_read_b128 v[88:91], v2 offset:4096
    s_waitcnt lgkmcnt(11)
    ds_read_b128 v[92:95], v2 offset:6144
    v_mfma_f32_16x16x32_bf16 v[32:35], v[152:155], v[112:115], v[32:35]
    v_mfma_f32_16x16x32_bf16 v[36:39], v[156:159], v[112:115], v[36:39]
    v_mfma_f32_16x16x32_bf16 v[40:43], v[152:155], v[116:119], v[40:43]
    v_mfma_f32_16x16x32_bf16 v[44:47], v[156:159], v[116:119], v[44:47]
    v_mfma_f32_16x16x32_bf16 v[48:51], v[152:155], v[120:123], v[48:51]
    v_mfma_f32_16x16x32_bf16 v[52:55], v[156:159], v[120:123], v[52:55]
    v_mfma_f32_16x16x32_bf16 v[56:59], v[152:155], v[124:127], v[56:59]
    v_mfma_f32_16x16x32_bf16 v[60:63], v[156:159], v[124:127], v[60:63]
    s_waitcnt lgkmcnt(0)
    s_barrier
    v_mfma_f32_16x16x32_bf16 v[32:35], v[128:131], v[64:67], v[32:35]
    ds_read_b64_tr_b16 v[144:145], v3 offset:16384
    ds_read_b64_tr_b16 v[146:147], v3 offset:17408
    v_mfma_f32_16x16x32_bf16 v[36:39], v[132:135], v[64:67], v[36:39]
    ds_read_b64_tr_b16 v[148:149], v4 offset:16384
    ds_read_b64_tr_b16 v[150:151], v4 offset:17408
    v_mfma_f32_16x16x32_bf16 v[40:43], v[128:131], v[68:71], v[40:43]
    ds_read_b128 v[96:99], v1 offset:8192
    ds_read_b128 v[100:103], v1 offset:10240
    v_mfma_f32_16x16x32_bf16 v[44:47], v[132:135], v[68:71], v[44:47]
    ds_read_b128 v[104:107], v1 offset:12288
    ds_read_b128 v[108:111], v1 offset:14336
    v_mfma_f32_16x16x32_bf16 v[48:51], v[128:131], v[72:75], v[48:51]
    ds_read_b64_tr_b16 v[152:153], v3 offset:24576
    ds_read_b64_tr_b16 v[154:155], v3 offset:25600
    v_mfma_f32_16x16x32_bf16 v[52:55], v[132:135], v[72:75], v[52:55]
    ds_read_b64_tr_b16 v[156:157], v4 offset:24576
    ds_read_b64_tr_b16 v[158:159], v4 offset:25600
    v_mfma_f32_16x16x32_bf16 v[56:59], v[128:131], v[76:79], v[56:59]
    ds_read_b128 v[112:115], v2 offset:8192
    ds_read_b128 v[116:119], v2 offset:10240
    v_mfma_f32_16x16x32_bf16 v[60:63], v[132:135], v[76:79], v[60:63]
    ds_read_b128 v[120:123], v2 offset:12288
    s_waitcnt lgkmcnt(11)
    ds_read_b128 v[124:127], v2 offset:14336
    v_mfma_f32_16x16x32_bf16 v[32:35], v[136:139], v[80:83], v[32:35]
    v_mfma_f32_16x16x32_bf16 v[36:39], v[140:143], v[80:83], v[36:39]
    v_mfma_f32_16x16x32_bf16 v[40:43], v[136:139], v[84:87], v[40:43]
    v_mfma_f32_16x16x32_bf16 v[44:47], v[140:143], v[84:87], v[44:47]
    v_mfma_f32_16x16x32_bf16 v[48:51], v[136:139], v[88:91], v[48:51]
    v_mfma_f32_16x16x32_bf16 v[52:55], v[140:143], v[88:91], v[52:55]
    v_mfma_f32_16x16x32_bf16 v[56:59], v[136:139], v[92:95], v[56:59]
    v_mfma_f32_16x16x32_bf16 v[60:63], v[140:143], v[92:95], v[60:63]
    s_waitcnt lgkmcnt(0)
    v_mfma_f32_16x16x32_bf16 v[32:35], v[144:147], v[96:99], v[32:35]
    v_mfma_f32_16x16x32_bf16 v[32:35], v[152:155], v[112:115], v[32:35]
    v_mfma_f32_16x16x32_bf16 v[36:39], v[148:151], v[96:99], v[36:39]
    v_mfma_f32_16x16x32_bf16 v[36:39], v[156:159], v[112:115], v[36:39]
    v_mfma_f32_16x16x32_bf16 v[40:43], v[144:147], v[100:103], v[40:43]
    v_mfma_f32_16x16x32_bf16 v[40:43], v[152:155], v[116:119], v[40:43]
    v_mfma_f32_16x16x32_bf16 v[44:47], v[148:151], v[100:103], v[44:47]
    v_mfma_f32_16x16x32_bf16 v[44:47], v[156:159], v[116:119], v[44:47]
    v_mfma_f32_16x16x32_bf16 v[48:51], v[144:147], v[104:107], v[48:51]
    v_mfma_f32_16x16x32_bf16 v[48:51], v[152:155], v[120:123], v[48:51]
    v_mfma_f32_16x16x32_bf16 v[52:55], v[148:151], v[104:107], v[52:55]
    v_mfma_f32_16x16x32_bf16 v[52:55], v[156:159], v[120:123], v[52:55]
    v_mfma_f32_16x16x32_bf16 v[56:59], v[144:147], v[108:111], v[56:59]
    v_mfma_f32_16x16x32_bf16 v[56:59], v[152:155], v[124:127], v[56:59]
    v_mfma_f32_16x16x32_bf16 v[60:63], v[148:151], v[108:111], v[60:63]
    v_mfma_f32_16x16x32_bf16 v[60:63], v[156:159], v[124:127], v[60:63]
    s_waitcnt vmcnt(3)
    v_lshlrev_b32 v176, 16, v160
    v_and_b32 v177, s68, v160
    v_lshlrev_b32 v178, 16, v161
    v_and_b32 v179, s68, v161
    v_lshlrev_b32 v180, 16, v162
    v_and_b32 v181, s68, v162
    v_lshlrev_b32 v182, 16, v163
    v_and_b32 v183, s68, v163
    v_pk_mul_f32 v[64:65], v[32:33], v[32:33]
    v_pk_mul_f32 v[66:67], v[34:35], v[34:35]
    v_pk_mul_f32 v[68:69], v[36:37], v[36:37]
    v_pk_mul_f32 v[70:71], v[38:39], v[38:39]
    v_pk_mul_f32 v[72:73], v[40:41], v[40:41]
    v_pk_mul_f32 v[74:75], v[42:43], v[42:43]
    v_pk_mul_f32 v[76:77], v[44:45], v[44:45]
    v_pk_mul_f32 v[78:79], v[46:47], v[46:47]
    v_pk_fma_f32 v[64:65], v[64:65], v[14:15], v[12:13]
    v_pk_fma_f32 v[66:67], v[66:67], v[14:15], v[12:13]
    v_pk_fma_f32 v[68:69], v[68:69], v[14:15], v[12:13]
    v_pk_fma_f32 v[70:71], v[70:71], v[14:15], v[12:13]
    v_pk_fma_f32 v[72:73], v[72:73], v[14:15], v[12:13]
    v_pk_fma_f32 v[74:75], v[74:75], v[14:15], v[12:13]
    v_pk_fma_f32 v[76:77], v[76:77], v[14:15], v[12:13]
    v_pk_fma_f32 v[78:79], v[78:79], v[14:15], v[12:13]
    v_pk_mul_f32 v[64:65], v[64:65], v[32:33]
    v_pk_mul_f32 v[66:67], v[66:67], v[34:35]
    v_pk_mul_f32 v[68:69], v[68:69], v[36:37]
    v_pk_mul_f32 v[70:71], v[70:71], v[38:39]
    v_pk_mul_f32 v[72:73], v[72:73], v[40:41]
    v_pk_mul_f32 v[74:75], v[74:75], v[42:43]
    v_pk_mul_f32 v[76:77], v[76:77], v[44:45]
    v_pk_mul_f32 v[78:79], v[78:79], v[46:47]
    v_exp_f32 v64, v64
    v_exp_f32 v66, v66
    v_exp_f32 v68, v68
    v_exp_f32 v70, v70
    v_exp_f32 v72, v72
    v_exp_f32 v74, v74
    v_exp_f32 v76, v76
    v_exp_f32 v78, v78
    v_exp_f32 v65, v65
    v_exp_f32 v67, v67
    v_exp_f32 v69, v69
    v_exp_f32 v71, v71
    v_exp_f32 v73, v73
    v_exp_f32 v75, v75
    v_exp_f32 v77, v77
    v_exp_f32 v79, v79
    v_pk_mul_f32 v[32:33], v[32:33], v[176:177]
    v_pk_mul_f32 v[34:35], v[34:35], v[178:179]
    v_pk_mul_f32 v[36:37], v[36:37], v[180:181]
    v_pk_mul_f32 v[38:39], v[38:39], v[182:183]
    v_pk_mul_f32 v[40:41], v[40:41], v[176:177]
    v_pk_mul_f32 v[42:43], v[42:43], v[178:179]
    v_pk_mul_f32 v[44:45], v[44:45], v[180:181]
    v_pk_mul_f32 v[46:47], v[46:47], v[182:183]
    v_pk_add_f32 v[64:65], v[64:65], 1.0 op_sel_hi:[1,0]
    v_pk_add_f32 v[66:67], v[66:67], 1.0 op_sel_hi:[1,0]
    v_pk_add_f32 v[68:69], v[68:69], 1.0 op_sel_hi:[1,0]
    v_pk_add_f32 v[70:71], v[70:71], 1.0 op_sel_hi:[1,0]
    v_pk_add_f32 v[72:73], v[72:73], 1.0 op_sel_hi:[1,0]
    v_pk_add_f32 v[74:75], v[74:75], 1.0 op_sel_hi:[1,0]
    v_pk_add_f32 v[76:77], v[76:77], 1.0 op_sel_hi:[1,0]
    v_pk_add_f32 v[78:79], v[78:79], 1.0 op_sel_hi:[1,0]
    v_rcp_f32 v64, v64
    v_rcp_f32 v66, v66
    v_rcp_f32 v68, v68
    v_rcp_f32 v70, v70
    v_rcp_f32 v72, v72
    v_rcp_f32 v74, v74
    v_rcp_f32 v76, v76
    v_rcp_f32 v78, v78
    v_rcp_f32 v65, v65
    v_rcp_f32 v67, v67
    v_rcp_f32 v69, v69
    v_rcp_f32 v71, v71
    v_rcp_f32 v73, v73
    v_rcp_f32 v75, v75
    v_rcp_f32 v77, v77
    v_rcp_f32 v79, v79
    v_pk_mul_f32 v[164:165], v[32:33], v[64:65]
    v_pk_fma_f32 v[164:165], v[34:35], v[66:67], v[164:165]
    v_pk_fma_f32 v[164:165], v[36:37], v[68:69], v[164:165]
    v_pk_fma_f32 v[164:165], v[38:39], v[70:71], v[164:165]
    v_pk_mul_f32 v[166:167], v[40:41], v[72:73]
    v_pk_fma_f32 v[166:167], v[42:43], v[74:75], v[166:167]
    v_pk_fma_f32 v[166:167], v[44:45], v[76:77], v[166:167]
    v_pk_fma_f32 v[166:167], v[46:47], v[78:79], v[166:167]
    v_pk_mul_f32 v[64:65], v[48:49], v[48:49]
    v_pk_mul_f32 v[66:67], v[50:51], v[50:51]
    v_pk_mul_f32 v[68:69], v[52:53], v[52:53]
    v_pk_mul_f32 v[70:71], v[54:55], v[54:55]
    v_pk_mul_f32 v[72:73], v[56:57], v[56:57]
    v_pk_mul_f32 v[74:75], v[58:59], v[58:59]
    v_pk_mul_f32 v[76:77], v[60:61], v[60:61]
    v_pk_mul_f32 v[78:79], v[62:63], v[62:63]
    v_pk_fma_f32 v[64:65], v[64:65], v[14:15], v[12:13]
    v_pk_fma_f32 v[66:67], v[66:67], v[14:15], v[12:13]
    v_pk_fma_f32 v[68:69], v[68:69], v[14:15], v[12:13]
    v_pk_fma_f32 v[70:71], v[70:71], v[14:15], v[12:13]
    v_pk_fma_f32 v[72:73], v[72:73], v[14:15], v[12:13]
    v_pk_fma_f32 v[74:75], v[74:75], v[14:15], v[12:13]
    v_pk_fma_f32 v[76:77], v[76:77], v[14:15], v[12:13]
    v_pk_fma_f32 v[78:79], v[78:79], v[14:15], v[12:13]
    v_pk_mul_f32 v[64:65], v[64:65], v[48:49]
    v_pk_mul_f32 v[66:67], v[66:67], v[50:51]
    v_pk_mul_f32 v[68:69], v[68:69], v[52:53]
    v_pk_mul_f32 v[70:71], v[70:71], v[54:55]
    v_pk_mul_f32 v[72:73], v[72:73], v[56:57]
    v_pk_mul_f32 v[74:75], v[74:75], v[58:59]
    v_pk_mul_f32 v[76:77], v[76:77], v[60:61]
    v_pk_mul_f32 v[78:79], v[78:79], v[62:63]
    v_exp_f32 v64, v64
    v_exp_f32 v66, v66
    v_exp_f32 v68, v68
    v_exp_f32 v70, v70
    v_exp_f32 v72, v72
    v_exp_f32 v74, v74
    v_exp_f32 v76, v76
    v_exp_f32 v78, v78
    v_exp_f32 v65, v65
    v_exp_f32 v67, v67
    v_exp_f32 v69, v69
    v_exp_f32 v71, v71
    v_exp_f32 v73, v73
    v_exp_f32 v75, v75
    v_exp_f32 v77, v77
    v_exp_f32 v79, v79
    v_pk_mul_f32 v[48:49], v[48:49], v[176:177]
    v_pk_mul_f32 v[50:51], v[50:51], v[178:179]
    v_pk_mul_f32 v[52:53], v[52:53], v[180:181]
    v_pk_mul_f32 v[54:55], v[54:55], v[182:183]
    v_pk_mul_f32 v[56:57], v[56:57], v[176:177]
    v_pk_mul_f32 v[58:59], v[58:59], v[178:179]
    v_pk_mul_f32 v[60:61], v[60:61], v[180:181]
    v_pk_mul_f32 v[62:63], v[62:63], v[182:183]
    v_pk_add_f32 v[64:65], v[64:65], 1.0 op_sel_hi:[1,0]
    v_pk_add_f32 v[66:67], v[66:67], 1.0 op_sel_hi:[1,0]
    v_pk_add_f32 v[68:69], v[68:69], 1.0 op_sel_hi:[1,0]
    v_pk_add_f32 v[70:71], v[70:71], 1.0 op_sel_hi:[1,0]
    v_pk_add_f32 v[72:73], v[72:73], 1.0 op_sel_hi:[1,0]
    v_pk_add_f32 v[74:75], v[74:75], 1.0 op_sel_hi:[1,0]
    v_pk_add_f32 v[76:77], v[76:77], 1.0 op_sel_hi:[1,0]
    v_pk_add_f32 v[78:79], v[78:79], 1.0 op_sel_hi:[1,0]
    v_rcp_f32 v64, v64
    v_rcp_f32 v66, v66
    v_rcp_f32 v68, v68
    v_rcp_f32 v70, v70
    v_rcp_f32 v72, v72
    v_rcp_f32 v74, v74
    v_rcp_f32 v76, v76
    v_rcp_f32 v78, v78
    v_rcp_f32 v65, v65
    v_rcp_f32 v67, v67
    v_rcp_f32 v69, v69
    v_rcp_f32 v71, v71
    v_rcp_f32 v73, v73
    v_rcp_f32 v75, v75
    v_rcp_f32 v77, v77
    v_rcp_f32 v79, v79
    v_pk_mul_f32 v[168:169], v[48:49], v[64:65]
    v_pk_fma_f32 v[168:169], v[50:51], v[66:67], v[168:169]
    v_pk_fma_f32 v[168:169], v[52:53], v[68:69], v[168:169]
    v_pk_fma_f32 v[168:169], v[54:55], v[70:71], v[168:169]
    v_pk_mul_f32 v[170:171], v[56:57], v[72:73]
    v_pk_fma_f32 v[170:171], v[58:59], v[74:75], v[170:171]
    v_pk_fma_f32 v[170:171], v[60:61], v[76:77], v[170:171]
    v_pk_fma_f32 v[170:171], v[62:63], v[78:79], v[170:171]
    v_add_f32 v164, v164, v165
    v_add_f32 v166, v166, v167
    v_add_f32 v168, v168, v169
    v_add_f32 v170, v170, v171
    v_lshlrev_b32 v1, 2, v0
    v_add_u32 v1, 65536, v1
    v_permlane32_swap_b32 v164, v168
    v_permlane32_swap_b32 v166, v170
    v_add_f32 v164, v164, v168
    v_add_f32 v166, v166, v170
    s_nop 1
    v_permlane16_swap_b32 v164, v166
    v_add_f32 v164, v164, v166
    ds_write_b32 v1, v164
    s_waitcnt lgkmcnt(0)
    s_barrier
    s_cmp_lg_u32 s52, 0
    s_cbranch_scc1 L_end
    ds_read_b32 v17, v1 offset:256
    ds_read_b32 v18, v1 offset:512
    ds_read_b32 v19, v1 offset:768
    s_lshl_b32 s57, s53, 2
    s_lshl_b32 s58, s54, 4
    s_lshl_b32 s58, 2, s58
    v_mov_b32 v6, s58
    s_waitcnt vmcnt(0) lgkmcnt(0)
    v_add_u32 v175, 1, v175
    v_add_u32 v193, 1, v193
    v_add_f32 v164, v164, v17
    v_add_f32 v18, v18, v19
    v_add_f32 v174, v164, v18
    buffer_store_dwordx2 v[174:175], v172, s[48:51], s59 offen
    v_mov_b32 v192, v174
    buffer_store_dwordx2 v[192:193], v172, s[48:51], s60 offen sc1
    v_readfirstlane_b32 s56, v173
    s_nop 0
    s_and_b32 s56, s56, 0x01000100
    s_cmp_eq_u32 s56, 0x01000100
    s_cbranch_scc1 L_end
    s_waitcnt vmcnt(0)
    s_mov_b64 exec, 1
    buffer_atomic_or v6, off, s[44:47], s57 sc1
L_end:
L_exit:
    s_endpgm
L_codeend:
.section .rodata,"a"
.p2align 6
.amdhsa_kernel standalone__deep_cross_fibinet__recsys_kernel
  .amdhsa_next_free_vgpr 256
  .amdhsa_next_free_sgpr 102
  .amdhsa_accum_offset 256
  .amdhsa_group_segment_fixed_size 0
  .amdhsa_kernarg_size 88
  .amdhsa_user_sgpr_count 2
  .amdhsa_user_sgpr_kernarg_segment_ptr 1
  .amdhsa_system_sgpr_workgroup_id_x 1
.end_amdhsa_kernel
```

```asm
; @launch grid=(256,1,1) block=(512,1,1) lds=163840
.amdgcn_target "amdgcn-amd-amdhsa--gfx950"
.text
.globl standalone__deep_cross_fibinet__recsys_kernel
.p2align 12
.type standalone__deep_cross_fibinet__recsys_kernel,@function
standalone__deep_cross_fibinet__recsys_kernel:
    s_cmp_ge_u32 s2, 256
    s_cbranch_scc1 L_exit
    s_load_dwordx2 s[8:9], s[0:1], 0
    s_load_dwordx2 s[16:17], s[0:1], 48
    s_load_dwordx2 s[12:13], s[0:1], 8
    s_load_dwordx8 s[84:91], s[0:1], 16
    s_load_dwordx8 s[92:99], s[0:1], 56
    s_lshr_b32 s56, s2, 2
    s_xor_b32 s56, s56, s2
    s_bfe_u32 s56, s56, 0x10004
    s_mul_i32 s56, s56, 80
    s_xor_b32 s2, s2, s56
    v_lshrrev_b32 v1, 6, v0
    s_lshr_b32 s56, s2, 5
    v_readfirstlane_b32 s52, v1
    s_and_b32 s57, s2, 7
    s_lshl3_add_u32 s53, s56, s57
    s_bfe_u32 s54, s2, 0x10003
    s_getpc_b64 s[20:21]
L_pc:
    s_mov_b32 s22, L_codeend-L_pc
    s_mov_b32 s23, 0x00020000
    s_andn2_b32 s56, s2, 7
    s_add_u32 s56, s56, s52
    s_lshl_b32 s56, s56, 7
    s_mov_b64 exec, 1
    buffer_load_dword v8, off, s[20:23], s56
    s_mov_b64 exec, -1
    s_mov_b32 s10, 425984
    s_mov_b32 s11, 0x00020000
    s_mov_b32 s18, 851968
    s_mov_b32 s19, 0x00020000
    s_mov_b32 s14, 12800000
    s_mov_b32 s15, 0x00020000
    s_bitcmp1_b32 s2, 4
    s_cbranch_scc1 L_B
    v_bfe_u32 v228, v0, 3, 5
    v_mul_u32_u24 v228, 104, v228
    v_and_b32 v229, 7, v0
    v_lshl_add_u32 v228, v229, 4, v228
    v_lshrrev_b32 v230, 8, v0
    v_lshl_add_u32 v228, v230, 4, v228
    v_mul_u32_u24 v230, 12, v230
    s_mov_b32 exec_lo, 0x40404040
    s_mov_b32 exec_hi, 0x40404040
    v_sub_u32 v228, v228, v230
    s_mov_b64 exec, -1
    s_lshl1_add_u32 s58, s53, s54
    s_mul_i32 s58, s58, 3328
    s_lshl_b32 s60, s52, 10
    s_and_b32 s79, s53, 3
    s_bfe_u32 s63, s53, 0x10003
    s_lshl1_add_u32 s63, s63, s54
    s_bfe_u32 s55, s53, 0x10004
    s_and_b32 s82, s53, 4
    s_lshl_b32 s82, s82, 26
    v_bfe_u32 v229, v0, 4, 1
    v_bfe_u32 v230, v0, 3, 1
    v_lshl_add_u32 v229, v229, 3, v230
    s_lshl3_add_u32 s56, s55, s79
    s_lshl_b32 s56, s56, 1
    v_add_u32 v229, s56, v229
    s_add_u32 s56, s79, 24
    v_min_u32 v229, s56, v229
    v_and_b32 v230, 7, v0
    v_lshl_add_u32 v229, v229, 3, v230
    v_lshlrev_b32 v229, 4, v229
    s_lshr_b32 s56, s52, 1
    s_lshl2_add_u32 s56, s56, s63
    s_min_u32 s56, s56, 12
    s_and_b32 s57, s52, 1
    s_lshl1_add_u32 s56, s56, s57
    s_lshr_b32 s57, s53, 5
    s_mul_i32 s57, s57, 26
    s_add_u32 s56, s56, s57
    s_mul_i32 s56, s56, 3328
    s_add_u32 s3, s56, s82
    s_mov_b32 s34, 173056
    s_mov_b32 s35, 0x00020000
    s_lshr_b32 s57, s60, 1
    s_add_u32 m0, s57, 106496
    s_lshr_b32 s6, s2, 5
    s_lshl1_add_u32 s6, s6, s54
    s_waitcnt lgkmcnt(0)
    buffer_load_dwordx4 v[2:5], v228, s[8:11], s58 offen
    s_mov_b64 s[32:33], s[90:91]
    s_mov_b32 exec_hi, 0
    buffer_load_dwordx4 v229, s[32:35], s3 offen lds
    s_mov_b64 exec, -1
    s_mov_b32 s26, 8192
    s_mov_b32 s27, 0x00020000
    s_mov_b64 s[24:25], s[88:89]
    v_lshlrev_b32 v231, 4, v0
    s_add_u32 m0, s60, 139264
    s_lshl_b32 s56, s6, 13
    buffer_load_dwordx4 v231, s[24:27], 0 offen lds
    v_and_b32 v230, 63, v0
    v_lshl_add_u32 v7, v230, 7, s56
    s_sub_u32 s57, s52, 6
    s_lshl_b32 s57, s57, 17
    s_add_u32 s57, s57, s56
    s_add_u32 s57, s57, 262144
    s_cmp_lt_u32 s52, 6
    s_cselect_b32 s57, 0x7f000000, s57
    s_cmp_eq_u32 s52, 0
    s_cselect_b64 s[28:29], s[84:85], s[86:87]
    s_min_u32 s56, s60, 2048
    s_add_u32 m0, s56, 155648
    s_cmp_lt_u32 s52, 2
    s_cselect_b64 s[28:29], s[28:29], s[16:17]
    s_cselect_b32 s30, 676, s18
    s_cselect_b32 s57, 0, s57
    s_cselect_b32 s59, 4, 7
    s_mov_b32 s31, 0x00020000
    v_lshlrev_b32 v232, s59, v230
    buffer_load_dwordx4 v232, s[28:31], s57 offen lds
    s_branch L_A2
L_B:
    s_cmp_lt_u32 s52, 4
    s_cbranch_scc1 L_Bc
    s_setprio 3
    v_bfe_u32 v14, v0, 4, 4
    v_lshlrev_b32 v14, 9, v14
    v_bfe_u32 v15, v0, 4, 2
    v_lshlrev_b32 v15, 2, v15
    s_and_b32 s56, s52, 2
    v_xor_b32 v15, v15, v0
    v_xor_b32 v15, s56, v15
    v_and_b32 v15, 15, v15
    v_lshl_add_u32 v14, v15, 4, v14
    s_lshl_b32 s56, s54, 8
    v_add_u32 v1, s56, v14
    s_and_b32 s60, s52, 3
    s_lshl_b32 s60, s60, 10
    v_bfe_u32 v14, v0, 3, 5
    v_mul_u32_u24 v14, 104, v14
    v_and_b32 v15, 7, v0
    v_lshl_add_u32 v14, v15, 4, v14
    s_mul_i32 s57, s53, 6656
    s_lshr_b32 s58, s2, 5
    s_lshl_b32 s56, s58, 15
    s_mov_b32 s59, 0
    s_waitcnt lgkmcnt(0)
    buffer_load_dwordx4 v[4:7], v14, s[8:11], s57 offen
    buffer_load_dwordx4 v[8:11], v14, s[8:11], s57 offen offset:3328
    s_mov_b32 s38, 512
    s_mov_b32 s39, 0x00020000
    s_mov_b64 s[36:37], s[92:93]
    s_lshr_b32 s58, s60, 3
    s_mov_b64 exec, 1
    buffer_load_dword v16, off, s[36:39], s58
    s_mov_b64 exec, -1
L_lead:
    s_lshr_b32 s58, s56, 1
    s_add_u32 m0, s58, s60
    s_add_u32 s59, s59, 1
    buffer_load_dwordx4 v1, s[16:19], s56 offen lds
    s_addk_i32 m0, 0x1000
    s_addk_i32 s56, 0x2000
    buffer_load_dwordx4 v1, s[16:19], s56 offen lds
    s_addk_i32 m0, 0x1000
    s_addk_i32 s56, 0x2000
    buffer_load_dwordx4 v1, s[16:19], s56 offen lds
    s_addk_i32 m0, 0x1000
    s_addk_i32 s56, 0x2000
    buffer_load_dwordx4 v1, s[16:19], s56 offen lds
    s_addk_i32 s56, 0x2000
    s_and_b32 s56, s56, 262143
    s_cmp_lt_u32 s59, 8
    s_cbranch_scc1 L_lead
    s_branch L_Bl2
L_A2:
    s_and_b32 s56, s60, 0x1000
    s_mul_i32 s56, s56, 3
    s_add_u32 s78, s60, s56
    v_lshrrev_b32 v229, 4, v0
    v_xor_b32 v229, v229, v0
    v_and_b32 v229, 7, v229
    v_lshlrev_b32 v1, 4, v229
    v_and_b32 v147, 15, v0
    v_bfe_u32 v148, v0, 4, 2
    v_bfe_u32 v228, v0, 1, 3
    s_and_b32 s56, s60, 0x400
    s_lshl_b32 s56, s56, 1
    v_lshl_add_u32 v15, v147, 7, s56
    v_xor_b32 v230, v148, v228
    v_lshl_add_u32 v10, v230, 4, v15
    v_xor_b32 v12, 64, v10
    v_xor_b32 v11, 0x800, v10
    v_xor_b32 v13, 0x800, v12
    v_bfe_u32 v150, v0, 2, 2
    v_and_b32 v229, 1, v0
    v_lshl_add_u32 v229, v150, 1, v229
    v_bfe_u32 v232, v0, 1, 1
    v_lshl_add_u32 v151, v232, 3, v229
    s_lshl_b32 s56, s52, 3
    v_xor_b32 v231, s56, v151
    v_lshl_add_u32 v231, v148, 9, v231
    s_mov_b32 s56, 139264
    v_lshl_add_u32 v149, v231, 1, s56
    s_lshl_b32 s56, s52, 11
    s_add_u32 s56, s56, 106496
    s_xor_b32 s57, s56, 0x800
    v_lshl_add_u32 v231, v148, 7, v147
    v_lshl_add_u32 v27, v231, 2, s57
    v_and_b32 v231, 63, v0
    v_lshl_add_u32 v25, v231, 2, s56
    v_and_b32 v232, 3, v0
    v_bfe_u32 v233, v0, 2, 3
    v_lshl_add_u32 v231, v232, 6, v233
    s_lshl_b32 s56, s52, 4
    s_add_u32 s56, s56, 106496
    v_lshl_add_u32 v96, v231, 1, s56
    v_mul_u32_u24 v231, 3328, v233
    v_lshl_add_u32 v97, v232, 4, v231
    v_mov_b32 v103, 0
    s_lshl2_add_u32 s57, s63, s79
    s_lshl_b32 s57, s57, 2
    s_mul_i32 s56, s79, 3
    s_min_u32 s56, s56, 8
    s_mul_i32 s58, s63, 10
    s_add_u32 s56, s56, s58
    s_add_u32 s56, s56, 64
    s_cmp_lt_u32 s79, 2
    s_mov_b32 s79, 0x33333333
    s_cselect_b32 s79, 0x77777777, s79
    s_cmp_eq_u32 s55, 0
    s_cselect_b32 s56, s57, s56
    s_cselect_b32 s79, -1, s79
    s_lshr_b32 s57, s53, 5
    s_mul_i32 s57, s57, 104
    s_add_u32 s56, s56, s57
    s_lshl_b32 s56, s56, 4
    s_mul_i32 s61, s52, 26624
    s_add_u32 s61, s61, 262144
    s_add_u32 s56, s56, s61
    s_add_u32 s62, s56, s82
    s_lshl_b32 s56, s63, 3
    s_lshl_b32 s55, 0xff, s56
    s_mov_b32 s50, 268435456
    s_mov_b32 s51, 0x00020000
    s_mov_b64 s[48:49], s[98:99]
    v_and_b32 v231, 31, v0
    v_bfe_u32 v232, v0, 5, 1
    v_lshl_add_u32 v231, v232, 6, v231
    s_lshl2_add_u32 s56, s53, s54
    s_lshl_b32 s56, s56, 8
    v_lshl_add_u32 v20, v231, 3, s56
    s_waitcnt vmcnt(3)
    v_lshlrev_b32 v2, 7, v2
    v_lshlrev_b32 v3, 7, v3
    v_lshlrev_b32 v4, 7, v4
    v_lshlrev_b32 v5, 7, v5
    v_add_u32_dpp v6, v2, v1 row_newbcast:0 row_mask:0xf bank_mask:0x3
    s_add_u32 m0, s78, 0
    v_add_u32_dpp v6, v2, v1 row_newbcast:8 row_mask:0xf bank_mask:0xc
    buffer_load_dwordx4 v6, s[12:15], 0 offen lds
    v_add_u32_dpp v9, v3, v1 row_newbcast:0 row_mask:0xf bank_mask:0x3
    s_add_u32 m0, s78, 4096
    v_add_u32_dpp v9, v3, v1 row_newbcast:8 row_mask:0xf bank_mask:0xc
    buffer_load_dwordx4 v9, s[12:15], 0 offen lds
    v_add_u32_dpp v6, v4, v1 row_newbcast:0 row_mask:0xf bank_mask:0x3
    s_add_u32 m0, s78, 8192
    v_add_u32_dpp v6, v4, v1 row_newbcast:8 row_mask:0xf bank_mask:0xc
    buffer_load_dwordx4 v6, s[12:15], 0 offen lds
    v_add_u32_dpp v9, v5, v1 row_newbcast:0 row_mask:0xf bank_mask:0x3
    s_add_u32 m0, s78, 12288
    v_add_u32_dpp v9, v5, v1 row_newbcast:8 row_mask:0xf bank_mask:0xc
    buffer_load_dwordx4 v9, s[12:15], 0 offen lds
    v_add_u32_dpp v6, v2, v1 row_newbcast:2 row_mask:0xf bank_mask:0x3
    s_add_u32 m0, s78, 32768
    v_add_u32_dpp v6, v2, v1 row_newbcast:10 row_mask:0xf bank_mask:0xc
    buffer_load_dwordx4 v6, s[12:15], 0 offen lds
    s_waitcnt vmcnt(6)
    s_barrier
    ds_read_u16 v108, v96 offset:0
    ds_read_u16 v109, v96 offset:512
    ds_read_u16 v110, v96 offset:1024
    ds_read_u16 v111, v96 offset:1536
    ds_read_u16 v112, v96 offset:2048
    ds_read_u16 v113, v96 offset:2560
    ds_read_u16 v114, v96 offset:3072
    ds_read_u16 v115, v96 offset:3584
    ds_read_u16 v196, v149 offset:0
    ds_read_u16 v197, v149 offset:128
    ds_read_u16 v198, v149 offset:256
    ds_read_u16 v199, v149 offset:384
    ds_read_u16 v200, v149 offset:512
    ds_read_u16 v201, v149 offset:640
    ds_read_u16 v202, v149 offset:768
    s_waitcnt lgkmcnt(11)
    ds_read_u16 v203, v149 offset:896
    ds_read_u16 v204, v149 offset:4096
    ds_read_u16 v205, v149 offset:4224
    ds_read_u16 v206, v149 offset:4352
    s_waitcnt lgkmcnt(11)
    ds_read_u16 v207, v149 offset:4480
    ds_read_u16 v208, v149 offset:4608
    ds_read_u16 v209, v149 offset:4736
    ds_read_u16 v210, v149 offset:4864
    s_waitcnt lgkmcnt(11)
    ds_read_u16 v211, v149 offset:4992
    s_cmp_ge_u32 s52, 4
    s_cbranch_scc1 L_o1
    s_lshl_b32 s56, s52, 28
    buffer_load_dword v21, v20, s[48:51], s56 offen offset:4 sc1
    s_add_u32 s56, s56, 0x10000
    buffer_load_dword v26, v20, s[48:51], s56 offen offset:4 sc1
L_o1:
    v_lshl_or_b32 v100, v109, 16, v108
    v_lshl_or_b32 v101, v111, 16, v110
    v_lshl_or_b32 v102, v113, 16, v112
    s_mov_b32 exec_hi, 0
    s_mov_b32 exec_lo, s55
    v_lshl_or_b32 v103, v115, 16, v114
    s_mov_b32 exec_lo, s79
    buffer_store_dwordx4 v[100:103], v97, s[48:51], s62 offen sc1
    s_mov_b64 exec, -1
    s_waitcnt lgkmcnt(0)
    v_lshl_or_b32 v152, v197, 16, v196
    v_lshl_or_b32 v153, v199, 16, v198
    v_lshl_or_b32 v154, v201, 16, v200
    v_lshl_or_b32 v155, v203, 16, v202
    v_lshl_or_b32 v156, v205, 16, v204
    v_lshl_or_b32 v157, v207, 16, v206
    v_lshl_or_b32 v158, v209, 16, v208
    v_lshl_or_b32 v159, v211, 16, v210
    s_cmp_ge_u32 s52, 4
    s_cbranch_scc1 L_o2
    v_and_b32 v232, 3, v0
    v_mov_b32 v233, 0x3c803c80
    v_cmp_eq_u32 vcc, 0, v232
    s_nop 1
    v_cndmask_b32 v128, 0, v233, vcc
    v_mov_b32 v129, v128
    v_mov_b32 v130, v128
    v_mov_b32 v131, v128
    v_cmp_eq_u32 vcc, 1, v232
    s_nop 1
    v_cndmask_b32 v132, 0, v233, vcc
    v_mov_b32 v133, v132
    v_mov_b32 v134, v132
    v_mov_b32 v135, v132
    v_cmp_eq_u32 vcc, 2, v232
    s_nop 1
    v_cndmask_b32 v136, 0, v233, vcc
    v_mov_b32 v137, v136
    v_mov_b32 v138, v136
    v_mov_b32 v139, v136
    v_cmp_eq_u32 vcc, 3, v232
    s_nop 1
    v_cndmask_b32 v140, 0, v233, vcc
    v_mov_b32 v141, v140
    v_mov_b32 v142, v140
    v_mov_b32 v143, v140
L_o2:
    v_add_u32_dpp v9, v3, v1 row_newbcast:2 row_mask:0xf bank_mask:0x3
    s_add_u32 m0, s78, 36864
    v_add_u32_dpp v9, v3, v1 row_newbcast:10 row_mask:0xf bank_mask:0xc
    buffer_load_dwordx4 v9, s[12:15], 0 offen lds
    s_cmp_ge_u32 s52, 4
    s_cbranch_scc1 L_o3
    s_waitcnt vmcnt(5)
L_o3:
    s_barrier
    ds_read_b128 v[196:199], v10 offset:0
    ds_read_b128 v[200:203], v12 offset:0
    ds_read_b128 v[204:207], v10 offset:4096
    ds_read_b128 v[208:211], v12 offset:4096
    ds_read_b128 v[212:215], v10 offset:8192
    ds_read_b128 v[216:219], v12 offset:8192
    ds_read_b128 v[220:223], v10 offset:12288
    ds_read_b128 v[224:227], v12 offset:12288
    v_add_u32_dpp v6, v4, v1 row_newbcast:2 row_mask:0xf bank_mask:0x3
    s_add_u32 m0, s78, 40960
    v_add_u32_dpp v6, v4, v1 row_newbcast:10 row_mask:0xf bank_mask:0xc
    buffer_load_dwordx4 v6, s[12:15], 0 offen lds
    v_bfe_u32 v98, v0, 1, 3
    v_xor_b32 v98, s52, v98
    v_lshl_add_u32 v98, v98, 4, v15
    v_lshl_add_u32 v14, v148, 13, v98
    v_xor_b32 v15, 0x800, v14
    v_min_u32 v99, 1, v148
    v_add_u32 v99, 24, v99
    v_lshl_add_u32 v16, v99, 12, v98
    v_xor_b32 v17, 0x800, v16
    v_and_b32 v98, 63, v0
    v_lshlrev_b32 v18, 4, v98
    s_lshl3_add_u32 s56, s6, s52
    s_mul_i32 s56, s56, 1664
    s_add_u32 s56, s56, 262144
    v_lshl_add_u32 v23, v98, 7, s56
    v_mul_u32_u24 v98, 3, v150
    v_min_u32 v98, 8, v98
    v_mad_u32_u24 v98, v148, 10, v98
    v_and_b32 v99, 3, v0
    v_bfrev_b32 v19, 2
    s_mov_b32 exec_lo, 0x33773377
    s_mov_b32 exec_hi, 0x33773377
    v_add_lshl_u32 v19, v98, v99, 4
    s_mov_b64 exec, -1
    s_and_b32 s56, s52, 1
    s_mul_i32 s58, s56, 2304
    s_sub_u32 s59, 160000, s58
    s_add_u32 s58, s58, 157696
    v_mul_u32_u24 v98, 144, v147
    v_lshl_add_u32 v98, v148, 5, v98
    v_add_u32 v29, s58, v98
    v_add_u32 v30, s59, v98
    s_lshl_b32 s7, s52, 11
    s_add_u32 s7, s7, 106496
    v_add_u32 v31, s7, v18
    s_cmp_ge_u32 s52, 4
    s_cbranch_scc1 L_o4
    s_and_b32 s57, s52, 2
    s_lshl_b32 s57, s57, 3
    v_add_u32 v98, s57, v151
    v_add_u32 v99, 24, v150
    v_min_u32 v98, v98, v99
    v_mov_b32 v149, 155648
    s_movk_i32 s59, 208
    v_mad_u32_u24 v99, v148, s59, v149
    v_lshl_add_u32 v146, v98, 1, v99
    v_lshl_add_u32 v149, v147, 1, v149
    v_mad_u32_u24 v145, v148, 26, v149
    v_mad_u32_u24 v144, v148, 52, v149
    v_add_u32 v28, s57, v29
    s_mov_b32 s42, 8192
    s_mov_b32 s43, 0x00020000
    s_mov_b32 s46, 256
    s_mov_b32 s47, 0x00020000
    s_mov_b64 s[40:41], s[94:95]
    s_mov_b64 s[44:45], s[96:97]
    s_mov_b32 s66, 0xc0135761
    s_mov_b32 s67, 0xbdd2d3e8
    s_mov_b32 s68, 0xffff0000
    s_mov_b32 s69, 0xbfb8aa3b
    v_mov_b32 v163, 0
L_o4:
    v_add_u32_dpp v9, v5, v1 row_newbcast:2 row_mask:0xf bank_mask:0x3
    s_add_u32 m0, s78, 45056
    v_add_u32_dpp v9, v5, v1 row_newbcast:10 row_mask:0xf bank_mask:0xc
    buffer_load_dwordx4 v9, s[12:15], 0 offen lds
    s_cmp_ge_u32 s52, 4
    s_cbranch_scc1 L_o5
    s_waitcnt lgkmcnt(4)
    ds_read_u16 v116, v144 offset:0
    ds_read_u16 v117, v144 offset:26
    ds_read_u16 v118, v144 offset:208
    ds_read_u16 v119, v144 offset:234
    ds_read_u16 v120, v144 offset:416
    ds_read_u16 v121, v144 offset:442
    ds_read_u16 v167, v145 offset:624
    ds_read_u16 v124, v146 offset:1024
    ds_read_u16 v125, v146 offset:1076
    ds_read_u16 v126, v146 offset:1128
    ds_read_u16 v127, v146 offset:1180
    s_waitcnt lgkmcnt(0)
    v_lshl_or_b32 v164, v117, 16, v116
    v_lshl_or_b32 v165, v119, 16, v118
    v_lshl_or_b32 v166, v121, 16, v120
    v_lshl_or_b32 v168, v125, 16, v124
    v_lshl_or_b32 v169, v127, 16, v126
L_o5:
    s_waitcnt vmcnt(3)
    s_barrier
    s_cmp_ge_u32 s52, 4
    s_cbranch_scc1 L_o6
    s_lshl_b32 s56, s54, 4
    s_lshl_b32 s56, 0x100, s56
    v_mov_b32 v151, s56
    s_lshl_b32 s56, s52, 6
    s_add_u32 s56, s56, s53
    s_lshl2_add_u32 s56, s56, s82
    s_mov_b64 exec, 1
    buffer_atomic_or v151, off, s[44:47], s56 sc1
    s_mov_b64 exec, -1
L_o6:
    s_waitcnt lgkmcnt(6)
    v_mfma_f32_16x16x32_bf16 v[180:183], v[152:155], v[196:199], 0
    ds_read_b128 v[236:239], v10 offset:16384
    v_mfma_f32_16x16x32_bf16 v[180:183], v[156:159], v[200:203], v[180:183]
    ds_read_b128 v[240:243], v12 offset:16384
    s_waitcnt lgkmcnt(6)
    v_mfma_f32_16x16x32_bf16 v[184:187], v[152:155], v[204:207], 0
    ds_read_b128 v[244:247], v10 offset:20480
    v_mfma_f32_16x16x32_bf16 v[184:187], v[156:159], v[208:211], v[184:187]
    ds_read_b128 v[248:251], v12 offset:20480
    s_waitcnt lgkmcnt(6)
    v_mfma_f32_16x16x32_bf16 v[188:191], v[152:155], v[212:215], 0
    ds_read_b128 v[228:231], v10 offset:24576
    v_mfma_f32_16x16x32_bf16 v[188:191], v[156:159], v[216:219], v[188:191]
    ds_read_b128 v[232:235], v12 offset:24576
    s_waitcnt lgkmcnt(6)
    v_mfma_f32_16x16x32_bf16 v[192:195], v[152:155], v[220:223], 0
    ds_read_b128 v[252:255], v10 offset:28672
    v_mfma_f32_16x16x32_bf16 v[192:195], v[156:159], v[224:227], v[192:195]
    ds_read_b128 v[172:175], v12 offset:28672
    v_add_u32_dpp v6, v2, v1 row_newbcast:4 row_mask:0xf bank_mask:0x3
    s_add_u32 m0, s78, 65536
    v_add_u32_dpp v6, v2, v1 row_newbcast:12 row_mask:0xf bank_mask:0xc
    buffer_load_dwordx4 v6, s[12:15], 0 offen lds
    v_cvt_pk_bf16_f32 v182, v182, v186
    v_cvt_pk_bf16_f32 v183, v183, v187
    ds_write2_b32 v27, v182, v183 offset0:0 offset1:64
    v_cvt_pk_bf16_f32 v32, v180, v184
    v_cvt_pk_bf16_f32 v40, v181, v185
    v_cvt_pk_bf16_f32 v190, v190, v194
    v_cvt_pk_bf16_f32 v191, v191, v195
    ds_write2_b32 v27, v190, v191 offset0:16 offset1:80
    v_cvt_pk_bf16_f32 v48, v188, v192
    v_cvt_pk_bf16_f32 v56, v189, v193
    v_add_u32_dpp v9, v3, v1 row_newbcast:4 row_mask:0xf bank_mask:0x3
    s_add_u32 m0, s78, 69632
    v_add_u32_dpp v9, v3, v1 row_newbcast:12 row_mask:0xf bank_mask:0xc
    buffer_load_dwordx4 v9, s[12:15], 0 offen lds
    s_cmp_ge_u32 s52, 4
    s_cbranch_scc1 L_o7
    v_mfma_f32_16x16x32_bf16 v[176:179], v[128:131], v[196:199], 0
    v_mfma_f32_16x16x32_bf16 v[176:179], v[128:131], v[200:203], v[176:179]
    v_mfma_f32_16x16x32_bf16 v[176:179], v[132:135], v[204:207], v[176:179]
    v_mfma_f32_16x16x32_bf16 v[176:179], v[132:135], v[208:211], v[176:179]
    v_mfma_f32_16x16x32_bf16 v[176:179], v[136:139], v[212:215], v[176:179]
    v_mfma_f32_16x16x32_bf16 v[176:179], v[136:139], v[216:219], v[176:179]
    v_mfma_f32_16x16x32_bf16 v[176:179], v[140:143], v[220:223], v[176:179]
    v_mfma_f32_16x16x32_bf16 v[176:179], v[140:143], v[224:227], v[176:179]
L_o7:
    s_cmp_ge_u32 s52, 4
    s_cbranch_scc1 L_o8
    s_waitcnt vmcnt(3)
L_o8:
    s_barrier
    s_waitcnt lgkmcnt(8)
    v_mfma_f32_16x16x32_bf16 v[180:183], v[152:155], v[236:239], 0
    ds_read_b128 v[196:199], v10 offset:32768
    v_mfma_f32_16x16x32_bf16 v[180:183], v[156:159], v[240:243], v[180:183]
    ds_read_b128 v[200:203], v12 offset:32768
    s_waitcnt lgkmcnt(8)
    v_mfma_f32_16x16x32_bf16 v[184:187], v[152:155], v[244:247], 0
    ds_read_b128 v[204:207], v10 offset:36864
    v_mfma_f32_16x16x32_bf16 v[184:187], v[156:159], v[248:251], v[184:187]
    ds_read_b128 v[208:211], v12 offset:36864
    s_waitcnt lgkmcnt(8)
    v_mfma_f32_16x16x32_bf16 v[188:191], v[152:155], v[228:231], 0
    ds_read_b128 v[212:215], v10 offset:40960
    v_mfma_f32_16x16x32_bf16 v[188:191], v[156:159], v[232:235], v[188:191]
    ds_read_b128 v[216:219], v12 offset:40960
    s_waitcnt lgkmcnt(8)
    v_mfma_f32_16x16x32_bf16 v[192:195], v[152:155], v[252:255], 0
    ds_read_b128 v[220:223], v10 offset:45056
    v_mfma_f32_16x16x32_bf16 v[192:195], v[156:159], v[172:175], v[192:195]
    ds_read_b128 v[224:227], v12 offset:45056
    v_add_u32_dpp v6, v4, v1 row_newbcast:4 row_mask:0xf bank_mask:0x3
    s_add_u32 m0, s78, 73728
    v_add_u32_dpp v6, v4, v1 row_newbcast:12 row_mask:0xf bank_mask:0xc
    buffer_load_dwordx4 v6, s[12:15], 0 offen lds
    v_cvt_pk_bf16_f32 v182, v182, v186
    v_cvt_pk_bf16_f32 v183, v183, v187
    ds_write2_b32 v27, v182, v183 offset0:32 offset1:96
    v_cvt_pk_bf16_f32 v64, v180, v184
    v_cvt_pk_bf16_f32 v72, v181, v185
    v_cvt_pk_bf16_f32 v190, v190, v194
    v_cvt_pk_bf16_f32 v191, v191, v195
    ds_write2_b32 v27, v190, v191 offset0:48 offset1:112
    v_cvt_pk_bf16_f32 v80, v188, v192
    v_cvt_pk_bf16_f32 v88, v189, v193
    v_permlane32_swap_b32 v32, v64
    v_permlane32_swap_b32 v48, v80
    v_permlane32_swap_b32 v40, v72
    v_permlane32_swap_b32 v56, v88
    v_permlane16_swap_b32 v32, v48
    v_permlane16_swap_b32 v64, v80
    v_permlane16_swap_b32 v40, v56
    v_permlane16_swap_b32 v72, v88
    v_add_u32_dpp v9, v5, v1 row_newbcast:4 row_mask:0xf bank_mask:0x3
    s_add_u32 m0, s78, 77824
    v_add_u32_dpp v9, v5, v1 row_newbcast:12 row_mask:0xf bank_mask:0xc
    buffer_load_dwordx4 v9, s[12:15], 0 offen lds
    s_cmp_ge_u32 s52, 4
    s_cbranch_scc1 L_o9
    v_cvt_pk_bf16_f32 v176, v176, v177
    v_cvt_pk_bf16_f32 v178, v178, v179
    s_nop 0
    v_mov_b32_dpp v160, v176 quad_perm:[0,1,2,3] row_mask:0x1 bank_mask:0xf
    v_mov_b32_dpp v160, v178 quad_perm:[0,1,2,3] row_mask:0x2 bank_mask:0xf
    v_mfma_f32_16x16x32_bf16 v[176:179], v[128:131], v[236:239], 0
    v_mfma_f32_16x16x32_bf16 v[176:179], v[128:131], v[240:243], v[176:179]
    v_mfma_f32_16x16x32_bf16 v[176:179], v[132:135], v[244:247], v[176:179]
    v_mfma_f32_16x16x32_bf16 v[176:179], v[132:135], v[248:251], v[176:179]
    v_mfma_f32_16x16x32_bf16 v[176:179], v[136:139], v[228:231], v[176:179]
    v_mfma_f32_16x16x32_bf16 v[176:179], v[136:139], v[232:235], v[176:179]
    v_mfma_f32_16x16x32_bf16 v[176:179], v[140:143], v[252:255], v[176:179]
    v_mfma_f32_16x16x32_bf16 v[176:179], v[140:143], v[172:175], v[176:179]
L_o9:
    s_cmp_lt_u32 s52, 4
    s_cbranch_scc1 L_o10
    s_waitcnt vmcnt(4)
L_o10:
    s_barrier
    s_waitcnt lgkmcnt(8)
    v_mfma_f32_16x16x32_bf16 v[180:183], v[152:155], v[196:199], 0
    ds_read_b128 v[236:239], v10 offset:49152
    v_mfma_f32_16x16x32_bf16 v[180:183], v[156:159], v[200:203], v[180:183]
    ds_read_b128 v[240:243], v12 offset:49152
    s_waitcnt lgkmcnt(8)
    v_mfma_f32_16x16x32_bf16 v[184:187], v[152:155], v[204:207], 0
    ds_read_b128 v[244:247], v10 offset:53248
    v_mfma_f32_16x16x32_bf16 v[184:187], v[156:159], v[208:211], v[184:187]
    ds_read_b128 v[248:251], v12 offset:53248
    s_waitcnt lgkmcnt(8)
    v_mfma_f32_16x16x32_bf16 v[188:191], v[152:155], v[212:215], 0
    ds_read_b128 v[228:231], v10 offset:57344
    v_mfma_f32_16x16x32_bf16 v[188:191], v[156:159], v[216:219], v[188:191]
    ds_read_b128 v[232:235], v12 offset:57344
    s_waitcnt lgkmcnt(8)
    v_mfma_f32_16x16x32_bf16 v[192:195], v[152:155], v[220:223], 0
    ds_read_b128 v[252:255], v10 offset:61440
    v_mfma_f32_16x16x32_bf16 v[192:195], v[156:159], v[224:227], v[192:195]
    ds_read_b128 v[172:175], v12 offset:61440
    v_add_u32_dpp v6, v2, v1 row_newbcast:6 row_mask:0xf bank_mask:0x3
    s_add_u32 m0, s60, 98304
    v_add_u32_dpp v6, v2, v1 row_newbcast:14 row_mask:0xf bank_mask:0xc
    buffer_load_dwordx4 v6, s[12:15], 0 offen lds
    v_add_u32 v27, 0x4000, v27
    v_cvt_pk_bf16_f32 v182, v182, v186
    v_cvt_pk_bf16_f32 v183, v183, v187
    ds_write2_b32 v27, v182, v183 offset0:0 offset1:64
    v_cvt_pk_bf16_f32 v33, v180, v184
    v_cvt_pk_bf16_f32 v41, v181, v185
    v_cvt_pk_bf16_f32 v190, v190, v194
    v_cvt_pk_bf16_f32 v191, v191, v195
    ds_write2_b32 v27, v190, v191 offset0:16 offset1:80
    v_cvt_pk_bf16_f32 v49, v188, v192
    v_cvt_pk_bf16_f32 v57, v189, v193
    s_cmp_ge_u32 s52, 4
    s_cbranch_scc1 L_o11
    v_lshrrev_b32 v22, 2, v18
    s_lshl_b32 s56, s52, 8
    buffer_load_dword v22, v22, s[44:47], s56 offen sc1
L_o11:
    v_add_u32 v10, 0x10000, v10
    v_add_u32 v11, 0x10000, v11
    v_add_u32 v12, 0x10000, v12
    v_add_u32 v13, 0x10000, v13
    s_cmp_ge_u32 s52, 4
    s_cbranch_scc1 L_o12
    v_cvt_pk_bf16_f32 v176, v176, v177
    v_cvt_pk_bf16_f32 v178, v178, v179
    s_nop 0
    v_mov_b32_dpp v160, v176 quad_perm:[0,1,2,3] row_mask:0x4 bank_mask:0xf
    v_mov_b32_dpp v160, v178 quad_perm:[0,1,2,3] row_mask:0x8 bank_mask:0xf
    v_mfma_f32_16x16x32_bf16 v[176:179], v[128:131], v[196:199], 0
    v_mfma_f32_16x16x32_bf16 v[176:179], v[128:131], v[200:203], v[176:179]
    v_mfma_f32_16x16x32_bf16 v[176:179], v[132:135], v[204:207], v[176:179]
    v_mfma_f32_16x16x32_bf16 v[176:179], v[132:135], v[208:211], v[176:179]
    v_mfma_f32_16x16x32_bf16 v[176:179], v[136:139], v[212:215], v[176:179]
    v_mfma_f32_16x16x32_bf16 v[176:179], v[136:139], v[216:219], v[176:179]
    v_mfma_f32_16x16x32_bf16 v[176:179], v[140:143], v[220:223], v[176:179]
    v_mfma_f32_16x16x32_bf16 v[176:179], v[140:143], v[224:227], v[176:179]
L_o12:
    s_cmp_ge_u32 s52, 4
    s_cbranch_scc1 L_o13
    s_waitcnt vmcnt(2)
L_o13:
    s_barrier
    s_waitcnt lgkmcnt(8)
    v_mfma_f32_16x16x32_bf16 v[180:183], v[152:155], v[236:239], 0
    ds_read_b128 v[196:199], v10 offset:0
    v_mfma_f32_16x16x32_bf16 v[180:183], v[156:159], v[240:243], v[180:183]
    ds_read_b128 v[200:203], v12 offset:0
    s_waitcnt lgkmcnt(8)
    v_mfma_f32_16x16x32_bf16 v[184:187], v[152:155], v[244:247], 0
    ds_read_b128 v[204:207], v10 offset:4096
    v_mfma_f32_16x16x32_bf16 v[184:187], v[156:159], v[248:251], v[184:187]
    ds_read_b128 v[208:211], v12 offset:4096
    s_waitcnt lgkmcnt(8)
    v_mfma_f32_16x16x32_bf16 v[188:191], v[152:155], v[228:231], 0
    ds_read_b128 v[212:215], v10 offset:8192
    v_mfma_f32_16x16x32_bf16 v[188:191], v[156:159], v[232:235], v[188:191]
    ds_read_b128 v[216:219], v12 offset:8192
    s_waitcnt lgkmcnt(8)
    v_mfma_f32_16x16x32_bf16 v[192:195], v[152:155], v[252:255], 0
    ds_read_b128 v[220:223], v10 offset:12288
    v_mfma_f32_16x16x32_bf16 v[192:195], v[156:159], v[172:175], v[192:195]
    ds_read_b128 v[224:227], v12 offset:12288
    v_cvt_pk_bf16_f32 v182, v182, v186
    v_cvt_pk_bf16_f32 v183, v183, v187
    ds_write2_b32 v27, v182, v183 offset0:32 offset1:96
    v_cvt_pk_bf16_f32 v65, v180, v184
    v_cvt_pk_bf16_f32 v73, v181, v185
    s_nop 1
    v_cvt_pk_bf16_f32 v190, v190, v194
    v_cvt_pk_bf16_f32 v191, v191, v195
    ds_write2_b32 v27, v190, v191 offset0:48 offset1:112
    v_cvt_pk_bf16_f32 v81, v188, v192
    v_cvt_pk_bf16_f32 v89, v189, v193
    v_permlane32_swap_b32 v33, v65
    v_permlane32_swap_b32 v49, v81
    v_permlane32_swap_b32 v41, v73
    v_permlane32_swap_b32 v57, v89
    v_permlane16_swap_b32 v33, v49
    v_permlane16_swap_b32 v65, v81
    v_permlane16_swap_b32 v41, v57
    v_permlane16_swap_b32 v73, v89
    s_cmp_ge_u32 s52, 4
    s_cbranch_scc1 L_o14
    s_lshl_b32 s57, s52, 17
    s_add_u32 s57, s57, 524288
    buffer_load_dword v8, v7, s[16:19], s57 offen
L_o14:
    s_cmp_ge_u32 s52, 4
    s_cbranch_scc1 L_o15
    v_cvt_pk_bf16_f32 v176, v176, v177
    v_cvt_pk_bf16_f32 v178, v178, v179
    s_nop 0
    v_mov_b32_dpp v161, v176 quad_perm:[0,1,2,3] row_mask:0x1 bank_mask:0xf
    v_mov_b32_dpp v161, v178 quad_perm:[0,1,2,3] row_mask:0x2 bank_mask:0xf
    v_mfma_f32_16x16x32_bf16 v[176:179], v[128:131], v[236:239], 0
    v_mfma_f32_16x16x32_bf16 v[176:179], v[128:131], v[240:243], v[176:179]
    v_mfma_f32_16x16x32_bf16 v[176:179], v[132:135], v[244:247], v[176:179]
    v_mfma_f32_16x16x32_bf16 v[176:179], v[132:135], v[248:251], v[176:179]
    v_mfma_f32_16x16x32_bf16 v[176:179], v[136:139], v[228:231], v[176:179]
    v_mfma_f32_16x16x32_bf16 v[176:179], v[136:139], v[232:235], v[176:179]
    v_mfma_f32_16x16x32_bf16 v[176:179], v[140:143], v[252:255], v[176:179]
    v_mfma_f32_16x16x32_bf16 v[176:179], v[140:143], v[172:175], v[176:179]
L_o15:
    s_cmp_ge_u32 s52, 4
    s_cbranch_scc1 L_o16
    s_waitcnt vmcnt(1)
L_o16:
    s_cmp_lt_u32 s52, 4
    s_cbranch_scc1 L_o17
    s_waitcnt vmcnt(0)
L_o17:
    s_waitcnt lgkmcnt(0)
    s_cmp_lg_u32 s52, 0
    s_cbranch_scc1 L_flok
L_flp:
    v_and_b32 v22, 0x01000100, v22
    v_cmp_ne_u32 vcc, 0x01000100, v22
    s_nop 0
    s_or_b32 vcc_lo, vcc_lo, vcc_hi
    s_and_b32 vcc_lo, vcc_lo, 0x0f0f0f0f
    s_cbranch_scc0 L_flok
    s_sleep 8
    v_lshrrev_b32 v22, 2, v18
    buffer_load_dword v22, v22, s[44:47], 0 offen sc1
    s_waitcnt vmcnt(0)
    s_branch L_flp
L_flok:
    s_barrier
    s_mov_b64 exec, 0x1fff
    buffer_load_dword v8, v23, s[48:51], 0 offen sc1
    s_mov_b64 exec, -1
    v_mfma_f32_16x16x32_bf16 v[180:183], v[152:155], v[196:199], 0
    ds_read_b128 v[236:239], v10 offset:16384
    v_mfma_f32_16x16x32_bf16 v[180:183], v[156:159], v[200:203], v[180:183]
    ds_read_b128 v[240:243], v12 offset:16384
    v_mfma_f32_16x16x32_bf16 v[184:187], v[152:155], v[204:207], 0
    ds_read_b128 v[244:247], v10 offset:20480
    v_mfma_f32_16x16x32_bf16 v[184:187], v[156:159], v[208:211], v[184:187]
    ds_read_b128 v[248:251], v12 offset:20480
    v_mfma_f32_16x16x32_bf16 v[188:191], v[152:155], v[212:215], 0
    ds_read_b128 v[228:231], v10 offset:24576
    v_mfma_f32_16x16x32_bf16 v[188:191], v[156:159], v[216:219], v[188:191]
    ds_read_b128 v[232:235], v12 offset:24576
    v_mfma_f32_16x16x32_bf16 v[192:195], v[152:155], v[220:223], 0
    ds_read_b128 v[252:255], v10 offset:28672
    v_mfma_f32_16x16x32_bf16 v[192:195], v[156:159], v[224:227], v[192:195]
    ds_read_b128 v[172:175], v12 offset:28672
    s_add_u32 s80, s61, 0
    buffer_load_dwordx4 v[96:99], v18, s[48:51], s80 offen offset:0 sc1
    s_add_u32 s81, s61, 3328
    buffer_load_dwordx4 v[100:103], v18, s[48:51], s81 offen offset:0 sc1
    v_add_u32 v27, 0x4000, v27
    v_cvt_pk_bf16_f32 v182, v182, v186
    v_cvt_pk_bf16_f32 v183, v183, v187
    ds_write2_b32 v27, v182, v183 offset0:0 offset1:64
    v_cvt_pk_bf16_f32 v34, v180, v184
    v_cvt_pk_bf16_f32 v42, v181, v185
    v_cvt_pk_bf16_f32 v190, v190, v194
    v_cvt_pk_bf16_f32 v191, v191, v195
    ds_write2_b32 v27, v190, v191 offset0:16 offset1:80
    v_cvt_pk_bf16_f32 v50, v188, v192
    v_cvt_pk_bf16_f32 v58, v189, v193
    ds_read2st64_b32 v[36:37], v25 offset0:0 offset1:64
    ds_read2st64_b32 v[44:45], v25 offset0:1 offset1:65
    ds_read2st64_b32 v[52:53], v25 offset0:2 offset1:66
    ds_read2st64_b32 v[60:61], v25 offset0:3 offset1:67
    ds_read2st64_b32 v[68:69], v25 offset0:4 offset1:68
    s_waitcnt lgkmcnt(11)
    ds_read2st64_b32 v[76:77], v25 offset0:5 offset1:69
    ds_read2st64_b32 v[84:85], v25 offset0:6 offset1:70
    ds_read2st64_b32 v[92:93], v25 offset0:7 offset1:71
    buffer_load_dwordx4 v[104:107], v18, s[48:51], s80 offen offset:1664 sc1
    buffer_load_dwordx4 v[108:111], v18, s[48:51], s81 offen offset:1664 sc1
    s_cmp_ge_u32 s52, 4
    s_cbranch_scc1 L_o18
    s_lshl_b32 s56, s54, 4
    s_lshl_b32 s56, 0x100, s56
    v_mov_b32 v151, s56
    s_lshl_b32 s56, s52, 6
    s_add_u32 s56, s56, s53
    s_lshl2_add_u32 s56, s56, s82
    s_xor_b32 s56, s56, 0x10000000
    s_mov_b64 exec, 1
    buffer_atomic_or v151, off, s[44:47], s56 sc1
    s_mov_b64 exec, -1
L_o18:
    s_cmp_ge_u32 s52, 4
    s_cbranch_scc1 L_o19
    v_cvt_pk_bf16_f32 v176, v176, v177
    v_cvt_pk_bf16_f32 v178, v178, v179
    s_nop 0
    v_mov_b32_dpp v161, v176 quad_perm:[0,1,2,3] row_mask:0x4 bank_mask:0xf
    v_mov_b32_dpp v161, v178 quad_perm:[0,1,2,3] row_mask:0x8 bank_mask:0xf
    v_mfma_f32_16x16x32_bf16 v[176:179], v[128:131], v[196:199], 0
    v_mfma_f32_16x16x32_bf16 v[176:179], v[128:131], v[200:203], v[176:179]
    v_mfma_f32_16x16x32_bf16 v[176:179], v[132:135], v[204:207], v[176:179]
    v_mfma_f32_16x16x32_bf16 v[176:179], v[132:135], v[208:211], v[176:179]
    v_mfma_f32_16x16x32_bf16 v[176:179], v[136:139], v[212:215], v[176:179]
    v_mfma_f32_16x16x32_bf16 v[176:179], v[136:139], v[216:219], v[176:179]
    v_mfma_f32_16x16x32_bf16 v[176:179], v[140:143], v[220:223], v[176:179]
    v_mfma_f32_16x16x32_bf16 v[176:179], v[140:143], v[224:227], v[176:179]
L_o19:
    ds_read_b128 v[196:199], v10 offset:32768
    s_waitcnt lgkmcnt(11)
    ds_read_b128 v[200:203], v12 offset:32768
    ds_read_b128 v[204:207], v10 offset:36864
    ds_read_b128 v[208:211], v12 offset:36864
    ds_read_b128 v[212:215], v11 offset:32768
    s_waitcnt lgkmcnt(11)
    ds_read_b128 v[216:219], v13 offset:32768
    ds_read_b128 v[220:223], v11 offset:36864
    ds_read_b128 v[224:227], v13 offset:36864
    v_add_u32 v22, 0x10000, v14
    v_add_u32 v23, 0x10000, v15
    s_cmp_ge_u32 s52, 4
    s_cbranch_scc1 L_nosenet
    v_cvt_pk_bf16_f32 v176, v176, v177
    v_cvt_pk_bf16_f32 v178, v178, v179
    s_nop 0
    v_mov_b32_dpp v162, v176 quad_perm:[0,1,2,3] row_mask:0x1 bank_mask:0xf
    v_mov_b32_dpp v162, v178 quad_perm:[0,1,2,3] row_mask:0x2 bank_mask:0xf
    v_mfma_f32_16x16x32_bf16 v[176:179], v[128:131], v[236:239], 0
    v_mfma_f32_16x16x32_bf16 v[176:179], v[128:131], v[240:243], v[176:179]
    v_mfma_f32_16x16x32_bf16 v[176:179], v[132:135], v[244:247], v[176:179]
    v_mfma_f32_16x16x32_bf16 v[176:179], v[132:135], v[248:251], v[176:179]
    v_mfma_f32_16x16x32_bf16 v[176:179], v[136:139], v[228:231], v[176:179]
    v_mfma_f32_16x16x32_bf16 v[176:179], v[136:139], v[232:235], v[176:179]
    v_mfma_f32_16x16x32_bf16 v[176:179], v[140:143], v[252:255], v[176:179]
    v_mfma_f32_16x16x32_bf16 v[176:179], v[140:143], v[172:175], v[176:179]
    s_waitcnt lgkmcnt(4)
    v_mfma_f32_16x16x32_bf16 v[112:115], v[128:131], v[196:199], 0
    v_mfma_f32_16x16x32_bf16 v[112:115], v[128:131], v[200:203], v[112:115]
    v_mfma_f32_16x16x32_bf16 v[112:115], v[132:135], v[204:207], v[112:115]
    v_mfma_f32_16x16x32_bf16 v[112:115], v[132:135], v[208:211], v[112:115]
    v_mfma_f32_16x16x32_bf16 v[180:183], v[152:155], v[236:239], 0
    v_mfma_f32_16x16x32_bf16 v[180:183], v[156:159], v[240:243], v[180:183]
    v_mfma_f32_16x16x32_bf16 v[184:187], v[152:155], v[244:247], 0
    v_mfma_f32_16x16x32_bf16 v[184:187], v[156:159], v[248:251], v[184:187]
    v_cvt_pk_bf16_f32 v176, v176, v177
    v_cvt_pk_bf16_f32 v178, v178, v179
    s_nop 0
    v_mov_b32_dpp v162, v176 quad_perm:[0,1,2,3] row_mask:0x4 bank_mask:0xf
    v_mov_b32_dpp v162, v178 quad_perm:[0,1,2,3] row_mask:0x8 bank_mask:0xf
    v_cvt_pk_bf16_f32 v112, v112, 0
    v_cvt_pk_bf16_f32 v113, v113, 0
    s_nop 0
    v_mov_b32_dpp v163, v112 quad_perm:[0,1,2,3] row_mask:0x1 bank_mask:0xf
    v_mov_b32_dpp v163, v113 quad_perm:[0,1,2,3] row_mask:0x2 bank_mask:0xf
    s_nop 1
    v_mfma_f32_16x16x32_bf16 v[128:131], v[164:167], v[160:163], 0
    v_mfma_f32_16x16x32_bf16 v[188:191], v[152:155], v[228:231], 0
    v_mfma_f32_16x16x32_bf16 v[188:191], v[156:159], v[232:235], v[188:191]
    v_mfma_f32_16x16x32_bf16 v[192:195], v[152:155], v[252:255], 0
    v_mfma_f32_16x16x32_bf16 v[192:195], v[156:159], v[172:175], v[192:195]
    v_cvt_pk_bf16_f32 v182, v182, v186
    v_cvt_pk_bf16_f32 v183, v183, v187
    ds_write2_b32 v27, v182, v183 offset0:32 offset1:96
    v_cvt_pk_bf16_f32 v66, v180, v184
    v_cvt_pk_bf16_f32 v74, v181, v185
    v_mov_b32 v148, s66
    v_cvt_pk_bf16_f32 v136, v128, v129
    v_cvt_pk_bf16_f32 v137, v130, v131
    v_lshlrev_b32 v128, 16, v136
    v_and_b32 v129, s68, v136
    v_lshlrev_b32 v130, 16, v137
    v_and_b32 v131, s68, v137
    v_mul_f32 v140, v128, v128
    v_mul_f32 v141, v129, v129
    v_mul_f32 v142, v130, v130
    v_mul_f32 v143, v131, v131
    v_fma_f32 v140, v140, s67, v148
    v_fma_f32 v141, v141, s67, v148
    v_fma_f32 v142, v142, s67, v148
    v_fma_f32 v143, v143, s67, v148
    v_mul_f32 v140, v140, v128
    v_mul_f32 v141, v141, v129
    v_mul_f32 v142, v142, v130
    v_mul_f32 v143, v143, v131
    v_exp_f32 v140, v140
    v_exp_f32 v141, v141
    v_exp_f32 v142, v142
    v_exp_f32 v143, v143
    v_add_f32 v140, 1.0, v140
    v_add_f32 v141, 1.0, v141
    v_add_f32 v142, 1.0, v142
    v_add_f32 v143, 1.0, v143
    v_rcp_f32 v140, v140
    v_rcp_f32 v141, v141
    v_rcp_f32 v142, v142
    v_rcp_f32 v143, v143
    v_mul_f32 v132, v128, v140
    v_mul_f32 v133, v129, v141
    v_mul_f32 v134, v130, v142
    v_mul_f32 v135, v131, v143
    v_cvt_pk_bf16_f32 v138, v132, v133
    v_cvt_pk_bf16_f32 v139, v134, v135
    s_nop 1
    v_mfma_f32_16x16x16_bf16 v[144:147], v[168:169], v[138:139], 0
    v_cvt_pk_bf16_f32 v190, v190, v194
    v_cvt_pk_bf16_f32 v191, v191, v195
    ds_write2_b32 v27, v190, v191 offset0:48 offset1:112
    v_cvt_pk_bf16_f32 v82, v188, v192
    v_cvt_pk_bf16_f32 v90, v189, v193
    s_nop 2
    v_cvt_pk_bf16_f32 v136, v144, v145
    v_cvt_pk_bf16_f32 v137, v146, v147
    v_lshlrev_b32 v128, 16, v136
    v_and_b32 v129, s68, v136
    v_lshlrev_b32 v130, 16, v137
    v_and_b32 v131, s68, v137
    v_mul_f32 v128, s69, v128
    v_mul_f32 v129, s69, v129
    v_mul_f32 v130, s69, v130
    v_mul_f32 v131, s69, v131
    v_exp_f32 v128, v128
    v_exp_f32 v129, v129
    v_exp_f32 v130, v130
    v_exp_f32 v131, v131
    v_add_f32 v128, 1.0, v128
    v_add_f32 v129, 1.0, v129
    v_add_f32 v130, 1.0, v130
    v_add_f32 v131, 1.0, v131
    v_rcp_f32 v128, v128
    v_rcp_f32 v129, v129
    v_rcp_f32 v130, v130
    v_rcp_f32 v131, v131
    v_cvt_pk_bf16_f32 v132, 0, v128
    v_cvt_pk_bf16_f32 v133, 0, v129
    v_cvt_pk_bf16_f32 v134, 0, v130
    v_cvt_pk_bf16_f32 v135, 0, v131
    ds_write_b128 v28, v[132:135]
    s_waitcnt lgkmcnt(0)
    s_barrier
    v_mfma_f32_16x16x32_bf16 v[228:231], v[152:155], v[196:199], 0
    v_mfma_f32_16x16x32_bf16 v[228:231], v[156:159], v[200:203], v[228:231]
    v_mfma_f32_16x16x32_bf16 v[232:235], v[152:155], v[204:207], 0
    v_mfma_f32_16x16x32_bf16 v[232:235], v[156:159], v[208:211], v[232:235]
    v_mfma_f32_16x16x32_bf16 v[236:239], v[152:155], v[212:215], 0
    v_mfma_f32_16x16x32_bf16 v[236:239], v[156:159], v[216:219], v[236:239]
    v_mfma_f32_16x16x32_bf16 v[240:243], v[152:155], v[220:223], 0
    v_mfma_f32_16x16x32_bf16 v[240:243], v[156:159], v[224:227], v[240:243]
    v_permlane32_swap_b32 v34, v66
    v_permlane32_swap_b32 v50, v82
    v_permlane32_swap_b32 v42, v74
    v_permlane32_swap_b32 v58, v90
    v_permlane16_swap_b32 v34, v50
    v_permlane16_swap_b32 v66, v82
    v_permlane16_swap_b32 v42, v58
    v_permlane16_swap_b32 v74, v90
    v_cvt_pk_bf16_f32 v35, v228, v232
    v_cvt_pk_bf16_f32 v43, v229, v233
    v_mov_b32 v51, v35
    v_mov_b32 v59, v43
    v_mov_b32 v67, v35
    v_mov_b32 v75, v43
    v_mov_b32 v83, v35
    v_mov_b32 v91, v43
    v_cvt_pk_bf16_f32 v39, v236, v240
    v_cvt_pk_bf16_f32 v47, v237, v241
    v_mov_b32 v55, v39
    v_mov_b32 v63, v47
    v_mov_b32 v71, v39
    v_mov_b32 v79, v47
    v_mov_b32 v87, v39
    v_mov_b32 v95, v47
    buffer_load_dwordx4 v[112:115], v19, s[48:51], s80 offen offset:1024 sc1
    buffer_load_dwordx4 v[116:119], v19, s[48:51], s81 offen offset:1024 sc1
    buffer_load_dwordx4 v[172:175], v19, s[48:51], s80 offen offset:2688 sc1
    buffer_load_dwordx4 v[176:179], v19, s[48:51], s81 offen offset:2688 sc1
    v_mov_b32 v134, 0
    v_mov_b32 v135, 0
    v_mov_b32 v150, 0
    v_mov_b32 v151, 0
    s_branch L_post
L_nosenet:
    s_nop 7
    v_mfma_f32_16x16x32_bf16 v[180:183], v[152:155], v[236:239], 0
    v_mfma_f32_16x16x32_bf16 v[180:183], v[156:159], v[240:243], v[180:183]
    v_mfma_f32_16x16x32_bf16 v[184:187], v[152:155], v[244:247], 0
    v_mfma_f32_16x16x32_bf16 v[184:187], v[156:159], v[248:251], v[184:187]
    v_mfma_f32_16x16x32_bf16 v[188:191], v[152:155], v[228:231], 0
    v_mfma_f32_16x16x32_bf16 v[188:191], v[156:159], v[232:235], v[188:191]
    v_mfma_f32_16x16x32_bf16 v[192:195], v[152:155], v[252:255], 0
    v_mfma_f32_16x16x32_bf16 v[192:195], v[156:159], v[172:175], v[192:195]
    s_waitcnt lgkmcnt(6)
    v_mfma_f32_16x16x32_bf16 v[228:231], v[152:155], v[196:199], 0
    v_mfma_f32_16x16x32_bf16 v[228:231], v[156:159], v[200:203], v[228:231]
    s_waitcnt lgkmcnt(4)
    v_mfma_f32_16x16x32_bf16 v[232:235], v[152:155], v[204:207], 0
    v_mfma_f32_16x16x32_bf16 v[232:235], v[156:159], v[208:211], v[232:235]
    s_waitcnt lgkmcnt(2)
    v_mfma_f32_16x16x32_bf16 v[236:239], v[152:155], v[212:215], 0
    v_mfma_f32_16x16x32_bf16 v[236:239], v[156:159], v[216:219], v[236:239]
    s_waitcnt lgkmcnt(0)
    v_mfma_f32_16x16x32_bf16 v[240:243], v[152:155], v[220:223], 0
    v_mfma_f32_16x16x32_bf16 v[240:243], v[156:159], v[224:227], v[240:243]
    v_cvt_pk_bf16_f32 v182, v182, v186
    v_cvt_pk_bf16_f32 v183, v183, v187
    ds_write2_b32 v27, v182, v183 offset0:32 offset1:96
    v_cvt_pk_bf16_f32 v66, v180, v184
    v_cvt_pk_bf16_f32 v74, v181, v185
    v_cvt_pk_bf16_f32 v190, v190, v194
    v_cvt_pk_bf16_f32 v191, v191, v195
    ds_write2_b32 v27, v190, v191 offset0:48 offset1:112
    v_cvt_pk_bf16_f32 v82, v188, v192
    v_cvt_pk_bf16_f32 v90, v189, v193
    v_permlane32_swap_b32 v34, v66
    v_permlane32_swap_b32 v50, v82
    v_permlane32_swap_b32 v42, v74
    v_permlane32_swap_b32 v58, v90
    v_permlane16_swap_b32 v34, v50
    v_permlane16_swap_b32 v66, v82
    v_permlane16_swap_b32 v42, v58
    v_permlane16_swap_b32 v74, v90
    v_cvt_pk_bf16_f32 v35, v228, v232
    v_cvt_pk_bf16_f32 v43, v229, v233
    v_mov_b32 v51, v35
    v_mov_b32 v59, v43
    v_mov_b32 v67, v35
    v_mov_b32 v75, v43
    v_mov_b32 v83, v35
    v_mov_b32 v91, v43
    v_cvt_pk_bf16_f32 v39, v236, v240
    v_cvt_pk_bf16_f32 v47, v237, v241
    v_mov_b32 v55, v39
    v_mov_b32 v63, v47
    v_mov_b32 v71, v39
    v_mov_b32 v79, v47
    v_mov_b32 v87, v39
    v_mov_b32 v95, v47
    buffer_load_dwordx4 v[112:115], v19, s[48:51], s80 offen offset:1024 sc1
    buffer_load_dwordx4 v[116:119], v19, s[48:51], s81 offen offset:1024 sc1
    buffer_load_dwordx4 v[172:175], v19, s[48:51], s80 offen offset:2688 sc1
    buffer_load_dwordx4 v[176:179], v19, s[48:51], s81 offen offset:2688 sc1
    v_mov_b32 v134, 0
    v_mov_b32 v135, 0
    v_mov_b32 v150, 0
    v_mov_b32 v151, 0
    s_waitcnt lgkmcnt(0)
    s_barrier
L_post:
    ds_read_b32 v38, v25 offset:32768
    ds_read_b32 v46, v25 offset:33024
    ds_read_b128 v[180:183], v29 offset:0
    ds_read_b128 v[184:187], v29 offset:16
    ds_read_b128 v[188:191], v30 offset:0
    ds_read_b128 v[192:195], v30 offset:16
    v_bfe_u32 v152, v0, 4, 2
    v_lshlrev_b32 v152, 5, v152
    v_sub_u32 v29, v29, v152
    ds_read2_b32 v[156:157], v29 offset0:6 offset1:14
    v_sub_u32 v30, v30, v152
    ds_read2_b32 v[158:159], v30 offset0:6 offset1:14
    ds_read_b32 v54, v25 offset:33280
    ds_read_b32 v62, v25 offset:33536
    ds_read_b32 v70, v25 offset:33792
    ds_read_b32 v78, v25 offset:34048
    ds_read_b32 v86, v25 offset:34304
    ds_read_b32 v94, v25 offset:34560
    s_waitcnt lgkmcnt(12)
    s_waitcnt vmcnt(6)
    v_mfma_f32_16x16x32_bf16 v[196:199], v[96:99], v[32:35], 0
    v_mfma_f32_16x16x32_bf16 v[200:203], v[96:99], v[36:39], 0
    v_mfma_f32_16x16x32_bf16 v[204:207], v[100:103], v[40:43], 0
    v_mfma_f32_16x16x32_bf16 v[208:211], v[100:103], v[44:47], 0
    s_waitcnt lgkmcnt(6)
    v_lshrrev_b32 v1, 16, v180
    v_lshrrev_b32 v6, 16, v182
    v_lshrrev_b32 v7, 16, v184
    v_mul_f32 v228, v228, v156
    v_mul_f32 v229, v229, v156
    v_mul_f32 v232, v232, v157
    v_mul_f32 v233, v233, v157
    v_lshrrev_b32 v8, 16, v188
    v_lshrrev_b32 v9, 16, v190
    v_lshrrev_b32 v27, 16, v192
    v_mul_f32 v236, v236, v158
    v_mul_f32 v237, v237, v158
    v_mul_f32 v240, v240, v159
    v_mul_f32 v241, v241, v159
    v_dot2_f32_bf16 v212, v32, v1, 0
    v_dot2_f32_bf16 v213, v32, v181, 0
    v_dot2_f32_bf16 v214, v33, v6, 0
    v_dot2_f32_bf16 v215, v33, v183, 0
    v_dot2_f32_bf16 v216, v34, v7, 0
    v_dot2_f32_bf16 v217, v34, v185, 0
    v_dot2_f32_bf16 v218, v36, v8, 0
    v_dot2_f32_bf16 v219, v36, v189, 0
    v_dot2_f32_bf16 v220, v37, v9, 0
    v_dot2_f32_bf16 v221, v37, v191, 0
    v_dot2_f32_bf16 v222, v38, v27, 0
    v_dot2_f32_bf16 v223, v38, v193, 0
    v_cvt_pk_bf16_f32 v155, v228, v232
    v_cvt_pk_bf16_f32 v152, v212, v213
    v_cvt_pk_bf16_f32 v153, v214, v215
    v_cvt_pk_bf16_f32 v154, v216, v217
    v_cvt_pk_bf16_f32 v159, v236, v240
    v_cvt_pk_bf16_f32 v156, v218, v219
    v_cvt_pk_bf16_f32 v157, v220, v221
    v_cvt_pk_bf16_f32 v158, v222, v223
    v_dot2_f32_bf16 v212, v40, v1, 0
    v_dot2_f32_bf16 v213, v40, v181, 0
    v_dot2_f32_bf16 v214, v41, v6, 0
    v_dot2_f32_bf16 v215, v41, v183, 0
    v_dot2_f32_bf16 v216, v42, v7, 0
    v_dot2_f32_bf16 v217, v42, v185, 0
    v_dot2_f32_bf16 v218, v44, v8, 0
    v_dot2_f32_bf16 v219, v44, v189, 0
    v_dot2_f32_bf16 v220, v45, v9, 0
    v_dot2_f32_bf16 v221, v45, v191, 0
    v_dot2_f32_bf16 v222, v46, v27, 0
    v_dot2_f32_bf16 v223, v46, v193, 0
    v_cvt_pk_bf16_f32 v163, v229, v233
    v_cvt_pk_bf16_f32 v160, v212, v213
    v_cvt_pk_bf16_f32 v161, v214, v215
    v_cvt_pk_bf16_f32 v162, v216, v217
    v_cvt_pk_bf16_f32 v167, v237, v241
    v_cvt_pk_bf16_f32 v164, v218, v219
    v_cvt_pk_bf16_f32 v165, v220, v221
    v_cvt_pk_bf16_f32 v166, v222, v223
    s_waitcnt vmcnt(4)
    v_mfma_f32_16x16x32_bf16 v[212:215], v[104:107], v[152:155], 0
    v_mfma_f32_16x16x32_bf16 v[216:219], v[104:107], v[156:159], 0
    v_mfma_f32_16x16x32_bf16 v[220:223], v[108:111], v[160:163], 0
    v_mfma_f32_16x16x32_bf16 v[224:227], v[108:111], v[164:167], 0
    s_add_u32 s80, s61, 6656
    buffer_load_dwordx4 v[96:99], v18, s[48:51], s80 offen offset:0 sc1
    s_add_u32 s81, s61, 9984
    buffer_load_dwordx4 v[100:103], v18, s[48:51], s81 offen offset:0 sc1
    buffer_load_dwordx4 v[104:107], v18, s[48:51], s80 offen offset:1664 sc1
    buffer_load_dwordx4 v[108:111], v18, s[48:51], s81 offen offset:1664 sc1
    s_waitcnt vmcnt(4)
    v_mfma_f32_16x16x32_bf16 v[228:231], v[112:115], v[32:35], 0
    v_fmac_f32 v196, v212, v180
    v_fmac_f32 v197, v213, v181
    v_fmac_f32 v198, v214, v182
    v_mfma_f32_16x16x32_bf16 v[232:235], v[112:115], v[36:39], 0
    v_fmac_f32 v199, v215, v183
    v_fmac_f32 v204, v220, v180
    v_fmac_f32 v205, v221, v181
    v_mfma_f32_16x16x32_bf16 v[236:239], v[116:119], v[40:43], 0
    v_fmac_f32 v206, v222, v182
    v_fmac_f32 v207, v223, v183
    v_cvt_pk_bf16_f32 v120, v196, v204
    v_mfma_f32_16x16x32_bf16 v[240:243], v[116:119], v[44:47], 0
    v_cvt_pk_bf16_f32 v122, v197, v205
    v_cvt_pk_bf16_f32 v124, v198, v206
    v_cvt_pk_bf16_f32 v126, v199, v207
    v_mfma_f32_16x16x32_bf16 v[244:247], v[172:175], v[152:155], 0
    v_fmac_f32 v200, v216, v188
    v_fmac_f32 v201, v217, v189
    v_fmac_f32 v202, v218, v190
    v_mfma_f32_16x16x32_bf16 v[248:251], v[172:175], v[156:159], 0
    v_fmac_f32 v203, v219, v191
    v_fmac_f32 v208, v224, v188
    v_fmac_f32 v209, v225, v189
    v_mfma_f32_16x16x32_bf16 v[252:255], v[176:179], v[160:163], 0
    v_fmac_f32 v210, v226, v190
    v_fmac_f32 v211, v227, v191
    v_cvt_pk_bf16_f32 v136, v200, v208
    v_mfma_f32_16x16x32_bf16 v[168:171], v[176:179], v[164:167], 0
    v_cvt_pk_bf16_f32 v138, v201, v209
    v_cvt_pk_bf16_f32 v140, v202, v210
    v_cvt_pk_bf16_f32 v142, v203, v211
    buffer_load_dwordx4 v[112:115], v19, s[48:51], s80 offen offset:1024 sc1
    buffer_load_dwordx4 v[116:119], v19, s[48:51], s81 offen offset:1024 sc1
    buffer_load_dwordx4 v[172:175], v19, s[48:51], s80 offen offset:2688 sc1
    buffer_load_dwordx4 v[176:179], v19, s[48:51], s81 offen offset:2688 sc1
    s_waitcnt lgkmcnt(0)
    v_pk_fma_f32 v[228:229], v[244:245], v[184:185], v[228:229]
    v_pk_fma_f32 v[236:237], v[252:253], v[184:185], v[236:237]
    v_pk_fma_f32 v[232:233], v[248:249], v[192:193], v[232:233]
    v_pk_fma_f32 v[240:241], v[168:169], v[192:193], v[240:241]
    v_dot2_f32_bf16 v212, v48, v1, 0
    v_dot2_f32_bf16 v213, v48, v181, 0
    v_dot2_f32_bf16 v214, v49, v6, 0
    v_dot2_f32_bf16 v215, v49, v183, 0
    v_dot2_f32_bf16 v216, v50, v7, 0
    v_dot2_f32_bf16 v217, v50, v185, 0
    v_dot2_f32_bf16 v218, v52, v8, 0
    v_dot2_f32_bf16 v219, v52, v189, 0
    v_dot2_f32_bf16 v220, v53, v9, 0
    v_dot2_f32_bf16 v221, v53, v191, 0
    v_dot2_f32_bf16 v222, v54, v27, 0
    v_dot2_f32_bf16 v223, v54, v193, 0
    v_cvt_pk_bf16_f32 v152, v212, v213
    v_cvt_pk_bf16_f32 v153, v214, v215
    v_cvt_pk_bf16_f32 v154, v216, v217
    v_cvt_pk_bf16_f32 v156, v218, v219
    v_cvt_pk_bf16_f32 v157, v220, v221
    v_cvt_pk_bf16_f32 v158, v222, v223
    v_dot2_f32_bf16 v212, v56, v1, 0
    v_dot2_f32_bf16 v213, v56, v181, 0
    v_dot2_f32_bf16 v214, v57, v6, 0
    v_dot2_f32_bf16 v215, v57, v183, 0
    v_dot2_f32_bf16 v216, v58, v7, 0
    v_dot2_f32_bf16 v217, v58, v185, 0
    v_dot2_f32_bf16 v218, v60, v8, 0
    v_dot2_f32_bf16 v219, v60, v189, 0
    v_dot2_f32_bf16 v220, v61, v9, 0
    v_dot2_f32_bf16 v221, v61, v191, 0
    v_dot2_f32_bf16 v222, v62, v27, 0
    v_dot2_f32_bf16 v223, v62, v193, 0
    s_waitcnt vmcnt(4)
    v_mfma_f32_16x16x32_bf16 v[196:199], v[96:99], v[48:51], 0
    v_cvt_pk_bf16_f32 v160, v212, v213
    v_cvt_pk_bf16_f32 v161, v214, v215
    v_mfma_f32_16x16x32_bf16 v[200:203], v[96:99], v[52:55], 0
    v_cvt_pk_bf16_f32 v162, v216, v217
    v_cvt_pk_bf16_f32 v164, v218, v219
    v_mfma_f32_16x16x32_bf16 v[204:207], v[100:103], v[56:59], 0
    v_cvt_pk_bf16_f32 v165, v220, v221
    v_cvt_pk_bf16_f32 v166, v222, v223
    v_mfma_f32_16x16x32_bf16 v[208:211], v[100:103], v[60:63], 0
    v_fmac_f32 v230, v246, v186
    v_fmac_f32 v238, v254, v186
    v_mfma_f32_16x16x32_bf16 v[212:215], v[104:107], v[152:155], 0
    v_cvt_pk_bf16_f32 v128, v228, v236
    v_cvt_pk_bf16_f32 v130, v229, v237
    v_mfma_f32_16x16x32_bf16 v[216:219], v[104:107], v[156:159], 0
    v_cvt_pk_bf16_f32 v132, v230, v238
    v_fmac_f32 v234, v250, v194
    v_mfma_f32_16x16x32_bf16 v[220:223], v[108:111], v[160:163], 0
    v_fmac_f32 v242, v170, v194
    v_cvt_pk_bf16_f32 v144, v232, v240
    v_mfma_f32_16x16x32_bf16 v[224:227], v[108:111], v[164:167], 0
    v_cvt_pk_bf16_f32 v146, v233, v241
    v_cvt_pk_bf16_f32 v148, v234, v242
    s_add_u32 s80, s61, 13312
    buffer_load_dwordx4 v[96:99], v18, s[48:51], s80 offen offset:0 sc1
    s_add_u32 s81, s61, 16640
    buffer_load_dwordx4 v[100:103], v18, s[48:51], s81 offen offset:0 sc1
    buffer_load_dwordx4 v[104:107], v18, s[48:51], s80 offen offset:1664 sc1
    buffer_load_dwordx4 v[108:111], v18, s[48:51], s81 offen offset:1664 sc1
    s_waitcnt vmcnt(4)
    v_mfma_f32_16x16x32_bf16 v[228:231], v[112:115], v[48:51], 0
    v_fmac_f32 v196, v212, v180
    v_fmac_f32 v197, v213, v181
    v_fmac_f32 v198, v214, v182
    v_mfma_f32_16x16x32_bf16 v[232:235], v[112:115], v[52:55], 0
    v_fmac_f32 v199, v215, v183
    v_fmac_f32 v204, v220, v180
    v_fmac_f32 v205, v221, v181
    v_mfma_f32_16x16x32_bf16 v[236:239], v[116:119], v[56:59], 0
    v_fmac_f32 v206, v222, v182
    v_fmac_f32 v207, v223, v183
    v_cvt_pk_bf16_f32 v121, v196, v204
    v_mfma_f32_16x16x32_bf16 v[240:243], v[116:119], v[60:63], 0
    v_cvt_pk_bf16_f32 v123, v197, v205
    v_cvt_pk_bf16_f32 v125, v198, v206
    v_cvt_pk_bf16_f32 v127, v199, v207
    v_mfma_f32_16x16x32_bf16 v[244:247], v[172:175], v[152:155], 0
    v_fmac_f32 v200, v216, v188
    v_fmac_f32 v201, v217, v189
    v_fmac_f32 v202, v218, v190
    v_mfma_f32_16x16x32_bf16 v[248:251], v[172:175], v[156:159], 0
    v_fmac_f32 v203, v219, v191
    v_fmac_f32 v208, v224, v188
    v_fmac_f32 v209, v225, v189
    v_mfma_f32_16x16x32_bf16 v[252:255], v[176:179], v[160:163], 0
    v_fmac_f32 v210, v226, v190
    v_fmac_f32 v211, v227, v191
    v_cvt_pk_bf16_f32 v137, v200, v208
    v_mfma_f32_16x16x32_bf16 v[168:171], v[176:179], v[164:167], 0
    v_cvt_pk_bf16_f32 v139, v201, v209
    v_cvt_pk_bf16_f32 v141, v202, v210
    v_cvt_pk_bf16_f32 v143, v203, v211
    buffer_load_dwordx4 v[112:115], v19, s[48:51], s80 offen offset:1024 sc1
    buffer_load_dwordx4 v[116:119], v19, s[48:51], s81 offen offset:1024 sc1
    buffer_load_dwordx4 v[172:175], v19, s[48:51], s80 offen offset:2688 sc1
    buffer_load_dwordx4 v[176:179], v19, s[48:51], s81 offen offset:2688 sc1
    ds_read_b64 v[32:33], v14 offset:0
    ds_read_b64 v[34:35], v14 offset:4096
    ds_read_b64 v[36:37], v14 offset:32768
    ds_read_b64 v[38:39], v14 offset:36864
    ds_read_b64 v[40:41], v22 offset:0
    ds_read_b64 v[42:43], v22 offset:4096
    ds_read_b64 v[44:45], v16 offset:0
    ds_read_b64 v[48:49], v15 offset:0
    ds_read_b64 v[50:51], v15 offset:4096
    ds_read_b64 v[52:53], v15 offset:32768
    ds_read_b64 v[54:55], v15 offset:36864
    ds_read_b64 v[56:57], v23 offset:0
    ds_read_b64 v[58:59], v23 offset:4096
    ds_read_b64 v[60:61], v17 offset:0
    v_pk_fma_f32 v[228:229], v[244:245], v[184:185], v[228:229]
    v_pk_fma_f32 v[236:237], v[252:253], v[184:185], v[236:237]
    v_pk_fma_f32 v[232:233], v[248:249], v[192:193], v[232:233]
    v_pk_fma_f32 v[240:241], v[168:169], v[192:193], v[240:241]
    v_dot2_f32_bf16 v212, v64, v1, 0
    v_dot2_f32_bf16 v213, v64, v181, 0
    v_dot2_f32_bf16 v214, v65, v6, 0
    v_dot2_f32_bf16 v215, v65, v183, 0
    v_dot2_f32_bf16 v216, v66, v7, 0
    v_dot2_f32_bf16 v217, v66, v185, 0
    v_dot2_f32_bf16 v218, v68, v8, 0
    v_dot2_f32_bf16 v219, v68, v189, 0
    v_dot2_f32_bf16 v220, v69, v9, 0
    v_dot2_f32_bf16 v221, v69, v191, 0
    v_dot2_f32_bf16 v222, v70, v27, 0
    v_dot2_f32_bf16 v223, v70, v193, 0
    v_cvt_pk_bf16_f32 v152, v212, v213
    v_cvt_pk_bf16_f32 v153, v214, v215
    v_cvt_pk_bf16_f32 v154, v216, v217
    v_cvt_pk_bf16_f32 v156, v218, v219
    v_cvt_pk_bf16_f32 v157, v220, v221
    v_cvt_pk_bf16_f32 v158, v222, v223
    v_dot2_f32_bf16 v212, v72, v1, 0
    v_dot2_f32_bf16 v213, v72, v181, 0
    v_dot2_f32_bf16 v214, v73, v6, 0
    v_dot2_f32_bf16 v215, v73, v183, 0
    v_dot2_f32_bf16 v216, v74, v7, 0
    v_dot2_f32_bf16 v217, v74, v185, 0
    v_dot2_f32_bf16 v218, v76, v8, 0
    v_dot2_f32_bf16 v219, v76, v189, 0
    v_dot2_f32_bf16 v220, v77, v9, 0
    v_dot2_f32_bf16 v221, v77, v191, 0
    v_dot2_f32_bf16 v222, v78, v27, 0
    v_dot2_f32_bf16 v223, v78, v193, 0
    s_waitcnt vmcnt(4)
    v_mfma_f32_16x16x32_bf16 v[196:199], v[96:99], v[64:67], 0
    v_cvt_pk_bf16_f32 v160, v212, v213
    v_cvt_pk_bf16_f32 v161, v214, v215
    v_mfma_f32_16x16x32_bf16 v[200:203], v[96:99], v[68:71], 0
    v_cvt_pk_bf16_f32 v162, v216, v217
    v_cvt_pk_bf16_f32 v164, v218, v219
    v_mfma_f32_16x16x32_bf16 v[204:207], v[100:103], v[72:75], 0
    v_cvt_pk_bf16_f32 v165, v220, v221
    v_cvt_pk_bf16_f32 v166, v222, v223
    v_mfma_f32_16x16x32_bf16 v[208:211], v[100:103], v[76:79], 0
    v_fmac_f32 v230, v246, v186
    v_fmac_f32 v238, v254, v186
    v_mfma_f32_16x16x32_bf16 v[212:215], v[104:107], v[152:155], 0
    v_cvt_pk_bf16_f32 v129, v228, v236
    v_cvt_pk_bf16_f32 v131, v229, v237
    v_mfma_f32_16x16x32_bf16 v[216:219], v[104:107], v[156:159], 0
    v_cvt_pk_bf16_f32 v133, v230, v238
    v_fmac_f32 v234, v250, v194
    v_mfma_f32_16x16x32_bf16 v[220:223], v[108:111], v[160:163], 0
    v_fmac_f32 v242, v170, v194
    v_cvt_pk_bf16_f32 v145, v232, v240
    v_mfma_f32_16x16x32_bf16 v[224:227], v[108:111], v[164:167], 0
    v_cvt_pk_bf16_f32 v147, v233, v241
    v_cvt_pk_bf16_f32 v149, v234, v242
    s_add_u32 s80, s61, 19968
    buffer_load_dwordx4 v[96:99], v18, s[48:51], s80 offen offset:0 sc1
    s_add_u32 s81, s61, 23296
    buffer_load_dwordx4 v[100:103], v18, s[48:51], s81 offen offset:0 sc1
    buffer_load_dwordx4 v[104:107], v18, s[48:51], s80 offen offset:1664 sc1
    buffer_load_dwordx4 v[108:111], v18, s[48:51], s81 offen offset:1664 sc1
    s_waitcnt lgkmcnt(0)
    v_mfma_f32_16x16x32_bf16 v[2:5], v[120:123], v[32:35], 0
    v_fmac_f32 v196, v212, v180
    v_fmac_f32 v197, v213, v181
    v_mfma_f32_16x16x32_bf16 v[10:13], v[136:139], v[48:51], 0
    v_fmac_f32 v198, v214, v182
    v_fmac_f32 v199, v215, v183
    v_mfma_f32_16x16x32_bf16 v[2:5], v[124:127], v[36:39], v[2:5]
    v_fmac_f32 v204, v220, v180
    v_fmac_f32 v205, v221, v181
    v_mfma_f32_16x16x32_bf16 v[10:13], v[140:143], v[52:55], v[10:13]
    v_fmac_f32 v206, v222, v182
    v_fmac_f32 v207, v223, v183
    v_mfma_f32_16x16x32_bf16 v[2:5], v[128:131], v[40:43], v[2:5]
    v_fmac_f32 v200, v216, v188
    v_fmac_f32 v201, v217, v189
    v_mfma_f32_16x16x32_bf16 v[10:13], v[144:147], v[56:59], v[10:13]
    v_fmac_f32 v202, v218, v190
    v_fmac_f32 v203, v219, v191
    v_mfma_f32_16x16x32_bf16 v[2:5], v[132:135], v[44:47], v[2:5]
    v_fmac_f32 v208, v224, v188
    v_fmac_f32 v209, v225, v189
    v_mfma_f32_16x16x32_bf16 v[10:13], v[148:151], v[60:63], v[10:13]
    v_fmac_f32 v210, v226, v190
    v_fmac_f32 v211, v227, v191
    s_waitcnt vmcnt(4)
    v_mfma_f32_16x16x32_bf16 v[228:231], v[112:115], v[64:67], 0
    v_cvt_pk_bf16_f32 v120, v196, v204
    v_mfma_f32_16x16x32_bf16 v[232:235], v[112:115], v[68:71], 0
    v_cvt_pk_bf16_f32 v122, v197, v205
    v_mfma_f32_16x16x32_bf16 v[236:239], v[116:119], v[72:75], 0
    v_cvt_pk_bf16_f32 v124, v198, v206
    v_mfma_f32_16x16x32_bf16 v[240:243], v[116:119], v[76:79], 0
    v_cvt_pk_bf16_f32 v126, v199, v207
    v_mfma_f32_16x16x32_bf16 v[244:247], v[172:175], v[152:155], 0
    v_cvt_pk_bf16_f32 v136, v200, v208
    v_mfma_f32_16x16x32_bf16 v[248:251], v[172:175], v[156:159], 0
    v_cvt_pk_bf16_f32 v138, v201, v209
    v_mfma_f32_16x16x32_bf16 v[252:255], v[176:179], v[160:163], 0
    v_cvt_pk_bf16_f32 v140, v202, v210
    v_mfma_f32_16x16x32_bf16 v[168:171], v[176:179], v[164:167], 0
    v_cvt_pk_bf16_f32 v142, v203, v211
    buffer_load_dwordx4 v[112:115], v19, s[48:51], s80 offen offset:1024 sc1
    buffer_load_dwordx4 v[116:119], v19, s[48:51], s81 offen offset:1024 sc1
    buffer_load_dwordx4 v[172:175], v19, s[48:51], s80 offen offset:2688 sc1
    buffer_load_dwordx4 v[176:179], v19, s[48:51], s81 offen offset:2688 sc1
    ds_read_b64 v[32:33], v14 offset:8
    ds_read_b64 v[34:35], v14 offset:4104
    ds_read_b64 v[36:37], v14 offset:32776
    ds_read_b64 v[38:39], v14 offset:36872
    ds_read_b64 v[40:41], v22 offset:8
    ds_read_b64 v[42:43], v22 offset:4104
    ds_read_b64 v[44:45], v16 offset:8
    ds_read_b64 v[48:49], v15 offset:8
    ds_read_b64 v[50:51], v15 offset:4104
    ds_read_b64 v[52:53], v15 offset:32776
    ds_read_b64 v[54:55], v15 offset:36872
    ds_read_b64 v[56:57], v23 offset:8
    ds_read_b64 v[58:59], v23 offset:4104
    ds_read_b64 v[60:61], v17 offset:8
    v_pk_fma_f32 v[228:229], v[244:245], v[184:185], v[228:229]
    v_pk_fma_f32 v[236:237], v[252:253], v[184:185], v[236:237]
    v_pk_fma_f32 v[232:233], v[248:249], v[192:193], v[232:233]
    v_pk_fma_f32 v[240:241], v[168:169], v[192:193], v[240:241]
    v_dot2_f32_bf16 v212, v80, v1, 0
    v_dot2_f32_bf16 v213, v80, v181, 0
    v_dot2_f32_bf16 v214, v81, v6, 0
    v_dot2_f32_bf16 v215, v81, v183, 0
    v_dot2_f32_bf16 v216, v82, v7, 0
    v_dot2_f32_bf16 v217, v82, v185, 0
    v_dot2_f32_bf16 v218, v84, v8, 0
    v_dot2_f32_bf16 v219, v84, v189, 0
    v_dot2_f32_bf16 v220, v85, v9, 0
    v_dot2_f32_bf16 v221, v85, v191, 0
    v_dot2_f32_bf16 v222, v86, v27, 0
    v_dot2_f32_bf16 v223, v86, v193, 0
    v_cvt_pk_bf16_f32 v152, v212, v213
    v_cvt_pk_bf16_f32 v153, v214, v215
    v_cvt_pk_bf16_f32 v154, v216, v217
    v_cvt_pk_bf16_f32 v156, v218, v219
    v_cvt_pk_bf16_f32 v157, v220, v221
    v_cvt_pk_bf16_f32 v158, v222, v223
    v_dot2_f32_bf16 v212, v88, v1, 0
    v_dot2_f32_bf16 v213, v88, v181, 0
    v_dot2_f32_bf16 v214, v89, v6, 0
    v_dot2_f32_bf16 v215, v89, v183, 0
    v_dot2_f32_bf16 v216, v90, v7, 0
    v_dot2_f32_bf16 v217, v90, v185, 0
    v_dot2_f32_bf16 v218, v92, v8, 0
    v_dot2_f32_bf16 v219, v92, v189, 0
    v_dot2_f32_bf16 v220, v93, v9, 0
    v_dot2_f32_bf16 v221, v93, v191, 0
    v_dot2_f32_bf16 v222, v94, v27, 0
    v_dot2_f32_bf16 v223, v94, v193, 0
    s_waitcnt vmcnt(4)
    v_mfma_f32_16x16x32_bf16 v[196:199], v[96:99], v[80:83], 0
    v_cvt_pk_bf16_f32 v160, v212, v213
    v_cvt_pk_bf16_f32 v161, v214, v215
    v_mfma_f32_16x16x32_bf16 v[200:203], v[96:99], v[84:87], 0
    v_cvt_pk_bf16_f32 v162, v216, v217
    v_cvt_pk_bf16_f32 v164, v218, v219
    v_mfma_f32_16x16x32_bf16 v[204:207], v[100:103], v[88:91], 0
    v_cvt_pk_bf16_f32 v165, v220, v221
    v_cvt_pk_bf16_f32 v166, v222, v223
    v_mfma_f32_16x16x32_bf16 v[208:211], v[100:103], v[92:95], 0
    v_fmac_f32 v230, v246, v186
    v_fmac_f32 v238, v254, v186
    v_mfma_f32_16x16x32_bf16 v[212:215], v[104:107], v[152:155], 0
    v_cvt_pk_bf16_f32 v128, v228, v236
    v_cvt_pk_bf16_f32 v130, v229, v237
    v_mfma_f32_16x16x32_bf16 v[216:219], v[104:107], v[156:159], 0
    v_cvt_pk_bf16_f32 v132, v230, v238
    v_fmac_f32 v234, v250, v194
    v_mfma_f32_16x16x32_bf16 v[220:223], v[108:111], v[160:163], 0
    v_fmac_f32 v242, v170, v194
    v_cvt_pk_bf16_f32 v144, v232, v240
    v_mfma_f32_16x16x32_bf16 v[224:227], v[108:111], v[164:167], 0
    v_cvt_pk_bf16_f32 v146, v233, v241
    v_cvt_pk_bf16_f32 v148, v234, v242
    s_waitcnt vmcnt(0)
    v_mfma_f32_16x16x32_bf16 v[228:231], v[112:115], v[80:83], 0
    v_fmac_f32 v196, v212, v180
    v_fmac_f32 v197, v213, v181
    v_fmac_f32 v198, v214, v182
    v_mfma_f32_16x16x32_bf16 v[232:235], v[112:115], v[84:87], 0
    v_fmac_f32 v199, v215, v183
    v_fmac_f32 v204, v220, v180
    v_fmac_f32 v205, v221, v181
    v_mfma_f32_16x16x32_bf16 v[236:239], v[116:119], v[88:91], 0
    v_fmac_f32 v206, v222, v182
    v_fmac_f32 v207, v223, v183
    v_cvt_pk_bf16_f32 v121, v196, v204
    v_mfma_f32_16x16x32_bf16 v[240:243], v[116:119], v[92:95], 0
    v_cvt_pk_bf16_f32 v123, v197, v205
    v_cvt_pk_bf16_f32 v125, v198, v206
    v_cvt_pk_bf16_f32 v127, v199, v207
    v_mfma_f32_16x16x32_bf16 v[244:247], v[172:175], v[152:155], 0
    v_fmac_f32 v200, v216, v188
    v_fmac_f32 v201, v217, v189
    v_fmac_f32 v202, v218, v190
    v_mfma_f32_16x16x32_bf16 v[248:251], v[172:175], v[156:159], 0
    v_fmac_f32 v203, v219, v191
    v_fmac_f32 v208, v224, v188
    v_fmac_f32 v209, v225, v189
    v_mfma_f32_16x16x32_bf16 v[252:255], v[176:179], v[160:163], 0
    v_fmac_f32 v210, v226, v190
    v_fmac_f32 v211, v227, v191
    v_cvt_pk_bf16_f32 v137, v200, v208
    v_mfma_f32_16x16x32_bf16 v[168:171], v[176:179], v[164:167], 0
    v_cvt_pk_bf16_f32 v139, v201, v209
    v_cvt_pk_bf16_f32 v141, v202, v210
    v_cvt_pk_bf16_f32 v143, v203, v211
    s_and_b32 s56, s60, 0x400
    v_add_u32 v31, s56, v31
    v_xor_b32 v29, 0x400, v31
    s_lshl_b32 s56, s52, 28
    buffer_load_dwordx2 v[24:25], v20, s[48:51], s56 offen sc1
    v_pk_fma_f32 v[228:229], v[244:245], v[184:185], v[228:229]
    v_pk_fma_f32 v[236:237], v[252:253], v[184:185], v[236:237]
    v_pk_fma_f32 v[232:233], v[248:249], v[192:193], v[232:233]
    v_pk_fma_f32 v[240:241], v[168:169], v[192:193], v[240:241]
    s_waitcnt lgkmcnt(0)
    v_mfma_f32_16x16x32_bf16 v[2:5], v[120:123], v[32:35], v[2:5]
    v_fmac_f32 v230, v246, v186
    v_fmac_f32 v238, v254, v186
    v_mfma_f32_16x16x32_bf16 v[10:13], v[136:139], v[48:51], v[10:13]
    v_cvt_pk_bf16_f32 v129, v228, v236
    v_cvt_pk_bf16_f32 v131, v229, v237
    v_cvt_pk_bf16_f32 v133, v230, v238
    v_mfma_f32_16x16x32_bf16 v[2:5], v[124:127], v[36:39], v[2:5]
    v_fmac_f32 v234, v250, v194
    v_fmac_f32 v242, v170, v194
    v_mfma_f32_16x16x32_bf16 v[10:13], v[140:143], v[52:55], v[10:13]
    v_cvt_pk_bf16_f32 v145, v232, v240
    v_cvt_pk_bf16_f32 v147, v233, v241
    v_cvt_pk_bf16_f32 v149, v234, v242
    v_mfma_f32_16x16x32_bf16 v[2:5], v[128:131], v[40:43], v[2:5]
    v_mfma_f32_16x16x32_bf16 v[10:13], v[144:147], v[56:59], v[10:13]
    v_mfma_f32_16x16x32_bf16 v[2:5], v[132:135], v[44:47], v[2:5]
    v_mfma_f32_16x16x32_bf16 v[10:13], v[148:151], v[60:63], v[10:13]
    s_cmp_lg_u32 s52, 0
    s_nop 5
    ds_write_b128 v31, v[2:5]
    ds_write_b128 v29, v[10:13]
    s_cbranch_scc0 L_w0
    s_waitcnt lgkmcnt(0)
    s_barrier
    s_branch L_end
L_w0:
    buffer_load_dwordx2 v[40:41], v20, s[48:51], 0 offen sc1
    v_and_b32 v1, 31, v0
    v_and_b32 v6, 15, v0
    v_lshrrev_b32 v7, 2, v6
    v_lshl_add_u32 v7, v7, 4, v6
    v_lshlrev_b32 v7, 4, v7
    v_and_b32 v6, 3, v0
    v_lshl_add_u32 v7, v6, 2, v7
    v_bfe_u32 v6, v0, 4, 1
    v_lshl_add_u32 v7, v6, 10, v7
    v_bfe_u32 v6, v0, 5, 1
    v_lshl_add_u32 v7, v6, 13, v7
    v_add_u32 v7, 106496, v7
    s_lshl1_add_u32 s56, s53, s54
    s_lshl_b32 s56, s56, 6
    v_lshlrev_b32 v9, 1, v1
    s_lshl_b32 s57, s53, 2
    s_mov_b32 s59, 0
L_poll:
    s_waitcnt vmcnt(1)
    v_cmp_eq_u32 vcc, v25, v21
    s_cbranch_vccz L_got
    buffer_load_dwordx2 v[24:25], v20, s[48:51], 0 offen sc1
    s_waitcnt vmcnt(1)
    v_cmp_eq_u32 vcc, v41, v21
    s_cbranch_vccz L_got2
    buffer_load_dwordx2 v[40:41], v20, s[48:51], 0 offen sc1
    s_add_u32 s59, s59, 1
    s_and_b32 s58, s59, 15
    s_cbranch_scc1 L_poll
    s_mov_b64 exec, 1
    buffer_load_dword v27, off, s[44:47], s57 sc1
    s_waitcnt vmcnt(0)
    v_readfirstlane_b32 s58, v27
    s_mov_b64 exec, -1
    s_bitcmp1_b32 s58, 1
    s_cselect_b32 s6, 0, -1
    s_bitcmp1_b32 s58, 17
    s_cselect_b32 s7, 0, -1
    s_mov_b32 s58, 0x10000
    buffer_load_dwordx2 v[24:25], v20, s[48:51], s58 offen sc1
    s_waitcnt vmcnt(0)
    v_cmp_eq_u32 vcc, v25, v26
    s_nop 0
    s_and_b64 vcc, vcc, s[6:7]
    s_cbranch_scc0 L_got
    buffer_load_dwordx2 v[24:25], v20, s[48:51], 0 offen sc1
    buffer_load_dwordx2 v[40:41], v20, s[48:51], 0 offen sc1
    s_branch L_poll
L_got:
    v_mov_b32 v8, v24
    s_branch L_got3
L_got2:
    v_mov_b32 v8, v40
L_got3:
    s_waitcnt lgkmcnt(0)
    s_barrier
    ds_read_b32 v32, v7 offset:0
    ds_read_b32 v33, v7 offset:2048
    ds_read_b32 v34, v7 offset:4096
    ds_read_b32 v35, v7 offset:6144
    s_waitcnt lgkmcnt(2)
    v_add_f32 v32, v32, v33
    v_add_f32 v32, v32, v8
    s_waitcnt lgkmcnt(0)
    v_add_f32 v34, v34, v35
    v_add_f32 v32, v32, v34
    v_mov_b32 v33, v32
    s_nop 1
    v_permlane32_swap_b32 v32, v33
    v_add_f32 v4, v32, v33
    v_cvt_pk_bf16_f32 v4, v4, v4
    s_mov_b32 exec_hi, 0
    buffer_store_short v4, v9, s[40:43], s56 offen
    s_branch L_end
L_Bl2:
    v_lshrrev_b32 v15, 4, v0
    v_xor_b32 v15, v15, v0
    v_and_b32 v15, 7, v15
    v_lshlrev_b32 v2, 4, v15
    s_waitcnt vmcnt(33)
    v_lshlrev_b32 v4, 7, v4
    v_lshlrev_b32 v5, 7, v5
    v_lshlrev_b32 v6, 7, v6
    v_lshlrev_b32 v7, 7, v7
    v_lshlrev_b32 v8, 7, v8
    v_lshlrev_b32 v9, 7, v9
    v_lshlrev_b32 v10, 7, v10
    v_lshlrev_b32 v11, 7, v11
    v_add_u32_dpp v12, v4, v2 row_newbcast:0 row_mask:0xf bank_mask:0x3
    v_add_u32_dpp v13, v8, v2 row_newbcast:0 row_mask:0xf bank_mask:0x3
    s_add_u32 m0, s60, 131072
    v_add_u32_dpp v12, v4, v2 row_newbcast:8 row_mask:0xf bank_mask:0xc
    v_add_u32_dpp v13, v8, v2 row_newbcast:8 row_mask:0xf bank_mask:0xc
    buffer_load_dwordx4 v12, s[12:15], 0 offen lds
    s_addk_i32 m0, 0x1000
    s_nop 0
    buffer_load_dwordx4 v13, s[12:15], 0 offen lds
    v_add_u32_dpp v12, v5, v2 row_newbcast:0 row_mask:0xf bank_mask:0x3
    v_add_u32_dpp v13, v9, v2 row_newbcast:0 row_mask:0xf bank_mask:0x3
    s_add_u32 m0, s60, 139264
    v_add_u32_dpp v12, v5, v2 row_newbcast:8 row_mask:0xf bank_mask:0xc
    v_add_u32_dpp v13, v9, v2 row_newbcast:8 row_mask:0xf bank_mask:0xc
    buffer_load_dwordx4 v12, s[12:15], 0 offen lds
    s_addk_i32 m0, 0x1000
    s_nop 0
    buffer_load_dwordx4 v13, s[12:15], 0 offen lds
    v_add_u32_dpp v12, v6, v2 row_newbcast:0 row_mask:0xf bank_mask:0x3
    v_add_u32_dpp v13, v10, v2 row_newbcast:0 row_mask:0xf bank_mask:0x3
    s_add_u32 m0, s60, 147456
    v_add_u32_dpp v12, v6, v2 row_newbcast:8 row_mask:0xf bank_mask:0xc
    v_add_u32_dpp v13, v10, v2 row_newbcast:8 row_mask:0xf bank_mask:0xc
    buffer_load_dwordx4 v12, s[12:15], 0 offen lds
    s_addk_i32 m0, 0x1000
    s_nop 0
    buffer_load_dwordx4 v13, s[12:15], 0 offen lds
    v_add_u32_dpp v12, v7, v2 row_newbcast:0 row_mask:0xf bank_mask:0x3
    v_add_u32_dpp v13, v11, v2 row_newbcast:0 row_mask:0xf bank_mask:0x3
    s_add_u32 m0, s60, 155648
    v_add_u32_dpp v12, v7, v2 row_newbcast:8 row_mask:0xf bank_mask:0xc
    v_add_u32_dpp v13, v11, v2 row_newbcast:8 row_mask:0xf bank_mask:0xc
    buffer_load_dwordx4 v12, s[12:15], 0 offen lds
    s_addk_i32 m0, 0x1000
    s_nop 0
    buffer_load_dwordx4 v13, s[12:15], 0 offen lds
    s_waitcnt vmcnt(6)
    s_barrier
    s_waitcnt vmcnt(4)
    s_barrier
    s_add_u32 m0, s60, 0
    s_mov_b32 s56, 262144
    buffer_load_dwordx4 v1, s[16:19], s56 offen lds
    s_add_u32 m0, s60, 4096
    s_mov_b32 s56, 270336
    buffer_load_dwordx4 v1, s[16:19], s56 offen lds
    s_add_u32 m0, s60, 8192
    s_mov_b32 s56, 278528
    buffer_load_dwordx4 v1, s[16:19], s56 offen lds
    v_add_u32_dpp v12, v4, v2 row_newbcast:1 row_mask:0xf bank_mask:0x3
    v_add_u32_dpp v13, v8, v2 row_newbcast:1 row_mask:0xf bank_mask:0x3
    s_add_u32 m0, s60, 131072
    v_add_u32_dpp v12, v4, v2 row_newbcast:9 row_mask:0xf bank_mask:0xc
    v_add_u32_dpp v13, v8, v2 row_newbcast:9 row_mask:0xf bank_mask:0xc
    buffer_load_dwordx4 v12, s[12:15], 0 offen lds
    s_addk_i32 m0, 0x1000
    s_nop 0
    buffer_load_dwordx4 v13, s[12:15], 0 offen lds
    s_waitcnt vmcnt(7)
    s_barrier
    s_add_u32 m0, s60, 12288
    s_mov_b32 s56, 286720
    buffer_load_dwordx4 v1, s[16:19], s56 offen lds
    s_add_u32 m0, s60, 16384
    s_mov_b32 s56, 294912
    buffer_load_dwordx4 v1, s[16:19], s56 offen lds
    s_add_u32 m0, s60, 20480
    s_mov_b32 s56, 303104
    buffer_load_dwordx4 v1, s[16:19], s56 offen lds
    v_add_u32_dpp v12, v5, v2 row_newbcast:1 row_mask:0xf bank_mask:0x3
    v_add_u32_dpp v13, v9, v2 row_newbcast:1 row_mask:0xf bank_mask:0x3
    s_add_u32 m0, s60, 139264
    v_add_u32_dpp v12, v5, v2 row_newbcast:9 row_mask:0xf bank_mask:0xc
    v_add_u32_dpp v13, v9, v2 row_newbcast:9 row_mask:0xf bank_mask:0xc
    buffer_load_dwordx4 v12, s[12:15], 0 offen lds
    s_addk_i32 m0, 0x1000
    s_nop 0
    buffer_load_dwordx4 v13, s[12:15], 0 offen lds
    s_waitcnt vmcnt(10)
    s_barrier
    s_add_u32 m0, s60, 24576
    s_mov_b32 s56, 311296
    buffer_load_dwordx4 v1, s[16:19], s56 offen lds
    s_add_u32 m0, s60, 28672
    s_mov_b32 s56, 319488
    buffer_load_dwordx4 v1, s[16:19], s56 offen lds
    s_add_u32 m0, s60, 32768
    s_mov_b32 s56, 327680
    buffer_load_dwordx4 v1, s[16:19], s56 offen lds
    v_add_u32_dpp v12, v6, v2 row_newbcast:1 row_mask:0xf bank_mask:0x3
    v_add_u32_dpp v13, v10, v2 row_newbcast:1 row_mask:0xf bank_mask:0x3
    s_add_u32 m0, s60, 147456
    v_add_u32_dpp v12, v6, v2 row_newbcast:9 row_mask:0xf bank_mask:0xc
    v_add_u32_dpp v13, v10, v2 row_newbcast:9 row_mask:0xf bank_mask:0xc
    buffer_load_dwordx4 v12, s[12:15], 0 offen lds
    s_addk_i32 m0, 0x1000
    s_nop 0
    buffer_load_dwordx4 v13, s[12:15], 0 offen lds
    s_waitcnt vmcnt(10)
    s_barrier
    s_add_u32 m0, s60, 36864
    s_mov_b32 s56, 335872
    buffer_load_dwordx4 v1, s[16:19], s56 offen lds
    s_add_u32 m0, s60, 40960
    s_mov_b32 s56, 344064
    buffer_load_dwordx4 v1, s[16:19], s56 offen lds
    s_add_u32 m0, s60, 45056
    s_mov_b32 s56, 352256
    buffer_load_dwordx4 v1, s[16:19], s56 offen lds
    s_add_u32 m0, s60, 49152
    s_mov_b32 s56, 360448
    buffer_load_dwordx4 v1, s[16:19], s56 offen lds
    v_add_u32_dpp v12, v7, v2 row_newbcast:1 row_mask:0xf bank_mask:0x3
    v_add_u32_dpp v13, v11, v2 row_newbcast:1 row_mask:0xf bank_mask:0x3
    s_add_u32 m0, s60, 155648
    v_add_u32_dpp v12, v7, v2 row_newbcast:9 row_mask:0xf bank_mask:0xc
    v_add_u32_dpp v13, v11, v2 row_newbcast:9 row_mask:0xf bank_mask:0xc
    buffer_load_dwordx4 v12, s[12:15], 0 offen lds
    s_addk_i32 m0, 0x1000
    s_nop 0
    buffer_load_dwordx4 v13, s[12:15], 0 offen lds
    s_waitcnt vmcnt(11)
    s_barrier
    s_add_u32 m0, s60, 53248
    s_mov_b32 s56, 368640
    buffer_load_dwordx4 v1, s[16:19], s56 offen lds
    s_add_u32 m0, s60, 57344
    s_mov_b32 s56, 376832
    buffer_load_dwordx4 v1, s[16:19], s56 offen lds
    s_add_u32 m0, s60, 61440
    s_mov_b32 s56, 385024
    buffer_load_dwordx4 v1, s[16:19], s56 offen lds
    v_add_u32_dpp v12, v4, v2 row_newbcast:2 row_mask:0xf bank_mask:0x3
    v_add_u32_dpp v13, v8, v2 row_newbcast:2 row_mask:0xf bank_mask:0x3
    s_add_u32 m0, s60, 131072
    v_add_u32_dpp v12, v4, v2 row_newbcast:10 row_mask:0xf bank_mask:0xc
    v_add_u32_dpp v13, v8, v2 row_newbcast:10 row_mask:0xf bank_mask:0xc
    buffer_load_dwordx4 v12, s[12:15], 0 offen lds
    s_addk_i32 m0, 0x1000
    s_nop 0
    buffer_load_dwordx4 v13, s[12:15], 0 offen lds
    s_waitcnt vmcnt(11)
    s_barrier
    s_add_u32 m0, s60, 65536
    s_mov_b32 s56, 393216
    buffer_load_dwordx4 v1, s[16:19], s56 offen lds
    s_add_u32 m0, s60, 69632
    s_mov_b32 s56, 401408
    buffer_load_dwordx4 v1, s[16:19], s56 offen lds
    s_add_u32 m0, s60, 73728
    s_mov_b32 s56, 409600
    buffer_load_dwordx4 v1, s[16:19], s56 offen lds
    v_add_u32_dpp v12, v5, v2 row_newbcast:2 row_mask:0xf bank_mask:0x3
    v_add_u32_dpp v13, v9, v2 row_newbcast:2 row_mask:0xf bank_mask:0x3
    s_add_u32 m0, s60, 139264
    v_add_u32_dpp v12, v5, v2 row_newbcast:10 row_mask:0xf bank_mask:0xc
    v_add_u32_dpp v13, v9, v2 row_newbcast:10 row_mask:0xf bank_mask:0xc
    buffer_load_dwordx4 v12, s[12:15], 0 offen lds
    s_addk_i32 m0, 0x1000
    s_nop 0
    buffer_load_dwordx4 v13, s[12:15], 0 offen lds
    s_waitcnt vmcnt(10)
    s_barrier
    s_add_u32 m0, s60, 77824
    s_mov_b32 s56, 417792
    buffer_load_dwordx4 v1, s[16:19], s56 offen lds
    s_add_u32 m0, s60, 81920
    s_mov_b32 s56, 425984
    buffer_load_dwordx4 v1, s[16:19], s56 offen lds
    s_add_u32 m0, s60, 86016
    s_mov_b32 s56, 434176
    buffer_load_dwordx4 v1, s[16:19], s56 offen lds
    v_add_u32_dpp v12, v6, v2 row_newbcast:2 row_mask:0xf bank_mask:0x3
    v_add_u32_dpp v13, v10, v2 row_newbcast:2 row_mask:0xf bank_mask:0x3
    s_add_u32 m0, s60, 147456
    v_add_u32_dpp v12, v6, v2 row_newbcast:10 row_mask:0xf bank_mask:0xc
    v_add_u32_dpp v13, v10, v2 row_newbcast:10 row_mask:0xf bank_mask:0xc
    buffer_load_dwordx4 v12, s[12:15], 0 offen lds
    s_addk_i32 m0, 0x1000
    s_nop 0
    buffer_load_dwordx4 v13, s[12:15], 0 offen lds
    s_waitcnt vmcnt(10)
    s_barrier
    s_add_u32 m0, s60, 90112
    s_mov_b32 s56, 442368
    buffer_load_dwordx4 v1, s[16:19], s56 offen lds
    s_add_u32 m0, s60, 94208
    s_mov_b32 s56, 450560
    buffer_load_dwordx4 v1, s[16:19], s56 offen lds
    s_add_u32 m0, s60, 98304
    s_mov_b32 s56, 458752
    buffer_load_dwordx4 v1, s[16:19], s56 offen lds
    s_add_u32 m0, s60, 102400
    s_mov_b32 s56, 466944
    buffer_load_dwordx4 v1, s[16:19], s56 offen lds
    v_add_u32_dpp v12, v7, v2 row_newbcast:2 row_mask:0xf bank_mask:0x3
    v_add_u32_dpp v13, v11, v2 row_newbcast:2 row_mask:0xf bank_mask:0x3
    s_add_u32 m0, s60, 155648
    v_add_u32_dpp v12, v7, v2 row_newbcast:10 row_mask:0xf bank_mask:0xc
    v_add_u32_dpp v13, v11, v2 row_newbcast:10 row_mask:0xf bank_mask:0xc
    buffer_load_dwordx4 v12, s[12:15], 0 offen lds
    s_addk_i32 m0, 0x1000
    s_nop 0
    buffer_load_dwordx4 v13, s[12:15], 0 offen lds
    s_waitcnt vmcnt(11)
    s_barrier
    s_add_u32 m0, s60, 106496
    s_mov_b32 s56, 475136
    buffer_load_dwordx4 v1, s[16:19], s56 offen lds
    s_add_u32 m0, s60, 110592
    s_mov_b32 s56, 483328
    buffer_load_dwordx4 v1, s[16:19], s56 offen lds
    s_add_u32 m0, s60, 114688
    s_mov_b32 s56, 491520
    buffer_load_dwordx4 v1, s[16:19], s56 offen lds
    v_add_u32_dpp v12, v4, v2 row_newbcast:3 row_mask:0xf bank_mask:0x3
    v_add_u32_dpp v13, v8, v2 row_newbcast:3 row_mask:0xf bank_mask:0x3
    s_add_u32 m0, s60, 131072
    v_add_u32_dpp v12, v4, v2 row_newbcast:11 row_mask:0xf bank_mask:0xc
    v_add_u32_dpp v13, v8, v2 row_newbcast:11 row_mask:0xf bank_mask:0xc
    buffer_load_dwordx4 v12, s[12:15], 0 offen lds
    s_addk_i32 m0, 0x1000
    s_nop 0
    buffer_load_dwordx4 v13, s[12:15], 0 offen lds
    s_waitcnt vmcnt(11)
    s_barrier
    s_add_u32 m0, s60, 118784
    s_mov_b32 s56, 499712
    buffer_load_dwordx4 v1, s[16:19], s56 offen lds
    s_add_u32 m0, s60, 122880
    s_mov_b32 s56, 507904
    buffer_load_dwordx4 v1, s[16:19], s56 offen lds
    s_add_u32 m0, s60, 126976
    s_mov_b32 s56, 516096
    buffer_load_dwordx4 v1, s[16:19], s56 offen lds
    v_add_u32_dpp v12, v5, v2 row_newbcast:3 row_mask:0xf bank_mask:0x3
    v_add_u32_dpp v13, v9, v2 row_newbcast:3 row_mask:0xf bank_mask:0x3
    s_add_u32 m0, s60, 139264
    v_add_u32_dpp v12, v5, v2 row_newbcast:11 row_mask:0xf bank_mask:0xc
    v_add_u32_dpp v13, v9, v2 row_newbcast:11 row_mask:0xf bank_mask:0xc
    buffer_load_dwordx4 v12, s[12:15], 0 offen lds
    s_addk_i32 m0, 0x1000
    s_nop 0
    buffer_load_dwordx4 v13, s[12:15], 0 offen lds
    s_waitcnt vmcnt(10)
    s_barrier
    s_add_u32 m0, s60, 0
    s_mov_b32 s56, 524288
    buffer_load_dwordx4 v1, s[16:19], s56 offen lds
    s_add_u32 m0, s60, 4096
    s_mov_b32 s56, 532480
    buffer_load_dwordx4 v1, s[16:19], s56 offen lds
    s_add_u32 m0, s60, 8192
    s_mov_b32 s56, 540672
    buffer_load_dwordx4 v1, s[16:19], s56 offen lds
    s_add_u32 m0, s60, 12288
    s_mov_b32 s56, 548864
    buffer_load_dwordx4 v1, s[16:19], s56 offen lds
    v_add_u32_dpp v12, v6, v2 row_newbcast:3 row_mask:0xf bank_mask:0x3
    v_add_u32_dpp v13, v10, v2 row_newbcast:3 row_mask:0xf bank_mask:0x3
    s_add_u32 m0, s60, 147456
    v_add_u32_dpp v12, v6, v2 row_newbcast:11 row_mask:0xf bank_mask:0xc
    v_add_u32_dpp v13, v10, v2 row_newbcast:11 row_mask:0xf bank_mask:0xc
    buffer_load_dwordx4 v12, s[12:15], 0 offen lds
    s_addk_i32 m0, 0x1000
    s_nop 0
    buffer_load_dwordx4 v13, s[12:15], 0 offen lds
    s_waitcnt vmcnt(11)
    s_barrier
    s_add_u32 m0, s60, 16384
    s_mov_b32 s56, 557056
    buffer_load_dwordx4 v1, s[16:19], s56 offen lds
    s_add_u32 m0, s60, 20480
    s_mov_b32 s56, 565248
    buffer_load_dwordx4 v1, s[16:19], s56 offen lds
    s_add_u32 m0, s60, 24576
    s_mov_b32 s56, 573440
    buffer_load_dwordx4 v1, s[16:19], s56 offen lds
    v_add_u32_dpp v12, v7, v2 row_newbcast:3 row_mask:0xf bank_mask:0x3
    v_add_u32_dpp v13, v11, v2 row_newbcast:3 row_mask:0xf bank_mask:0x3
    s_add_u32 m0, s60, 155648
    v_add_u32_dpp v12, v7, v2 row_newbcast:11 row_mask:0xf bank_mask:0xc
    v_add_u32_dpp v13, v11, v2 row_newbcast:11 row_mask:0xf bank_mask:0xc
    buffer_load_dwordx4 v12, s[12:15], 0 offen lds
    s_addk_i32 m0, 0x1000
    s_nop 0
    buffer_load_dwordx4 v13, s[12:15], 0 offen lds
    s_waitcnt vmcnt(11)
    s_barrier
    s_add_u32 m0, s60, 28672
    s_mov_b32 s56, 581632
    buffer_load_dwordx4 v1, s[16:19], s56 offen lds
    s_add_u32 m0, s60, 32768
    s_mov_b32 s56, 589824
    buffer_load_dwordx4 v1, s[16:19], s56 offen lds
    s_add_u32 m0, s60, 36864
    s_mov_b32 s56, 598016
    buffer_load_dwordx4 v1, s[16:19], s56 offen lds
    v_add_u32_dpp v12, v4, v2 row_newbcast:4 row_mask:0xf bank_mask:0x3
    v_add_u32_dpp v13, v8, v2 row_newbcast:4 row_mask:0xf bank_mask:0x3
    s_add_u32 m0, s60, 131072
    v_add_u32_dpp v12, v4, v2 row_newbcast:12 row_mask:0xf bank_mask:0xc
    v_add_u32_dpp v13, v8, v2 row_newbcast:12 row_mask:0xf bank_mask:0xc
    buffer_load_dwordx4 v12, s[12:15], 0 offen lds
    s_addk_i32 m0, 0x1000
    s_nop 0
    buffer_load_dwordx4 v13, s[12:15], 0 offen lds
    s_waitcnt vmcnt(10)
    s_barrier
    s_add_u32 m0, s60, 40960
    s_mov_b32 s56, 606208
    buffer_load_dwordx4 v1, s[16:19], s56 offen lds
    s_add_u32 m0, s60, 45056
    s_mov_b32 s56, 614400
    buffer_load_dwordx4 v1, s[16:19], s56 offen lds
    s_add_u32 m0, s60, 49152
    s_mov_b32 s56, 622592
    buffer_load_dwordx4 v1, s[16:19], s56 offen lds
    v_add_u32_dpp v12, v5, v2 row_newbcast:4 row_mask:0xf bank_mask:0x3
    v_add_u32_dpp v13, v9, v2 row_newbcast:4 row_mask:0xf bank_mask:0x3
    s_add_u32 m0, s60, 139264
    v_add_u32_dpp v12, v5, v2 row_newbcast:12 row_mask:0xf bank_mask:0xc
    v_add_u32_dpp v13, v9, v2 row_newbcast:12 row_mask:0xf bank_mask:0xc
    buffer_load_dwordx4 v12, s[12:15], 0 offen lds
    s_addk_i32 m0, 0x1000
    s_nop 0
    buffer_load_dwordx4 v13, s[12:15], 0 offen lds
    s_waitcnt vmcnt(10)
    s_barrier
    s_add_u32 m0, s60, 53248
    s_mov_b32 s56, 630784
    buffer_load_dwordx4 v1, s[16:19], s56 offen lds
    s_add_u32 m0, s60, 57344
    s_mov_b32 s56, 638976
    buffer_load_dwordx4 v1, s[16:19], s56 offen lds
    s_add_u32 m0, s60, 61440
    s_mov_b32 s56, 647168
    buffer_load_dwordx4 v1, s[16:19], s56 offen lds
    s_add_u32 m0, s60, 65536
    s_mov_b32 s56, 655360
    buffer_load_dwordx4 v1, s[16:19], s56 offen lds
    v_add_u32_dpp v12, v6, v2 row_newbcast:4 row_mask:0xf bank_mask:0x3
    v_add_u32_dpp v13, v10, v2 row_newbcast:4 row_mask:0xf bank_mask:0x3
    s_add_u32 m0, s60, 147456
    v_add_u32_dpp v12, v6, v2 row_newbcast:12 row_mask:0xf bank_mask:0xc
    v_add_u32_dpp v13, v10, v2 row_newbcast:12 row_mask:0xf bank_mask:0xc
    buffer_load_dwordx4 v12, s[12:15], 0 offen lds
    s_addk_i32 m0, 0x1000
    s_nop 0
    buffer_load_dwordx4 v13, s[12:15], 0 offen lds
    s_waitcnt vmcnt(11)
    s_barrier
    s_add_u32 m0, s60, 69632
    s_mov_b32 s56, 663552
    buffer_load_dwordx4 v1, s[16:19], s56 offen lds
    s_add_u32 m0, s60, 73728
    s_mov_b32 s56, 671744
    buffer_load_dwordx4 v1, s[16:19], s56 offen lds
    s_add_u32 m0, s60, 77824
    s_mov_b32 s56, 679936
    buffer_load_dwordx4 v1, s[16:19], s56 offen lds
    v_add_u32_dpp v12, v7, v2 row_newbcast:4 row_mask:0xf bank_mask:0x3
    v_add_u32_dpp v13, v11, v2 row_newbcast:4 row_mask:0xf bank_mask:0x3
    s_add_u32 m0, s60, 155648
    v_add_u32_dpp v12, v7, v2 row_newbcast:12 row_mask:0xf bank_mask:0xc
    v_add_u32_dpp v13, v11, v2 row_newbcast:12 row_mask:0xf bank_mask:0xc
    buffer_load_dwordx4 v12, s[12:15], 0 offen lds
    s_addk_i32 m0, 0x1000
    s_nop 0
    buffer_load_dwordx4 v13, s[12:15], 0 offen lds
    s_waitcnt vmcnt(11)
    s_barrier
    s_add_u32 m0, s60, 81920
    s_mov_b32 s56, 688128
    buffer_load_dwordx4 v1, s[16:19], s56 offen lds
    s_add_u32 m0, s60, 86016
    s_mov_b32 s56, 696320
    buffer_load_dwordx4 v1, s[16:19], s56 offen lds
    s_add_u32 m0, s60, 90112
    s_mov_b32 s56, 704512
    buffer_load_dwordx4 v1, s[16:19], s56 offen lds
    v_add_u32_dpp v12, v4, v2 row_newbcast:5 row_mask:0xf bank_mask:0x3
    v_add_u32_dpp v13, v8, v2 row_newbcast:5 row_mask:0xf bank_mask:0x3
    s_add_u32 m0, s60, 131072
    v_add_u32_dpp v12, v4, v2 row_newbcast:13 row_mask:0xf bank_mask:0xc
    v_add_u32_dpp v13, v8, v2 row_newbcast:13 row_mask:0xf bank_mask:0xc
    buffer_load_dwordx4 v12, s[12:15], 0 offen lds
    s_addk_i32 m0, 0x1000
    s_nop 0
    buffer_load_dwordx4 v13, s[12:15], 0 offen lds
    s_waitcnt vmcnt(10)
    s_barrier
    s_add_u32 m0, s60, 94208
    s_mov_b32 s56, 712704
    buffer_load_dwordx4 v1, s[16:19], s56 offen lds
    s_add_u32 m0, s60, 98304
    s_mov_b32 s56, 720896
    buffer_load_dwordx4 v1, s[16:19], s56 offen lds
    s_add_u32 m0, s60, 102400
    s_mov_b32 s56, 729088
    buffer_load_dwordx4 v1, s[16:19], s56 offen lds
    v_add_u32_dpp v12, v5, v2 row_newbcast:5 row_mask:0xf bank_mask:0x3
    v_add_u32_dpp v13, v9, v2 row_newbcast:5 row_mask:0xf bank_mask:0x3
    s_add_u32 m0, s60, 139264
    v_add_u32_dpp v12, v5, v2 row_newbcast:13 row_mask:0xf bank_mask:0xc
    v_add_u32_dpp v13, v9, v2 row_newbcast:13 row_mask:0xf bank_mask:0xc
    buffer_load_dwordx4 v12, s[12:15], 0 offen lds
    s_addk_i32 m0, 0x1000
    s_nop 0
    buffer_load_dwordx4 v13, s[12:15], 0 offen lds
    s_waitcnt vmcnt(10)
    s_barrier
    s_add_u32 m0, s60, 106496
    s_mov_b32 s56, 737280
    buffer_load_dwordx4 v1, s[16:19], s56 offen lds
    s_add_u32 m0, s60, 110592
    s_mov_b32 s56, 745472
    buffer_load_dwordx4 v1, s[16:19], s56 offen lds
    s_add_u32 m0, s60, 114688
    s_mov_b32 s56, 753664
    buffer_load_dwordx4 v1, s[16:19], s56 offen lds
    s_add_u32 m0, s60, 118784
    s_mov_b32 s56, 761856
    buffer_load_dwordx4 v1, s[16:19], s56 offen lds
    v_add_u32_dpp v12, v6, v2 row_newbcast:5 row_mask:0xf bank_mask:0x3
    v_add_u32_dpp v13, v10, v2 row_newbcast:5 row_mask:0xf bank_mask:0x3
    s_add_u32 m0, s60, 147456
    v_add_u32_dpp v12, v6, v2 row_newbcast:13 row_mask:0xf bank_mask:0xc
    v_add_u32_dpp v13, v10, v2 row_newbcast:13 row_mask:0xf bank_mask:0xc
    buffer_load_dwordx4 v12, s[12:15], 0 offen lds
    s_addk_i32 m0, 0x1000
    s_nop 0
    buffer_load_dwordx4 v13, s[12:15], 0 offen lds
    s_waitcnt vmcnt(11)
    s_barrier
    s_add_u32 m0, s60, 122880
    s_mov_b32 s56, 770048
    buffer_load_dwordx4 v1, s[16:19], s56 offen lds
    s_add_u32 m0, s60, 126976
    s_mov_b32 s56, 778240
    buffer_load_dwordx4 v1, s[16:19], s56 offen lds
    s_add_u32 m0, s60, 0
    s_mov_b32 s56, 786432
    buffer_load_dwordx4 v1, s[16:19], s56 offen lds
    v_add_u32_dpp v12, v7, v2 row_newbcast:5 row_mask:0xf bank_mask:0x3
    v_add_u32_dpp v13, v11, v2 row_newbcast:5 row_mask:0xf bank_mask:0x3
    s_add_u32 m0, s60, 155648
    v_add_u32_dpp v12, v7, v2 row_newbcast:13 row_mask:0xf bank_mask:0xc
    v_add_u32_dpp v13, v11, v2 row_newbcast:13 row_mask:0xf bank_mask:0xc
    buffer_load_dwordx4 v12, s[12:15], 0 offen lds
    s_addk_i32 m0, 0x1000
    s_nop 0
    buffer_load_dwordx4 v13, s[12:15], 0 offen lds
    s_waitcnt vmcnt(11)
    s_barrier
    s_add_u32 m0, s60, 4096
    s_mov_b32 s56, 794624
    buffer_load_dwordx4 v1, s[16:19], s56 offen lds
    s_add_u32 m0, s60, 8192
    s_mov_b32 s56, 802816
    buffer_load_dwordx4 v1, s[16:19], s56 offen lds
    s_add_u32 m0, s60, 12288
    s_mov_b32 s56, 811008
    buffer_load_dwordx4 v1, s[16:19], s56 offen lds
    v_add_u32_dpp v12, v4, v2 row_newbcast:6 row_mask:0xf bank_mask:0x3
    v_add_u32_dpp v13, v8, v2 row_newbcast:6 row_mask:0xf bank_mask:0x3
    s_add_u32 m0, s60, 131072
    v_add_u32_dpp v12, v4, v2 row_newbcast:14 row_mask:0xf bank_mask:0xc
    v_add_u32_dpp v13, v8, v2 row_newbcast:14 row_mask:0xf bank_mask:0xc
    buffer_load_dwordx4 v12, s[12:15], 0 offen lds
    s_addk_i32 m0, 0x1000
    s_nop 0
    buffer_load_dwordx4 v13, s[12:15], 0 offen lds
    s_waitcnt vmcnt(10)
    s_barrier
    s_add_u32 m0, s60, 16384
    s_mov_b32 s56, 819200
    buffer_load_dwordx4 v1, s[16:19], s56 offen lds
    s_add_u32 m0, s60, 20480
    s_mov_b32 s56, 827392
    buffer_load_dwordx4 v1, s[16:19], s56 offen lds
    s_add_u32 m0, s60, 24576
    s_mov_b32 s56, 835584
    buffer_load_dwordx4 v1, s[16:19], s56 offen lds
    s_add_u32 m0, s60, 28672
    s_mov_b32 s56, 843776
    buffer_load_dwordx4 v1, s[16:19], s56 offen lds
    v_add_u32_dpp v12, v5, v2 row_newbcast:6 row_mask:0xf bank_mask:0x3
    v_add_u32_dpp v13, v9, v2 row_newbcast:6 row_mask:0xf bank_mask:0x3
    s_add_u32 m0, s60, 139264
    v_add_u32_dpp v12, v5, v2 row_newbcast:14 row_mask:0xf bank_mask:0xc
    v_add_u32_dpp v13, v9, v2 row_newbcast:14 row_mask:0xf bank_mask:0xc
    buffer_load_dwordx4 v12, s[12:15], 0 offen lds
    s_addk_i32 m0, 0x1000
    s_nop 0
    buffer_load_dwordx4 v13, s[12:15], 0 offen lds
    s_waitcnt vmcnt(11)
    s_barrier
    s_waitcnt vmcnt(6)
    s_barrier
    s_waitcnt vmcnt(0)
    s_barrier
    s_branch L_end
L_Bc:
    s_mov_b32 s30, 676
    s_mov_b32 s31, 0x00020000
    s_mov_b32 s34, 676
    s_mov_b32 s35, 0x00020000
    s_mov_b32 s26, 8192
    s_mov_b32 s27, 0x00020000
    s_mov_b32 s22, 173056
    s_mov_b32 s23, 0x00020000
    s_mov_b32 s38, 512
    s_mov_b32 s39, 0x00020000
    s_mov_b32 s42, 8192
    s_mov_b32 s43, 0x00020000
    s_mov_b32 s46, 256
    s_mov_b32 s47, 0x00020000
    s_mov_b32 s50, 268435456
    s_mov_b32 s51, 0x00020000
    s_mov_b32 s64, 0x05040100
    s_mov_b32 s65, 0x07060302
    s_mov_b32 s66, 0xc0135761
    s_mov_b32 s67, 0xbdd2d3e8
    s_mov_b32 s68, 0xffff0000
    s_mov_b32 s69, 0xbfb8aa3b
    v_and_b32 v7, 15, v0
    v_bfe_u32 v9, v0, 4, 2
    v_bfe_u32 v10, v0, 1, 3
    v_xor_b32 v10, v10, v9
    v_lshlrev_b32 v10, 4, v10
    v_lshl_add_u32 v10, v7, 7, v10
    v_add_u32 v1, 131072, v10
    v_xor_b32 v2, 64, v1
    v_bfe_u32 v7, v0, 2, 2
    v_lshl_add_u32 v10, v9, 3, v7
    v_lshlrev_b32 v10, 8, v10
    v_xor_b32 v7, s52, v7
    v_lshl_add_u32 v10, v7, 6, v10
    v_bfe_u32 v7, v0, 4, 1
    v_lshl_add_u32 v10, v7, 5, v10
    v_and_b32 v7, 3, v0
    v_lshl_add_u32 v3, v7, 3, v10
    v_xor_b32 v4, 32, v3
    v_add_u32 v5, 0x10000, v3
    v_add_u32 v6, 0x10000, v4
    s_lshl_b32 s56, s54, 8
    s_lshl_b32 s57, s52, 6
    s_add_u32 s56, s56, s57
    v_lshlrev_b32 v9, 3, v9
    s_waitcnt lgkmcnt(0)
    s_mov_b64 s[28:29], s[84:85]
    s_mov_b64 s[32:33], s[86:87]
    s_mov_b64 s[24:25], s[88:89]
    s_mov_b64 s[20:21], s[90:91]
    s_mov_b64 s[36:37], s[92:93]
    s_mov_b64 s[40:41], s[94:95]
    s_mov_b64 s[44:45], s[96:97]
    s_mov_b64 s[48:49], s[98:99]
    s_mov_b32 s58, s56
    v_mov_b32 v32, 0
    v_mov_b32 v33, 0
    v_mov_b32 v34, 0
    v_mov_b32 v35, 0
    v_mov_b32 v36, 0
    v_mov_b32 v37, 0
    v_mov_b32 v38, 0
    v_mov_b32 v39, 0
    v_mov_b32 v40, 0
    v_mov_b32 v41, 0
    v_mov_b32 v42, 0
    v_mov_b32 v43, 0
    v_mov_b32 v44, 0
    v_mov_b32 v45, 0
    v_mov_b32 v46, 0
    v_mov_b32 v47, 0
    v_mov_b32 v48, 0
    v_mov_b32 v49, 0
    v_mov_b32 v50, 0
    v_mov_b32 v51, 0
    v_mov_b32 v52, 0
    v_mov_b32 v53, 0
    v_mov_b32 v54, 0
    v_mov_b32 v55, 0
    v_mov_b32 v56, 0
    v_mov_b32 v57, 0
    v_mov_b32 v58, 0
    v_mov_b32 v59, 0
    v_mov_b32 v60, 0
    v_mov_b32 v61, 0
    v_mov_b32 v62, 0
    v_mov_b32 v63, 0
    v_mov_b32 v12, s66
    v_mov_b32 v13, s66
    v_mov_b32 v14, s67
    v_mov_b32 v15, s67
    v_lshlrev_b32 v172, 3, v0
    s_lshl1_add_u32 s59, s53, s54
    s_lshl_b32 s59, s59, 9
    s_lshl_b32 s56, s52, 28
    s_add_u32 s59, s59, s56
    s_barrier
    ds_read_b64_tr_b16 v[128:129], v3 offset:0
    ds_read_b64_tr_b16 v[130:131], v3 offset:1024
    ds_read_b64_tr_b16 v[132:133], v4 offset:0
    ds_read_b64_tr_b16 v[134:135], v4 offset:1024
    ds_read_b128 v[64:67], v1 offset:0
    ds_read_b128 v[68:71], v1 offset:2048
    ds_read_b128 v[72:75], v1 offset:4096
    ds_read_b128 v[76:79], v1 offset:6144
    ds_read_b64_tr_b16 v[136:137], v3 offset:8192
    ds_read_b64_tr_b16 v[138:139], v3 offset:9216
    ds_read_b64_tr_b16 v[140:141], v4 offset:8192
    ds_read_b64_tr_b16 v[142:143], v4 offset:9216
    s_waitcnt lgkmcnt(7)
    v_mfma_f32_16x16x32_bf16 v[32:35], v[128:131], v[64:67], v[32:35]
    ds_read_b128 v[80:83], v2 offset:0
    v_mfma_f32_16x16x32_bf16 v[36:39], v[132:135], v[64:67], v[36:39]
    ds_read_b128 v[84:87], v2 offset:2048
    s_waitcnt lgkmcnt(8)
    v_mfma_f32_16x16x32_bf16 v[40:43], v[128:131], v[68:71], v[40:43]
    ds_read_b128 v[88:91], v2 offset:4096
    v_mfma_f32_16x16x32_bf16 v[44:47], v[132:135], v[68:71], v[44:47]
    ds_read_b128 v[92:95], v2 offset:6144
    s_waitcnt lgkmcnt(9)
    v_mfma_f32_16x16x32_bf16 v[48:51], v[128:131], v[72:75], v[48:51]
    v_mfma_f32_16x16x32_bf16 v[52:55], v[132:135], v[72:75], v[52:55]
    s_waitcnt lgkmcnt(8)
    v_mfma_f32_16x16x32_bf16 v[56:59], v[128:131], v[76:79], v[56:59]
    v_mfma_f32_16x16x32_bf16 v[60:63], v[132:135], v[76:79], v[60:63]
    s_waitcnt lgkmcnt(0)
    s_barrier
    ds_read_b64_tr_b16 v[144:145], v3 offset:16384
    ds_read_b64_tr_b16 v[146:147], v3 offset:17408
    ds_read_b64_tr_b16 v[148:149], v4 offset:16384
    ds_read_b64_tr_b16 v[150:151], v4 offset:17408
    ds_read_b128 v[96:99], v1 offset:8192
    v_mfma_f32_16x16x32_bf16 v[32:35], v[136:139], v[80:83], v[32:35]
    ds_read_b128 v[100:103], v1 offset:10240
    v_mfma_f32_16x16x32_bf16 v[36:39], v[140:143], v[80:83], v[36:39]
    ds_read_b128 v[104:107], v1 offset:12288
    v_mfma_f32_16x16x32_bf16 v[40:43], v[136:139], v[84:87], v[40:43]
    ds_read_b128 v[108:111], v1 offset:14336
    v_mfma_f32_16x16x32_bf16 v[44:47], v[140:143], v[84:87], v[44:47]
    v_mfma_f32_16x16x32_bf16 v[48:51], v[136:139], v[88:91], v[48:51]
    ds_read_b64_tr_b16 v[152:153], v3 offset:24576
    v_mfma_f32_16x16x32_bf16 v[52:55], v[140:143], v[88:91], v[52:55]
    ds_read_b64_tr_b16 v[154:155], v3 offset:25600
    v_mfma_f32_16x16x32_bf16 v[56:59], v[136:139], v[92:95], v[56:59]
    ds_read_b64_tr_b16 v[156:157], v4 offset:24576
    v_mfma_f32_16x16x32_bf16 v[60:63], v[140:143], v[92:95], v[60:63]
    ds_read_b64_tr_b16 v[158:159], v4 offset:25600
    s_waitcnt lgkmcnt(7)
    v_mfma_f32_16x16x32_bf16 v[32:35], v[144:147], v[96:99], v[32:35]
    ds_read_b128 v[112:115], v2 offset:8192
    v_mfma_f32_16x16x32_bf16 v[36:39], v[148:151], v[96:99], v[36:39]
    ds_read_b128 v[116:119], v2 offset:10240
    s_waitcnt lgkmcnt(8)
    v_mfma_f32_16x16x32_bf16 v[40:43], v[144:147], v[100:103], v[40:43]
    ds_read_b128 v[120:123], v2 offset:12288
    v_mfma_f32_16x16x32_bf16 v[44:47], v[148:151], v[100:103], v[44:47]
    ds_read_b128 v[124:127], v2 offset:14336
    s_waitcnt lgkmcnt(9)
    v_mfma_f32_16x16x32_bf16 v[48:51], v[144:147], v[104:107], v[48:51]
    v_mfma_f32_16x16x32_bf16 v[52:55], v[148:151], v[104:107], v[52:55]
    s_waitcnt lgkmcnt(8)
    v_mfma_f32_16x16x32_bf16 v[56:59], v[144:147], v[108:111], v[56:59]
    v_mfma_f32_16x16x32_bf16 v[60:63], v[148:151], v[108:111], v[60:63]
    s_waitcnt lgkmcnt(0)
    s_barrier
    ds_read_b64_tr_b16 v[128:129], v3 offset:32768
    ds_read_b64_tr_b16 v[130:131], v3 offset:33792
    ds_read_b64_tr_b16 v[132:133], v4 offset:32768
    ds_read_b64_tr_b16 v[134:135], v4 offset:33792
    ds_read_b128 v[64:67], v1 offset:16384
    v_mfma_f32_16x16x32_bf16 v[32:35], v[152:155], v[112:115], v[32:35]
    ds_read_b128 v[68:71], v1 offset:18432
    v_mfma_f32_16x16x32_bf16 v[36:39], v[156:159], v[112:115], v[36:39]
    ds_read_b128 v[72:75], v1 offset:20480
    v_mfma_f32_16x16x32_bf16 v[40:43], v[152:155], v[116:119], v[40:43]
    ds_read_b128 v[76:79], v1 offset:22528
    v_mfma_f32_16x16x32_bf16 v[44:47], v[156:159], v[116:119], v[44:47]
    v_mfma_f32_16x16x32_bf16 v[48:51], v[152:155], v[120:123], v[48:51]
    ds_read_b64_tr_b16 v[136:137], v3 offset:40960
    v_mfma_f32_16x16x32_bf16 v[52:55], v[156:159], v[120:123], v[52:55]
    ds_read_b64_tr_b16 v[138:139], v3 offset:41984
    v_mfma_f32_16x16x32_bf16 v[56:59], v[152:155], v[124:127], v[56:59]
    ds_read_b64_tr_b16 v[140:141], v4 offset:40960
    v_mfma_f32_16x16x32_bf16 v[60:63], v[156:159], v[124:127], v[60:63]
    ds_read_b64_tr_b16 v[142:143], v4 offset:41984
    s_waitcnt lgkmcnt(7)
    v_mfma_f32_16x16x32_bf16 v[32:35], v[128:131], v[64:67], v[32:35]
    ds_read_b128 v[80:83], v2 offset:16384
    v_mfma_f32_16x16x32_bf16 v[36:39], v[132:135], v[64:67], v[36:39]
    ds_read_b128 v[84:87], v2 offset:18432
    s_waitcnt lgkmcnt(8)
    v_mfma_f32_16x16x32_bf16 v[40:43], v[128:131], v[68:71], v[40:43]
    ds_read_b128 v[88:91], v2 offset:20480
    v_mfma_f32_16x16x32_bf16 v[44:47], v[132:135], v[68:71], v[44:47]
    ds_read_b128 v[92:95], v2 offset:22528
    s_waitcnt lgkmcnt(9)
    v_mfma_f32_16x16x32_bf16 v[48:51], v[128:131], v[72:75], v[48:51]
    v_mfma_f32_16x16x32_bf16 v[52:55], v[132:135], v[72:75], v[52:55]
    s_waitcnt lgkmcnt(8)
    v_mfma_f32_16x16x32_bf16 v[56:59], v[128:131], v[76:79], v[56:59]
    v_mfma_f32_16x16x32_bf16 v[60:63], v[132:135], v[76:79], v[60:63]
    s_waitcnt lgkmcnt(0)
    s_barrier
    ds_read_b64_tr_b16 v[144:145], v3 offset:49152
    ds_read_b64_tr_b16 v[146:147], v3 offset:50176
    ds_read_b64_tr_b16 v[148:149], v4 offset:49152
    ds_read_b64_tr_b16 v[150:151], v4 offset:50176
    ds_read_b128 v[96:99], v1 offset:24576
    v_mfma_f32_16x16x32_bf16 v[32:35], v[136:139], v[80:83], v[32:35]
    ds_read_b128 v[100:103], v1 offset:26624
    v_mfma_f32_16x16x32_bf16 v[36:39], v[140:143], v[80:83], v[36:39]
    ds_read_b128 v[104:107], v1 offset:28672
    v_mfma_f32_16x16x32_bf16 v[40:43], v[136:139], v[84:87], v[40:43]
    ds_read_b128 v[108:111], v1 offset:30720
    v_mfma_f32_16x16x32_bf16 v[44:47], v[140:143], v[84:87], v[44:47]
    v_mfma_f32_16x16x32_bf16 v[48:51], v[136:139], v[88:91], v[48:51]
    ds_read_b64_tr_b16 v[152:153], v3 offset:57344
    v_mfma_f32_16x16x32_bf16 v[52:55], v[140:143], v[88:91], v[52:55]
    ds_read_b64_tr_b16 v[154:155], v3 offset:58368
    v_mfma_f32_16x16x32_bf16 v[56:59], v[136:139], v[92:95], v[56:59]
    ds_read_b64_tr_b16 v[156:157], v4 offset:57344
    v_mfma_f32_16x16x32_bf16 v[60:63], v[140:143], v[92:95], v[60:63]
    ds_read_b64_tr_b16 v[158:159], v4 offset:58368
    s_waitcnt lgkmcnt(7)
    v_mfma_f32_16x16x32_bf16 v[32:35], v[144:147], v[96:99], v[32:35]
    ds_read_b128 v[112:115], v2 offset:24576
    v_mfma_f32_16x16x32_bf16 v[36:39], v[148:151], v[96:99], v[36:39]
    ds_read_b128 v[116:119], v2 offset:26624
    s_waitcnt lgkmcnt(8)
    v_mfma_f32_16x16x32_bf16 v[40:43], v[144:147], v[100:103], v[40:43]
    ds_read_b128 v[120:123], v2 offset:28672
    v_mfma_f32_16x16x32_bf16 v[44:47], v[148:151], v[100:103], v[44:47]
    ds_read_b128 v[124:127], v2 offset:30720
    s_waitcnt lgkmcnt(9)
    v_mfma_f32_16x16x32_bf16 v[48:51], v[144:147], v[104:107], v[48:51]
    v_mfma_f32_16x16x32_bf16 v[52:55], v[148:151], v[104:107], v[52:55]
    s_waitcnt lgkmcnt(8)
    v_mfma_f32_16x16x32_bf16 v[56:59], v[144:147], v[108:111], v[56:59]
    v_mfma_f32_16x16x32_bf16 v[60:63], v[148:151], v[108:111], v[60:63]
    s_waitcnt lgkmcnt(0)
    s_barrier
    ds_read_b64_tr_b16 v[128:129], v5 offset:0
    ds_read_b64_tr_b16 v[130:131], v5 offset:1024
    ds_read_b64_tr_b16 v[132:133], v6 offset:0
    ds_read_b64_tr_b16 v[134:135], v6 offset:1024
    ds_read_b128 v[64:67], v1 offset:0
    v_mfma_f32_16x16x32_bf16 v[32:35], v[152:155], v[112:115], v[32:35]
    ds_read_b128 v[68:71], v1 offset:2048
    v_mfma_f32_16x16x32_bf16 v[36:39], v[156:159], v[112:115], v[36:39]
    ds_read_b128 v[72:75], v1 offset:4096
    v_mfma_f32_16x16x32_bf16 v[40:43], v[152:155], v[116:119], v[40:43]
    ds_read_b128 v[76:79], v1 offset:6144
    v_mfma_f32_16x16x32_bf16 v[44:47], v[156:159], v[116:119], v[44:47]
    v_mfma_f32_16x16x32_bf16 v[48:51], v[152:155], v[120:123], v[48:51]
    ds_read_b64_tr_b16 v[136:137], v5 offset:8192
    v_mfma_f32_16x16x32_bf16 v[52:55], v[156:159], v[120:123], v[52:55]
    ds_read_b64_tr_b16 v[138:139], v5 offset:9216
    v_mfma_f32_16x16x32_bf16 v[56:59], v[152:155], v[124:127], v[56:59]
    ds_read_b64_tr_b16 v[140:141], v6 offset:8192
    v_mfma_f32_16x16x32_bf16 v[60:63], v[156:159], v[124:127], v[60:63]
    ds_read_b64_tr_b16 v[142:143], v6 offset:9216
    s_waitcnt lgkmcnt(7)
    v_mfma_f32_16x16x32_bf16 v[32:35], v[128:131], v[64:67], v[32:35]
    ds_read_b128 v[80:83], v2 offset:0
    v_mfma_f32_16x16x32_bf16 v[36:39], v[132:135], v[64:67], v[36:39]
    ds_read_b128 v[84:87], v2 offset:2048
    s_waitcnt lgkmcnt(8)
    v_mfma_f32_16x16x32_bf16 v[40:43], v[128:131], v[68:71], v[40:43]
    ds_read_b128 v[88:91], v2 offset:4096
    v_mfma_f32_16x16x32_bf16 v[44:47], v[132:135], v[68:71], v[44:47]
    ds_read_b128 v[92:95], v2 offset:6144
    s_waitcnt lgkmcnt(9)
    v_mfma_f32_16x16x32_bf16 v[48:51], v[128:131], v[72:75], v[48:51]
    v_mfma_f32_16x16x32_bf16 v[52:55], v[132:135], v[72:75], v[52:55]
    s_waitcnt lgkmcnt(8)
    v_mfma_f32_16x16x32_bf16 v[56:59], v[128:131], v[76:79], v[56:59]
    v_mfma_f32_16x16x32_bf16 v[60:63], v[132:135], v[76:79], v[60:63]
    s_waitcnt lgkmcnt(0)
    s_barrier
    ds_read_b64_tr_b16 v[144:145], v5 offset:16384
    ds_read_b64_tr_b16 v[146:147], v5 offset:17408
    ds_read_b64_tr_b16 v[148:149], v6 offset:16384
    ds_read_b64_tr_b16 v[150:151], v6 offset:17408
    ds_read_b128 v[96:99], v1 offset:8192
    v_mfma_f32_16x16x32_bf16 v[32:35], v[136:139], v[80:83], v[32:35]
    ds_read_b128 v[100:103], v1 offset:10240
    v_mfma_f32_16x16x32_bf16 v[36:39], v[140:143], v[80:83], v[36:39]
    ds_read_b128 v[104:107], v1 offset:12288
    v_mfma_f32_16x16x32_bf16 v[40:43], v[136:139], v[84:87], v[40:43]
    ds_read_b128 v[108:111], v1 offset:14336
    v_mfma_f32_16x16x32_bf16 v[44:47], v[140:143], v[84:87], v[44:47]
    v_mfma_f32_16x16x32_bf16 v[48:51], v[136:139], v[88:91], v[48:51]
    ds_read_b64_tr_b16 v[152:153], v5 offset:24576
    v_mfma_f32_16x16x32_bf16 v[52:55], v[140:143], v[88:91], v[52:55]
    ds_read_b64_tr_b16 v[154:155], v5 offset:25600
    v_mfma_f32_16x16x32_bf16 v[56:59], v[136:139], v[92:95], v[56:59]
    ds_read_b64_tr_b16 v[156:157], v6 offset:24576
    v_mfma_f32_16x16x32_bf16 v[60:63], v[140:143], v[92:95], v[60:63]
    ds_read_b64_tr_b16 v[158:159], v6 offset:25600
    s_waitcnt lgkmcnt(7)
    v_mfma_f32_16x16x32_bf16 v[32:35], v[144:147], v[96:99], v[32:35]
    ds_read_b128 v[112:115], v2 offset:8192
    v_mfma_f32_16x16x32_bf16 v[36:39], v[148:151], v[96:99], v[36:39]
    ds_read_b128 v[116:119], v2 offset:10240
    s_waitcnt lgkmcnt(8)
    v_mfma_f32_16x16x32_bf16 v[40:43], v[144:147], v[100:103], v[40:43]
    ds_read_b128 v[120:123], v2 offset:12288
    v_mfma_f32_16x16x32_bf16 v[44:47], v[148:151], v[100:103], v[44:47]
    ds_read_b128 v[124:127], v2 offset:14336
    s_waitcnt lgkmcnt(9)
    v_mfma_f32_16x16x32_bf16 v[48:51], v[144:147], v[104:107], v[48:51]
    v_mfma_f32_16x16x32_bf16 v[52:55], v[148:151], v[104:107], v[52:55]
    s_waitcnt lgkmcnt(8)
    v_mfma_f32_16x16x32_bf16 v[56:59], v[144:147], v[108:111], v[56:59]
    v_mfma_f32_16x16x32_bf16 v[60:63], v[148:151], v[108:111], v[60:63]
    s_waitcnt lgkmcnt(0)
    s_barrier
    ds_read_b64_tr_b16 v[128:129], v5 offset:32768
    ds_read_b64_tr_b16 v[130:131], v5 offset:33792
    ds_read_b64_tr_b16 v[132:133], v6 offset:32768
    ds_read_b64_tr_b16 v[134:135], v6 offset:33792
    ds_read_b128 v[64:67], v1 offset:16384
    v_mfma_f32_16x16x32_bf16 v[32:35], v[152:155], v[112:115], v[32:35]
    ds_read_b128 v[68:71], v1 offset:18432
    v_mfma_f32_16x16x32_bf16 v[36:39], v[156:159], v[112:115], v[36:39]
    ds_read_b128 v[72:75], v1 offset:20480
    v_mfma_f32_16x16x32_bf16 v[40:43], v[152:155], v[116:119], v[40:43]
    ds_read_b128 v[76:79], v1 offset:22528
    v_mfma_f32_16x16x32_bf16 v[44:47], v[156:159], v[116:119], v[44:47]
    v_mfma_f32_16x16x32_bf16 v[48:51], v[152:155], v[120:123], v[48:51]
    ds_read_b64_tr_b16 v[136:137], v5 offset:40960
    v_mfma_f32_16x16x32_bf16 v[52:55], v[156:159], v[120:123], v[52:55]
    ds_read_b64_tr_b16 v[138:139], v5 offset:41984
    v_mfma_f32_16x16x32_bf16 v[56:59], v[152:155], v[124:127], v[56:59]
    ds_read_b64_tr_b16 v[140:141], v6 offset:40960
    v_mfma_f32_16x16x32_bf16 v[60:63], v[156:159], v[124:127], v[60:63]
    ds_read_b64_tr_b16 v[142:143], v6 offset:41984
    s_waitcnt lgkmcnt(7)
    v_mfma_f32_16x16x32_bf16 v[32:35], v[128:131], v[64:67], v[32:35]
    ds_read_b128 v[80:83], v2 offset:16384
    v_mfma_f32_16x16x32_bf16 v[36:39], v[132:135], v[64:67], v[36:39]
    ds_read_b128 v[84:87], v2 offset:18432
    s_waitcnt lgkmcnt(8)
    v_mfma_f32_16x16x32_bf16 v[40:43], v[128:131], v[68:71], v[40:43]
    ds_read_b128 v[88:91], v2 offset:20480
    v_mfma_f32_16x16x32_bf16 v[44:47], v[132:135], v[68:71], v[44:47]
    ds_read_b128 v[92:95], v2 offset:22528
    s_waitcnt lgkmcnt(9)
    v_mfma_f32_16x16x32_bf16 v[48:51], v[128:131], v[72:75], v[48:51]
    v_mfma_f32_16x16x32_bf16 v[52:55], v[132:135], v[72:75], v[52:55]
    s_waitcnt lgkmcnt(8)
    v_mfma_f32_16x16x32_bf16 v[56:59], v[128:131], v[76:79], v[56:59]
    v_mfma_f32_16x16x32_bf16 v[60:63], v[132:135], v[76:79], v[60:63]
    s_waitcnt lgkmcnt(0)
    s_barrier
    ds_read_b64_tr_b16 v[144:145], v5 offset:49152
    ds_read_b64_tr_b16 v[146:147], v5 offset:50176
    ds_read_b64_tr_b16 v[148:149], v6 offset:49152
    ds_read_b64_tr_b16 v[150:151], v6 offset:50176
    ds_read_b128 v[96:99], v1 offset:24576
    v_mfma_f32_16x16x32_bf16 v[32:35], v[136:139], v[80:83], v[32:35]
    ds_read_b128 v[100:103], v1 offset:26624
    v_mfma_f32_16x16x32_bf16 v[36:39], v[140:143], v[80:83], v[36:39]
    ds_read_b128 v[104:107], v1 offset:28672
    v_mfma_f32_16x16x32_bf16 v[40:43], v[136:139], v[84:87], v[40:43]
    ds_read_b128 v[108:111], v1 offset:30720
    v_mfma_f32_16x16x32_bf16 v[44:47], v[140:143], v[84:87], v[44:47]
    v_mfma_f32_16x16x32_bf16 v[48:51], v[136:139], v[88:91], v[48:51]
    ds_read_b64_tr_b16 v[152:153], v5 offset:57344
    v_mfma_f32_16x16x32_bf16 v[52:55], v[140:143], v[88:91], v[52:55]
    ds_read_b64_tr_b16 v[154:155], v5 offset:58368
    v_mfma_f32_16x16x32_bf16 v[56:59], v[136:139], v[92:95], v[56:59]
    ds_read_b64_tr_b16 v[156:157], v6 offset:57344
    v_mfma_f32_16x16x32_bf16 v[60:63], v[140:143], v[92:95], v[60:63]
    ds_read_b64_tr_b16 v[158:159], v6 offset:58368
    s_waitcnt lgkmcnt(7)
    v_mfma_f32_16x16x32_bf16 v[32:35], v[144:147], v[96:99], v[32:35]
    ds_read_b128 v[112:115], v2 offset:24576
    v_mfma_f32_16x16x32_bf16 v[36:39], v[148:151], v[96:99], v[36:39]
    ds_read_b128 v[116:119], v2 offset:26624
    s_waitcnt lgkmcnt(8)
    v_mfma_f32_16x16x32_bf16 v[40:43], v[144:147], v[100:103], v[40:43]
    ds_read_b128 v[120:123], v2 offset:28672
    v_mfma_f32_16x16x32_bf16 v[44:47], v[148:151], v[100:103], v[44:47]
    ds_read_b128 v[124:127], v2 offset:30720
    s_waitcnt lgkmcnt(9)
    v_mfma_f32_16x16x32_bf16 v[48:51], v[144:147], v[104:107], v[48:51]
    v_mfma_f32_16x16x32_bf16 v[52:55], v[148:151], v[104:107], v[52:55]
    s_waitcnt lgkmcnt(8)
    v_mfma_f32_16x16x32_bf16 v[56:59], v[144:147], v[108:111], v[56:59]
    v_mfma_f32_16x16x32_bf16 v[60:63], v[148:151], v[108:111], v[60:63]
    s_waitcnt lgkmcnt(0)
    s_barrier
    ds_read_b64_tr_b16 v[128:129], v3 offset:0
    ds_read_b64_tr_b16 v[130:131], v3 offset:1024
    ds_read_b64_tr_b16 v[132:133], v4 offset:0
    ds_read_b64_tr_b16 v[134:135], v4 offset:1024
    ds_read_b128 v[64:67], v1 offset:0
    v_mfma_f32_16x16x32_bf16 v[32:35], v[152:155], v[112:115], v[32:35]
    ds_read_b128 v[68:71], v1 offset:2048
    v_mfma_f32_16x16x32_bf16 v[36:39], v[156:159], v[112:115], v[36:39]
    ds_read_b128 v[72:75], v1 offset:4096
    v_mfma_f32_16x16x32_bf16 v[40:43], v[152:155], v[116:119], v[40:43]
    ds_read_b128 v[76:79], v1 offset:6144
    v_mfma_f32_16x16x32_bf16 v[44:47], v[156:159], v[116:119], v[44:47]
    v_mfma_f32_16x16x32_bf16 v[48:51], v[152:155], v[120:123], v[48:51]
    ds_read_b64_tr_b16 v[136:137], v3 offset:8192
    v_mfma_f32_16x16x32_bf16 v[52:55], v[156:159], v[120:123], v[52:55]
    ds_read_b64_tr_b16 v[138:139], v3 offset:9216
    v_mfma_f32_16x16x32_bf16 v[56:59], v[152:155], v[124:127], v[56:59]
    ds_read_b64_tr_b16 v[140:141], v4 offset:8192
    v_mfma_f32_16x16x32_bf16 v[60:63], v[156:159], v[124:127], v[60:63]
    ds_read_b64_tr_b16 v[142:143], v4 offset:9216
    s_waitcnt lgkmcnt(7)
    v_mfma_f32_16x16x32_bf16 v[32:35], v[128:131], v[64:67], v[32:35]
    ds_read_b128 v[80:83], v2 offset:0
    v_mfma_f32_16x16x32_bf16 v[36:39], v[132:135], v[64:67], v[36:39]
    ds_read_b128 v[84:87], v2 offset:2048
    s_waitcnt lgkmcnt(8)
    v_mfma_f32_16x16x32_bf16 v[40:43], v[128:131], v[68:71], v[40:43]
    ds_read_b128 v[88:91], v2 offset:4096
    v_mfma_f32_16x16x32_bf16 v[44:47], v[132:135], v[68:71], v[44:47]
    ds_read_b128 v[92:95], v2 offset:6144
    s_waitcnt lgkmcnt(9)
    v_mfma_f32_16x16x32_bf16 v[48:51], v[128:131], v[72:75], v[48:51]
    v_mfma_f32_16x16x32_bf16 v[52:55], v[132:135], v[72:75], v[52:55]
    s_waitcnt lgkmcnt(8)
    v_mfma_f32_16x16x32_bf16 v[56:59], v[128:131], v[76:79], v[56:59]
    v_mfma_f32_16x16x32_bf16 v[60:63], v[132:135], v[76:79], v[60:63]
    s_waitcnt lgkmcnt(0)
    s_barrier
    ds_read_b64_tr_b16 v[144:145], v3 offset:16384
    ds_read_b64_tr_b16 v[146:147], v3 offset:17408
    ds_read_b64_tr_b16 v[148:149], v4 offset:16384
    ds_read_b64_tr_b16 v[150:151], v4 offset:17408
    ds_read_b128 v[96:99], v1 offset:8192
    v_mfma_f32_16x16x32_bf16 v[32:35], v[136:139], v[80:83], v[32:35]
    ds_read_b128 v[100:103], v1 offset:10240
    v_mfma_f32_16x16x32_bf16 v[36:39], v[140:143], v[80:83], v[36:39]
    ds_read_b128 v[104:107], v1 offset:12288
    v_mfma_f32_16x16x32_bf16 v[40:43], v[136:139], v[84:87], v[40:43]
    ds_read_b128 v[108:111], v1 offset:14336
    v_mfma_f32_16x16x32_bf16 v[44:47], v[140:143], v[84:87], v[44:47]
    v_mfma_f32_16x16x32_bf16 v[48:51], v[136:139], v[88:91], v[48:51]
    ds_read_b64_tr_b16 v[152:153], v3 offset:24576
    v_mfma_f32_16x16x32_bf16 v[52:55], v[140:143], v[88:91], v[52:55]
    ds_read_b64_tr_b16 v[154:155], v3 offset:25600
    v_mfma_f32_16x16x32_bf16 v[56:59], v[136:139], v[92:95], v[56:59]
    ds_read_b64_tr_b16 v[156:157], v4 offset:24576
    v_mfma_f32_16x16x32_bf16 v[60:63], v[140:143], v[92:95], v[60:63]
    ds_read_b64_tr_b16 v[158:159], v4 offset:25600
    s_waitcnt lgkmcnt(7)
    v_mfma_f32_16x16x32_bf16 v[32:35], v[144:147], v[96:99], v[32:35]
    ds_read_b128 v[112:115], v2 offset:8192
    v_mfma_f32_16x16x32_bf16 v[36:39], v[148:151], v[96:99], v[36:39]
    ds_read_b128 v[116:119], v2 offset:10240
    s_waitcnt lgkmcnt(8)
    v_mfma_f32_16x16x32_bf16 v[40:43], v[144:147], v[100:103], v[40:43]
    ds_read_b128 v[120:123], v2 offset:12288
    v_mfma_f32_16x16x32_bf16 v[44:47], v[148:151], v[100:103], v[44:47]
    ds_read_b128 v[124:127], v2 offset:14336
    s_waitcnt lgkmcnt(9)
    v_mfma_f32_16x16x32_bf16 v[48:51], v[144:147], v[104:107], v[48:51]
    v_mfma_f32_16x16x32_bf16 v[52:55], v[148:151], v[104:107], v[52:55]
    s_waitcnt lgkmcnt(8)
    v_mfma_f32_16x16x32_bf16 v[56:59], v[144:147], v[108:111], v[56:59]
    v_mfma_f32_16x16x32_bf16 v[60:63], v[148:151], v[108:111], v[60:63]
    s_waitcnt lgkmcnt(0)
    s_barrier
    ds_read_b64_tr_b16 v[128:129], v3 offset:32768
    ds_read_b64_tr_b16 v[130:131], v3 offset:33792
    ds_read_b64_tr_b16 v[132:133], v4 offset:32768
    ds_read_b64_tr_b16 v[134:135], v4 offset:33792
    ds_read_b128 v[64:67], v1 offset:16384
    v_mfma_f32_16x16x32_bf16 v[32:35], v[152:155], v[112:115], v[32:35]
    ds_read_b128 v[68:71], v1 offset:18432
    v_mfma_f32_16x16x32_bf16 v[36:39], v[156:159], v[112:115], v[36:39]
    ds_read_b128 v[72:75], v1 offset:20480
    v_mfma_f32_16x16x32_bf16 v[40:43], v[152:155], v[116:119], v[40:43]
    ds_read_b128 v[76:79], v1 offset:22528
    v_mfma_f32_16x16x32_bf16 v[44:47], v[156:159], v[116:119], v[44:47]
    v_mfma_f32_16x16x32_bf16 v[48:51], v[152:155], v[120:123], v[48:51]
    ds_read_b64_tr_b16 v[136:137], v3 offset:40960
    v_mfma_f32_16x16x32_bf16 v[52:55], v[156:159], v[120:123], v[52:55]
    ds_read_b64_tr_b16 v[138:139], v3 offset:41984
    v_mfma_f32_16x16x32_bf16 v[56:59], v[152:155], v[124:127], v[56:59]
    ds_read_b64_tr_b16 v[140:141], v4 offset:40960
    v_mfma_f32_16x16x32_bf16 v[60:63], v[156:159], v[124:127], v[60:63]
    ds_read_b64_tr_b16 v[142:143], v4 offset:41984
    s_waitcnt lgkmcnt(7)
    v_mfma_f32_16x16x32_bf16 v[32:35], v[128:131], v[64:67], v[32:35]
    ds_read_b128 v[80:83], v2 offset:16384
    v_mfma_f32_16x16x32_bf16 v[36:39], v[132:135], v[64:67], v[36:39]
    ds_read_b128 v[84:87], v2 offset:18432
    s_waitcnt lgkmcnt(8)
    v_mfma_f32_16x16x32_bf16 v[40:43], v[128:131], v[68:71], v[40:43]
    ds_read_b128 v[88:91], v2 offset:20480
    v_mfma_f32_16x16x32_bf16 v[44:47], v[132:135], v[68:71], v[44:47]
    ds_read_b128 v[92:95], v2 offset:22528
    s_waitcnt lgkmcnt(9)
    v_mfma_f32_16x16x32_bf16 v[48:51], v[128:131], v[72:75], v[48:51]
    v_mfma_f32_16x16x32_bf16 v[52:55], v[132:135], v[72:75], v[52:55]
    s_waitcnt lgkmcnt(8)
    v_mfma_f32_16x16x32_bf16 v[56:59], v[128:131], v[76:79], v[56:59]
    v_mfma_f32_16x16x32_bf16 v[60:63], v[132:135], v[76:79], v[60:63]
    s_waitcnt lgkmcnt(0)
    s_barrier
    ds_read_b64_tr_b16 v[144:145], v3 offset:49152
    ds_read_b64_tr_b16 v[146:147], v3 offset:50176
    ds_read_b64_tr_b16 v[148:149], v4 offset:49152
    ds_read_b64_tr_b16 v[150:151], v4 offset:50176
    ds_read_b128 v[96:99], v1 offset:24576
    v_mfma_f32_16x16x32_bf16 v[32:35], v[136:139], v[80:83], v[32:35]
    ds_read_b128 v[100:103], v1 offset:26624
    v_mfma_f32_16x16x32_bf16 v[36:39], v[140:143], v[80:83], v[36:39]
    ds_read_b128 v[104:107], v1 offset:28672
    v_mfma_f32_16x16x32_bf16 v[40:43], v[136:139], v[84:87], v[40:43]
    ds_read_b128 v[108:111], v1 offset:30720
    v_mfma_f32_16x16x32_bf16 v[44:47], v[140:143], v[84:87], v[44:47]
    v_mfma_f32_16x16x32_bf16 v[48:51], v[136:139], v[88:91], v[48:51]
    ds_read_b64_tr_b16 v[152:153], v3 offset:57344
    v_mfma_f32_16x16x32_bf16 v[52:55], v[140:143], v[88:91], v[52:55]
    ds_read_b64_tr_b16 v[154:155], v3 offset:58368
    v_mfma_f32_16x16x32_bf16 v[56:59], v[136:139], v[92:95], v[56:59]
    ds_read_b64_tr_b16 v[156:157], v4 offset:57344
    v_mfma_f32_16x16x32_bf16 v[60:63], v[140:143], v[92:95], v[60:63]
    ds_read_b64_tr_b16 v[158:159], v4 offset:58368
    s_waitcnt lgkmcnt(7)
    v_mfma_f32_16x16x32_bf16 v[32:35], v[144:147], v[96:99], v[32:35]
    ds_read_b128 v[112:115], v2 offset:24576
    v_mfma_f32_16x16x32_bf16 v[36:39], v[148:151], v[96:99], v[36:39]
    ds_read_b128 v[116:119], v2 offset:26624
    s_waitcnt lgkmcnt(8)
    v_mfma_f32_16x16x32_bf16 v[40:43], v[144:147], v[100:103], v[40:43]
    ds_read_b128 v[120:123], v2 offset:28672
    v_mfma_f32_16x16x32_bf16 v[44:47], v[148:151], v[100:103], v[44:47]
    ds_read_b128 v[124:127], v2 offset:30720
    s_waitcnt lgkmcnt(9)
    v_mfma_f32_16x16x32_bf16 v[48:51], v[144:147], v[104:107], v[48:51]
    v_mfma_f32_16x16x32_bf16 v[52:55], v[148:151], v[104:107], v[52:55]
    s_waitcnt lgkmcnt(8)
    v_mfma_f32_16x16x32_bf16 v[56:59], v[144:147], v[108:111], v[56:59]
    v_mfma_f32_16x16x32_bf16 v[60:63], v[148:151], v[108:111], v[60:63]
    s_waitcnt lgkmcnt(0)
    s_barrier
    ds_read_b64_tr_b16 v[128:129], v5 offset:0
    ds_read_b64_tr_b16 v[130:131], v5 offset:1024
    ds_read_b64_tr_b16 v[132:133], v6 offset:0
    ds_read_b64_tr_b16 v[134:135], v6 offset:1024
    ds_read_b128 v[64:67], v1 offset:0
    v_mfma_f32_16x16x32_bf16 v[32:35], v[152:155], v[112:115], v[32:35]
    ds_read_b128 v[68:71], v1 offset:2048
    v_mfma_f32_16x16x32_bf16 v[36:39], v[156:159], v[112:115], v[36:39]
    ds_read_b128 v[72:75], v1 offset:4096
    v_mfma_f32_16x16x32_bf16 v[40:43], v[152:155], v[116:119], v[40:43]
    ds_read_b128 v[76:79], v1 offset:6144
    v_mfma_f32_16x16x32_bf16 v[44:47], v[156:159], v[116:119], v[44:47]
    v_mfma_f32_16x16x32_bf16 v[48:51], v[152:155], v[120:123], v[48:51]
    ds_read_b64_tr_b16 v[136:137], v5 offset:8192
    v_mfma_f32_16x16x32_bf16 v[52:55], v[156:159], v[120:123], v[52:55]
    ds_read_b64_tr_b16 v[138:139], v5 offset:9216
    v_mfma_f32_16x16x32_bf16 v[56:59], v[152:155], v[124:127], v[56:59]
    ds_read_b64_tr_b16 v[140:141], v6 offset:8192
    v_mfma_f32_16x16x32_bf16 v[60:63], v[156:159], v[124:127], v[60:63]
    ds_read_b64_tr_b16 v[142:143], v6 offset:9216
    s_waitcnt lgkmcnt(7)
    v_mfma_f32_16x16x32_bf16 v[32:35], v[128:131], v[64:67], v[32:35]
    ds_read_b128 v[80:83], v2 offset:0
    v_mfma_f32_16x16x32_bf16 v[36:39], v[132:135], v[64:67], v[36:39]
    ds_read_b128 v[84:87], v2 offset:2048
    s_waitcnt lgkmcnt(8)
    v_mfma_f32_16x16x32_bf16 v[40:43], v[128:131], v[68:71], v[40:43]
    ds_read_b128 v[88:91], v2 offset:4096
    v_mfma_f32_16x16x32_bf16 v[44:47], v[132:135], v[68:71], v[44:47]
    ds_read_b128 v[92:95], v2 offset:6144
    s_waitcnt lgkmcnt(9)
    v_mfma_f32_16x16x32_bf16 v[48:51], v[128:131], v[72:75], v[48:51]
    v_mfma_f32_16x16x32_bf16 v[52:55], v[132:135], v[72:75], v[52:55]
    s_waitcnt lgkmcnt(8)
    v_mfma_f32_16x16x32_bf16 v[56:59], v[128:131], v[76:79], v[56:59]
    v_mfma_f32_16x16x32_bf16 v[60:63], v[132:135], v[76:79], v[60:63]
    s_waitcnt lgkmcnt(0)
    s_barrier
    ds_read_b64_tr_b16 v[144:145], v5 offset:16384
    ds_read_b64_tr_b16 v[146:147], v5 offset:17408
    ds_read_b64_tr_b16 v[148:149], v6 offset:16384
    ds_read_b64_tr_b16 v[150:151], v6 offset:17408
    ds_read_b128 v[96:99], v1 offset:8192
    v_mfma_f32_16x16x32_bf16 v[32:35], v[136:139], v[80:83], v[32:35]
    ds_read_b128 v[100:103], v1 offset:10240
    v_mfma_f32_16x16x32_bf16 v[36:39], v[140:143], v[80:83], v[36:39]
    ds_read_b128 v[104:107], v1 offset:12288
    v_mfma_f32_16x16x32_bf16 v[40:43], v[136:139], v[84:87], v[40:43]
    ds_read_b128 v[108:111], v1 offset:14336
    v_mfma_f32_16x16x32_bf16 v[44:47], v[140:143], v[84:87], v[44:47]
    v_mfma_f32_16x16x32_bf16 v[48:51], v[136:139], v[88:91], v[48:51]
    ds_read_b64_tr_b16 v[152:153], v5 offset:24576
    v_mfma_f32_16x16x32_bf16 v[52:55], v[140:143], v[88:91], v[52:55]
    ds_read_b64_tr_b16 v[154:155], v5 offset:25600
    v_mfma_f32_16x16x32_bf16 v[56:59], v[136:139], v[92:95], v[56:59]
    ds_read_b64_tr_b16 v[156:157], v6 offset:24576
    v_mfma_f32_16x16x32_bf16 v[60:63], v[140:143], v[92:95], v[60:63]
    ds_read_b64_tr_b16 v[158:159], v6 offset:25600
    s_waitcnt lgkmcnt(7)
    v_mfma_f32_16x16x32_bf16 v[32:35], v[144:147], v[96:99], v[32:35]
    ds_read_b128 v[112:115], v2 offset:8192
    v_mfma_f32_16x16x32_bf16 v[36:39], v[148:151], v[96:99], v[36:39]
    ds_read_b128 v[116:119], v2 offset:10240
    s_waitcnt lgkmcnt(8)
    v_mfma_f32_16x16x32_bf16 v[40:43], v[144:147], v[100:103], v[40:43]
    ds_read_b128 v[120:123], v2 offset:12288
    v_mfma_f32_16x16x32_bf16 v[44:47], v[148:151], v[100:103], v[44:47]
    ds_read_b128 v[124:127], v2 offset:14336
    s_waitcnt lgkmcnt(9)
    v_mfma_f32_16x16x32_bf16 v[48:51], v[144:147], v[104:107], v[48:51]
    v_mfma_f32_16x16x32_bf16 v[52:55], v[148:151], v[104:107], v[52:55]
    s_waitcnt lgkmcnt(8)
    v_mfma_f32_16x16x32_bf16 v[56:59], v[144:147], v[108:111], v[56:59]
    v_mfma_f32_16x16x32_bf16 v[60:63], v[148:151], v[108:111], v[60:63]
    s_waitcnt lgkmcnt(0)
    s_barrier
    ds_read_b64_tr_b16 v[128:129], v5 offset:32768
    ds_read_b64_tr_b16 v[130:131], v5 offset:33792
    ds_read_b64_tr_b16 v[132:133], v6 offset:32768
    ds_read_b64_tr_b16 v[134:135], v6 offset:33792
    ds_read_b128 v[64:67], v1 offset:16384
    v_mfma_f32_16x16x32_bf16 v[32:35], v[152:155], v[112:115], v[32:35]
    ds_read_b128 v[68:71], v1 offset:18432
    v_mfma_f32_16x16x32_bf16 v[36:39], v[156:159], v[112:115], v[36:39]
    ds_read_b128 v[72:75], v1 offset:20480
    v_mfma_f32_16x16x32_bf16 v[40:43], v[152:155], v[116:119], v[40:43]
    ds_read_b128 v[76:79], v1 offset:22528
    v_mfma_f32_16x16x32_bf16 v[44:47], v[156:159], v[116:119], v[44:47]
    v_mfma_f32_16x16x32_bf16 v[48:51], v[152:155], v[120:123], v[48:51]
    ds_read_b64_tr_b16 v[136:137], v5 offset:40960
    v_mfma_f32_16x16x32_bf16 v[52:55], v[156:159], v[120:123], v[52:55]
    ds_read_b64_tr_b16 v[138:139], v5 offset:41984
    v_mfma_f32_16x16x32_bf16 v[56:59], v[152:155], v[124:127], v[56:59]
    ds_read_b64_tr_b16 v[140:141], v6 offset:40960
    v_mfma_f32_16x16x32_bf16 v[60:63], v[156:159], v[124:127], v[60:63]
    ds_read_b64_tr_b16 v[142:143], v6 offset:41984
    s_waitcnt lgkmcnt(7)
    v_mfma_f32_16x16x32_bf16 v[32:35], v[128:131], v[64:67], v[32:35]
    ds_read_b128 v[80:83], v2 offset:16384
    v_mfma_f32_16x16x32_bf16 v[36:39], v[132:135], v[64:67], v[36:39]
    ds_read_b128 v[84:87], v2 offset:18432
    s_waitcnt lgkmcnt(8)
    v_mfma_f32_16x16x32_bf16 v[40:43], v[128:131], v[68:71], v[40:43]
    ds_read_b128 v[88:91], v2 offset:20480
    v_mfma_f32_16x16x32_bf16 v[44:47], v[132:135], v[68:71], v[44:47]
    ds_read_b128 v[92:95], v2 offset:22528
    s_waitcnt lgkmcnt(9)
    v_mfma_f32_16x16x32_bf16 v[48:51], v[128:131], v[72:75], v[48:51]
    v_mfma_f32_16x16x32_bf16 v[52:55], v[132:135], v[72:75], v[52:55]
    s_waitcnt lgkmcnt(8)
    v_mfma_f32_16x16x32_bf16 v[56:59], v[128:131], v[76:79], v[56:59]
    v_mfma_f32_16x16x32_bf16 v[60:63], v[132:135], v[76:79], v[60:63]
    s_waitcnt lgkmcnt(0)
    s_barrier
    ds_read_b64_tr_b16 v[144:145], v5 offset:49152
    ds_read_b64_tr_b16 v[146:147], v5 offset:50176
    ds_read_b64_tr_b16 v[148:149], v6 offset:49152
    ds_read_b64_tr_b16 v[150:151], v6 offset:50176
    ds_read_b128 v[96:99], v1 offset:24576
    v_mfma_f32_16x16x32_bf16 v[32:35], v[136:139], v[80:83], v[32:35]
    ds_read_b128 v[100:103], v1 offset:26624
    v_mfma_f32_16x16x32_bf16 v[36:39], v[140:143], v[80:83], v[36:39]
    ds_read_b128 v[104:107], v1 offset:28672
    v_mfma_f32_16x16x32_bf16 v[40:43], v[136:139], v[84:87], v[40:43]
    ds_read_b128 v[108:111], v1 offset:30720
    v_mfma_f32_16x16x32_bf16 v[44:47], v[140:143], v[84:87], v[44:47]
    v_mfma_f32_16x16x32_bf16 v[48:51], v[136:139], v[88:91], v[48:51]
    ds_read_b64_tr_b16 v[152:153], v5 offset:57344
    v_mfma_f32_16x16x32_bf16 v[52:55], v[140:143], v[88:91], v[52:55]
    ds_read_b64_tr_b16 v[154:155], v5 offset:58368
    v_mfma_f32_16x16x32_bf16 v[56:59], v[136:139], v[92:95], v[56:59]
    ds_read_b64_tr_b16 v[156:157], v6 offset:57344
    v_mfma_f32_16x16x32_bf16 v[60:63], v[140:143], v[92:95], v[60:63]
    ds_read_b64_tr_b16 v[158:159], v6 offset:58368
    s_waitcnt lgkmcnt(7)
    v_mfma_f32_16x16x32_bf16 v[32:35], v[144:147], v[96:99], v[32:35]
    ds_read_b128 v[112:115], v2 offset:24576
    v_mfma_f32_16x16x32_bf16 v[36:39], v[148:151], v[96:99], v[36:39]
    ds_read_b128 v[116:119], v2 offset:26624
    s_waitcnt lgkmcnt(8)
    v_mfma_f32_16x16x32_bf16 v[40:43], v[144:147], v[100:103], v[40:43]
    ds_read_b128 v[120:123], v2 offset:28672
    v_mfma_f32_16x16x32_bf16 v[44:47], v[148:151], v[100:103], v[44:47]
    ds_read_b128 v[124:127], v2 offset:30720
    s_waitcnt lgkmcnt(9)
    v_mfma_f32_16x16x32_bf16 v[48:51], v[144:147], v[104:107], v[48:51]
    v_mfma_f32_16x16x32_bf16 v[52:55], v[148:151], v[104:107], v[52:55]
    s_waitcnt lgkmcnt(8)
    v_mfma_f32_16x16x32_bf16 v[56:59], v[144:147], v[108:111], v[56:59]
    v_mfma_f32_16x16x32_bf16 v[60:63], v[148:151], v[108:111], v[60:63]
    s_waitcnt lgkmcnt(0)
    s_barrier
    ds_read_b64_tr_b16 v[128:129], v3 offset:0
    ds_read_b64_tr_b16 v[130:131], v3 offset:1024
    ds_read_b64_tr_b16 v[132:133], v4 offset:0
    ds_read_b64_tr_b16 v[134:135], v4 offset:1024
    ds_read_b128 v[64:67], v1 offset:0
    v_mfma_f32_16x16x32_bf16 v[32:35], v[152:155], v[112:115], v[32:35]
    ds_read_b128 v[68:71], v1 offset:2048
    v_mfma_f32_16x16x32_bf16 v[36:39], v[156:159], v[112:115], v[36:39]
    ds_read_b128 v[72:75], v1 offset:4096
    v_mfma_f32_16x16x32_bf16 v[40:43], v[152:155], v[116:119], v[40:43]
    ds_read_b128 v[76:79], v1 offset:6144
    v_mfma_f32_16x16x32_bf16 v[44:47], v[156:159], v[116:119], v[44:47]
    v_mfma_f32_16x16x32_bf16 v[48:51], v[152:155], v[120:123], v[48:51]
    ds_read_b64_tr_b16 v[136:137], v3 offset:8192
    v_mfma_f32_16x16x32_bf16 v[52:55], v[156:159], v[120:123], v[52:55]
    ds_read_b64_tr_b16 v[138:139], v3 offset:9216
    v_mfma_f32_16x16x32_bf16 v[56:59], v[152:155], v[124:127], v[56:59]
    ds_read_b64_tr_b16 v[140:141], v4 offset:8192
    v_mfma_f32_16x16x32_bf16 v[60:63], v[156:159], v[124:127], v[60:63]
    ds_read_b64_tr_b16 v[142:143], v4 offset:9216
    s_waitcnt lgkmcnt(7)
    v_mfma_f32_16x16x32_bf16 v[32:35], v[128:131], v[64:67], v[32:35]
    ds_read_b128 v[80:83], v2 offset:0
    v_mfma_f32_16x16x32_bf16 v[36:39], v[132:135], v[64:67], v[36:39]
    ds_read_b128 v[84:87], v2 offset:2048
    s_waitcnt lgkmcnt(8)
    v_mfma_f32_16x16x32_bf16 v[40:43], v[128:131], v[68:71], v[40:43]
    ds_read_b128 v[88:91], v2 offset:4096
    v_mfma_f32_16x16x32_bf16 v[44:47], v[132:135], v[68:71], v[44:47]
    ds_read_b128 v[92:95], v2 offset:6144
    s_waitcnt lgkmcnt(9)
    v_mfma_f32_16x16x32_bf16 v[48:51], v[128:131], v[72:75], v[48:51]
    v_mfma_f32_16x16x32_bf16 v[52:55], v[132:135], v[72:75], v[52:55]
    s_waitcnt lgkmcnt(8)
    v_mfma_f32_16x16x32_bf16 v[56:59], v[128:131], v[76:79], v[56:59]
    v_mfma_f32_16x16x32_bf16 v[60:63], v[132:135], v[76:79], v[60:63]
    s_waitcnt lgkmcnt(0)
    s_barrier
    ds_read_b64_tr_b16 v[144:145], v3 offset:16384
    ds_read_b64_tr_b16 v[146:147], v3 offset:17408
    ds_read_b64_tr_b16 v[148:149], v4 offset:16384
    ds_read_b64_tr_b16 v[150:151], v4 offset:17408
    ds_read_b128 v[96:99], v1 offset:8192
    v_mfma_f32_16x16x32_bf16 v[32:35], v[136:139], v[80:83], v[32:35]
    ds_read_b128 v[100:103], v1 offset:10240
    v_mfma_f32_16x16x32_bf16 v[36:39], v[140:143], v[80:83], v[36:39]
    ds_read_b128 v[104:107], v1 offset:12288
    v_mfma_f32_16x16x32_bf16 v[40:43], v[136:139], v[84:87], v[40:43]
    ds_read_b128 v[108:111], v1 offset:14336
    v_mfma_f32_16x16x32_bf16 v[44:47], v[140:143], v[84:87], v[44:47]
    v_mfma_f32_16x16x32_bf16 v[48:51], v[136:139], v[88:91], v[48:51]
    ds_read_b64_tr_b16 v[152:153], v3 offset:24576
    v_mfma_f32_16x16x32_bf16 v[52:55], v[140:143], v[88:91], v[52:55]
    ds_read_b64_tr_b16 v[154:155], v3 offset:25600
    v_mfma_f32_16x16x32_bf16 v[56:59], v[136:139], v[92:95], v[56:59]
    ds_read_b64_tr_b16 v[156:157], v4 offset:24576
    v_mfma_f32_16x16x32_bf16 v[60:63], v[140:143], v[92:95], v[60:63]
    ds_read_b64_tr_b16 v[158:159], v4 offset:25600
    s_waitcnt lgkmcnt(7)
    v_mfma_f32_16x16x32_bf16 v[32:35], v[144:147], v[96:99], v[32:35]
    ds_read_b128 v[112:115], v2 offset:8192
    v_mfma_f32_16x16x32_bf16 v[36:39], v[148:151], v[96:99], v[36:39]
    ds_read_b128 v[116:119], v2 offset:10240
    s_waitcnt lgkmcnt(8)
    v_mfma_f32_16x16x32_bf16 v[40:43], v[144:147], v[100:103], v[40:43]
    ds_read_b128 v[120:123], v2 offset:12288
    v_mfma_f32_16x16x32_bf16 v[44:47], v[148:151], v[100:103], v[44:47]
    ds_read_b128 v[124:127], v2 offset:14336
    s_waitcnt lgkmcnt(9)
    v_mfma_f32_16x16x32_bf16 v[48:51], v[144:147], v[104:107], v[48:51]
    v_mfma_f32_16x16x32_bf16 v[52:55], v[148:151], v[104:107], v[52:55]
    s_waitcnt lgkmcnt(8)
    v_mfma_f32_16x16x32_bf16 v[56:59], v[144:147], v[108:111], v[56:59]
    v_mfma_f32_16x16x32_bf16 v[60:63], v[148:151], v[108:111], v[60:63]
    s_waitcnt lgkmcnt(0)
    s_barrier
    ds_read_b64_tr_b16 v[128:129], v3 offset:32768
    ds_read_b64_tr_b16 v[130:131], v3 offset:33792
    ds_read_b64_tr_b16 v[132:133], v4 offset:32768
    ds_read_b64_tr_b16 v[134:135], v4 offset:33792
    ds_read_b128 v[64:67], v1 offset:16384
    v_mfma_f32_16x16x32_bf16 v[32:35], v[152:155], v[112:115], v[32:35]
    ds_read_b128 v[68:71], v1 offset:18432
    v_mfma_f32_16x16x32_bf16 v[36:39], v[156:159], v[112:115], v[36:39]
    ds_read_b128 v[72:75], v1 offset:20480
    v_mfma_f32_16x16x32_bf16 v[40:43], v[152:155], v[116:119], v[40:43]
    ds_read_b128 v[76:79], v1 offset:22528
    v_mfma_f32_16x16x32_bf16 v[44:47], v[156:159], v[116:119], v[44:47]
    v_mfma_f32_16x16x32_bf16 v[48:51], v[152:155], v[120:123], v[48:51]
    ds_read_b64_tr_b16 v[136:137], v3 offset:40960
    v_mfma_f32_16x16x32_bf16 v[52:55], v[156:159], v[120:123], v[52:55]
    ds_read_b64_tr_b16 v[138:139], v3 offset:41984
    v_mfma_f32_16x16x32_bf16 v[56:59], v[152:155], v[124:127], v[56:59]
    ds_read_b64_tr_b16 v[140:141], v4 offset:40960
    v_mfma_f32_16x16x32_bf16 v[60:63], v[156:159], v[124:127], v[60:63]
    ds_read_b64_tr_b16 v[142:143], v4 offset:41984
    s_waitcnt lgkmcnt(7)
    v_mfma_f32_16x16x32_bf16 v[32:35], v[128:131], v[64:67], v[32:35]
    ds_read_b128 v[80:83], v2 offset:16384
    v_mfma_f32_16x16x32_bf16 v[36:39], v[132:135], v[64:67], v[36:39]
    ds_read_b128 v[84:87], v2 offset:18432
    s_waitcnt lgkmcnt(8)
    v_mfma_f32_16x16x32_bf16 v[40:43], v[128:131], v[68:71], v[40:43]
    ds_read_b128 v[88:91], v2 offset:20480
    v_mfma_f32_16x16x32_bf16 v[44:47], v[132:135], v[68:71], v[44:47]
    ds_read_b128 v[92:95], v2 offset:22528
    s_waitcnt lgkmcnt(9)
    v_mfma_f32_16x16x32_bf16 v[48:51], v[128:131], v[72:75], v[48:51]
    v_mfma_f32_16x16x32_bf16 v[52:55], v[132:135], v[72:75], v[52:55]
    s_waitcnt lgkmcnt(8)
    v_mfma_f32_16x16x32_bf16 v[56:59], v[128:131], v[76:79], v[56:59]
    v_mfma_f32_16x16x32_bf16 v[60:63], v[132:135], v[76:79], v[60:63]
    s_waitcnt lgkmcnt(0)
    s_barrier
    ds_read_b64_tr_b16 v[144:145], v3 offset:49152
    ds_read_b64_tr_b16 v[146:147], v3 offset:50176
    ds_read_b64_tr_b16 v[148:149], v4 offset:49152
    ds_read_b64_tr_b16 v[150:151], v4 offset:50176
    ds_read_b128 v[96:99], v1 offset:24576
    v_mfma_f32_16x16x32_bf16 v[32:35], v[136:139], v[80:83], v[32:35]
    ds_read_b128 v[100:103], v1 offset:26624
    v_mfma_f32_16x16x32_bf16 v[36:39], v[140:143], v[80:83], v[36:39]
    ds_read_b128 v[104:107], v1 offset:28672
    v_mfma_f32_16x16x32_bf16 v[40:43], v[136:139], v[84:87], v[40:43]
    ds_read_b128 v[108:111], v1 offset:30720
    v_mfma_f32_16x16x32_bf16 v[44:47], v[140:143], v[84:87], v[44:47]
    v_mfma_f32_16x16x32_bf16 v[48:51], v[136:139], v[88:91], v[48:51]
    ds_read_b64_tr_b16 v[152:153], v3 offset:57344
    v_mfma_f32_16x16x32_bf16 v[52:55], v[140:143], v[88:91], v[52:55]
    ds_read_b64_tr_b16 v[154:155], v3 offset:58368
    v_mfma_f32_16x16x32_bf16 v[56:59], v[136:139], v[92:95], v[56:59]
    ds_read_b64_tr_b16 v[156:157], v4 offset:57344
    v_mfma_f32_16x16x32_bf16 v[60:63], v[140:143], v[92:95], v[60:63]
    ds_read_b64_tr_b16 v[158:159], v4 offset:58368
    s_waitcnt lgkmcnt(7)
    v_mfma_f32_16x16x32_bf16 v[32:35], v[144:147], v[96:99], v[32:35]
    ds_read_b128 v[112:115], v2 offset:24576
    v_mfma_f32_16x16x32_bf16 v[36:39], v[148:151], v[96:99], v[36:39]
    ds_read_b128 v[116:119], v2 offset:26624
    s_waitcnt lgkmcnt(8)
    v_mfma_f32_16x16x32_bf16 v[40:43], v[144:147], v[100:103], v[40:43]
    ds_read_b128 v[120:123], v2 offset:28672
    v_mfma_f32_16x16x32_bf16 v[44:47], v[148:151], v[100:103], v[44:47]
    ds_read_b128 v[124:127], v2 offset:30720
    s_waitcnt lgkmcnt(9)
    v_mfma_f32_16x16x32_bf16 v[48:51], v[144:147], v[104:107], v[48:51]
    v_mfma_f32_16x16x32_bf16 v[52:55], v[148:151], v[104:107], v[52:55]
    s_waitcnt lgkmcnt(8)
    v_mfma_f32_16x16x32_bf16 v[56:59], v[144:147], v[108:111], v[56:59]
    v_mfma_f32_16x16x32_bf16 v[60:63], v[148:151], v[108:111], v[60:63]
    s_waitcnt lgkmcnt(0)
    s_barrier
    ds_read_b64_tr_b16 v[128:129], v5 offset:0
    ds_read_b64_tr_b16 v[130:131], v5 offset:1024
    ds_read_b64_tr_b16 v[132:133], v6 offset:0
    ds_read_b64_tr_b16 v[134:135], v6 offset:1024
    ds_read_b128 v[64:67], v1 offset:0
    v_mfma_f32_16x16x32_bf16 v[32:35], v[152:155], v[112:115], v[32:35]
    ds_read_b128 v[68:71], v1 offset:2048
    v_mfma_f32_16x16x32_bf16 v[36:39], v[156:159], v[112:115], v[36:39]
    ds_read_b128 v[72:75], v1 offset:4096
    v_mfma_f32_16x16x32_bf16 v[40:43], v[152:155], v[116:119], v[40:43]
    ds_read_b128 v[76:79], v1 offset:6144
    v_mfma_f32_16x16x32_bf16 v[44:47], v[156:159], v[116:119], v[44:47]
    v_mfma_f32_16x16x32_bf16 v[48:51], v[152:155], v[120:123], v[48:51]
    ds_read_b64_tr_b16 v[136:137], v5 offset:8192
    v_mfma_f32_16x16x32_bf16 v[52:55], v[156:159], v[120:123], v[52:55]
    ds_read_b64_tr_b16 v[138:139], v5 offset:9216
    v_mfma_f32_16x16x32_bf16 v[56:59], v[152:155], v[124:127], v[56:59]
    ds_read_b64_tr_b16 v[140:141], v6 offset:8192
    v_mfma_f32_16x16x32_bf16 v[60:63], v[156:159], v[124:127], v[60:63]
    ds_read_b64_tr_b16 v[142:143], v6 offset:9216
    s_waitcnt lgkmcnt(7)
    v_mfma_f32_16x16x32_bf16 v[32:35], v[128:131], v[64:67], v[32:35]
    ds_read_b128 v[80:83], v2 offset:0
    v_mfma_f32_16x16x32_bf16 v[36:39], v[132:135], v[64:67], v[36:39]
    ds_read_b128 v[84:87], v2 offset:2048
    s_waitcnt lgkmcnt(8)
    v_mfma_f32_16x16x32_bf16 v[40:43], v[128:131], v[68:71], v[40:43]
    ds_read_b128 v[88:91], v2 offset:4096
    v_mfma_f32_16x16x32_bf16 v[44:47], v[132:135], v[68:71], v[44:47]
    ds_read_b128 v[92:95], v2 offset:6144
    s_waitcnt lgkmcnt(9)
    v_mfma_f32_16x16x32_bf16 v[48:51], v[128:131], v[72:75], v[48:51]
    v_mfma_f32_16x16x32_bf16 v[52:55], v[132:135], v[72:75], v[52:55]
    s_waitcnt lgkmcnt(8)
    v_mfma_f32_16x16x32_bf16 v[56:59], v[128:131], v[76:79], v[56:59]
    v_mfma_f32_16x16x32_bf16 v[60:63], v[132:135], v[76:79], v[60:63]
    s_waitcnt lgkmcnt(0)
    s_barrier
    ds_read_b64_tr_b16 v[144:145], v5 offset:16384
    ds_read_b64_tr_b16 v[146:147], v5 offset:17408
    ds_read_b64_tr_b16 v[148:149], v6 offset:16384
    ds_read_b64_tr_b16 v[150:151], v6 offset:17408
    ds_read_b128 v[96:99], v1 offset:8192
    v_mfma_f32_16x16x32_bf16 v[32:35], v[136:139], v[80:83], v[32:35]
    ds_read_b128 v[100:103], v1 offset:10240
    v_mfma_f32_16x16x32_bf16 v[36:39], v[140:143], v[80:83], v[36:39]
    ds_read_b128 v[104:107], v1 offset:12288
    v_mfma_f32_16x16x32_bf16 v[40:43], v[136:139], v[84:87], v[40:43]
    ds_read_b128 v[108:111], v1 offset:14336
    v_mfma_f32_16x16x32_bf16 v[44:47], v[140:143], v[84:87], v[44:47]
    v_mfma_f32_16x16x32_bf16 v[48:51], v[136:139], v[88:91], v[48:51]
    ds_read_b64_tr_b16 v[152:153], v5 offset:24576
    v_mfma_f32_16x16x32_bf16 v[52:55], v[140:143], v[88:91], v[52:55]
    ds_read_b64_tr_b16 v[154:155], v5 offset:25600
    v_mfma_f32_16x16x32_bf16 v[56:59], v[136:139], v[92:95], v[56:59]
    ds_read_b64_tr_b16 v[156:157], v6 offset:24576
    v_mfma_f32_16x16x32_bf16 v[60:63], v[140:143], v[92:95], v[60:63]
    ds_read_b64_tr_b16 v[158:159], v6 offset:25600
    s_waitcnt lgkmcnt(7)
    v_mfma_f32_16x16x32_bf16 v[32:35], v[144:147], v[96:99], v[32:35]
    ds_read_b128 v[112:115], v2 offset:8192
    v_mfma_f32_16x16x32_bf16 v[36:39], v[148:151], v[96:99], v[36:39]
    ds_read_b128 v[116:119], v2 offset:10240
    s_waitcnt lgkmcnt(8)
    v_mfma_f32_16x16x32_bf16 v[40:43], v[144:147], v[100:103], v[40:43]
    ds_read_b128 v[120:123], v2 offset:12288
    v_mfma_f32_16x16x32_bf16 v[44:47], v[148:151], v[100:103], v[44:47]
    ds_read_b128 v[124:127], v2 offset:14336
    s_waitcnt lgkmcnt(9)
    v_mfma_f32_16x16x32_bf16 v[48:51], v[144:147], v[104:107], v[48:51]
    v_mfma_f32_16x16x32_bf16 v[52:55], v[148:151], v[104:107], v[52:55]
    s_waitcnt lgkmcnt(8)
    v_mfma_f32_16x16x32_bf16 v[56:59], v[144:147], v[108:111], v[56:59]
    v_mfma_f32_16x16x32_bf16 v[60:63], v[148:151], v[108:111], v[60:63]
    s_waitcnt lgkmcnt(0)
    s_barrier
    ds_read_b64_tr_b16 v[128:129], v5 offset:32768
    ds_read_b64_tr_b16 v[130:131], v5 offset:33792
    ds_read_b64_tr_b16 v[132:133], v6 offset:32768
    ds_read_b64_tr_b16 v[134:135], v6 offset:33792
    ds_read_b128 v[64:67], v1 offset:16384
    v_mfma_f32_16x16x32_bf16 v[32:35], v[152:155], v[112:115], v[32:35]
    ds_read_b128 v[68:71], v1 offset:18432
    v_mfma_f32_16x16x32_bf16 v[36:39], v[156:159], v[112:115], v[36:39]
    ds_read_b128 v[72:75], v1 offset:20480
    v_mfma_f32_16x16x32_bf16 v[40:43], v[152:155], v[116:119], v[40:43]
    ds_read_b128 v[76:79], v1 offset:22528
    v_mfma_f32_16x16x32_bf16 v[44:47], v[156:159], v[116:119], v[44:47]
    v_mfma_f32_16x16x32_bf16 v[48:51], v[152:155], v[120:123], v[48:51]
    ds_read_b64_tr_b16 v[136:137], v5 offset:40960
    v_mfma_f32_16x16x32_bf16 v[52:55], v[156:159], v[120:123], v[52:55]
    ds_read_b64_tr_b16 v[138:139], v5 offset:41984
    v_mfma_f32_16x16x32_bf16 v[56:59], v[152:155], v[124:127], v[56:59]
    ds_read_b64_tr_b16 v[140:141], v6 offset:40960
    v_mfma_f32_16x16x32_bf16 v[60:63], v[156:159], v[124:127], v[60:63]
    ds_read_b64_tr_b16 v[142:143], v6 offset:41984
    s_waitcnt lgkmcnt(7)
    v_mfma_f32_16x16x32_bf16 v[32:35], v[128:131], v[64:67], v[32:35]
    ds_read_b128 v[80:83], v2 offset:16384
    v_mfma_f32_16x16x32_bf16 v[36:39], v[132:135], v[64:67], v[36:39]
    ds_read_b128 v[84:87], v2 offset:18432
    s_waitcnt lgkmcnt(8)
    v_mfma_f32_16x16x32_bf16 v[40:43], v[128:131], v[68:71], v[40:43]
    ds_read_b128 v[88:91], v2 offset:20480
    v_mfma_f32_16x16x32_bf16 v[44:47], v[132:135], v[68:71], v[44:47]
    ds_read_b128 v[92:95], v2 offset:22528
    s_waitcnt lgkmcnt(9)
    v_mfma_f32_16x16x32_bf16 v[48:51], v[128:131], v[72:75], v[48:51]
    v_mfma_f32_16x16x32_bf16 v[52:55], v[132:135], v[72:75], v[52:55]
    s_waitcnt lgkmcnt(8)
    v_mfma_f32_16x16x32_bf16 v[56:59], v[128:131], v[76:79], v[56:59]
    v_mfma_f32_16x16x32_bf16 v[60:63], v[132:135], v[76:79], v[60:63]
    s_waitcnt lgkmcnt(0)
    s_barrier
    ds_read_b64_tr_b16 v[144:145], v5 offset:49152
    ds_read_b64_tr_b16 v[146:147], v5 offset:50176
    ds_read_b64_tr_b16 v[148:149], v6 offset:49152
    ds_read_b64_tr_b16 v[150:151], v6 offset:50176
    ds_read_b128 v[96:99], v1 offset:24576
    v_mfma_f32_16x16x32_bf16 v[32:35], v[136:139], v[80:83], v[32:35]
    ds_read_b128 v[100:103], v1 offset:26624
    v_mfma_f32_16x16x32_bf16 v[36:39], v[140:143], v[80:83], v[36:39]
    ds_read_b128 v[104:107], v1 offset:28672
    v_mfma_f32_16x16x32_bf16 v[40:43], v[136:139], v[84:87], v[40:43]
    ds_read_b128 v[108:111], v1 offset:30720
    v_mfma_f32_16x16x32_bf16 v[44:47], v[140:143], v[84:87], v[44:47]
    v_mfma_f32_16x16x32_bf16 v[48:51], v[136:139], v[88:91], v[48:51]
    ds_read_b64_tr_b16 v[152:153], v5 offset:57344
    v_mfma_f32_16x16x32_bf16 v[52:55], v[140:143], v[88:91], v[52:55]
    ds_read_b64_tr_b16 v[154:155], v5 offset:58368
    v_mfma_f32_16x16x32_bf16 v[56:59], v[136:139], v[92:95], v[56:59]
    ds_read_b64_tr_b16 v[156:157], v6 offset:57344
    v_mfma_f32_16x16x32_bf16 v[60:63], v[140:143], v[92:95], v[60:63]
    ds_read_b64_tr_b16 v[158:159], v6 offset:58368
    s_waitcnt lgkmcnt(7)
    v_mfma_f32_16x16x32_bf16 v[32:35], v[144:147], v[96:99], v[32:35]
    ds_read_b128 v[112:115], v2 offset:24576
    v_mfma_f32_16x16x32_bf16 v[36:39], v[148:151], v[96:99], v[36:39]
    ds_read_b128 v[116:119], v2 offset:26624
    s_waitcnt lgkmcnt(8)
    v_mfma_f32_16x16x32_bf16 v[40:43], v[144:147], v[100:103], v[40:43]
    ds_read_b128 v[120:123], v2 offset:28672
    v_mfma_f32_16x16x32_bf16 v[44:47], v[148:151], v[100:103], v[44:47]
    ds_read_b128 v[124:127], v2 offset:30720
    s_waitcnt lgkmcnt(9)
    v_mfma_f32_16x16x32_bf16 v[48:51], v[144:147], v[104:107], v[48:51]
    v_mfma_f32_16x16x32_bf16 v[52:55], v[148:151], v[104:107], v[52:55]
    s_waitcnt lgkmcnt(8)
    v_mfma_f32_16x16x32_bf16 v[56:59], v[144:147], v[108:111], v[56:59]
    v_mfma_f32_16x16x32_bf16 v[60:63], v[148:151], v[108:111], v[60:63]
    buffer_load_dwordx2 v[160:161], v9, s[36:39], s58 offen offset:0
    buffer_load_dwordx2 v[162:163], v9, s[36:39], s58 offen offset:32
    buffer_load_dword v175, v172, s[48:51], s59 offen offset:4 sc1
    s_add_u32 s60, s59, 0x10000
    buffer_load_dword v193, v172, s[48:51], s60 offen offset:4 sc1
    s_lshl_b32 s56, s52, 6
    s_add_u32 s56, s56, s53
    s_lshl_b32 s56, s56, 2
    s_mov_b64 exec, 1
    buffer_load_dword v173, off, s[44:47], s56 sc1
    s_mov_b64 exec, -1
    s_waitcnt lgkmcnt(0)
    s_barrier
    ds_read_b64_tr_b16 v[128:129], v3 offset:0
    ds_read_b64_tr_b16 v[130:131], v3 offset:1024
    ds_read_b64_tr_b16 v[132:133], v4 offset:0
    ds_read_b64_tr_b16 v[134:135], v4 offset:1024
    ds_read_b128 v[64:67], v1 offset:0
    v_mfma_f32_16x16x32_bf16 v[32:35], v[152:155], v[112:115], v[32:35]
    ds_read_b128 v[68:71], v1 offset:2048
    v_mfma_f32_16x16x32_bf16 v[36:39], v[156:159], v[112:115], v[36:39]
    ds_read_b128 v[72:75], v1 offset:4096
    v_mfma_f32_16x16x32_bf16 v[40:43], v[152:155], v[116:119], v[40:43]
    ds_read_b128 v[76:79], v1 offset:6144
    v_mfma_f32_16x16x32_bf16 v[44:47], v[156:159], v[116:119], v[44:47]
    v_mfma_f32_16x16x32_bf16 v[48:51], v[152:155], v[120:123], v[48:51]
    ds_read_b64_tr_b16 v[136:137], v3 offset:8192
    v_mfma_f32_16x16x32_bf16 v[52:55], v[156:159], v[120:123], v[52:55]
    ds_read_b64_tr_b16 v[138:139], v3 offset:9216
    v_mfma_f32_16x16x32_bf16 v[56:59], v[152:155], v[124:127], v[56:59]
    ds_read_b64_tr_b16 v[140:141], v4 offset:8192
    v_mfma_f32_16x16x32_bf16 v[60:63], v[156:159], v[124:127], v[60:63]
    ds_read_b64_tr_b16 v[142:143], v4 offset:9216
    s_waitcnt lgkmcnt(7)
    v_mfma_f32_16x16x32_bf16 v[32:35], v[128:131], v[64:67], v[32:35]
    ds_read_b128 v[80:83], v2 offset:0
    v_mfma_f32_16x16x32_bf16 v[36:39], v[132:135], v[64:67], v[36:39]
    ds_read_b128 v[84:87], v2 offset:2048
    s_waitcnt lgkmcnt(8)
    v_mfma_f32_16x16x32_bf16 v[40:43], v[128:131], v[68:71], v[40:43]
    ds_read_b128 v[88:91], v2 offset:4096
    v_mfma_f32_16x16x32_bf16 v[44:47], v[132:135], v[68:71], v[44:47]
    ds_read_b128 v[92:95], v2 offset:6144
    s_waitcnt lgkmcnt(9)
    v_mfma_f32_16x16x32_bf16 v[48:51], v[128:131], v[72:75], v[48:51]
    v_mfma_f32_16x16x32_bf16 v[52:55], v[132:135], v[72:75], v[52:55]
    s_waitcnt lgkmcnt(8)
    v_mfma_f32_16x16x32_bf16 v[56:59], v[128:131], v[76:79], v[56:59]
    v_mfma_f32_16x16x32_bf16 v[60:63], v[132:135], v[76:79], v[60:63]
    s_waitcnt lgkmcnt(0)
    s_barrier
    ds_read_b64_tr_b16 v[144:145], v3 offset:16384
    ds_read_b64_tr_b16 v[146:147], v3 offset:17408
    ds_read_b64_tr_b16 v[148:149], v4 offset:16384
    ds_read_b64_tr_b16 v[150:151], v4 offset:17408
    ds_read_b128 v[96:99], v1 offset:8192
    v_mfma_f32_16x16x32_bf16 v[32:35], v[136:139], v[80:83], v[32:35]
    ds_read_b128 v[100:103], v1 offset:10240
    v_mfma_f32_16x16x32_bf16 v[36:39], v[140:143], v[80:83], v[36:39]
    ds_read_b128 v[104:107], v1 offset:12288
    v_mfma_f32_16x16x32_bf16 v[40:43], v[136:139], v[84:87], v[40:43]
    ds_read_b128 v[108:111], v1 offset:14336
    v_mfma_f32_16x16x32_bf16 v[44:47], v[140:143], v[84:87], v[44:47]
    v_mfma_f32_16x16x32_bf16 v[48:51], v[136:139], v[88:91], v[48:51]
    ds_read_b64_tr_b16 v[152:153], v3 offset:24576
    v_mfma_f32_16x16x32_bf16 v[52:55], v[140:143], v[88:91], v[52:55]
    ds_read_b64_tr_b16 v[154:155], v3 offset:25600
    v_mfma_f32_16x16x32_bf16 v[56:59], v[136:139], v[92:95], v[56:59]
    ds_read_b64_tr_b16 v[156:157], v4 offset:24576
    v_mfma_f32_16x16x32_bf16 v[60:63], v[140:143], v[92:95], v[60:63]
    ds_read_b64_tr_b16 v[158:159], v4 offset:25600
    s_waitcnt lgkmcnt(7)
    v_mfma_f32_16x16x32_bf16 v[32:35], v[144:147], v[96:99], v[32:35]
    ds_read_b128 v[112:115], v2 offset:8192
    v_mfma_f32_16x16x32_bf16 v[36:39], v[148:151], v[96:99], v[36:39]
    ds_read_b128 v[116:119], v2 offset:10240
    s_waitcnt lgkmcnt(8)
    v_mfma_f32_16x16x32_bf16 v[40:43], v[144:147], v[100:103], v[40:43]
    ds_read_b128 v[120:123], v2 offset:12288
    v_mfma_f32_16x16x32_bf16 v[44:47], v[148:151], v[100:103], v[44:47]
    ds_read_b128 v[124:127], v2 offset:14336
    s_waitcnt lgkmcnt(9)
    v_mfma_f32_16x16x32_bf16 v[48:51], v[144:147], v[104:107], v[48:51]
    v_mfma_f32_16x16x32_bf16 v[52:55], v[148:151], v[104:107], v[52:55]
    s_waitcnt lgkmcnt(8)
    v_mfma_f32_16x16x32_bf16 v[56:59], v[144:147], v[108:111], v[56:59]
    v_mfma_f32_16x16x32_bf16 v[60:63], v[148:151], v[108:111], v[60:63]
    s_waitcnt lgkmcnt(0)
    v_mfma_f32_16x16x32_bf16 v[32:35], v[152:155], v[112:115], v[32:35]
    v_mfma_f32_16x16x32_bf16 v[36:39], v[156:159], v[112:115], v[36:39]
    v_mfma_f32_16x16x32_bf16 v[40:43], v[152:155], v[116:119], v[40:43]
    v_mfma_f32_16x16x32_bf16 v[44:47], v[156:159], v[116:119], v[44:47]
    v_mfma_f32_16x16x32_bf16 v[48:51], v[152:155], v[120:123], v[48:51]
    v_mfma_f32_16x16x32_bf16 v[52:55], v[156:159], v[120:123], v[52:55]
    v_mfma_f32_16x16x32_bf16 v[56:59], v[152:155], v[124:127], v[56:59]
    v_mfma_f32_16x16x32_bf16 v[60:63], v[156:159], v[124:127], v[60:63]
    s_waitcnt vmcnt(3)
    v_lshlrev_b32 v176, 16, v160
    v_and_b32 v177, s68, v160
    v_lshlrev_b32 v178, 16, v161
    v_and_b32 v179, s68, v161
    v_lshlrev_b32 v180, 16, v162
    v_and_b32 v181, s68, v162
    v_lshlrev_b32 v182, 16, v163
    v_and_b32 v183, s68, v163
    v_pk_mul_f32 v[64:65], v[32:33], v[32:33]
    v_pk_mul_f32 v[66:67], v[34:35], v[34:35]
    v_pk_mul_f32 v[68:69], v[36:37], v[36:37]
    v_pk_mul_f32 v[70:71], v[38:39], v[38:39]
    v_pk_mul_f32 v[72:73], v[40:41], v[40:41]
    v_pk_mul_f32 v[74:75], v[42:43], v[42:43]
    v_pk_mul_f32 v[76:77], v[44:45], v[44:45]
    v_pk_mul_f32 v[78:79], v[46:47], v[46:47]
    v_pk_fma_f32 v[64:65], v[64:65], v[14:15], v[12:13]
    v_pk_fma_f32 v[66:67], v[66:67], v[14:15], v[12:13]
    v_pk_fma_f32 v[68:69], v[68:69], v[14:15], v[12:13]
    v_pk_fma_f32 v[70:71], v[70:71], v[14:15], v[12:13]
    v_pk_fma_f32 v[72:73], v[72:73], v[14:15], v[12:13]
    v_pk_fma_f32 v[74:75], v[74:75], v[14:15], v[12:13]
    v_pk_fma_f32 v[76:77], v[76:77], v[14:15], v[12:13]
    v_pk_fma_f32 v[78:79], v[78:79], v[14:15], v[12:13]
    v_pk_mul_f32 v[64:65], v[64:65], v[32:33]
    v_pk_mul_f32 v[66:67], v[66:67], v[34:35]
    v_pk_mul_f32 v[68:69], v[68:69], v[36:37]
    v_pk_mul_f32 v[70:71], v[70:71], v[38:39]
    v_pk_mul_f32 v[72:73], v[72:73], v[40:41]
    v_pk_mul_f32 v[74:75], v[74:75], v[42:43]
    v_pk_mul_f32 v[76:77], v[76:77], v[44:45]
    v_pk_mul_f32 v[78:79], v[78:79], v[46:47]
    v_exp_f32 v64, v64
    v_exp_f32 v66, v66
    v_exp_f32 v68, v68
    v_exp_f32 v70, v70
    v_exp_f32 v72, v72
    v_exp_f32 v74, v74
    v_exp_f32 v76, v76
    v_exp_f32 v78, v78
    v_exp_f32 v65, v65
    v_exp_f32 v67, v67
    v_exp_f32 v69, v69
    v_exp_f32 v71, v71
    v_exp_f32 v73, v73
    v_exp_f32 v75, v75
    v_exp_f32 v77, v77
    v_exp_f32 v79, v79
    v_pk_mul_f32 v[32:33], v[32:33], v[176:177]
    v_pk_mul_f32 v[34:35], v[34:35], v[178:179]
    v_pk_mul_f32 v[36:37], v[36:37], v[180:181]
    v_pk_mul_f32 v[38:39], v[38:39], v[182:183]
    v_pk_mul_f32 v[40:41], v[40:41], v[176:177]
    v_pk_mul_f32 v[42:43], v[42:43], v[178:179]
    v_pk_mul_f32 v[44:45], v[44:45], v[180:181]
    v_pk_mul_f32 v[46:47], v[46:47], v[182:183]
    v_pk_add_f32 v[64:65], v[64:65], 1.0 op_sel_hi:[1,0]
    v_pk_add_f32 v[66:67], v[66:67], 1.0 op_sel_hi:[1,0]
    v_pk_add_f32 v[68:69], v[68:69], 1.0 op_sel_hi:[1,0]
    v_pk_add_f32 v[70:71], v[70:71], 1.0 op_sel_hi:[1,0]
    v_pk_add_f32 v[72:73], v[72:73], 1.0 op_sel_hi:[1,0]
    v_pk_add_f32 v[74:75], v[74:75], 1.0 op_sel_hi:[1,0]
    v_pk_add_f32 v[76:77], v[76:77], 1.0 op_sel_hi:[1,0]
    v_pk_add_f32 v[78:79], v[78:79], 1.0 op_sel_hi:[1,0]
    v_rcp_f32 v64, v64
    v_rcp_f32 v66, v66
    v_rcp_f32 v68, v68
    v_rcp_f32 v70, v70
    v_rcp_f32 v72, v72
    v_rcp_f32 v74, v74
    v_rcp_f32 v76, v76
    v_rcp_f32 v78, v78
    v_rcp_f32 v65, v65
    v_rcp_f32 v67, v67
    v_rcp_f32 v69, v69
    v_rcp_f32 v71, v71
    v_rcp_f32 v73, v73
    v_rcp_f32 v75, v75
    v_rcp_f32 v77, v77
    v_rcp_f32 v79, v79
    v_pk_mul_f32 v[164:165], v[32:33], v[64:65]
    v_pk_fma_f32 v[164:165], v[34:35], v[66:67], v[164:165]
    v_pk_fma_f32 v[164:165], v[36:37], v[68:69], v[164:165]
    v_pk_fma_f32 v[164:165], v[38:39], v[70:71], v[164:165]
    v_pk_mul_f32 v[166:167], v[40:41], v[72:73]
    v_pk_fma_f32 v[166:167], v[42:43], v[74:75], v[166:167]
    v_pk_fma_f32 v[166:167], v[44:45], v[76:77], v[166:167]
    v_pk_fma_f32 v[166:167], v[46:47], v[78:79], v[166:167]
    v_pk_mul_f32 v[64:65], v[48:49], v[48:49]
    v_pk_mul_f32 v[66:67], v[50:51], v[50:51]
    v_pk_mul_f32 v[68:69], v[52:53], v[52:53]
    v_pk_mul_f32 v[70:71], v[54:55], v[54:55]
    v_pk_mul_f32 v[72:73], v[56:57], v[56:57]
    v_pk_mul_f32 v[74:75], v[58:59], v[58:59]
    v_pk_mul_f32 v[76:77], v[60:61], v[60:61]
    v_pk_mul_f32 v[78:79], v[62:63], v[62:63]
    v_pk_fma_f32 v[64:65], v[64:65], v[14:15], v[12:13]
    v_pk_fma_f32 v[66:67], v[66:67], v[14:15], v[12:13]
    v_pk_fma_f32 v[68:69], v[68:69], v[14:15], v[12:13]
    v_pk_fma_f32 v[70:71], v[70:71], v[14:15], v[12:13]
    v_pk_fma_f32 v[72:73], v[72:73], v[14:15], v[12:13]
    v_pk_fma_f32 v[74:75], v[74:75], v[14:15], v[12:13]
    v_pk_fma_f32 v[76:77], v[76:77], v[14:15], v[12:13]
    v_pk_fma_f32 v[78:79], v[78:79], v[14:15], v[12:13]
    v_pk_mul_f32 v[64:65], v[64:65], v[48:49]
    v_pk_mul_f32 v[66:67], v[66:67], v[50:51]
    v_pk_mul_f32 v[68:69], v[68:69], v[52:53]
    v_pk_mul_f32 v[70:71], v[70:71], v[54:55]
    v_pk_mul_f32 v[72:73], v[72:73], v[56:57]
    v_pk_mul_f32 v[74:75], v[74:75], v[58:59]
    v_pk_mul_f32 v[76:77], v[76:77], v[60:61]
    v_pk_mul_f32 v[78:79], v[78:79], v[62:63]
    v_exp_f32 v64, v64
    v_exp_f32 v66, v66
    v_exp_f32 v68, v68
    v_exp_f32 v70, v70
    v_exp_f32 v72, v72
    v_exp_f32 v74, v74
    v_exp_f32 v76, v76
    v_exp_f32 v78, v78
    v_exp_f32 v65, v65
    v_exp_f32 v67, v67
    v_exp_f32 v69, v69
    v_exp_f32 v71, v71
    v_exp_f32 v73, v73
    v_exp_f32 v75, v75
    v_exp_f32 v77, v77
    v_exp_f32 v79, v79
    v_pk_mul_f32 v[48:49], v[48:49], v[176:177]
    v_pk_mul_f32 v[50:51], v[50:51], v[178:179]
    v_pk_mul_f32 v[52:53], v[52:53], v[180:181]
    v_pk_mul_f32 v[54:55], v[54:55], v[182:183]
    v_pk_mul_f32 v[56:57], v[56:57], v[176:177]
    v_pk_mul_f32 v[58:59], v[58:59], v[178:179]
    v_pk_mul_f32 v[60:61], v[60:61], v[180:181]
    v_pk_mul_f32 v[62:63], v[62:63], v[182:183]
    v_pk_add_f32 v[64:65], v[64:65], 1.0 op_sel_hi:[1,0]
    v_pk_add_f32 v[66:67], v[66:67], 1.0 op_sel_hi:[1,0]
    v_pk_add_f32 v[68:69], v[68:69], 1.0 op_sel_hi:[1,0]
    v_pk_add_f32 v[70:71], v[70:71], 1.0 op_sel_hi:[1,0]
    v_pk_add_f32 v[72:73], v[72:73], 1.0 op_sel_hi:[1,0]
    v_pk_add_f32 v[74:75], v[74:75], 1.0 op_sel_hi:[1,0]
    v_pk_add_f32 v[76:77], v[76:77], 1.0 op_sel_hi:[1,0]
    v_pk_add_f32 v[78:79], v[78:79], 1.0 op_sel_hi:[1,0]
    v_rcp_f32 v64, v64
    v_rcp_f32 v66, v66
    v_rcp_f32 v68, v68
    v_rcp_f32 v70, v70
    v_rcp_f32 v72, v72
    v_rcp_f32 v74, v74
    v_rcp_f32 v76, v76
    v_rcp_f32 v78, v78
    v_rcp_f32 v65, v65
    v_rcp_f32 v67, v67
    v_rcp_f32 v69, v69
    v_rcp_f32 v71, v71
    v_rcp_f32 v73, v73
    v_rcp_f32 v75, v75
    v_rcp_f32 v77, v77
    v_rcp_f32 v79, v79
    v_pk_mul_f32 v[168:169], v[48:49], v[64:65]
    v_pk_fma_f32 v[168:169], v[50:51], v[66:67], v[168:169]
    v_pk_fma_f32 v[168:169], v[52:53], v[68:69], v[168:169]
    v_pk_fma_f32 v[168:169], v[54:55], v[70:71], v[168:169]
    v_pk_mul_f32 v[170:171], v[56:57], v[72:73]
    v_pk_fma_f32 v[170:171], v[58:59], v[74:75], v[170:171]
    v_pk_fma_f32 v[170:171], v[60:61], v[76:77], v[170:171]
    v_pk_fma_f32 v[170:171], v[62:63], v[78:79], v[170:171]
    v_add_f32 v164, v164, v165
    v_add_f32 v166, v166, v167
    v_add_f32 v168, v168, v169
    v_add_f32 v170, v170, v171
    v_lshlrev_b32 v1, 2, v0
    v_add_u32 v1, 65536, v1
    v_permlane32_swap_b32 v164, v168
    v_permlane32_swap_b32 v166, v170
    v_add_f32 v164, v164, v168
    v_add_f32 v166, v166, v170
    s_nop 1
    v_permlane16_swap_b32 v164, v166
    v_add_f32 v164, v164, v166
    ds_write_b32 v1, v164
    s_waitcnt lgkmcnt(0)
    s_barrier
    s_cmp_lg_u32 s52, 0
    s_cbranch_scc1 L_end
    ds_read_b32 v17, v1 offset:256
    ds_read_b32 v18, v1 offset:512
    ds_read_b32 v19, v1 offset:768
    s_lshl_b32 s57, s53, 2
    s_lshl_b32 s58, s54, 4
    s_lshl_b32 s58, 2, s58
    v_mov_b32 v6, s58
    s_waitcnt vmcnt(0) lgkmcnt(0)
    v_add_u32 v175, 1, v175
    v_add_u32 v193, 1, v193
    v_add_f32 v164, v164, v17
    v_add_f32 v18, v18, v19
    v_add_f32 v174, v164, v18
    buffer_store_dwordx2 v[174:175], v172, s[48:51], s59 offen
    v_mov_b32 v192, v174
    buffer_store_dwordx2 v[192:193], v172, s[48:51], s60 offen sc1
    v_readfirstlane_b32 s56, v173
    s_nop 0
    s_and_b32 s56, s56, 0x01000100
    s_cmp_eq_u32 s56, 0x01000100
    s_cbranch_scc1 L_end
    s_waitcnt vmcnt(0)
    s_mov_b64 exec, 1
    buffer_atomic_or v6, off, s[44:47], s57 sc1
L_end:
L_exit:
    s_endpgm
L_codeend:
.section .rodata,"a"
.p2align 6
.amdhsa_kernel standalone__deep_cross_fibinet__recsys_kernel
  .amdhsa_next_free_vgpr 256
  .amdhsa_next_free_sgpr 102
  .amdhsa_accum_offset 256
  .amdhsa_group_segment_fixed_size 0
  .amdhsa_kernarg_size 88
  .amdhsa_user_sgpr_count 2
  .amdhsa_user_sgpr_kernarg_segment_ptr 1
  .amdhsa_system_sgpr_workgroup_id_x 1
.end_amdhsa_kernel
```
